```python
import torch

def _softmax(x, axis=-1):
    return torch.softmax(x, dim=axis)
def _gelu(x):
    return torch.nn.functional.gelu(x, approximate="tanh")
def _silu(x):
    return torch.nn.functional.silu(x)
def _sigmoid(x):
    return torch.sigmoid(x)
def _layernorm(x, axis=-1, eps=1e-5):
    m = x.mean(dim=axis, keepdim=True)
    v = x.var(dim=axis, keepdim=True, unbiased=False)
    return (x - m) / torch.sqrt(v + eps)
def _scatter_add(tgt, idx, src, axis=0):
    return tgt.clone().index_add_(axis, idx, src)
def _segment_sum(src, seg, n):
    out = torch.zeros((n,) + src.shape[1:], dtype=src.dtype)
    return out.index_add_(0, seg, src)
def _pad(x, pw):
    flat = tuple(v for pair in reversed(pw) for v in pair)
    return torch.nn.functional.pad(x, flat)

kernel_name = 'interleave_layers__sliding_local_dilated__geglu_ffn__prompt'

def setup_inputs():

    _w = (lambda a: (lambda t: t.to(torch.bfloat16) if t.is_floating_point() else t)(torch.as_tensor(a)))
    def _A_setup():
        B, S, D = 1, 2048, 512
        return {
            "x": _w((lambda *s: torch.randn(*s, dtype=torch.bfloat16) * 0.05)(B, S, D)),
            "wqkv": _w((lambda *s: torch.randn(*s, dtype=torch.bfloat16) * 0.05)(D, 3 * D)),
            "wo": _w((lambda *s: torch.randn(*s, dtype=torch.bfloat16) * 0.05)(D, D)),
        }
    _A_in = _A_setup()

    def _B_setup():
        B, S, D, F = 1, 2048, 512, 1792
        return {
            "x": _w((lambda *s: torch.randn(*s, dtype=torch.bfloat16) * 0.05)(B, S, D)),
            "w_gate": _w((lambda *s: torch.randn(*s, dtype=torch.bfloat16) * 0.05)(D, F)),
            "w_up": _w((lambda *s: torch.randn(*s, dtype=torch.bfloat16) * 0.05)(D, F)),
            "w_down": _w((lambda *s: torch.randn(*s, dtype=torch.bfloat16) * 0.05)(F, D)),
        }
    _B_in = _B_setup()

    return {
        "A_x": _A_in["x"],
        "A_wqkv": _A_in["wqkv"],
        "A_wo": _A_in["wo"],
        "B_x": _B_in["x"],
        "B_w_gate": _B_in["w_gate"],
        "B_w_up": _B_in["w_up"],
        "B_w_down": _B_in["w_down"],
    }

def reference(A_x, A_wqkv, A_wo, B_x, B_w_gate, B_w_up, B_w_down):
    def _A_ref(x, wqkv, wo):
        B, S, D = x.shape
        H = 32; Dh = D // H
        W, dil = 8, 2
        qkv = (lambda x, *d: x.permute(*d))((x @ wqkv).reshape(B, S, 3, H, Dh), 2, 0, 3, 1, 4)
        q, k, v = qkv[0], qkv[1], qkv[2]
        scale = Dh ** -0.5
        pos = torch.arange(S)
        off = torch.arange(W) * dil
        idx = pos[:, None] - off[None, :]
        mask = idx >= 0
        idx_c = torch.where(mask, idx, 0).reshape(-1)
        kg = k[:, :, idx_c, :].reshape(B, H, S, W, Dh)
        vg = v[:, :, idx_c, :].reshape(B, H, S, W, Dh)
        logits = torch.einsum("bhsd,bhswd->bhsw", q, kg) * scale
        logits = torch.where(mask[None, None, :, :], logits, -1e9)
        attn = _softmax(logits, axis=-1)
        o = torch.einsum("bhsw,bhswd->bhsd", attn, vg)
        return (lambda x, *d: x.permute(*d))(o, 0, 2, 1, 3).reshape(B, S, D) @ wo

    def _B_ref(x, w_gate, w_up, w_down):
        return (_gelu(x @ w_gate) * (x @ w_up)) @ w_down

    x = A_x
    x = x + _A_ref(_layernorm(x, axis=-1), A_wqkv, A_wo)
    x = x + _B_ref(_layernorm(x, axis=-1), B_w_gate, B_w_up, B_w_down)
    x = x + _A_ref(_layernorm(x, axis=-1), A_wqkv, A_wo)
    x = x + _B_ref(_layernorm(x, axis=-1), B_w_gate, B_w_up, B_w_down)
    return x
```

```asm
; @launch grid=(256,1,1) block=(256,1,1) lds=163840
.amdgcn_target "amdgcn-amd-amdhsa--gfx950"
.text
.globl interleave_layers__sliding_local_dilated__geglu_ffn__prompt_kernel
.p2align 8
.type interleave_layers__sliding_local_dilated__geglu_ffn__prompt_kernel,@function
interleave_layers__sliding_local_dilated__geglu_ffn__prompt_kernel:
 s_cmp_ge_u32 s2, 256
 s_cbranch_scc1 .Lend
 s_load_dwordx16 s[28:43], s[0:1], 0
 s_load_dwordx4 s[44:47], s[0:1], 64
 s_memrealtime s[96:97]
 s_getpc_b64 s[82:83]
.Lpc0:
 s_sub_u32 s82, s82, .Lpc0-interleave_layers__sliding_local_dilated__geglu_ffn__prompt_kernel
 s_subb_u32 s83, s83, 0
 s_lshr_b32 s50, s2, 3
 v_min_u32 v25, 15, v0
 s_lshl_b32 s88, s50, 11
 v_lshl_add_u32 v25, v25, 7, s88
 v_min_u32 v25, .Lfast_end-interleave_layers__sliding_local_dilated__geglu_ffn__prompt_kernel-4, v25
 global_load_dword a252, v25, s[82:83]
 v_and_b32 v1, 63, v0
 v_lshrrev_b32 v3, 6, v0
 v_lshlrev_b32 v2, 4, v1
 v_readfirstlane_b32 s48, v3
 v_min_u32 v27, 47, v1
 v_lshlrev_b32 v27, 7, v27
 v_mov_b32 v4, 0
 v_mov_b32 v8, 0
 s_and_b32 s49, s2, 7
 s_lshr_b32 s51, s50, 3
 s_and_b32 s52, s50, 7
 s_mov_b32 s53, 0
 s_mov_b32 s54, 0
 s_and_b32 s88, s49, 3
 s_lshl_b32 s88, s88, 2
 s_add_u32 s88, s88, s51
 s_cmp_eq_u32 s88, 0
 s_cselect_b32 s55, 1, 0
 s_lshr_b32 s89, s49, 2
 s_lshl_b32 s89, s89, 10
 s_lshl_b32 s56, s88, 17
 s_add_u32 s56, s56, s89
 s_lshl_b32 s57, s48, 13
 s_add_u32 s57, s57, s56
 s_lshl_b32 s80, s48, 12
 s_add_u32 s80, s80, 0x1c000
 s_lshl_b32 s91, s48, 6
 v_xor_b32 v15, s91, v2
 v_and_b32 v28, 15, v1
 v_lshrrev_b32 v29, 4, v1
 s_lshl_b32 s89, s52, 7
 s_lshl_b32 s88, s48, 13
 s_add_u32 s88, s88, s89
 v_lshlrev_b32 v13, 11, v29
 v_lshl_add_u32 v13, v28, 3, v13
 v_add_u32 v13, s88, v13
 v_lshrrev_b32 v24, 3, v1
 v_and_b32 v25, 2, v24
 v_and_b32 v31, 7, v1
 v_xor_b32 v31, v31, v25
 v_lshlrev_b32 v31, 4, v31
 v_mul_u32_u24 v30, 3072, v24
 v_add_u32 v30, v30, v31
 s_and_b32 s88, s48, 1
 s_lshl_b32 s88, s88, 6
 v_xor_b32 v30, s88, v30
 s_mul_i32 s85, s48, 24576
 s_add_u32 s85, s85, s89
 s_lshl_b32 s86, s48, 10
 v_lshl_add_u32 v33, v24, 10, v31
 v_xor_b32 v34, 64, v33
 s_lshl_b32 s61, s49, 12
 s_add_u32 s61, s61, 0x8b0000
 s_lshl_b32 s90, s48, 8
 s_add_u32 s90, s90, s2
 s_and_b32 s91, s90, 7
 s_cmp_lt_u32 s90, 128
 s_cselect_b32 s88, 0, 128
 s_cselect_b32 s89, 16, 56
 s_sub_u32 s88, s90, s88
 s_lshr_b32 s88, s88, 3
 s_mul_i32 s89, s89, s91
 s_add_u32 s89, s89, s88
 s_lshl_b32 s89, s89, 12
 s_lshl_b32 s70, s88, 15
 s_lshl_b32 s91, s91, 7
 s_add_u32 s70, s70, s91
 s_mov_b32 s91, 0x200000
 s_cmp_lt_u32 s90, 128
 s_cselect_b32 s91, 0x100000, s91
 s_add_u32 s98, s89, s91
 s_cmp_ge_u32 s90, 576
 s_cselect_b32 s98, 0x2000000, s98
 s_lshl_b32 s87, s48, 12
 s_add_u32 s87, s87, 0x21000
 s_and_b32 s88, s48, 1
 s_lshl_b32 s74, s88, 13
 s_add_u32 s74, s74, 0x24000
 s_lshl_b32 s88, s88, 3
 s_add_u32 s88, s88, s49
 s_mul_i32 s89, s50, 112
 s_mul_i32 s73, s88, 114688
 s_add_u32 s73, s73, s89
 s_lshl_b32 s89, s50, 4
 s_add_u32 s89, s89, s88
 s_mul_i32 s72, s89, 7168
 s_add_u32 s72, s72, 0xe00000
 s_lshl_b32 s75, s89, 9
 s_add_u32 s75, s75, 0x180000
 s_lshl_b32 s89, s50, 2
 s_add_u32 s89, s89, s88
 s_mul_i32 s89, s89, 7168
 s_add_u32 s89, s89, 0x6eb000
 s_cmp_ge_u32 s88, 12
 s_cselect_b32 s72, s89, s72
 s_mov_b32 s88, 9363
 s_mov_b32 s89, 3472
 v_add_u32 v26, 0, v1
 v_mul_lo_u32 v25, v26, s88
 v_lshrrev_b32 v25, 16, v25
 v_mul_lo_u32 v25, v25, s89
 v_add_u32 v35, v2, v25
 v_add_u32 v26, 64, v1
 v_mul_lo_u32 v25, v26, s88
 v_lshrrev_b32 v25, 16, v25
 v_mul_lo_u32 v25, v25, s89
 v_add_u32 v36, v2, v25
 v_add_u32 v26, 128, v1
 v_mul_lo_u32 v25, v26, s88
 v_lshrrev_b32 v25, 16, v25
 v_mul_lo_u32 v25, v25, s89
 v_add_u32 v37, v2, v25
 v_add_u32 v26, 192, v1
 v_mul_lo_u32 v25, v26, s88
 v_lshrrev_b32 v25, 16, v25
 v_mul_lo_u32 v25, v25, s89
 v_add_u32 v38, v2, v25
 v_lshrrev_b32 v25, 5, v1
 v_lshl_add_u32 v38, v25, 25, v38
 s_lshl_b32 s71, s50, 2
 s_add_u32 s71, s71, s48
 s_waitcnt lgkmcnt(0)
 s_cmp_lt_u32 s48, 2
 s_cbranch_scc1 .LnoB_3
 s_mov_b32 s16, s36
 s_and_b32 s17, s37, 0xffff
 s_mov_b32 s18, 0x1c0000
 s_mov_b32 s19, 0x20000
 s_add_u32 m0, s74, 0
 s_nop 0
 buffer_load_dwordx4 v35, s[16:19], s73 offen lds
 buffer_load_dwordx4 v36, s[16:19], s73 offen offset:1024 lds
 buffer_load_dwordx4 v37, s[16:19], s73 offen offset:2048 lds
 buffer_load_dwordx4 v38, s[16:19], s73 offen offset:3072 lds
 s_mov_b32 s16, s38
 s_and_b32 s17, s39, 0xffff
 s_mov_b32 s18, 0x1c0000
 s_mov_b32 s19, 0x20000
 s_add_u32 m0, s74, 4096
 s_nop 0
 buffer_load_dwordx4 v35, s[16:19], s73 offen lds
 buffer_load_dwordx4 v36, s[16:19], s73 offen offset:1024 lds
 buffer_load_dwordx4 v37, s[16:19], s73 offen offset:2048 lds
 buffer_load_dwordx4 v38, s[16:19], s73 offen offset:3072 lds
.LnoB_3:
 s_cmp_ge_u32 s90, 576
 s_cbranch_scc1 .LnoA_1
 s_cmp_lt_u32 s90, 128
 s_cselect_b32 s16, s32, s40
 s_cselect_b32 s17, s33, s41
 s_mov_b32 s18, 0x1c0000
 s_cselect_b32 s18, 0x80000, s18
 s_and_b32 s17, s17, 0xffff
 s_mov_b32 s19, 0x20000
 s_add_u32 m0, s87, 0
 s_nop 0
 buffer_load_dwordx4 v33, s[16:19], s70 offen lds
 s_add_u32 s70, s70, 0x2000
 s_add_u32 m0, s87, 1024
 s_nop 0
 buffer_load_dwordx4 v34, s[16:19], s70 offen lds
 s_add_u32 s70, s70, 0x2000
 s_add_u32 m0, s87, 2048
 s_nop 0
 buffer_load_dwordx4 v33, s[16:19], s70 offen lds
 s_add_u32 s70, s70, 0x2000
 s_add_u32 m0, s87, 3072
 s_nop 0
 buffer_load_dwordx4 v34, s[16:19], s70 offen lds
.LnoA_1:
 s_mov_b32 s4, s46
 s_and_b32 s5, s47, 0xffff
 s_mov_b32 s6, 0x1180000
 s_mov_b32 s7, 0x20000
 s_mov_b32 s24, s44
 s_and_b32 s25, s45, 0xffff
 s_mov_b32 s26, 0x100
 s_mov_b32 s27, 0x20000
 s_mov_b32 s8, s28
 s_and_b32 s9, s29, 0xffff
 s_mov_b32 s10, 0x200000
 s_mov_b32 s11, 0x20000
 s_lshl_b32 s89, s52, 2
 s_add_u32 s89, s89, s48
 s_lshl_b32 s88, s89, 12
 s_add_u32 s88, s88, s56
 buffer_load_dwordx4 v[232:235], v2, s[8:11], s88 offen
 buffer_load_dwordx4 v[236:239], v2, s[8:11], s88 offen offset:2048
 s_or_b32 s88, s96, 8
 v_mov_b32 v146, s88
 v_mov_b32 v147, s97
 s_cmp_eq_u32 s90, 0
 s_cselect_b32 s88, 0, 0x2000000
 buffer_store_dwordx2 v[146:147], off, s[24:27], s88 sc1
 v_lshlrev_b32 v25, 21, v1
 s_lshl_b32 s88, s2, 7
 s_add_u32 s88, s88, 0x1c0000
 s_cmp_eq_u32 s48, 1
 s_cselect_b32 s88, s88, 0x2000000
 s_mov_b32 s20, s30
 s_and_b32 s21, s31, 0xffff
 s_mov_b32 s22, 0x180000
 s_mov_b32 s23, 0x20000
 s_mul_i32 s88, s71, 6144
 buffer_load_dword a253, v27, s[20:23], s88 offen
 s_mul_i32 s88, s71, 6144
 s_add_u32 s88, s88, 0xc0000
 buffer_load_dword a253, v27, s[20:23], s88 offen
 v_bfe_u32 v25, v1, 2, 2
 v_lshl_add_u32 v26, v29, 3, v25
 v_lshlrev_b32 v32, 7, v26
 v_and_b32 v24, 1, v29
 v_lshlrev_b32 v24, 1, v24
 v_lshrrev_b32 v25, 1, v25
 v_or_b32 v24, v24, v25
 v_lshl_add_u32 v32, v24, 5, v32
 v_and_b32 v25, 3, v1
 v_lshl_add_u32 v32, v25, 3, v32
 v_mul_u32_u24 v26, 112, v26
 v_add_u32 v26, s74, v26
 v_lshl_add_u32 v72, v25, 4, v26
 v_lshl_add_u32 v73, v25, 3, v26
 v_lshrrev_b32 v25, 1, v25
 v_mul_u32_u24 v25, 4080, v25
 v_add_u32 v74, v73, v25
 v_add_u32 v24, s87, v32
 v_xor_b32 v39, 0, v24
 v_xor_b32 v40, 32, v24
 v_xor_b32 v41, 64, v24
 v_xor_b32 v42, 96, v24
 v_and_b32 v6, 31, v1
 v_lshlrev_b32 v6, 2, v6
 v_and_b32 v7, 28, v6
 s_lshl_b32 s91, s48, 6
 v_and_b32 v14, 48, v1
 v_add_u32 v14, s91, v14
 s_lshr_b32 s91, s52, 1
 s_lshl_b32 s91, s91, 8
 v_add_u32 v14, s91, v14
 s_and_b32 s91, s52, 1
 s_lshl_b32 s91, s91, 3
 v_add_u32 v14, s91, v14
 v_bfe_u32 v24, v1, 3, 1
 v_lshl_add_u32 v14, v24, 2, v14
 v_and_b32 v9, 7, v28
 v_xor_b32 v9, v9, v29
 v_lshlrev_b32 v9, 4, v9
 v_lshl_add_u32 v9, v28, 8, v9
 v_add_u32 v9, s80, v9
 v_xor_b32 v10, 64, v9
 s_lshl_b32 s91, s48, 2
 v_add_u32 v25, s91, v29
 v_and_b32 v11, 7, v25
 v_xor_b32 v11, v11, v28
 v_lshlrev_b32 v11, 4, v11
 v_lshl_add_u32 v11, v25, 8, v11
 v_add_u32 v11, 114688, v11
 v_lshrrev_b32 v24, 3, v28
 v_lshlrev_b32 v12, 11, v24
 v_bfe_u32 v24, v28, 1, 2
 v_lshl_add_u32 v12, v24, 8, v12
 v_lshl_add_u32 v12, v25, 4, v12
 v_and_b32 v24, 1, v28
 v_lshl_add_u32 v12, v24, 3, v12
 s_lshl_b32 s91, s52, 12
 v_add_u32 v12, s91, v12
 s_lshl_b32 s88, s48, 5
 v_xor_b32 v75, s88, v32
 v_add_u32 v76, 61440, v75
 v_add_u32 v77, 122880, v75
 v_add_u32 v26, s86, v2
 v_mov_b32 v78, 0x3f803f80
 v_mov_b32 v79, 0x3f803f80
 v_mov_b32 v80, 0x3f803f80
 v_mov_b32 v81, 0x3f803f80
 s_lshl_b32 s91, s49, 5
 s_add_u32 s91, s91, s50
 s_lshl_b32 s91, s91, 2
 s_add_u32 s91, s91, s48
 s_lshr_b32 s88, s91, 5
 s_mul_i32 s88, s88, 114688
 s_add_u32 s88, s88, 0xa00000
 s_and_b32 s89, s91, 31
 v_lshl_add_u32 v25, v1, 7, s88
 s_lshl_b32 s88, s89, 11
 v_add_u32 v191, s88, v25
 s_mul_i32 s88, s89, 1536
 s_add_u32 s88, s88, 0xf800
 v_add_u32 v24, s88, v25
 v_cmp_lt_u32 vcc, 15, v1
 s_nop 1
 v_cndmask_b32 v191, v191, v24, vcc
 s_lshl_b32 s88, s91, 9
 s_add_u32 s88, s88, 0x5ff200
 v_lshl_add_u32 v24, v1, 7, s88
 v_cmp_lt_u32 vcc, 27, v1
 s_nop 1
 v_cndmask_b32 v191, v191, v24, vcc
 s_lshl_b32 s88, s91, 11
 s_add_u32 s88, s88, 0x3ff000
 v_lshl_add_u32 v24, v1, 7, s88
 v_cmp_lt_u32 vcc, 31, v1
 s_nop 1
 v_cndmask_b32 v191, v191, v24, vcc
 s_lshl_b32 s88, s2, 3
 s_add_u32 s88, s88, s48
 s_lshl_b32 s88, s88, 9
 v_and_b32 v24, 3, v1
 v_lshl_add_u32 v24, v24, 7, s88
 v_cmp_lt_u32 vcc, 47, v1
 s_nop 1
 v_cndmask_b32 v191, v191, v24, vcc
 s_lshl_b32 s88, s91, 7
 s_add_u32 s88, s88, 0x860000
 v_and_b32 v24, 1, v1
 v_lshl_add_u32 v24, v24, 17, s88
 v_cmp_lt_u32 vcc, 55, v1
 s_nop 1
 v_cndmask_b32 v191, v191, v24, vcc
 s_waitcnt vmcnt(3)
 s_cmp_lt_u32 s48, 2
 s_cbranch_scc1 .LnoB_5
 ds_read_b64_tr_b16 v[204:205], v72
 ds_read_b64_tr_b16 v[206:207], v72 offset:448
 ds_read_b64_tr_b16 v[208:209], v72 offset:4096
 ds_read_b64_tr_b16 v[210:211], v72 offset:4544
 ds_read_b64_tr_b16 v[212:213], v72 offset:8
 ds_read_b64_tr_b16 v[214:215], v72 offset:456
 ds_read_b64_tr_b16 v[216:217], v72 offset:4104
 ds_read_b64_tr_b16 v[218:219], v72 offset:4552
 ds_read_b64_tr_b16 v[220:221], v73 offset:64
 ds_read_b64_tr_b16 v[222:223], v73 offset:512
 ds_read_b64_tr_b16 v[224:225], v73 offset:4160
 ds_read_b64_tr_b16 v[226:227], v73 offset:4608
 ds_read_b64_tr_b16 v[228:229], v74 offset:96
 ds_read_b64_tr_b16 v[230:231], v74 offset:544
 s_waitcnt lgkmcnt(0)
 buffer_store_dwordx4 v[204:207], v2, s[4:7], s72 offen sc1
 v_mfma_f32_16x16x32_bf16 v[44:47], v[78:81], v[204:207], 0
 buffer_store_dwordx4 v[208:211], v2, s[4:7], s72 offen offset:1024 sc1
 v_mfma_f32_16x16x32_bf16 v[48:51], v[78:81], v[208:211], 0
 buffer_store_dwordx4 v[212:215], v2, s[4:7], s72 offen offset:2048 sc1
 v_mfma_f32_16x16x32_bf16 v[52:55], v[78:81], v[212:215], 0
 buffer_store_dwordx4 v[216:219], v2, s[4:7], s72 offen offset:3072 sc1
 v_mfma_f32_16x16x32_bf16 v[56:59], v[78:81], v[216:219], 0
 s_add_u32 s72, s72, 4096
 buffer_store_dwordx4 v[220:223], v2, s[4:7], s72 offen sc1
 v_mfma_f32_16x16x32_bf16 v[60:63], v[78:81], v[220:223], 0
 buffer_store_dwordx4 v[224:227], v2, s[4:7], s72 offen offset:1024 sc1
 v_mfma_f32_16x16x32_bf16 v[64:67], v[78:81], v[224:227], 0
 buffer_store_dwordx4 v[228:231], v2, s[4:7], s72 offen offset:2048 sc1
 v_mfma_f32_16x16x32_bf16 v[68:71], v[78:81], v[228:231], 0
 v_cmp_eq_u32 vcc, 1, v29
 s_nop 1
 v_cndmask_b32 v44, v44, v48, vcc
 s_nop 1
 v_cndmask_b32 v60, v60, v64, vcc
 v_cmp_eq_u32 vcc, 2, v29
 s_nop 1
 v_cndmask_b32 v44, v44, v52, vcc
 v_cndmask_b32 v60, v60, v68, vcc
 v_cmp_eq_u32 vcc, 3, v29
 s_nop 1
 v_cndmask_b32 v44, v44, v56, vcc
 v_lshlrev_b32 v24, 2, v1
 buffer_store_dword v44, v24, s[4:7], s75 offen sc1
 buffer_store_dword v60, v24, s[4:7], s75 offen offset:256 sc1
.LnoB_5:
 s_cmp_ge_u32 s90, 576
 s_cbranch_scc1 .LnoA_4
 ds_read_b64_tr_b16 v[148:149], v39
 ds_read_b64_tr_b16 v[150:151], v39 offset:512
 ds_read_b64_tr_b16 v[152:153], v40
 ds_read_b64_tr_b16 v[154:155], v40 offset:512
 ds_read_b64_tr_b16 v[156:157], v41
 ds_read_b64_tr_b16 v[158:159], v41 offset:512
 ds_read_b64_tr_b16 v[160:161], v42
 ds_read_b64_tr_b16 v[162:163], v42 offset:512
 s_waitcnt lgkmcnt(0)
 buffer_store_dwordx4 v[148:151], v2, s[4:7], s98 offen sc1
 buffer_store_dwordx4 v[152:155], v2, s[4:7], s98 offen offset:1024 sc1
 buffer_store_dwordx4 v[156:159], v2, s[4:7], s98 offen offset:2048 sc1
 buffer_store_dwordx4 v[160:163], v2, s[4:7], s98 offen offset:3072 sc1
.LnoA_4:
 s_mov_b32 s84, 0xbb000000
 v_lshlrev_b32 v240, 16, v232
 v_and_b32 v241, 0xffff0000, v232
 v_lshlrev_b32 v242, 16, v233
 v_and_b32 v243, 0xffff0000, v233
 v_lshlrev_b32 v244, 16, v234
 v_and_b32 v245, 0xffff0000, v234
 v_lshlrev_b32 v246, 16, v235
 v_and_b32 v247, 0xffff0000, v235
 v_add_f32 v248, v240, v241
 v_mul_f32 v249, v240, v240
 v_fmac_f32 v249, v241, v241
 v_add_f32 v248, v248, v242
 v_fmac_f32 v249, v242, v242
 v_add_f32 v248, v248, v243
 v_fmac_f32 v249, v243, v243
 v_add_f32 v248, v248, v244
 v_fmac_f32 v249, v244, v244
 v_add_f32 v248, v248, v245
 v_fmac_f32 v249, v245, v245
 v_add_f32 v248, v248, v246
 v_fmac_f32 v249, v246, v246
 v_add_f32 v248, v248, v247
 v_fmac_f32 v249, v247, v247
 v_lshlrev_b32 v240, 16, v236
 v_and_b32 v241, 0xffff0000, v236
 v_lshlrev_b32 v242, 16, v237
 v_and_b32 v243, 0xffff0000, v237
 v_lshlrev_b32 v244, 16, v238
 v_and_b32 v245, 0xffff0000, v238
 v_lshlrev_b32 v246, 16, v239
 v_and_b32 v247, 0xffff0000, v239
 v_add_f32 v250, v240, v241
 v_mul_f32 v251, v240, v240
 v_fmac_f32 v251, v241, v241
 v_add_f32 v250, v250, v242
 v_fmac_f32 v251, v242, v242
 v_add_f32 v250, v250, v243
 v_fmac_f32 v251, v243, v243
 v_add_f32 v250, v250, v244
 v_fmac_f32 v251, v244, v244
 v_add_f32 v250, v250, v245
 v_fmac_f32 v251, v245, v245
 v_add_f32 v250, v250, v246
 v_fmac_f32 v251, v246, v246
 v_add_f32 v250, v250, v247
 v_fmac_f32 v251, v247, v247
 v_add_f32_dpp v248, v248, v248 row_ror:8 row_mask:0xf bank_mask:0xf
 v_add_f32_dpp v249, v249, v249 row_ror:8 row_mask:0xf bank_mask:0xf
 v_add_f32_dpp v250, v250, v250 row_ror:8 row_mask:0xf bank_mask:0xf
 v_add_f32_dpp v251, v251, v251 row_ror:8 row_mask:0xf bank_mask:0xf
 v_add_f32_dpp v248, v248, v248 row_ror:4 row_mask:0xf bank_mask:0xf
 v_add_f32_dpp v249, v249, v249 row_ror:4 row_mask:0xf bank_mask:0xf
 v_add_f32_dpp v250, v250, v250 row_ror:4 row_mask:0xf bank_mask:0xf
 v_add_f32_dpp v251, v251, v251 row_ror:4 row_mask:0xf bank_mask:0xf
 v_add_f32_dpp v248, v248, v248 row_ror:2 row_mask:0xf bank_mask:0xf
 v_add_f32_dpp v249, v249, v249 row_ror:2 row_mask:0xf bank_mask:0xf
 v_add_f32_dpp v250, v250, v250 row_ror:2 row_mask:0xf bank_mask:0xf
 v_add_f32_dpp v251, v251, v251 row_ror:2 row_mask:0xf bank_mask:0xf
 v_add_f32_dpp v248, v248, v248 row_ror:1 row_mask:0xf bank_mask:0xf
 v_add_f32_dpp v249, v249, v249 row_ror:1 row_mask:0xf bank_mask:0xf
 v_add_f32_dpp v250, v250, v250 row_ror:1 row_mask:0xf bank_mask:0xf
 v_add_f32_dpp v251, v251, v251 row_ror:1 row_mask:0xf bank_mask:0xf
 v_mov_b32 v240, v248
 v_mov_b32 v241, v249
 v_mov_b32 v242, v250
 v_mov_b32 v243, v251
 v_permlane16_swap_b32 v248, v240
 v_permlane16_swap_b32 v249, v241
 v_permlane16_swap_b32 v250, v242
 v_permlane16_swap_b32 v251, v243
 v_add_f32 v248, v248, v240
 v_add_f32 v249, v249, v241
 v_add_f32 v250, v250, v242
 v_add_f32 v251, v251, v243
 v_mov_b32 v240, v248
 v_mov_b32 v241, v249
 v_mov_b32 v242, v250
 v_mov_b32 v243, v251
 v_permlane32_swap_b32 v248, v240
 v_permlane32_swap_b32 v249, v241
 v_permlane32_swap_b32 v250, v242
 v_permlane32_swap_b32 v251, v243
 v_add_f32 v248, v248, v240
 v_add_f32 v249, v249, v241
 v_add_f32 v250, v250, v242
 v_add_f32 v251, v251, v243
 v_mul_f32 v252, s84, v248
 v_mul_f32 v253, s84, v249
 v_fmac_f32 v253, v252, v252
 v_min_f32 v253, 0, v253
 v_sub_f32 v253, 0x3727c5ac, v253
 v_rsq_f32 v253, v253
 v_mul_f32 v254, s84, v250
 v_mul_f32 v255, s84, v251
 v_fmac_f32 v255, v254, v254
 v_min_f32 v255, 0, v255
 v_sub_f32 v255, 0x3727c5ac, v255
 v_rsq_f32 v255, v255
 s_lshl_b32 s89, s48, 4
 v_mov_b32 v24, s89
 ds_write_b128 v24, v[252:255] offset:61440
 v_and_b32 v24, 60, v6
 s_waitcnt lgkmcnt(0)
 s_barrier
 ds_read_b32 v25, v24 offset:61440
 s_lshl_b32 s89, s49, 5
 s_add_u32 s89, s89, s50
 s_lshl_b32 s89, s89, 7
 s_add_u32 s89, s89, 0x840000
 s_cmp_eq_u32 s48, 1
 s_cselect_b32 s89, s89, 0x2000000
 s_waitcnt lgkmcnt(0)
 buffer_store_dword v25, v6, s[4:7], s89 offen sc1
 s_lshl_b32 s89, s50, 7
 s_add_u32 s89, s89, s61
 s_cmp_eq_u32 s48, 0
 s_cselect_b32 s89, s89, 0x2000000
 s_cmp_lt_u32 s50, 24
 s_cselect_b32 s89, s89, 0x2000000
 buffer_store_dword v8, v6, s[4:7], s89 offen sc1
 buffer_load_dwordx2 v[146:147], off, s[24:27], 0 sc1
 s_add_u32 s88, s56, 0x0
 buffer_load_dwordx2 v[16:17], v13, s[8:11], s88 offen
 s_add_u32 s88, s56, 0x8000
 buffer_load_dwordx2 v[18:19], v13, s[8:11], s88 offen
 s_add_u32 s88, s56, 0x10000
 buffer_load_dwordx2 v[20:21], v13, s[8:11], s88 offen
 s_add_u32 s88, s56, 0x18000
 buffer_load_dwordx2 v[22:23], v13, s[8:11], s88 offen
 s_add_u32 s88, s85, 0x0
 s_add_u32 m0, s86, 0
 s_nop 0
 buffer_load_dwordx4 v30, s[20:23], s88 offen lds
 s_add_u32 m0, s86, 3072
 s_nop 0
 buffer_load_dwordx4 v30, s[20:23], s88 offen offset:1024 lds
 s_add_u32 m0, s86, 6144
 s_nop 0
 buffer_load_dwordx4 v30, s[20:23], s88 offen offset:2048 lds
 s_add_u32 s88, s85, 0x18000
 s_add_u32 m0, s86, 12288
 s_nop 0
 buffer_load_dwordx4 v30, s[20:23], s88 offen lds
 s_add_u32 m0, s86, 15360
 s_nop 0
 buffer_load_dwordx4 v30, s[20:23], s88 offen offset:1024 lds
 s_add_u32 m0, s86, 18432
 s_nop 0
 buffer_load_dwordx4 v30, s[20:23], s88 offen offset:2048 lds
 s_add_u32 s88, s85, 0x30000
 s_add_u32 m0, s86, 24576
 s_nop 0
 buffer_load_dwordx4 v30, s[20:23], s88 offen lds
 s_add_u32 m0, s86, 27648
 s_nop 0
 buffer_load_dwordx4 v30, s[20:23], s88 offen offset:1024 lds
 s_add_u32 m0, s86, 30720
 s_nop 0
 buffer_load_dwordx4 v30, s[20:23], s88 offen offset:2048 lds
 s_waitcnt vmcnt(13)
.Lnc_6:
 v_readfirstlane_b32 s96, v146
 v_readfirstlane_b32 s97, v147
 s_getreg_b32 s89, hwreg(HW_REG_XCC_ID, 0, 3)
 s_and_b32 s96, s96, -8
 s_cbranch_scc0 .Lnr_7
 s_or_b32 s96, s96, s89
 v_mov_b32 v146, s96
 s_lshl_b32 s89, s49, 5
 s_add_u32 s89, s89, s50
 s_lshl_b32 s89, s89, 7
 s_add_u32 s89, s89, 0x8c0000
 v_lshlrev_b32 v24, 3, v28
 s_cmp_eq_u32 s48, 0
 s_cselect_b32 s89, s89, 0x2000000
 s_barrier
 buffer_store_dwordx2 v[146:147], v24, s[4:7], s89 offen sc1
 s_add_u32 s88, s85, 0x48000
 s_add_u32 m0, s86, 36864
 s_nop 0
 buffer_load_dwordx4 v30, s[20:23], s88 offen lds
 s_add_u32 m0, s86, 39936
 s_nop 0
 buffer_load_dwordx4 v30, s[20:23], s88 offen offset:1024 lds
 s_add_u32 m0, s86, 43008
 s_nop 0
 buffer_load_dwordx4 v30, s[20:23], s88 offen offset:2048 lds
 s_add_u32 s88, s85, 0x60000
 s_add_u32 m0, s86, 49152
 s_nop 0
 buffer_load_dwordx4 v30, s[20:23], s88 offen lds
 s_add_u32 m0, s86, 52224
 s_nop 0
 buffer_load_dwordx4 v30, s[20:23], s88 offen offset:1024 lds
 s_add_u32 m0, s86, 55296
 s_nop 0
 buffer_load_dwordx4 v30, s[20:23], s88 offen offset:2048 lds
 s_add_u32 s88, s85, 0x78000
 s_add_u32 m0, s86, 61440
 s_nop 0
 buffer_load_dwordx4 v30, s[20:23], s88 offen lds
 s_add_u32 m0, s86, 64512
 s_nop 0
 buffer_load_dwordx4 v30, s[20:23], s88 offen offset:1024 lds
 s_add_u32 m0, s86, 67584
 s_nop 0
 buffer_load_dwordx4 v30, s[20:23], s88 offen offset:2048 lds
 s_add_u32 s88, s85, 0x90000
 s_add_u32 m0, s86, 73728
 s_nop 0
 buffer_load_dwordx4 v30, s[20:23], s88 offen lds
 s_add_u32 m0, s86, 76800
 s_nop 0
 buffer_load_dwordx4 v30, s[20:23], s88 offen offset:1024 lds
 s_add_u32 m0, s86, 79872
 s_nop 0
 buffer_load_dwordx4 v30, s[20:23], s88 offen offset:2048 lds
 s_add_u32 s88, s85, 0xa8000
 s_add_u32 m0, s86, 86016
 s_nop 0
 buffer_load_dwordx4 v30, s[20:23], s88 offen lds
 s_add_u32 m0, s86, 89088
 s_nop 0
 buffer_load_dwordx4 v30, s[20:23], s88 offen offset:1024 lds
 s_add_u32 m0, s86, 92160
 s_nop 0
 buffer_load_dwordx4 v30, s[20:23], s88 offen offset:2048 lds
 s_add_u32 s88, s85, 0xc0000
 s_add_u32 m0, s86, 98304
 s_nop 0
 buffer_load_dwordx4 v30, s[20:23], s88 offen lds
 s_add_u32 m0, s86, 101376
 s_nop 0
 buffer_load_dwordx4 v30, s[20:23], s88 offen offset:1024 lds
 s_add_u32 m0, s86, 104448
 s_nop 0
 buffer_load_dwordx4 v30, s[20:23], s88 offen offset:2048 lds
 s_add_u32 s88, s85, 0xd8000
 s_add_u32 m0, s86, 110592
 s_nop 0
 buffer_load_dwordx4 v30, s[20:23], s88 offen lds
 s_add_u32 m0, s86, 113664
 s_nop 0
 buffer_load_dwordx4 v30, s[20:23], s88 offen offset:1024 lds
 s_add_u32 m0, s86, 116736
 s_nop 0
 buffer_load_dwordx4 v30, s[20:23], s88 offen offset:2048 lds
 s_waitcnt vmcnt(22)
 s_barrier
 ds_read_b64_tr_b16 a[0:1], v75
 ds_read_b64_tr_b16 a[2:3], v75 offset:512
 ds_read_b64_tr_b16 a[64:65], v75 offset:4096
 ds_read_b64_tr_b16 a[66:67], v75 offset:4608
 ds_read_b64_tr_b16 a[128:129], v75 offset:8192
 ds_read_b64_tr_b16 a[130:131], v75 offset:8704
 ds_read_b64_tr_b16 a[4:5], v75 offset:12288
 ds_read_b64_tr_b16 a[6:7], v75 offset:12800
 ds_read_b64_tr_b16 a[68:69], v75 offset:16384
 ds_read_b64_tr_b16 a[70:71], v75 offset:16896
 ds_read_b64_tr_b16 a[132:133], v75 offset:20480
 ds_read_b64_tr_b16 a[134:135], v75 offset:20992
 ds_read_b64_tr_b16 a[8:9], v75 offset:24576
 ds_read_b64_tr_b16 a[10:11], v75 offset:25088
 ds_read_b64_tr_b16 a[72:73], v75 offset:28672
 ds_read_b64_tr_b16 a[74:75], v75 offset:29184
 ds_read_b64_tr_b16 a[136:137], v75 offset:32768
 ds_read_b64_tr_b16 a[138:139], v75 offset:33280
 s_add_u32 s88, s85, 0xf0000
 s_add_u32 m0, s86, 122880
 s_nop 0
 buffer_load_dwordx4 v30, s[20:23], s88 offen lds
 s_add_u32 m0, s86, 125952
 s_nop 0
 buffer_load_dwordx4 v30, s[20:23], s88 offen offset:1024 lds
 s_add_u32 m0, s86, 129024
 s_nop 0
 buffer_load_dwordx4 v30, s[20:23], s88 offen offset:2048 lds
 s_add_u32 s88, s85, 0x108000
 s_add_u32 m0, s86, 135168
 s_nop 0
 buffer_load_dwordx4 v30, s[20:23], s88 offen lds
 s_add_u32 m0, s86, 138240
 s_nop 0
 buffer_load_dwordx4 v30, s[20:23], s88 offen offset:1024 lds
 s_add_u32 m0, s86, 141312
 s_nop 0
 buffer_load_dwordx4 v30, s[20:23], s88 offen offset:2048 lds
 s_add_u32 s88, s85, 0x120000
 s_add_u32 m0, s86, 147456
 s_nop 0
 buffer_load_dwordx4 v30, s[20:23], s88 offen lds
 s_add_u32 m0, s86, 150528
 s_nop 0
 buffer_load_dwordx4 v30, s[20:23], s88 offen offset:1024 lds
 s_add_u32 m0, s86, 153600
 s_nop 0
 buffer_load_dwordx4 v30, s[20:23], s88 offen offset:2048 lds
 s_waitcnt vmcnt(9) lgkmcnt(0)
 s_barrier
 s_add_u32 s88, s85, 0x138000
 s_add_u32 m0, s86, 0
 s_nop 0
 buffer_load_dwordx4 v30, s[20:23], s88 offen lds
 s_add_u32 m0, s86, 3072
 s_nop 0
 buffer_load_dwordx4 v30, s[20:23], s88 offen offset:1024 lds
 s_add_u32 m0, s86, 6144
 s_nop 0
 buffer_load_dwordx4 v30, s[20:23], s88 offen offset:2048 lds
 ds_read_b64_tr_b16 a[24:25], v76 offset:12288
 ds_read_b64_tr_b16 a[26:27], v76 offset:12800
 ds_read_b64_tr_b16 a[88:89], v76 offset:16384
 ds_read_b64_tr_b16 a[90:91], v76 offset:16896
 ds_read_b64_tr_b16 a[152:153], v76 offset:20480
 ds_read_b64_tr_b16 a[154:155], v76 offset:20992
 ds_read_b64_tr_b16 a[28:29], v76 offset:24576
 ds_read_b64_tr_b16 a[30:31], v76 offset:25088
 s_add_u32 s88, s85, 0x150000
 s_add_u32 m0, s86, 12288
 s_nop 0
 buffer_load_dwordx4 v30, s[20:23], s88 offen lds
 s_add_u32 m0, s86, 15360
 s_nop 0
 buffer_load_dwordx4 v30, s[20:23], s88 offen offset:1024 lds
 s_add_u32 m0, s86, 18432
 s_nop 0
 buffer_load_dwordx4 v30, s[20:23], s88 offen offset:2048 lds
 ds_read_b64_tr_b16 a[92:93], v76 offset:28672
 ds_read_b64_tr_b16 a[94:95], v76 offset:29184
 ds_read_b64_tr_b16 a[156:157], v76 offset:32768
 ds_read_b64_tr_b16 a[158:159], v76 offset:33280
 ds_read_b64_tr_b16 a[32:33], v76 offset:36864
 ds_read_b64_tr_b16 a[34:35], v76 offset:37376
 ds_read_b64_tr_b16 a[96:97], v76 offset:40960
 ds_read_b64_tr_b16 a[98:99], v76 offset:41472
 s_add_u32 s88, s85, 0x168000
 s_add_u32 m0, s86, 24576
 s_nop 0
 buffer_load_dwordx4 v30, s[20:23], s88 offen lds
 s_add_u32 m0, s86, 27648
 s_nop 0
 buffer_load_dwordx4 v30, s[20:23], s88 offen offset:1024 lds
 s_add_u32 m0, s86, 30720
 s_nop 0
 buffer_load_dwordx4 v30, s[20:23], s88 offen offset:2048 lds
 ds_read_b64_tr_b16 a[160:161], v76 offset:45056
 ds_read_b64_tr_b16 a[162:163], v76 offset:45568
 ds_read_b64_tr_b16 a[36:37], v76 offset:49152
 ds_read_b64_tr_b16 a[38:39], v76 offset:49664
 ds_read_b64_tr_b16 a[100:101], v76 offset:53248
 ds_read_b64_tr_b16 a[102:103], v76 offset:53760
 ds_read_b64_tr_b16 a[164:165], v76 offset:57344
 ds_read_b64_tr_b16 a[166:167], v76 offset:57856
 ds_read_b64_tr_b16 a[12:13], v75 offset:36864
 ds_read_b64_tr_b16 a[14:15], v75 offset:37376
 ds_read_b64_tr_b16 a[76:77], v75 offset:40960
 ds_read_b64_tr_b16 a[78:79], v75 offset:41472
 ds_read_b64_tr_b16 a[140:141], v75 offset:45056
 ds_read_b64_tr_b16 a[142:143], v75 offset:45568
 ds_read_b64_tr_b16 a[16:17], v75 offset:49152
 ds_read_b64_tr_b16 a[18:19], v75 offset:49664
 ds_read_b64_tr_b16 a[80:81], v75 offset:53248
 ds_read_b64_tr_b16 a[82:83], v75 offset:53760
 ds_read_b64_tr_b16 a[144:145], v75 offset:57344
 ds_read_b64_tr_b16 a[146:147], v75 offset:57856
 ds_read_b64_tr_b16 a[20:21], v76
 ds_read_b64_tr_b16 a[22:23], v76 offset:512
 ds_read_b64_tr_b16 a[84:85], v76 offset:4096
 ds_read_b64_tr_b16 a[86:87], v76 offset:4608
 ds_read_b64_tr_b16 a[148:149], v76 offset:8192
 ds_read_b64_tr_b16 a[150:151], v76 offset:8704
 s_mov_b32 exec_lo, 0xf000ffff
 buffer_load_dword a252, v191, s[4:7], 0 offen
 s_mov_b32 exec_lo, -1
 v_mov_b32 v8, v191
 s_mov_b32 s84, 0xbb000000
 s_mov_b32 s12, s42
 s_and_b32 s13, s43, 0xffff
 s_mov_b32 s14, 0x200000
 s_mov_b32 s15, 0x20000
 s_lshl_b32 s79, s2, 12
 s_sub_u32 s58, s57, 32768
 s_cmp_eq_u32 s55, 1
 s_cselect_b32 s58, s57, s58
 s_lshl_b32 s63, s51, 7
 s_add_u32 s63, s63, s61
 s_lshl_b32 s64, s48, 5
 s_add_u32 s64, s64, s63
 s_add_u32 s66, s64, 0x600
 s_add_u32 s64, s64, 0x200
 s_lshl_b32 s65, s48, 7
 s_add_u32 s65, s65, s61
 s_lshl_b32 s68, s50, 2
 s_add_u32 s68, s68, s65
 s_add_u32 s68, s68, 0x600
 s_add_u32 s65, s65, 0x400
 s_lshl_b32 s90, s52, 2
 s_add_u32 s90, s90, s48
 s_lshl_b32 s67, s90, 2
 s_add_u32 s67, s67, s63
 s_lshl_b32 s77, s90, 14
 s_add_u32 s77, s77, 0x100000
 s_mul_i32 s78, s90, 57344
 s_add_u32 s78, s78, 0x200000
 s_lshl_b32 s85, s49, 2
 s_add_u32 s85, s85, s51
 s_lshl_b32 s86, s49, 2
 s_add_u32 s86, s86, s48
 s_mul_i32 s91, s85, 114688
 s_add_u32 s91, s91, 0xa00000
 s_lshl_b32 s69, s90, 9
 s_add_u32 s69, s69, s91
 s_lshl_b32 s70, s48, 12
 s_add_u32 s70, s70, s91
 s_mul_i32 s76, s48, 14336
 s_add_u32 s76, s76, s91
 s_lshl_b32 s71, s85, 16
 s_add_u32 s71, s71, 0x400000
 s_lshl_b32 s72, s85, 12
 s_add_u32 s72, s72, 0x860000
 s_add_u32 s59, s72, 0x20000
 s_lshl_b32 s73, s86, 16
 s_add_u32 s73, s73, 0x400000
 s_lshl_b32 s74, s86, 12
 s_add_u32 s74, s74, 0x860000
 s_mul_i32 s91, s86, 114688
 s_add_u32 s91, s91, 0xa00000
 s_mul_i32 s75, s50, 1792
 s_add_u32 s75, s75, s91
 s_sub_u32 s60, s59, 1024
 s_sub_u32 s62, s63, 128
 s_lshl_b32 s90, s85, 10
 s_add_u32 s90, s90, 0x89fc00
 s_sub_u32 s91, s61, 1664
 s_cmp_eq_u32 s51, 0
 s_cselect_b32 s60, s90, s60
 s_cselect_b32 s62, s91, s62
 s_cmp_eq_u32 s55, 1
 s_cselect_b32 s60, s59, s60
 s_cselect_b32 s62, s63, s62
 v_mfma_f32_16x16x32_bf16 v[192:195], a[0:3], v[78:81], 0
 v_mfma_f32_16x16x32_bf16 v[196:199], a[64:67], v[78:81], 0
 v_mfma_f32_16x16x32_bf16 v[200:203], a[128:131], v[78:81], 0
 v_mfma_f32_16x16x32_bf16 v[192:195], a[4:7], v[78:81], v[192:195]
 v_mfma_f32_16x16x32_bf16 v[196:199], a[68:71], v[78:81], v[196:199]
 v_mfma_f32_16x16x32_bf16 v[200:203], a[132:135], v[78:81], v[200:203]
 v_mfma_f32_16x16x32_bf16 v[192:195], a[8:11], v[78:81], v[192:195]
 v_mfma_f32_16x16x32_bf16 v[196:199], a[72:75], v[78:81], v[196:199]
 v_mfma_f32_16x16x32_bf16 v[200:203], a[136:139], v[78:81], v[200:203]
 s_waitcnt vmcnt(10) lgkmcnt(0)
 s_barrier
 s_add_u32 s89, s57, 0x18000
 s_add_u32 m0, s80, -32768
 s_nop 0
 buffer_load_dwordx4 v15, s[8:11], s89 offen sc1 lds
 v_xor_b32 v24, 1040, v15
 v_xor_b32 v25, 2080, v15
 buffer_load_dwordx4 v24, s[8:11], s89 offen offset:1024 sc1 lds
 buffer_load_dwordx4 v25, s[8:11], s89 offen offset:2048 sc1 lds
 v_xor_b32 v24, 3120, v15
 buffer_load_dwordx4 v24, s[8:11], s89 offen offset:3072 sc1 lds
 ds_read_b64_tr_b16 a[40:41], v77
 ds_read_b64_tr_b16 a[42:43], v77 offset:512
 ds_read_b64_tr_b16 a[104:105], v77 offset:4096
 ds_read_b64_tr_b16 a[106:107], v77 offset:4608
 ds_read_b64_tr_b16 a[168:169], v77 offset:8192
 ds_read_b64_tr_b16 a[170:171], v77 offset:8704
 ds_read_b64_tr_b16 a[44:45], v77 offset:12288
 ds_read_b64_tr_b16 a[46:47], v77 offset:12800
 ds_read_b64_tr_b16 a[108:109], v77 offset:16384
 ds_read_b64_tr_b16 a[110:111], v77 offset:16896
 ds_read_b64_tr_b16 a[172:173], v77 offset:20480
 ds_read_b64_tr_b16 a[174:175], v77 offset:20992
 ds_read_b64_tr_b16 a[48:49], v77 offset:24576
 ds_read_b64_tr_b16 a[50:51], v77 offset:25088
 ds_read_b64_tr_b16 a[112:113], v77 offset:28672
 ds_read_b64_tr_b16 a[114:115], v77 offset:29184
 ds_read_b64_tr_b16 a[176:177], v77 offset:32768
 ds_read_b64_tr_b16 a[178:179], v77 offset:33280
 s_add_u32 s89, s57, 0x10000
 s_add_u32 m0, s80, -16384
 s_nop 0
 buffer_load_dwordx4 v15, s[8:11], s89 offen sc1 lds
 v_xor_b32 v24, 1040, v15
 v_xor_b32 v25, 2080, v15
 buffer_load_dwordx4 v24, s[8:11], s89 offen offset:1024 sc1 lds
 buffer_load_dwordx4 v25, s[8:11], s89 offen offset:2048 sc1 lds
 v_xor_b32 v24, 3120, v15
 buffer_load_dwordx4 v24, s[8:11], s89 offen offset:3072 sc1 lds
 v_lshlrev_b32 v132, 7, v1
 s_lshl_b32 s85, s48, 13
 s_add_u32 s85, s85, 0x8c0000
 buffer_load_dwordx2 v[128:129], v132, s[4:7], s85 offen sc1
 v_lshlrev_b32 v133, 5, v6
 s_lshl_b32 s86, s49, 12
 s_add_u32 s86, s86, 0x8c0000
 buffer_load_dwordx2 v[130:131], v133, s[4:7], s86 offen sc1
 v_mfma_f32_16x16x32_bf16 v[192:195], a[12:15], v[78:81], v[192:195]
 v_mfma_f32_16x16x32_bf16 v[196:199], a[76:79], v[78:81], v[196:199]
 v_mfma_f32_16x16x32_bf16 v[200:203], a[140:143], v[78:81], v[200:203]
 v_mfma_f32_16x16x32_bf16 v[192:195], a[16:19], v[78:81], v[192:195]
 v_mfma_f32_16x16x32_bf16 v[196:199], a[80:83], v[78:81], v[196:199]
 v_mfma_f32_16x16x32_bf16 v[200:203], a[144:147], v[78:81], v[200:203]
 v_mfma_f32_16x16x32_bf16 v[192:195], a[20:23], v[78:81], v[192:195]
 v_mfma_f32_16x16x32_bf16 v[196:199], a[84:87], v[78:81], v[196:199]
 v_mfma_f32_16x16x32_bf16 v[200:203], a[148:151], v[78:81], v[200:203]
 v_mfma_f32_16x16x32_bf16 v[192:195], a[24:27], v[78:81], v[192:195]
 v_mfma_f32_16x16x32_bf16 v[196:199], a[88:91], v[78:81], v[196:199]
 v_mfma_f32_16x16x32_bf16 v[200:203], a[152:155], v[78:81], v[200:203]
 v_mfma_f32_16x16x32_bf16 v[192:195], a[28:31], v[78:81], v[192:195]
 v_mfma_f32_16x16x32_bf16 v[196:199], a[92:95], v[78:81], v[196:199]
 v_mfma_f32_16x16x32_bf16 v[200:203], a[156:159], v[78:81], v[200:203]
 v_mfma_f32_16x16x32_bf16 v[192:195], a[32:35], v[78:81], v[192:195]
 v_mfma_f32_16x16x32_bf16 v[196:199], a[96:99], v[78:81], v[196:199]
 v_mfma_f32_16x16x32_bf16 v[200:203], a[160:163], v[78:81], v[200:203]
 v_mfma_f32_16x16x32_bf16 v[192:195], a[36:39], v[78:81], v[192:195]
 v_mfma_f32_16x16x32_bf16 v[196:199], a[100:103], v[78:81], v[196:199]
 v_mfma_f32_16x16x32_bf16 v[200:203], a[164:167], v[78:81], v[200:203]
 s_waitcnt lgkmcnt(0)
 v_mfma_f32_16x16x32_bf16 v[192:195], a[40:43], v[78:81], v[192:195]
 v_mfma_f32_16x16x32_bf16 v[196:199], a[104:107], v[78:81], v[196:199]
 v_mfma_f32_16x16x32_bf16 v[200:203], a[168:171], v[78:81], v[200:203]
 s_waitcnt vmcnt(11)
 s_barrier
 ds_read_b64_tr_b16 a[52:53], v75
 ds_read_b64_tr_b16 a[54:55], v75 offset:512
 ds_read_b64_tr_b16 a[116:117], v75 offset:4096
 ds_read_b64_tr_b16 a[118:119], v75 offset:4608
 ds_read_b64_tr_b16 a[180:181], v75 offset:8192
 ds_read_b64_tr_b16 a[182:183], v75 offset:8704
 ds_read_b64_tr_b16 a[56:57], v75 offset:12288
 ds_read_b64_tr_b16 a[58:59], v75 offset:12800
 ds_read_b64_tr_b16 a[120:121], v75 offset:16384
 ds_read_b64_tr_b16 a[122:123], v75 offset:16896
 ds_read_b64_tr_b16 a[184:185], v75 offset:20480
 ds_read_b64_tr_b16 a[186:187], v75 offset:20992
 ds_read_b64_tr_b16 a[60:61], v75 offset:24576
 ds_read_b64_tr_b16 a[62:63], v75 offset:25088
 ds_read_b64_tr_b16 a[124:125], v75 offset:28672
 ds_read_b64_tr_b16 a[126:127], v75 offset:29184
 ds_read_b64_tr_b16 a[188:189], v75 offset:32768
 ds_read_b64_tr_b16 a[190:191], v75 offset:33280
.Lk1f:
 v_and_b32 v24, 15, v1
 v_lshrrev_b32 v25, 4, v1
 v_xor_b32 v26, v25, v24
 v_lshlrev_b32 v26, 4, v26
 v_lshl_add_u32 v26, v24, 10, v26
 v_add_u32 v30, 81920, v26
 v_xor_b32 v31, 64, v30
 v_xor_b32 v32, 128, v30
 v_xor_b32 v33, 192, v30
 v_mov_b32 v64, 0x3f803f80
 v_mov_b32 v65, 0x3f803f80
 v_mov_b32 v66, 0x3f803f80
 v_mov_b32 v67, 0x3f803f80
 s_waitcnt vmcnt(6) lgkmcnt(0)
 s_barrier
 ds_read_b128 v[216:219], v30
 ds_read_b128 v[220:223], v31
 ds_read_b128 v[224:227], v32
 ds_read_b128 v[228:231], v33
 ds_read_b128 v[232:235], v30 offset:256
 s_mul_i32 s16, s48, 7168
 s_mul_i32 s88, s50, 114688
 s_add_u32 s88, s88, s16
 s_add_u32 s88, s88, 0xe00000
 s_waitcnt lgkmcnt(4)
 v_mfma_f32_16x16x32_bf16 v[112:115], a[0:3], v[216:219], 0
 s_add_u32 s91, s57, 0x8000
 s_add_u32 m0, s80, 0
 s_nop 0
 buffer_load_dwordx4 v15, s[8:11], s91 offen sc1 lds
 v_xor_b32 v143, 1040, v15
 v_mfma_f32_16x16x32_bf16 v[116:119], a[64:67], v[216:219], 0
 v_lshlrev_b32 v94, 2, v25
 v_sub_u32 v94, v94, v24
 v_mov_b32 v95, 0x3f80
 v_mfma_f32_16x16x32_bf16 v[120:123], a[128:131], v[216:219], 0
 s_waitcnt lgkmcnt(3)
 buffer_load_dwordx4 v143, s[8:11], s91 offen offset:1024 sc1 lds
 ds_read_b128 v[236:239], v31 offset:256
 v_mfma_f32_16x16x32_bf16 v[112:115], a[4:7], v[220:223], v[112:115]
 v_xor_b32 v144, 2080, v15
 v_sub_u32 v42, 0, v94
 v_lshlrev_b32 v43, 4, v42
 v_mfma_f32_16x16x32_bf16 v[116:119], a[68:71], v[220:223], v[116:119]
 v_lshlrev_b32 v92, v43, v95
 v_lshrrev_b32 v42, 1, v42
 v_min_u32 v42, 1, v42
 v_mfma_f32_16x16x32_bf16 v[120:123], a[132:135], v[220:223], v[120:123]
 s_waitcnt lgkmcnt(1)
 buffer_load_dwordx4 v144, s[8:11], s91 offen offset:2048 sc1 lds
 ds_read_b128 v[216:219], v32 offset:256
 v_mfma_f32_16x16x32_bf16 v[112:115], a[8:11], v[224:227], v[112:115]
 v_xor_b32 v143, 3120, v15
 v_add_u32 v42, -1, v42
 v_and_b32 v92, v92, v42
 v_mfma_f32_16x16x32_bf16 v[116:119], a[72:75], v[224:227], v[116:119]
 v_sub_u32 v42, -2, v94
 v_lshlrev_b32 v43, 4, v42
 v_lshlrev_b32 v93, v43, v95
 v_mfma_f32_16x16x32_bf16 v[120:123], a[136:139], v[224:227], v[120:123]
 buffer_load_dwordx4 v143, s[8:11], s91 offen offset:3072 sc1 lds
 ds_read_b128 v[220:223], v33 offset:256
 v_lshrrev_b32 v42, 1, v42
 v_mfma_f32_16x16x32_bf16 v[112:115], a[12:15], v[228:231], v[112:115]
 v_min_u32 v42, 1, v42
 v_add_u32 v42, -1, v42
 v_mfma_f32_16x16x32_bf16 v[116:119], a[76:79], v[228:231], v[116:119]
 s_add_u32 m0, s80, 16384
 v_and_b32 v93, v93, v42
 v_lshrrev_b32 v52, 1, v25
 v_lshlrev_b32 v34, 8, v52
 v_mfma_f32_16x16x32_bf16 v[120:123], a[140:143], v[228:231], v[120:123]
 s_add_u32 s91, s57, 0x0
 buffer_load_dwordx4 v15, s[8:11], s91 offen sc1 lds
 ds_read_b128 v[224:227], v30 offset:512
 v_mfma_f32_16x16x32_bf16 v[112:115], a[16:19], v[232:235], v[112:115]
 s_mov_b32 s95, 0xff800000
 v_xor_b32 v143, 1040, v15
 v_lshl_add_u32 v34, v24, 4, v34
 v_mfma_f32_16x16x32_bf16 v[116:119], a[80:83], v[232:235], v[116:119]
 s_mul_i32 s94, s55, 0xff800000
 v_and_b32 v52, 1, v25
 v_lshl_add_u32 v34, v52, 3, v34
 v_mfma_f32_16x16x32_bf16 v[120:123], a[144:147], v[232:235], v[120:123]
 s_waitcnt lgkmcnt(1)
 buffer_load_dwordx4 v143, s[8:11], s91 offen offset:1024 sc1 lds
 ds_read_b128 v[228:231], v31 offset:512
 v_xor_b32 v144, 2080, v15
 v_mfma_f32_16x16x32_bf16 v[112:115], a[20:23], v[236:239], v[112:115]
 v_add_u32 v96, -9, v94
 v_ashrrev_i32 v96, 31, v96
 v_and_b32 v96, s95, v96
 v_mfma_f32_16x16x32_bf16 v[116:119], a[84:87], v[236:239], v[116:119]
 v_or_b32 v60, s94, v96
 v_add_u32 v53, 7, v94
 v_mfma_f32_16x16x32_bf16 v[120:123], a[148:151], v[236:239], v[120:123]
 buffer_load_dwordx4 v144, s[8:11], s91 offen offset:2048 sc1 lds
 ds_read_b128 v[232:235], v32 offset:512
 v_xor_b32 v143, 3120, v15
 v_mfma_f32_16x16x32_bf16 v[112:115], a[24:27], v[216:219], v[112:115]
 v_sub_u32 v56, 0, v94
 v_or_b32 v56, v56, v53
 v_ashrrev_i32 v56, 31, v56
 v_mfma_f32_16x16x32_bf16 v[116:119], a[88:91], v[216:219], v[116:119]
 v_and_b32 v56, s95, v56
 v_add_u32 v97, -8, v94
 v_mfma_f32_16x16x32_bf16 v[120:123], a[152:155], v[216:219], v[120:123]
 buffer_load_dwordx4 v143, s[8:11], s91 offen offset:3072 sc1 lds
 ds_read_b128 v[236:239], v33 offset:512
 v_ashrrev_i32 v97, 31, v97
 v_mfma_f32_16x16x32_bf16 v[112:115], a[28:31], v[220:223], v[112:115]
 v_and_b32 v97, s95, v97
 v_or_b32 v61, s94, v97
 v_mfma_f32_16x16x32_bf16 v[116:119], a[92:95], v[220:223], v[116:119]
 s_waitcnt lgkmcnt(1)
 v_add_u32 v53, 8, v94
 v_sub_u32 v57, -1, v94
 v_or_b32 v57, v57, v53
 v_mfma_f32_16x16x32_bf16 v[120:123], a[156:159], v[220:223], v[120:123]
 s_add_u32 m0, s80, 32768
 s_nop 0
 buffer_load_dwordx4 v15, s[8:11], s58 offen sc1 lds
 ds_read_b128 v[216:219], v30 offset:768
 v_mfma_f32_16x16x32_bf16 v[112:115], a[32:35], v[224:227], v[112:115]
 v_xor_b32 v143, 1040, v15
 v_ashrrev_i32 v57, 31, v57
 v_and_b32 v57, s95, v57
 v_mfma_f32_16x16x32_bf16 v[116:119], a[96:99], v[224:227], v[116:119]
 v_add_u32 v98, -7, v94
 v_ashrrev_i32 v98, 31, v98
 v_mfma_f32_16x16x32_bf16 v[120:123], a[160:163], v[224:227], v[120:123]
 buffer_load_dwordx4 v143, s[8:11], s58 offen offset:1024 sc1 lds
 ds_read_b128 v[220:223], v31 offset:768
 v_xor_b32 v144, 2080, v15
 v_mfma_f32_16x16x32_bf16 v[112:115], a[36:39], v[228:231], v[112:115]
 v_and_b32 v98, s95, v98
 v_or_b32 v62, s94, v98
 v_mfma_f32_16x16x32_bf16 v[116:119], a[100:103], v[228:231], v[116:119]
 v_add_u32 v53, 9, v94
 v_sub_u32 v58, -2, v94
 v_or_b32 v58, v58, v53
 v_mfma_f32_16x16x32_bf16 v[120:123], a[164:167], v[228:231], v[120:123]
 buffer_load_dwordx4 v144, s[8:11], s58 offen offset:2048 sc1 lds
 ds_read_b128 v[224:227], v32 offset:768
 v_xor_b32 v143, 3120, v15
 v_mfma_f32_16x16x32_bf16 v[112:115], a[40:43], v[232:235], v[112:115]
 v_ashrrev_i32 v58, 31, v58
 v_and_b32 v58, s95, v58
 v_mfma_f32_16x16x32_bf16 v[116:119], a[104:107], v[232:235], v[116:119]
 v_add_u32 v99, -6, v94
 v_ashrrev_i32 v99, 31, v99
 v_mfma_f32_16x16x32_bf16 v[120:123], a[168:171], v[232:235], v[120:123]
 s_waitcnt lgkmcnt(2)
 buffer_load_dwordx4 v143, s[8:11], s58 offen offset:3072 sc1 lds
 ds_read_b128 v[228:231], v33 offset:768
 v_mfma_f32_16x16x32_bf16 v[112:115], a[44:47], v[236:239], v[112:115]
 v_and_b32 v99, s95, v99
 v_or_b32 v63, s94, v99
 v_add_u32 v53, 10, v94
 v_mfma_f32_16x16x32_bf16 v[116:119], a[108:111], v[236:239], v[116:119]
 v_sub_u32 v59, -3, v94
 v_or_b32 v59, v59, v53
 v_mfma_f32_16x16x32_bf16 v[120:123], a[172:175], v[236:239], v[120:123]
 v_ashrrev_i32 v59, 31, v59
 v_and_b32 v59, s95, v59
 v_mfma_f32_16x16x32_bf16 v[112:115], a[48:51], v[216:219], v[112:115]
.Lrc_8:
 s_waitcnt vmcnt(12)
 v_xor_b32 v128, s96, v128
 v_xor_b32 v129, s97, v129
 v_xor_b32 v130, s96, v130
 v_xor_b32 v131, s97, v131
 v_or_b32 v128, v128, v130
 v_lshrrev_b32 v128, 3, v128
 v_or3_b32 v128, v128, v129, v131
 v_cmp_ne_u32 vcc, 0, v128
 s_nop 0
 s_cbranch_vccnz .Lrr_9
 v_cmp_ne_u32 vcc, 0, v130
 s_nop 0
 s_or_b32 s98, vcc_lo, vcc_hi
 s_barrier
 s_cmp_lg_u32 s98, 0
 s_cbranch_scc1 .Lslow
 v_and_b32 v29, 32, v6
 v_mfma_f32_16x16x32_bf16 v[116:119], a[112:115], v[216:219], v[116:119]
 s_lshl_b32 s85, s49, 2
 v_lshlrev_b32 v28, 1, v7
 v_lshl_add_u32 v28, v29, 2, v28
 s_add_u32 s85, s85, s51
 s_lshl_b32 s85, s85, 10
 s_add_u32 s85, s85, 0x840000
 buffer_load_dwordx2 v[204:205], v28, s[4:7], s85 offen offset:768 sc1
 buffer_load_dwordx2 v[206:207], v28, s[4:7], s85 offen offset:512 sc1
 buffer_load_dwordx2 v[208:209], v28, s[4:7], s85 offen offset:256 sc1
 buffer_load_dwordx2 v[210:211], v28, s[4:7], s85 offen sc1
 s_sub_u32 s86, s85, 256
 s_cmp_eq_u32 s55, 1
 s_cselect_b32 s86, s85, s86
 buffer_load_dwordx2 v[212:213], v28, s[4:7], s86 offen sc1
 v_mfma_f32_16x16x32_bf16 v[120:123], a[176:179], v[216:219], v[120:123]
 s_waitcnt lgkmcnt(0)
 s_barrier
 ds_read_b128 v[232:235], v30 offset:16384
 ds_read_b128 v[236:239], v31 offset:16384
 v_mfma_f32_16x16x32_bf16 v[112:115], a[52:55], v[220:223], v[112:115]
 s_add_u32 m0, s16, 0
 s_add_u32 s89, s88, 0x0
 buffer_load_dwordx4 v2, s[4:7], s89 offen sc1 lds
 v_mfma_f32_16x16x32_bf16 v[116:119], a[116:119], v[220:223], v[116:119]
 v_mfma_f32_16x16x32_bf16 v[120:123], a[180:183], v[220:223], v[120:123]
 ds_read_b128 v[216:219], v32 offset:16384
 v_mfma_f32_16x16x32_bf16 v[112:115], a[56:59], v[224:227], v[112:115]
 v_mfma_f32_16x16x32_bf16 v[116:119], a[120:123], v[224:227], v[116:119]
 v_mfma_f32_16x16x32_bf16 v[120:123], a[184:187], v[224:227], v[120:123]
 ds_read_b128 v[220:223], v33 offset:16384
 v_mfma_f32_16x16x32_bf16 v[112:115], a[60:63], v[228:231], v[112:115]
 v_mfma_f32_16x16x32_bf16 v[116:119], a[124:127], v[228:231], v[116:119]
 v_mfma_f32_16x16x32_bf16 v[120:123], a[188:191], v[228:231], v[120:123]
 s_waitcnt lgkmcnt(3)
 buffer_load_dwordx4 v2, s[4:7], s89 offen offset:1024 sc1 lds
 v_mfma_f32_16x16x32_bf16 v[240:243], a[0:3], v[232:235], 0
 ds_read_b128 v[224:227], v30 offset:16640
 v_mfma_f32_16x16x32_bf16 v[192:195], a[44:47], v[64:67], v[192:195]
 v_mfma_f32_16x16x32_bf16 v[244:247], a[64:67], v[232:235], 0
 v_mfma_f32_16x16x32_bf16 v[196:199], a[108:111], v[64:67], v[196:199]
 v_mfma_f32_16x16x32_bf16 v[248:251], a[128:131], v[232:235], 0
 v_mfma_f32_16x16x32_bf16 v[200:203], a[172:175], v[64:67], v[200:203]
 s_waitcnt lgkmcnt(2)
 ds_read_b128 v[228:231], v31 offset:16640
 v_mfma_f32_16x16x32_bf16 v[240:243], a[4:7], v[236:239], v[240:243]
 v_mfma_f32_16x16x32_bf16 v[192:195], a[48:51], v[64:67], v[192:195]
 s_lshl_b32 s86, s51, 2
 v_mfma_f32_16x16x32_bf16 v[244:247], a[68:71], v[236:239], v[244:247]
 s_and_b32 s85, s77, -65536
 s_add_u32 s86, s86, s48
 s_lshl_b32 s86, s86, 12
 s_add_u32 s85, s85, s86
 v_lshlrev_b32 v5, 5, v6
 v_mfma_f32_16x16x32_bf16 v[196:199], a[112:115], v[64:67], v[196:199]
 buffer_load_dword a255, v5, s[4:7], s85 offen sc1
 v_mfma_f32_16x16x32_bf16 v[248:251], a[132:135], v[236:239], v[248:251]
 ds_read_b128 v[232:235], v32 offset:16640
 v_mfma_f32_16x16x32_bf16 v[200:203], a[176:179], v[64:67], v[200:203]
 v_and_b32 v5, 60, v6
 v_lshlrev_b32 v5, 5, v5
 v_mfma_f32_16x16x32_bf16 v[240:243], a[8:11], v[216:219], v[240:243]
 buffer_load_dword a255, v5, s[4:7], s61 offen sc1
 v_mfma_f32_16x16x32_bf16 v[192:195], a[52:55], v[64:67], v[192:195]
 v_mfma_f32_16x16x32_bf16 v[244:247], a[72:75], v[216:219], v[244:247]
 v_lshrrev_b32 v184, 3, v1
 v_mfma_f32_16x16x32_bf16 v[196:199], a[116:119], v[64:67], v[196:199]
 s_lshl_b32 s87, s50, 13
 v_lshlrev_b32 v185, 2, v7
 v_lshl_add_u32 v184, v184, 9, v185
 v_mfma_f32_16x16x32_bf16 v[248:251], a[136:139], v[216:219], v[248:251]
 s_lshl_b32 s86, s48, 7
 s_add_u32 s87, s87, s86
 s_add_u32 s87, s87, 0x180000
 buffer_load_dwordx4 v[176:179], v184, s[4:7], s87 offen sc1
 v_mfma_f32_16x16x32_bf16 v[200:203], a[180:183], v[64:67], v[200:203]
 s_waitcnt lgkmcnt(1)
 s_add_u32 s87, s87, 0x1000
 buffer_load_dwordx4 v[180:183], v184, s[4:7], s87 offen sc1
 v_mfma_f32_16x16x32_bf16 v[240:243], a[12:15], v[220:223], v[240:243]
 ds_read_b128 v[236:239], v33 offset:16640
 v_mfma_f32_16x16x32_bf16 v[192:195], a[56:59], v[64:67], v[192:195]
 v_mfma_f32_16x16x32_bf16 v[244:247], a[76:79], v[220:223], v[244:247]
 v_mfma_f32_16x16x32_bf16 v[196:199], a[120:123], v[64:67], v[196:199]
 v_mfma_f32_16x16x32_bf16 v[248:251], a[140:143], v[220:223], v[248:251]
 v_mfma_f32_16x16x32_bf16 v[200:203], a[184:187], v[64:67], v[200:203]
 ds_read_b128 v[216:219], v30 offset:16896
 v_mfma_f32_16x16x32_bf16 v[240:243], a[16:19], v[224:227], v[240:243]
 v_mfma_f32_16x16x32_bf16 v[192:195], a[60:63], v[64:67], v[192:195]
 v_mfma_f32_16x16x32_bf16 v[244:247], a[80:83], v[224:227], v[244:247]
 v_mfma_f32_16x16x32_bf16 v[196:199], a[124:127], v[64:67], v[196:199]
 v_mfma_f32_16x16x32_bf16 v[248:251], a[144:147], v[224:227], v[248:251]
 buffer_load_dwordx4 v2, s[4:7], s89 offen offset:2048 sc1 lds
 v_mfma_f32_16x16x32_bf16 v[200:203], a[188:191], v[64:67], v[200:203]
 ds_read_b128 v[220:223], v31 offset:16896
 v_mfma_f32_16x16x32_bf16 v[240:243], a[20:23], v[228:231], v[240:243]
 v_mfma_f32_16x16x32_bf16 v[244:247], a[84:87], v[228:231], v[244:247]
 v_mfma_f32_16x16x32_bf16 v[248:251], a[148:151], v[228:231], v[248:251]
 s_waitcnt lgkmcnt(2)
 ds_read_b128 v[224:227], v32 offset:16896
 v_mfma_f32_16x16x32_bf16 v[240:243], a[24:27], v[232:235], v[240:243]
 v_mfma_f32_16x16x32_bf16 v[244:247], a[88:91], v[232:235], v[244:247]
 v_mfma_f32_16x16x32_bf16 v[248:251], a[152:155], v[232:235], v[248:251]
 ds_read_b128 v[228:231], v33 offset:16896
 v_mfma_f32_16x16x32_bf16 v[240:243], a[28:31], v[236:239], v[240:243]
 v_mfma_f32_16x16x32_bf16 v[244:247], a[92:95], v[236:239], v[244:247]
 v_mfma_f32_16x16x32_bf16 v[248:251], a[156:159], v[236:239], v[248:251]
 s_waitcnt lgkmcnt(3)
 ds_read_b128 v[232:235], v30 offset:17152
 v_mfma_f32_16x16x32_bf16 v[240:243], a[32:35], v[216:219], v[240:243]
 buffer_load_dwordx4 v2, s[4:7], s89 offen offset:3072 sc1 lds
 v_mfma_f32_16x16x32_bf16 v[244:247], a[96:99], v[216:219], v[244:247]
 s_waitcnt lgkmcnt(2)
 v_and_b32 v145, 48, v1
 v_mfma_f32_16x16x32_bf16 v[248:251], a[160:163], v[216:219], v[248:251]
 s_lshl_b32 s85, s48, 8
 s_add_u32 s85, s85, s79
 buffer_store_dwordx4 v[192:195], v145, s[4:7], s85 offen offset:512
 buffer_store_dwordx4 v[196:199], v145, s[4:7], s85 offen offset:576
 v_mfma_f32_16x16x32_bf16 v[240:243], a[36:39], v[220:223], v[240:243]
 buffer_store_dwordx4 v[200:203], v145, s[4:7], s85 offen offset:640
 ds_read_b128 v[236:239], v31 offset:17152
 v_mfma_f32_16x16x32_bf16 v[244:247], a[100:103], v[220:223], v[244:247]
 s_waitcnt vmcnt(15)
 v_fmac_f32 v120, v200, v204
 v_fmac_f32 v121, v201, v204
 v_fmac_f32 v122, v202, v204
 v_mfma_f32_16x16x32_bf16 v[248:251], a[164:167], v[220:223], v[248:251]
 ds_read_b128 v[216:219], v32 offset:17152
 v_fmac_f32 v123, v203, v204
 v_mfma_f32_16x16x32_bf16 v[240:243], a[40:43], v[224:227], v[240:243]
 v_mul_f32 v120, v120, v205
 v_mul_f32 v121, v121, v205
 v_mul_f32 v122, v122, v205
 v_mfma_f32_16x16x32_bf16 v[244:247], a[104:107], v[224:227], v[244:247]
 v_mul_f32 v123, v123, v205
 v_cvt_pk_bf16_f32 v40, v120, v121
 v_mfma_f32_16x16x32_bf16 v[248:251], a[168:171], v[224:227], v[248:251]
 s_waitcnt lgkmcnt(2)
 ds_read_b128 v[220:223], v33 offset:17152
 v_cvt_pk_bf16_f32 v41, v122, v123
 v_mfma_f32_16x16x32_bf16 v[240:243], a[44:47], v[228:231], v[240:243]
 v_fmac_f32 v116, v196, v204
 v_fmac_f32 v117, v197, v204
 v_mfma_f32_16x16x32_bf16 v[244:247], a[108:111], v[228:231], v[244:247]
 v_mfma_f32_16x16x16_bf16 v[120:123], v[40:41], v[92:93], 0
 s_add_u32 s89, s88, 0x1000
 v_fmac_f32 v118, v198, v204
 v_mfma_f32_16x16x32_bf16 v[248:251], a[172:175], v[228:231], v[248:251]
 s_add_u32 m0, s16, 4096
 s_nop 0
 buffer_load_dwordx4 v2, s[4:7], s89 offen sc1 lds
 v_fmac_f32 v119, v199, v204
 v_mfma_f32_16x16x32_bf16 v[240:243], a[48:51], v[232:235], v[240:243]
 v_mul_f32 v116, v116, v205
 v_mul_f32 v117, v117, v205
 v_mfma_f32_16x16x32_bf16 v[244:247], a[112:115], v[232:235], v[244:247]
 v_mul_f32 v118, v118, v205
 v_mul_f32 v119, v119, v205
 v_mfma_f32_16x16x32_bf16 v[248:251], a[176:179], v[232:235], v[248:251]
 s_waitcnt lgkmcnt(0)
 s_barrier
 v_add_u32 v30, 32768, v30
 v_add_u32 v31, 32768, v31
 v_add_u32 v32, 32768, v32
 v_add_u32 v33, 32768, v33
 v_mfma_f32_16x16x32_bf16 v[240:243], a[52:55], v[236:239], v[240:243]
 ds_read_b128 v[224:227], v30
 ds_read_b128 v[228:231], v31
 v_mfma_f32_16x16x32_bf16 v[244:247], a[116:119], v[236:239], v[244:247]
 v_cvt_pk_bf16_f32 v80, v116, v117
 v_cvt_pk_bf16_f32 v81, v118, v119
 v_mfma_f32_16x16x32_bf16 v[248:251], a[180:183], v[236:239], v[248:251]
 ds_read_b128 v[232:235], v32
 v_mfma_f32_16x16x32_bf16 v[240:243], a[56:59], v[216:219], v[240:243]
 v_fmac_f32 v112, v192, v204
 v_fmac_f32 v113, v193, v204
 v_mfma_f32_16x16x32_bf16 v[244:247], a[120:123], v[216:219], v[244:247]
 v_fmac_f32 v114, v194, v204
 v_fmac_f32 v115, v195, v204
 v_mfma_f32_16x16x32_bf16 v[248:251], a[184:187], v[216:219], v[248:251]
 ds_read_b128 v[236:239], v33
 v_cvt_pk_bf16_f32 v68, v112, v113
 v_mfma_f32_16x16x32_bf16 v[240:243], a[60:63], v[220:223], v[240:243]
 v_cvt_pk_bf16_f32 v69, v114, v115
 v_mul_f32 v38, 0x3eb8aa3b, v205
 v_mfma_f32_16x16x32_bf16 v[244:247], a[124:127], v[220:223], v[244:247]
 buffer_load_dwordx4 v2, s[4:7], s89 offen offset:1024 sc1 lds
 v_cvt_pk_bf16_f32 v90, v120, v121
 v_mfma_f32_16x16x32_bf16 v[248:251], a[188:191], v[220:223], v[248:251]
 s_waitcnt lgkmcnt(2)
 ds_read_b128 v[216:219], v30 offset:256
 v_cvt_pk_bf16_f32 v91, v122, v123
 v_mfma_f32_16x16x32_bf16 v[112:115], a[0:3], v[224:227], 0
 buffer_load_dwordx4 v2, s[4:7], s89 offen offset:2048 sc1 lds
 v_mfma_f32_16x16x32_bf16 v[116:119], a[64:67], v[224:227], 0
 v_mfma_f32_16x16x32_bf16 v[120:123], a[128:131], v[224:227], 0
 ds_read_b128 v[220:223], v31 offset:256
 v_mfma_f32_16x16x32_bf16 v[112:115], a[4:7], v[228:231], v[112:115]
 s_add_u32 s89, s88, 0x7000
 v_mfma_f32_16x16x32_bf16 v[116:119], a[68:71], v[228:231], v[116:119]
 s_add_u32 m0, s16, 28672
 s_nop 0
 buffer_load_dwordx4 v2, s[4:7], s89 offen sc1 lds
 s_waitcnt vmcnt(15)
 v_fmac_f32 v248, v200, v206
 v_fmac_f32 v249, v201, v206
 v_mfma_f32_16x16x32_bf16 v[120:123], a[132:135], v[228:231], v[120:123]
 s_waitcnt lgkmcnt(2)
 ds_read_b128 v[224:227], v32 offset:256
 v_fmac_f32 v250, v202, v206
 v_fmac_f32 v251, v203, v206
 v_mfma_f32_16x16x32_bf16 v[112:115], a[8:11], v[232:235], v[112:115]
 v_mul_f32 v248, v248, v207
 v_mul_f32 v249, v249, v207
 v_mfma_f32_16x16x32_bf16 v[116:119], a[72:75], v[232:235], v[116:119]
 v_mul_f32 v250, v250, v207
 v_mul_f32 v251, v251, v207
 v_cvt_pk_bf16_f32 v40, v248, v249
 v_mfma_f32_16x16x32_bf16 v[120:123], a[136:139], v[232:235], v[120:123]
 ds_read_b128 v[228:231], v33 offset:256
 v_cvt_pk_bf16_f32 v41, v250, v251
 v_fmac_f32 v244, v196, v206
 v_mfma_f32_16x16x32_bf16 v[112:115], a[12:15], v[236:239], v[112:115]
 buffer_load_dwordx4 v2, s[4:7], s89 offen offset:1024 sc1 lds
 v_fmac_f32 v245, v197, v206
 v_mfma_f32_16x16x32_bf16 v[116:119], a[76:79], v[236:239], v[116:119]
 v_mfma_f32_16x16x16_bf16 v[248:251], v[40:41], v[92:93], 0
 v_fmac_f32 v246, v198, v206
 v_mfma_f32_16x16x32_bf16 v[120:123], a[140:143], v[236:239], v[120:123]
 s_waitcnt lgkmcnt(1)
 ds_read_b128 v[232:235], v30 offset:512
 v_fmac_f32 v247, v199, v206
 v_mul_f32 v244, v244, v207
 v_mfma_f32_16x16x32_bf16 v[112:115], a[16:19], v[216:219], v[112:115]
 v_mul_f32 v245, v245, v207
 v_mul_f32 v246, v246, v207
 v_mul_f32 v247, v247, v207
 v_mfma_f32_16x16x32_bf16 v[116:119], a[80:83], v[216:219], v[116:119]
 v_cvt_pk_bf16_f32 v78, v244, v245
 v_cvt_pk_bf16_f32 v79, v246, v247
 v_mfma_f32_16x16x32_bf16 v[120:123], a[144:147], v[216:219], v[120:123]
 buffer_load_dwordx4 v2, s[4:7], s89 offen offset:2048 sc1 lds
 ds_read_b128 v[236:239], v31 offset:512
 v_mfma_f32_16x16x32_bf16 v[112:115], a[20:23], v[220:223], v[112:115]
 v_mfma_f32_16x16x16_bf16 v[104:107], v[80:81], v[68:69], v[56:59]
 v_mfma_f32_16x16x32_bf16 v[116:119], a[84:87], v[220:223], v[116:119]
 v_mfma_f32_16x16x16_bf16 v[100:103], v[78:79], v[68:69], v[96:99]
 v_fmac_f32 v240, v192, v206
 v_mfma_f32_16x16x32_bf16 v[120:123], a[148:151], v[220:223], v[120:123]
 ds_read_b128 v[216:219], v32 offset:512
 v_fmac_f32 v241, v193, v206
 v_fmac_f32 v242, v194, v206
 v_mfma_f32_16x16x32_bf16 v[112:115], a[24:27], v[224:227], v[112:115]
 v_fmac_f32 v243, v195, v206
 v_cvt_pk_bf16_f32 v70, v240, v241
 v_cvt_pk_bf16_f32 v71, v242, v243
 v_mfma_f32_16x16x32_bf16 v[116:119], a[88:91], v[224:227], v[116:119]
 s_waitcnt lgkmcnt(1)
 v_mul_f32 v39, 0x3eb8aa3b, v207
 v_cvt_pk_bf16_f32 v88, v248, v249
 v_mfma_f32_16x16x32_bf16 v[120:123], a[152:155], v[224:227], v[120:123]
 s_add_u32 s91, s77, 0x0
 buffer_load_dwordx4 v[128:131], v2, s[4:7], s91 offen sc1
 ds_read_b128 v[220:223], v33 offset:512
 v_cvt_pk_bf16_f32 v89, v250, v251
 v_mfma_f32_16x16x32_bf16 v[112:115], a[28:31], v[228:231], v[112:115]
 v_max3_f32 v24, v104, v105, v106
 v_max3_f32 v24, v24, v107, v100
 v_max3_f32 v24, v24, v101, v102
 v_mfma_f32_16x16x32_bf16 v[116:119], a[92:95], v[228:231], v[116:119]
 v_max_f32 v24, v24, v103
 v_mov_b32 v25, v24
 v_mfma_f32_16x16x32_bf16 v[120:123], a[156:159], v[228:231], v[120:123]
 ds_read_b128 v[224:227], v30 offset:768
 v_permlane32_swap_b32 v24, v25
 v_max_f32 v24, v24, v25
 v_mfma_f32_16x16x32_bf16 v[112:115], a[32:35], v[232:235], v[112:115]
 buffer_load_dwordx4 v[132:135], v2, s[4:7], s91 offen offset:1024 sc1
 v_mov_b32 v25, v24
 v_mfma_f32_16x16x32_bf16 v[116:119], a[96:99], v[232:235], v[116:119]
 ds_read_b128 v[228:231], v31 offset:768
 v_mfma_f32_16x16x32_bf16 v[120:123], a[160:163], v[232:235], v[120:123]
 v_permlane16_swap_b32 v24, v25
 v_mfma_f32_16x16x32_bf16 v[112:115], a[36:39], v[236:239], v[112:115]
 v_max_f32 v24, v24, v25
 v_mul_f32 v24, v24, v38
 v_fma_f32 v100, v100, v38, -v24
 v_mfma_f32_16x16x32_bf16 v[116:119], a[100:103], v[236:239], v[116:119]
 v_exp_f32 v100, v100
 v_fma_f32 v101, v101, v38, -v24
 v_mfma_f32_16x16x32_bf16 v[120:123], a[164:167], v[236:239], v[120:123]
 s_waitcnt lgkmcnt(1)
 buffer_load_dwordx4 v[136:139], v2, s[4:7], s91 offen offset:2048 sc1
 ds_read_b128 v[232:235], v32 offset:768
 v_exp_f32 v101, v101
 v_mfma_f32_16x16x32_bf16 v[112:115], a[40:43], v[216:219], v[112:115]
 v_fma_f32 v102, v102, v38, -v24
 v_exp_f32 v102, v102
 v_mfma_f32_16x16x32_bf16 v[116:119], a[104:107], v[216:219], v[116:119]
 v_fma_f32 v103, v103, v38, -v24
 v_mfma_f32_16x16x32_bf16 v[120:123], a[168:171], v[216:219], v[120:123]
 ds_read_b128 v[236:239], v33 offset:768
 v_exp_f32 v103, v103
 v_mfma_f32_16x16x32_bf16 v[112:115], a[44:47], v[220:223], v[112:115]
 v_fma_f32 v104, v104, v38, -v24
 v_cvt_pk_bf16_f32 v108, v100, v101
 v_exp_f32 v104, v104
 v_mfma_f32_16x16x32_bf16 v[116:119], a[108:111], v[220:223], v[116:119]
 buffer_load_dwordx4 v[140:143], v2, s[4:7], s91 offen offset:3072 sc1
 v_fma_f32 v105, v105, v38, -v24
 v_mfma_f32_16x16x32_bf16 v[120:123], a[172:175], v[220:223], v[120:123]
 v_exp_f32 v105, v105
 v_fma_f32 v106, v106, v38, -v24
 v_mfma_f32_16x16x32_bf16 v[112:115], a[48:51], v[224:227], v[112:115]
 v_cvt_pk_bf16_f32 v109, v102, v103
 v_exp_f32 v106, v106
 v_mfma_f32_16x16x32_bf16 v[116:119], a[112:115], v[224:227], v[116:119]
 v_fma_f32 v107, v107, v38, -v24
 v_mfma_f32_16x16x32_bf16 v[120:123], a[176:179], v[224:227], v[120:123]
 s_waitcnt lgkmcnt(0)
 s_barrier
 ds_read_b128 v[216:219], v30 offset:16384
 v_mfma_f32_16x16x32_bf16 v[112:115], a[52:55], v[228:231], v[112:115]
 s_add_u32 s91, s77, 0x1000
 ds_read_b128 v[220:223], v31 offset:16384
 buffer_load_dwordx4 v[144:147], v2, s[4:7], s91 offen sc1
 v_mfma_f32_16x16x32_bf16 v[116:119], a[116:119], v[228:231], v[116:119]
 s_add_u32 s90, s69, 0xc000
 v_exp_f32 v107, v107
 v_cvt_pk_bf16_f32 v110, v104, v105
 v_mfma_f32_16x16x32_bf16 v[120:123], a[180:183], v[228:231], v[120:123]
 ds_read_b128 v[224:227], v32 offset:16384
 v_cvt_pk_bf16_f32 v111, v106, v107
 v_mfma_f32_16x16x32_bf16 v[112:115], a[56:59], v[232:235], v[112:115]
 v_mfma_f32_16x16x32_bf16 v[116:119], a[120:123], v[232:235], v[116:119]
 v_mfma_f32_16x16x32_bf16 v[48:51], v[64:67], v[108:111], 0
 v_mfma_f32_16x16x32_bf16 v[44:47], v[88:91], v[108:111], 0
 v_mfma_f32_16x16x32_bf16 v[120:123], a[184:187], v[232:235], v[120:123]
 buffer_load_dwordx4 v[148:151], v2, s[4:7], s91 offen offset:1024 sc1
 ds_read_b128 v[228:231], v33 offset:16384
 v_mfma_f32_16x16x32_bf16 v[112:115], a[60:63], v[236:239], v[112:115]
 v_mfma_f32_16x16x32_bf16 v[116:119], a[124:127], v[236:239], v[116:119]
 v_mfma_f32_16x16x32_bf16 v[120:123], a[188:191], v[236:239], v[120:123]
 s_waitcnt lgkmcnt(1)
 v_rcp_f32 v24, v48
 s_nop 0
 v_mul_f32 v52, v44, v24
 v_mul_f32 v53, v45, v24
 v_mul_f32 v54, v46, v24
 v_mul_f32 v55, v47, v24
 v_cvt_pk_bf16_f32 v42, v52, v53
 v_cvt_pk_bf16_f32 v43, v54, v55
 v_mfma_f32_16x16x32_bf16 v[240:243], a[0:3], v[216:219], 0
 s_waitcnt vmcnt(17)
 buffer_store_dwordx2 v[42:43], v34, s[4:7], s90 offen
 ds_read_b128 v[232:235], v30 offset:16640
 buffer_load_dwordx4 v2, s[4:7], s89 offen offset:3072 sc1 lds
 v_add_f32 v176, v176, v180
 v_mfma_f32_16x16x32_bf16 v[244:247], a[64:67], v[216:219], 0
 v_add_f32 v177, v177, v181
 v_add_f32 v178, v178, v182
 v_add_f32 v179, v179, v183
 v_add_f32_dpp v176, v176, v176 row_ror:8 row_mask:0xf bank_mask:0xf
 v_fmac_f32 v120, v200, v208
 v_fmac_f32 v121, v201, v208
 v_mfma_f32_16x16x32_bf16 v[248:251], a[128:131], v[216:219], 0
 ds_read_b128 v[236:239], v31 offset:16640
 v_fmac_f32 v122, v202, v208
 v_fmac_f32 v123, v203, v208
 v_mul_f32 v120, v120, v209
 v_mfma_f32_16x16x32_bf16 v[240:243], a[4:7], v[220:223], v[240:243]
 s_add_u32 s89, s88, 0x8000
 v_mul_f32 v121, v121, v209
 v_mul_f32 v122, v122, v209
 v_mul_f32 v123, v123, v209
 v_cvt_pk_bf16_f32 v40, v120, v121
 v_mfma_f32_16x16x32_bf16 v[244:247], a[68:71], v[220:223], v[244:247]
 s_add_u32 m0, s16, 32768
 s_nop 0
 buffer_load_dwordx4 v2, s[4:7], s89 offen sc1 lds
 v_cvt_pk_bf16_f32 v41, v122, v123
 v_fmac_f32 v116, v196, v208
 v_mfma_f32_16x16x32_bf16 v[248:251], a[132:135], v[220:223], v[248:251]
 ds_read_b128 v[216:219], v32 offset:16640
 v_fmac_f32 v117, v197, v208
 v_mfma_f32_16x16x16_bf16 v[120:123], v[40:41], v[92:93], 0
 v_fmac_f32 v118, v198, v208
 v_fmac_f32 v119, v199, v208
 v_mfma_f32_16x16x32_bf16 v[240:243], a[8:11], v[224:227], v[240:243]
 v_mul_f32 v116, v116, v209
 v_mul_f32 v117, v117, v209
 v_mul_f32 v118, v118, v209
 v_mfma_f32_16x16x32_bf16 v[244:247], a[72:75], v[224:227], v[244:247]
 v_mul_f32 v119, v119, v209
 v_cvt_pk_bf16_f32 v76, v116, v117
 v_cvt_pk_bf16_f32 v77, v118, v119
 v_mfma_f32_16x16x32_bf16 v[248:251], a[136:139], v[224:227], v[248:251]
 ds_read_b128 v[220:223], v33 offset:16640
 v_mfma_f32_16x16x16_bf16 v[104:107], v[78:79], v[70:71], v[56:59]
 s_waitcnt lgkmcnt(2)
 v_add_f32_dpp v177, v177, v177 row_ror:8 row_mask:0xf bank_mask:0xf
 v_mfma_f32_16x16x32_bf16 v[240:243], a[12:15], v[228:231], v[240:243]
 buffer_load_dwordx4 v2, s[4:7], s89 offen offset:1024 sc1 lds
 v_mfma_f32_16x16x16_bf16 v[100:103], v[76:77], v[70:71], v[96:99]
 v_fmac_f32 v112, v192, v208
 v_fmac_f32 v113, v193, v208
 v_mfma_f32_16x16x32_bf16 v[244:247], a[76:79], v[228:231], v[244:247]
 v_fmac_f32 v114, v194, v208
 v_fmac_f32 v115, v195, v208
 v_cvt_pk_bf16_f32 v68, v112, v113
 v_mfma_f32_16x16x32_bf16 v[248:251], a[140:143], v[228:231], v[248:251]
 ds_read_b128 v[224:227], v30 offset:16896
 v_cvt_pk_bf16_f32 v69, v114, v115
 v_mul_f32 v38, 0x3eb8aa3b, v209
 v_cvt_pk_bf16_f32 v86, v120, v121
 v_mfma_f32_16x16x32_bf16 v[240:243], a[16:19], v[232:235], v[240:243]
 v_cvt_pk_bf16_f32 v87, v122, v123
 v_max3_f32 v24, v104, v105, v106
 v_max3_f32 v24, v24, v107, v100
 v_max3_f32 v24, v24, v101, v102
 v_mfma_f32_16x16x32_bf16 v[244:247], a[80:83], v[232:235], v[244:247]
 v_max_f32 v24, v24, v103
 v_mov_b32 v25, v24
 v_add_f32_dpp v178, v178, v178 row_ror:8 row_mask:0xf bank_mask:0xf
 v_add_f32_dpp v179, v179, v179 row_ror:8 row_mask:0xf bank_mask:0xf
 v_mfma_f32_16x16x32_bf16 v[248:251], a[144:147], v[232:235], v[248:251]
 buffer_load_dwordx4 v2, s[4:7], s89 offen offset:2048 sc1 lds
 ds_read_b128 v[228:231], v31 offset:16896
 v_permlane32_swap_b32 v24, v25
 v_mfma_f32_16x16x32_bf16 v[240:243], a[20:23], v[236:239], v[240:243]
 v_max_f32 v24, v24, v25
 v_mov_b32 v25, v24
 v_mov_b32 v180, v176
 v_mov_b32 v181, v177
 v_mfma_f32_16x16x32_bf16 v[244:247], a[84:87], v[236:239], v[244:247]
 v_permlane16_swap_b32 v24, v25
 v_max_f32 v24, v24, v25
 v_mul_f32 v24, v24, v39
 v_fma_f32 v100, v100, v39, -v24
 v_mfma_f32_16x16x32_bf16 v[248:251], a[148:151], v[236:239], v[248:251]
 s_waitcnt lgkmcnt(1)
 ds_read_b128 v[232:235], v32 offset:16896
 v_exp_f32 v100, v100
 v_fma_f32 v101, v101, v39, -v24
 v_mfma_f32_16x16x32_bf16 v[240:243], a[24:27], v[216:219], v[240:243]
 v_exp_f32 v101, v101
 v_fma_f32 v102, v102, v39, -v24
 v_mfma_f32_16x16x32_bf16 v[244:247], a[88:91], v[216:219], v[244:247]
 v_exp_f32 v102, v102
 v_fma_f32 v103, v103, v39, -v24
 v_exp_f32 v103, v103
 v_mfma_f32_16x16x32_bf16 v[248:251], a[152:155], v[216:219], v[248:251]
 buffer_load_dwordx4 v[152:155], v2, s[4:7], s91 offen offset:2048 sc1
 ds_read_b128 v[236:239], v33 offset:16896
 v_mfma_f32_16x16x32_bf16 v[240:243], a[28:31], v[220:223], v[240:243]
 s_waitcnt vmcnt(5)
 v_fma_f32 v104, v104, v39, -v24
 v_mov_b32 v5, 1
 v_mfma_f32_16x16x32_bf16 v[244:247], a[92:95], v[220:223], v[244:247]
 buffer_store_dword v5, off, s[4:7], s67 offset:512
 v_cvt_pk_bf16_f32 v108, v100, v101
 v_exp_f32 v104, v104
 v_fma_f32 v105, v105, v39, -v24
 v_mfma_f32_16x16x32_bf16 v[248:251], a[156:159], v[220:223], v[248:251]
 ds_read_b128 v[216:219], v30 offset:17152
 v_exp_f32 v105, v105
 v_fma_f32 v106, v106, v39, -v24
 v_mfma_f32_16x16x32_bf16 v[240:243], a[32:35], v[224:227], v[240:243]
 buffer_load_dwordx4 v[156:159], v2, s[4:7], s91 offen offset:3072 sc1
 v_cvt_pk_bf16_f32 v109, v102, v103
 v_exp_f32 v106, v106
 v_mfma_f32_16x16x32_bf16 v[244:247], a[96:99], v[224:227], v[244:247]
 s_waitcnt lgkmcnt(1)
 v_fma_f32 v107, v107, v39, -v24
 v_exp_f32 v107, v107
 v_cvt_pk_bf16_f32 v110, v104, v105
 v_mfma_f32_16x16x32_bf16 v[248:251], a[160:163], v[224:227], v[248:251]
 s_add_u32 s90, s69, 0x8000
 ds_read_b128 v[220:223], v31 offset:17152
 v_cvt_pk_bf16_f32 v111, v106, v107
 v_mfma_f32_16x16x32_bf16 v[240:243], a[36:39], v[228:231], v[240:243]
 v_mov_b32 v182, v178
 v_mov_b32 v183, v179
 v_mfma_f32_16x16x32_bf16 v[48:51], v[64:67], v[108:111], 0
 v_permlane16_swap_b32 v176, v180
 v_mfma_f32_16x16x32_bf16 v[244:247], a[100:103], v[228:231], v[244:247]
 v_permlane16_swap_b32 v177, v181
 v_mfma_f32_16x16x32_bf16 v[44:47], v[86:89], v[108:111], 0
 v_permlane16_swap_b32 v178, v182
 v_mfma_f32_16x16x32_bf16 v[248:251], a[164:167], v[228:231], v[248:251]
 s_add_u32 s91, s77, 0x2000
 buffer_load_dwordx4 v[160:163], v2, s[4:7], s91 offen sc1
 ds_read_b128 v[224:227], v32 offset:17152
 v_permlane16_swap_b32 v179, v183
 v_mfma_f32_16x16x32_bf16 v[240:243], a[40:43], v[232:235], v[240:243]
 v_add_f32 v176, v176, v180
 v_add_f32 v177, v177, v181
 v_add_f32 v178, v178, v182
 v_mfma_f32_16x16x32_bf16 v[244:247], a[104:107], v[232:235], v[244:247]
 v_add_f32 v179, v179, v183
 v_mov_b32 v180, v176
 v_mov_b32 v181, v177
 v_mov_b32 v182, v178
 v_mfma_f32_16x16x32_bf16 v[248:251], a[168:171], v[232:235], v[248:251]
 ds_read_b128 v[228:231], v33 offset:17152
 v_mov_b32 v183, v179
 v_rcp_f32 v24, v48
 v_permlane32_swap_b32 v176, v180
 v_mfma_f32_16x16x32_bf16 v[240:243], a[44:47], v[236:239], v[240:243]
 v_permlane32_swap_b32 v177, v181
 v_permlane32_swap_b32 v178, v182
 v_mfma_f32_16x16x32_bf16 v[244:247], a[108:111], v[236:239], v[244:247]
 buffer_load_dwordx4 v[164:167], v2, s[4:7], s91 offen offset:1024 sc1
 v_mul_f32 v52, v44, v24
 v_permlane32_swap_b32 v179, v183
 v_mfma_f32_16x16x32_bf16 v[248:251], a[172:175], v[236:239], v[248:251]
 s_waitcnt lgkmcnt(1)
 v_mul_f32 v53, v45, v24
 v_add_f32 v176, v176, v180
 v_mul_f32 v54, v46, v24
 v_add_f32 v177, v177, v181
 v_mfma_f32_16x16x32_bf16 v[240:243], a[48:51], v[216:219], v[240:243]
 v_mul_f32 v55, v47, v24
 v_add_f32 v178, v178, v182
 v_cvt_pk_bf16_f32 v42, v52, v53
 v_add_f32 v179, v179, v183
 v_cvt_pk_bf16_f32 v43, v54, v55
 v_mfma_f32_16x16x32_bf16 v[244:247], a[112:115], v[216:219], v[244:247]
 s_lshl_b32 s87, s48, 7
 s_add_u32 s87, s87, s79
 buffer_store_dwordx4 v[176:179], v185, s[4:7], s87 offen
 v_mfma_f32_16x16x32_bf16 v[248:251], a[176:179], v[216:219], v[248:251]
 s_waitcnt lgkmcnt(0)
 s_barrier
 ds_read_b128 v[232:235], v30 offset:32768
 v_mfma_f32_16x16x32_bf16 v[240:243], a[52:55], v[220:223], v[240:243]
 ds_read_b128 v[236:239], v31 offset:32768
 buffer_load_dwordx4 v[168:171], v2, s[4:7], s91 offen offset:2048 sc1
 v_mfma_f32_16x16x32_bf16 v[244:247], a[116:119], v[220:223], v[244:247]
 buffer_store_dwordx2 v[42:43], v34, s[4:7], s90 offen
 v_mfma_f32_16x16x32_bf16 v[248:251], a[180:183], v[220:223], v[248:251]
 ds_read_b128 v[216:219], v32 offset:32768
 v_mfma_f32_16x16x32_bf16 v[240:243], a[56:59], v[224:227], v[240:243]
 buffer_load_dword v3, v7, s[4:7], s64 offen sc1
 v_mfma_f32_16x16x32_bf16 v[244:247], a[120:123], v[224:227], v[244:247]
 v_mfma_f32_16x16x32_bf16 v[248:251], a[184:187], v[224:227], v[248:251]
 buffer_load_dwordx4 v[172:175], v2, s[4:7], s91 offen offset:3072 sc1
 ds_read_b128 v[220:223], v33 offset:32768
 v_mfma_f32_16x16x32_bf16 v[240:243], a[60:63], v[228:231], v[240:243]
 v_mfma_f32_16x16x32_bf16 v[244:247], a[124:127], v[228:231], v[244:247]
 v_mfma_f32_16x16x32_bf16 v[248:251], a[188:191], v[228:231], v[248:251]
 s_waitcnt lgkmcnt(3)
 ds_read_b128 v[224:227], v30 offset:33024
 v_mfma_f32_16x16x32_bf16 v[116:119], a[64:67], v[232:235], 0
 s_add_u32 s91, s77, 0x3000
 buffer_load_dwordx4 v[176:179], v2, s[4:7], s91 offen sc1
 v_mfma_f32_16x16x32_bf16 v[120:123], a[128:131], v[232:235], 0
 s_add_u32 m0, s16, 57344
 s_add_u32 s89, s88, 0xe000
 buffer_load_dwordx4 v2, s[4:7], s89 offen sc1 lds
 ds_read_b128 v[228:231], v31 offset:33024
 s_waitcnt lgkmcnt(4)
 v_mfma_f32_16x16x32_bf16 v[116:119], a[68:71], v[236:239], v[116:119]
 v_fmac_f32 v248, v200, v210
 v_fmac_f32 v249, v201, v210
 v_fmac_f32 v250, v202, v210
 v_fmac_f32 v251, v203, v210
 v_mul_f32 v248, v248, v211
 v_mfma_f32_16x16x32_bf16 v[120:123], a[132:135], v[236:239], v[120:123]
 s_waitcnt lgkmcnt(2)
 ds_read_b128 v[232:235], v32 offset:33024
 v_mul_f32 v249, v249, v211
 v_mul_f32 v250, v250, v211
 v_mul_f32 v251, v251, v211
 v_mfma_f32_16x16x32_bf16 v[116:119], a[72:75], v[216:219], v[116:119]
 buffer_load_dwordx4 v[180:183], v2, s[4:7], s91 offen offset:1024 sc1
 v_cvt_pk_bf16_f32 v40, v248, v249
 v_cvt_pk_bf16_f32 v41, v250, v251
 v_fmac_f32 v244, v196, v210
 v_mfma_f32_16x16x32_bf16 v[120:123], a[136:139], v[216:219], v[120:123]
 ds_read_b128 v[236:239], v33 offset:33024
 v_fmac_f32 v245, v197, v210
 v_mfma_f32_16x16x16_bf16 v[248:251], v[40:41], v[92:93], 0
 v_fmac_f32 v246, v198, v210
 v_mfma_f32_16x16x32_bf16 v[116:119], a[76:79], v[220:223], v[116:119]
 v_fmac_f32 v247, v199, v210
 v_mul_f32 v244, v244, v211
 v_mfma_f32_16x16x32_bf16 v[120:123], a[140:143], v[220:223], v[120:123]
 s_waitcnt lgkmcnt(2)
 buffer_load_dwordx4 v2, s[4:7], s89 offen offset:1024 sc1 lds
 ds_read_b128 v[216:219], v30 offset:33280
 v_mul_f32 v245, v245, v211
 v_mul_f32 v246, v246, v211
 v_mfma_f32_16x16x32_bf16 v[116:119], a[80:83], v[224:227], v[116:119]
 buffer_load_dwordx4 v[184:187], v2, s[4:7], s91 offen offset:2048 sc1
 v_mul_f32 v247, v247, v211
 v_cvt_pk_bf16_f32 v74, v244, v245
 v_mfma_f32_16x16x32_bf16 v[120:123], a[144:147], v[224:227], v[120:123]
 s_waitcnt vmcnt(7)
 v_cvt_pk_bf16_f32 v75, v246, v247
 v_mov_b32 v5, 2
 v_mfma_f32_16x16x32_bf16 v[116:119], a[84:87], v[228:231], v[116:119]
 buffer_store_dword v5, off, s[4:7], s67 offset:512
 v_mfma_f32_16x16x16_bf16 v[104:107], v[76:77], v[68:69], v[56:59]
 ds_read_b128 v[220:223], v31 offset:33280
 v_mfma_f32_16x16x32_bf16 v[120:123], a[148:151], v[228:231], v[120:123]
 ds_read_b128 v[224:227], v32 offset:33280
 v_mfma_f32_16x16x16_bf16 v[100:103], v[74:75], v[68:69], v[96:99]
 s_waitcnt lgkmcnt(3)
 v_fmac_f32 v240, v192, v210
 v_fmac_f32 v241, v193, v210
 v_mfma_f32_16x16x32_bf16 v[116:119], a[88:91], v[232:235], v[116:119]
 buffer_load_dwordx4 v[188:191], v2, s[4:7], s91 offen offset:3072 sc1
 v_fmac_f32 v242, v194, v210
 v_fmac_f32 v243, v195, v210
 v_cvt_pk_bf16_f32 v70, v240, v241
 v_mfma_f32_16x16x32_bf16 v[120:123], a[152:155], v[232:235], v[120:123]
 ds_read_b128 v[228:231], v33 offset:33280
 v_cvt_pk_bf16_f32 v71, v242, v243
 v_mul_f32 v39, 0x3eb8aa3b, v211
 v_mfma_f32_16x16x32_bf16 v[116:119], a[92:95], v[236:239], v[116:119]
 s_waitcnt vmcnt(8)
 buffer_load_dwordx4 v2, s[4:7], s89 offen offset:2048 sc1 lds
 v_cvt_pk_bf16_f32 v84, v248, v249
 v_cvt_pk_bf16_f32 v85, v250, v251
 v_max3_f32 v24, v104, v105, v106
 v_cmp_gt_u32 vcc, 1, v3
 v_mfma_f32_16x16x32_bf16 v[120:123], a[156:159], v[236:239], v[120:123]
 s_add_u32 s85, s70, 0xc000
 s_cbranch_vccnz .Lps_10
.Lpb_11:
 ds_read_b128 v[232:235], v30 offset:33536
 v_max3_f32 v24, v24, v107, v100
 v_max3_f32 v24, v24, v101, v102
 s_waitcnt lgkmcnt(2)
 v_mfma_f32_16x16x32_bf16 v[116:119], a[96:99], v[216:219], v[116:119]
 v_max_f32 v24, v24, v103
 v_mov_b32 v25, v24
 v_mfma_f32_16x16x32_bf16 v[120:123], a[160:163], v[216:219], v[120:123]
 buffer_load_dwordx4 v[204:207], v2, s[4:7], s85 offen sc1
 ds_read_b128 v[236:239], v31 offset:33536
 v_permlane32_swap_b32 v24, v25
 v_mfma_f32_16x16x32_bf16 v[116:119], a[100:103], v[220:223], v[116:119]
 v_max_f32 v24, v24, v25
 v_mov_b32 v25, v24
 v_mfma_f32_16x16x32_bf16 v[120:123], a[164:167], v[220:223], v[120:123]
 ds_read_b128 v[216:219], v32 offset:33536
 v_permlane16_swap_b32 v24, v25
 v_max_f32 v24, v24, v25
 v_mul_f32 v24, v24, v38
 v_fma_f32 v100, v100, v38, -v24
 v_mfma_f32_16x16x32_bf16 v[116:119], a[104:107], v[224:227], v[116:119]
 buffer_load_dwordx4 v[124:127], v2, s[4:7], s85 offen offset:1024 sc1
 v_exp_f32 v100, v100
 v_fma_f32 v101, v101, v38, -v24
 v_mfma_f32_16x16x32_bf16 v[120:123], a[168:171], v[224:227], v[120:123]
 s_waitcnt lgkmcnt(2)
 ds_read_b128 v[220:223], v33 offset:33536
 v_exp_f32 v101, v101
 v_fma_f32 v102, v102, v38, -v24
 v_mfma_f32_16x16x32_bf16 v[116:119], a[108:111], v[228:231], v[116:119]
 v_exp_f32 v102, v102
 v_fma_f32 v103, v103, v38, -v24
 v_mfma_f32_16x16x32_bf16 v[120:123], a[172:175], v[228:231], v[120:123]
 buffer_load_dwordx4 v[252:255], v2, s[4:7], s85 offen offset:2048 sc1
 buffer_load_dword v3, v7, s[4:7], s64 offen sc1
 v_exp_f32 v103, v103
 v_fma_f32 v104, v104, v38, -v24
 v_mfma_f32_16x16x32_bf16 v[116:119], a[112:115], v[232:235], v[116:119]
 v_cvt_pk_bf16_f32 v108, v100, v101
 v_exp_f32 v104, v104
 v_fma_f32 v105, v105, v38, -v24
 v_mfma_f32_16x16x32_bf16 v[120:123], a[176:179], v[232:235], v[120:123]
 s_waitcnt lgkmcnt(0)
 v_exp_f32 v105, v105
 v_fma_f32 v106, v106, v38, -v24
 v_cvt_pk_bf16_f32 v109, v102, v103
 v_mfma_f32_16x16x32_bf16 v[116:119], a[116:119], v[236:239], v[116:119]
 buffer_load_dwordx4 v[240:243], v2, s[4:7], s85 offen offset:3072 sc1
 v_exp_f32 v106, v106
 v_mfma_f32_16x16x32_bf16 v[120:123], a[180:183], v[236:239], v[120:123]
 s_add_u32 s90, s69, 0x4000
 v_fma_f32 v107, v107, v38, -v24
 v_exp_f32 v107, v107
 v_mfma_f32_16x16x32_bf16 v[116:119], a[120:123], v[216:219], v[116:119]
 v_cvt_pk_bf16_f32 v110, v104, v105
 v_cvt_pk_bf16_f32 v111, v106, v107
 v_mfma_f32_16x16x32_bf16 v[120:123], a[184:187], v[216:219], v[120:123]
 v_mfma_f32_16x16x32_bf16 v[116:119], a[124:127], v[220:223], v[116:119]
 v_mfma_f32_16x16x32_bf16 v[48:51], v[64:67], v[108:111], 0
 v_mfma_f32_16x16x32_bf16 v[44:47], v[84:87], v[108:111], 0
 s_waitcnt vmcnt(1)
 v_mfma_f32_16x16x32_bf16 v[120:123], a[188:191], v[220:223], v[120:123]
 s_add_u32 s85, s70, 0x8000
 s_nop 3
 v_rcp_f32 v24, v48
 s_nop 0
 v_mul_f32 v52, v44, v24
 v_mul_f32 v53, v45, v24
 v_mul_f32 v54, v46, v24
 v_mul_f32 v55, v47, v24
 v_cvt_pk_bf16_f32 v42, v52, v53
 v_cvt_pk_bf16_f32 v43, v54, v55
 buffer_store_dwordx2 v[42:43], v34, s[4:7], s90 offen
 v_cmp_gt_u32 vcc, 2, v3
 s_nop 0
 s_cbranch_vccnz .Lps_12
.Lpb_13:
 v_mfma_f32_16x16x32_bf16 v[244:247], v[128:131], v[204:207], 0
 buffer_load_dwordx4 v[216:219], v2, s[4:7], s85 offen sc1
 v_mfma_f32_16x16x32_bf16 v[248:251], v[132:135], v[204:207], 0
 buffer_load_dwordx4 v[220:223], v2, s[4:7], s85 offen offset:1024 sc1
 v_mfma_f32_16x16x32_bf16 v[232:235], v[136:139], v[204:207], 0
 buffer_load_dwordx4 v[224:227], v2, s[4:7], s85 offen offset:2048 sc1
 v_fmac_f32 v120, v200, v212
 v_mfma_f32_16x16x32_bf16 v[236:239], v[140:143], v[204:207], 0
 v_fmac_f32 v121, v201, v212
 v_fmac_f32 v122, v202, v212
 v_fmac_f32 v123, v203, v212
 v_mfma_f32_16x16x32_bf16 v[244:247], v[144:147], v[124:127], v[244:247]
 v_mul_f32 v120, v120, v213
 v_mul_f32 v121, v121, v213
 v_mul_f32 v122, v122, v213
 v_mfma_f32_16x16x32_bf16 v[248:251], v[148:151], v[124:127], v[248:251]
 buffer_load_dwordx4 v[228:231], v2, s[4:7], s85 offen offset:3072 sc1
 v_mul_f32 v123, v123, v213
 v_cvt_pk_bf16_f32 v40, v120, v121
 v_mfma_f32_16x16x32_bf16 v[232:235], v[152:155], v[124:127], v[232:235]
 v_cvt_pk_bf16_f32 v41, v122, v123
 v_fmac_f32 v116, v196, v212
 v_fmac_f32 v117, v197, v212
 v_mfma_f32_16x16x16_bf16 v[120:123], v[40:41], v[92:93], 0
 v_fmac_f32 v118, v198, v212
 v_mfma_f32_16x16x32_bf16 v[236:239], v[156:159], v[124:127], v[236:239]
 v_fmac_f32 v119, v199, v212
 v_mul_f32 v116, v116, v213
 v_mfma_f32_16x16x32_bf16 v[244:247], v[160:163], v[252:255], v[244:247]
 buffer_load_dwordx4 v2, s[4:7], s89 offen offset:3072 sc1 lds
 v_mul_f32 v117, v117, v213
 v_mul_f32 v118, v118, v213
 v_mfma_f32_16x16x32_bf16 v[248:251], v[164:167], v[252:255], v[248:251]
 s_waitcnt vmcnt(5)
 v_mul_f32 v119, v119, v213
 v_mov_b32 v5, 3
 v_mfma_f32_16x16x32_bf16 v[232:235], v[168:171], v[252:255], v[232:235]
 buffer_store_dword v5, off, s[4:7], s67 offset:512
 v_mfma_f32_16x16x16_bf16 v[104:107], v[74:75], v[70:71], v[56:59]
 s_add_u32 s89, s88, 0xf000
 v_cvt_pk_bf16_f32 v72, v116, v117
 v_cvt_pk_bf16_f32 v73, v118, v119
 v_mfma_f32_16x16x32_bf16 v[236:239], v[172:175], v[252:255], v[236:239]
 s_add_u32 m0, s16, 61440
 s_nop 0
 buffer_load_dwordx4 v2, s[4:7], s89 offen sc1 lds
 v_mfma_f32_16x16x32_bf16 v[244:247], v[176:179], v[240:243], v[244:247]
 v_mfma_f32_16x16x16_bf16 v[100:103], v[72:73], v[70:71], v[60:63]
 v_cvt_pk_bf16_f32 v82, v120, v121
 v_cvt_pk_bf16_f32 v83, v122, v123
 v_mfma_f32_16x16x32_bf16 v[248:251], v[180:183], v[240:243], v[248:251]
 v_mfma_f32_16x16x32_bf16 v[232:235], v[184:187], v[240:243], v[232:235]
 buffer_load_dwordx4 v2, s[4:7], s89 offen offset:1024 sc1 lds
 v_mfma_f32_16x16x32_bf16 v[236:239], v[188:191], v[240:243], v[236:239]
 s_waitcnt vmcnt(7)
 v_max3_f32 v24, v104, v105, v106
 v_max3_f32 v24, v24, v107, v100
 v_max3_f32 v24, v24, v101, v102
 v_mfma_f32_16x16x32_bf16 v[96:99], v[128:131], v[216:219], 0
 v_max_f32 v24, v24, v103
 v_mov_b32 v25, v24
 v_mfma_f32_16x16x32_bf16 v[192:195], v[132:135], v[216:219], 0
 buffer_load_dwordx4 v2, s[4:7], s89 offen offset:2048 sc1 lds
 v_permlane32_swap_b32 v24, v25
 v_mfma_f32_16x16x32_bf16 v[196:199], v[136:139], v[216:219], 0
 v_max_f32 v24, v24, v25
 v_mov_b32 v25, v24
 v_mfma_f32_16x16x32_bf16 v[200:203], v[140:143], v[216:219], 0
 s_waitcnt vmcnt(7)
 v_permlane16_swap_b32 v24, v25
 v_max_f32 v24, v24, v25
 v_mul_f32 v24, v24, v39
 v_fma_f32 v100, v100, v39, -v24
 v_mfma_f32_16x16x32_bf16 v[96:99], v[144:147], v[220:223], v[96:99]
 s_add_u32 s87, s78, 0x0
 buffer_load_dwordx4 a[192:195], v2, s[4:7], s87 offen sc1
 v_exp_f32 v100, v100
 v_fma_f32 v101, v101, v39, -v24
 v_mfma_f32_16x16x32_bf16 v[192:195], v[148:151], v[220:223], v[192:195]
 ds_write_b128 v9, v[244:247]
 v_exp_f32 v101, v101
 v_mfma_f32_16x16x32_bf16 v[196:199], v[152:155], v[220:223], v[196:199]
 v_fma_f32 v102, v102, v39, -v24
 v_exp_f32 v102, v102
 v_fma_f32 v103, v103, v39, -v24
 v_exp_f32 v103, v103
 v_mfma_f32_16x16x32_bf16 v[200:203], v[156:159], v[220:223], v[200:203]
 s_waitcnt vmcnt(7)
 v_fma_f32 v104, v104, v39, -v24
 v_cvt_pk_bf16_f32 v108, v100, v101
 v_exp_f32 v104, v104
 v_mfma_f32_16x16x32_bf16 v[96:99], v[160:163], v[224:227], v[96:99]
 buffer_load_dword v3, v7, s[4:7], s64 offen sc1
 ds_write_b128 v10, v[248:251]
 v_mfma_f32_16x16x32_bf16 v[192:195], v[164:167], v[224:227], v[192:195]
 v_fma_f32 v105, v105, v39, -v24
 v_exp_f32 v105, v105
 v_fma_f32 v106, v106, v39, -v24
 v_cvt_pk_bf16_f32 v109, v102, v103
 v_mfma_f32_16x16x32_bf16 v[196:199], v[168:171], v[224:227], v[196:199]
 s_waitcnt vmcnt(7)
 v_exp_f32 v106, v106
 v_fma_f32 v107, v107, v39, -v24
 v_exp_f32 v107, v107
 v_mfma_f32_16x16x32_bf16 v[200:203], v[172:175], v[224:227], v[200:203]
 s_add_u32 s90, s69, 0x0
 ds_write_b128 v9, v[232:235] offset:128
 v_cvt_pk_bf16_f32 v110, v104, v105
 v_cvt_pk_bf16_f32 v111, v106, v107
 v_mfma_f32_16x16x32_bf16 v[96:99], v[176:179], v[228:231], v[96:99]
 v_mfma_f32_16x16x32_bf16 v[192:195], v[180:183], v[228:231], v[192:195]
 v_mfma_f32_16x16x32_bf16 v[48:51], v[64:67], v[108:111], 0
 v_mfma_f32_16x16x32_bf16 v[44:47], v[82:85], v[108:111], 0
 v_mfma_f32_16x16x32_bf16 v[196:199], v[184:187], v[228:231], v[196:199]
 ds_write_b128 v10, v[236:239] offset:128
 v_mfma_f32_16x16x32_bf16 v[200:203], v[188:191], v[228:231], v[200:203]
 s_add_u32 s87, s78, 0x0
 s_nop 2
 v_rcp_f32 v24, v48
 s_nop 0
 v_mul_f32 v52, v44, v24
 v_mul_f32 v53, v45, v24
 v_mul_f32 v54, v46, v24
 v_mul_f32 v55, v47, v24
 v_cvt_pk_bf16_f32 v42, v52, v53
 v_cvt_pk_bf16_f32 v43, v54, v55
 buffer_store_dwordx2 v[42:43], v34, s[4:7], s90 offen
 ds_write_b128 v9, v[96:99] offset:16384
 ds_write_b128 v10, v[192:195] offset:16384
 ds_write_b128 v9, v[196:199] offset:16512
 ds_write_b128 v10, v[200:203] offset:16512
 buffer_load_dwordx4 a[196:199], v2, s[4:7], s87 offen offset:1024 sc1
 v_add_u32 v26, 57344, v2
 v_and_b32 v24, 15, v1
 v_lshrrev_b32 v25, 4, v1
 v_lshlrev_b32 v29, 4, v25
 s_add_u32 s87, s78, 0x0
 buffer_load_dwordx4 a[200:203], v2, s[4:7], s87 offen offset:2048 sc1
 v_and_b32 v28, 1, v25
 v_lshlrev_b32 v28, 3, v28
 v_lshl_add_u32 v28, v24, 4, v28
 v_lshrrev_b32 v25, 1, v25
 s_add_u32 s87, s78, 0x1000
 buffer_load_dwordx4 a[204:207], v2, s[4:7], s87 offen sc1
 v_lshl_add_u32 v27, v25, 8, v28
 v_xor_b32 v25, 1, v25
 v_mul_u32_u24 v25, 57344, v25
 v_add_u32 v28, v28, v25
 s_waitcnt lgkmcnt(0)
 s_barrier
 ds_read_b128 v[204:207], v11
 ds_read_b128 v[124:127], v11 offset:4096
 ds_read_b128 v[252:255], v11 offset:8192
 ds_read_b128 v[240:243], v11 offset:12288
 ds_read_b128 v[216:219], v11 offset:16384
 ds_read_b128 v[220:223], v11 offset:20480
 ds_read_b128 v[224:227], v11 offset:24576
 ds_read_b128 v[228:231], v11 offset:28672
 s_add_u32 s85, s70, 0x4000
 s_waitcnt vmcnt(4)
 v_cmp_gt_u32 vcc, 3, v3
 s_nop 0
 s_cbranch_vccnz .Lps_14
.Lpb_15:
 buffer_load_dwordx4 v[44:47], v2, s[4:7], s85 offen sc1
 buffer_load_dwordx4 v[48:51], v2, s[4:7], s85 offen offset:1024 sc1
 v_mov_b32 v5, 4
 s_waitcnt vmcnt(5)
 buffer_store_dword v5, off, s[4:7], s67 offset:512
 buffer_load_dwordx4 v[52:55], v2, s[4:7], s85 offen offset:2048 sc1
 s_add_u32 s90, s71, 0x8000
 s_add_u32 s91, s71, 0x8000
 v_lshlrev_b32 v100, 16, v22
 v_lshlrev_b32 v104, 16, v20
 v_and_b32 v101, 0xffff0000, v22
 v_and_b32 v105, 0xffff0000, v20
 v_lshlrev_b32 v102, 16, v23
 v_lshlrev_b32 v106, 16, v21
 v_and_b32 v103, 0xffff0000, v23
 v_and_b32 v107, 0xffff0000, v21
 s_waitcnt lgkmcnt(6)
 v_pk_add_f32 v[204:205], v[204:205], v[124:125]
 s_waitcnt lgkmcnt(2)
 v_pk_add_f32 v[216:217], v[216:217], v[220:221]
 v_pk_add_f32 v[252:253], v[252:253], v[240:241]
 s_waitcnt lgkmcnt(0)
 v_pk_add_f32 v[224:225], v[224:225], v[228:229]
 v_pk_add_f32 v[206:207], v[206:207], v[126:127]
 v_pk_add_f32 v[218:219], v[218:219], v[222:223]
 buffer_load_dwordx4 v[56:59], v2, s[4:7], s85 offen offset:3072 sc1
 v_pk_add_f32 v[254:255], v[254:255], v[242:243]
 v_pk_add_f32 v[226:227], v[226:227], v[230:231]
 v_pk_add_f32 v[204:205], v[204:205], v[252:253]
 v_pk_add_f32 v[216:217], v[216:217], v[224:225]
 v_pk_add_f32 v[206:207], v[206:207], v[254:255]
 v_pk_add_f32 v[218:219], v[218:219], v[226:227]
 v_pk_add_f32 v[100:101], v[100:101], v[204:205]
 v_pk_add_f32 v[104:105], v[104:105], v[216:217]
 v_pk_add_f32 v[102:103], v[102:103], v[206:207]
 v_pk_add_f32 v[106:107], v[106:107], v[218:219]
 v_cvt_pk_bf16_f32 v22, v100, v101
 v_cvt_pk_bf16_f32 v20, v104, v105
 v_cvt_pk_bf16_f32 v23, v102, v103
 v_cvt_pk_bf16_f32 v21, v106, v107
 buffer_store_dwordx2 v[22:23], v12, s[4:7], s90 offen
 buffer_store_dwordx2 v[20:21], v12, s[4:7], s91 offen offset:1024
 v_add_f32 v108, v100, v101
 v_add_f32 v110, v104, v105
 v_mul_f32 v109, v100, v100
 v_mul_f32 v111, v104, v104
 v_add_f32 v108, v108, v102
 v_add_f32 v110, v110, v106
 v_fmac_f32 v109, v101, v101
 v_fmac_f32 v111, v105, v105
 v_add_f32 v108, v108, v103
 v_add_f32 v110, v110, v107
 v_fmac_f32 v109, v102, v102
 v_fmac_f32 v111, v106, v106
 v_fmac_f32 v109, v103, v103
 v_fmac_f32 v111, v107, v107
 v_add_f32_dpp v108, v108, v108 row_ror:8 row_mask:0xf bank_mask:0xf
 v_add_f32_dpp v110, v110, v110 row_ror:8 row_mask:0xf bank_mask:0xf
 v_add_f32_dpp v108, v109, v109 row_ror:8 row_mask:0xf bank_mask:0xc
 v_add_f32_dpp v110, v111, v111 row_ror:8 row_mask:0xf bank_mask:0xc
 s_nop 0
 v_add_f32_dpp v108, v108, v108 row_half_mirror row_mask:0xf bank_mask:0xf
 v_add_f32_dpp v110, v110, v110 row_half_mirror row_mask:0xf bank_mask:0xf
 s_nop 0
 v_add_f32_dpp v108, v108, v108 quad_perm:[1,0,3,2] row_mask:0xf bank_mask:0xf
 v_add_f32_dpp v110, v110, v110 quad_perm:[1,0,3,2] row_mask:0xf bank_mask:0xf
 s_nop 0
 v_add_f32_dpp v108, v108, v108 quad_perm:[2,3,0,1] row_mask:0xf bank_mask:0xf
 v_add_f32_dpp v110, v110, v110 quad_perm:[2,3,0,1] row_mask:0xf bank_mask:0xf
 buffer_store_dword v108, v14, s[4:7], s72 offen offset:3072
 buffer_store_dword v110, v14, s[4:7], s72 offen offset:2048
 buffer_load_dword v3, v7, s[4:7], s64 offen sc1
 s_waitcnt vmcnt(9)
 v_mfma_f32_16x16x32_bf16 v[116:119], v[128:131], v[44:47], 0
 v_mfma_f32_16x16x32_bf16 v[120:123], v[132:135], v[44:47], 0
 v_mfma_f32_16x16x32_bf16 v[212:215], v[136:139], v[44:47], 0
 s_add_u32 s87, s78, 0x1000
 buffer_load_dwordx4 a[208:211], v2, s[4:7], s87 offen offset:1024 sc1
 v_mfma_f32_16x16x32_bf16 v[208:211], v[140:143], v[44:47], 0
 s_waitcnt vmcnt(9)
 v_mfma_f32_16x16x32_bf16 v[116:119], v[144:147], v[48:51], v[116:119]
 v_mfma_f32_16x16x32_bf16 v[120:123], v[148:151], v[48:51], v[120:123]
 v_mfma_f32_16x16x32_bf16 v[212:215], v[152:155], v[48:51], v[212:215]
 s_add_u32 s87, s78, 0x1000
 buffer_load_dwordx4 a[212:215], v2, s[4:7], s87 offen offset:2048 sc1
 v_mfma_f32_16x16x32_bf16 v[208:211], v[156:159], v[48:51], v[208:211]
 s_waitcnt vmcnt(8)
 v_mfma_f32_16x16x32_bf16 v[116:119], v[160:163], v[52:55], v[116:119]
 v_mfma_f32_16x16x32_bf16 v[120:123], v[164:167], v[52:55], v[120:123]
 v_mfma_f32_16x16x32_bf16 v[212:215], v[168:171], v[52:55], v[212:215]
 s_add_u32 s87, s78, 0x2000
 buffer_load_dwordx4 a[216:219], v2, s[4:7], s87 offen sc1
 v_mfma_f32_16x16x32_bf16 v[208:211], v[172:175], v[52:55], v[208:211]
 s_waitcnt vmcnt(8)
 v_mfma_f32_16x16x32_bf16 v[116:119], v[176:179], v[56:59], v[116:119]
 v_mfma_f32_16x16x32_bf16 v[120:123], v[180:183], v[56:59], v[120:123]
 v_mfma_f32_16x16x32_bf16 v[212:215], v[184:187], v[56:59], v[212:215]
 s_add_u32 s87, s78, 0x2000
 buffer_load_dwordx4 a[220:223], v2, s[4:7], s87 offen offset:1024 sc1
 v_mfma_f32_16x16x32_bf16 v[208:211], v[188:191], v[56:59], v[208:211]
 s_waitcnt vmcnt(5)
 v_mov_b32 v5, 2
 buffer_store_dword v5, off, s[4:7], s67 offset:1024
 s_add_u32 s85, s70, 0x0
 s_waitcnt vmcnt(5)
 v_cmp_gt_u32 vcc, 4, v3
 s_nop 0
 s_cbranch_vccnz .Lps_16
.Lpb_17:
 buffer_load_dwordx4 v[60:63], v2, s[4:7], s85 offen sc1
 buffer_load_dwordx4 v[64:67], v2, s[4:7], s85 offen offset:1024 sc1
 buffer_load_dwordx4 v[68:71], v2, s[4:7], s85 offen offset:2048 sc1
 buffer_load_dwordx4 v[112:115], v2, s[4:7], s85 offen offset:3072 sc1
 ds_write_b128 v9, v[116:119] offset:32768
 ds_write_b128 v10, v[120:123] offset:32768
 ds_write_b128 v9, v[212:215] offset:32896
 ds_write_b128 v10, v[208:211] offset:32896
 s_add_u32 s87, s78, 0x2000
 buffer_load_dwordx4 a[224:227], v2, s[4:7], s87 offen offset:2048 sc1
 s_add_u32 s87, s78, 0x3000
 buffer_load_dwordx4 a[228:231], v2, s[4:7], s87 offen sc1
 s_add_u32 s87, s78, 0x3000
 buffer_load_dwordx4 a[232:235], v2, s[4:7], s87 offen offset:1024 sc1
 s_waitcnt lgkmcnt(0)
 s_barrier
 ds_read_b128 v[44:47], v11 offset:32768
 ds_read_b128 v[48:51], v11 offset:36864
 ds_read_b128 v[52:55], v11 offset:40960
 ds_read_b128 v[56:59], v11 offset:45056
 s_waitcnt vmcnt(6)
 v_mfma_f32_16x16x32_bf16 v[192:195], v[128:131], v[60:63], 0
 v_lshlrev_b32 v100, 16, v18
 v_and_b32 v101, 0xffff0000, v18
 v_mfma_f32_16x16x32_bf16 v[196:199], v[132:135], v[60:63], 0
 v_lshlrev_b32 v102, 16, v19
 v_and_b32 v103, 0xffff0000, v19
 v_mfma_f32_16x16x32_bf16 v[200:203], v[136:139], v[60:63], 0
 s_waitcnt lgkmcnt(0)
 buffer_load_dword v3, v6, s[4:7], s65 offen sc1
 v_mfma_f32_16x16x32_bf16 v[124:127], v[140:143], v[60:63], 0
 s_waitcnt lgkmcnt(2)
 v_add_f32 v44, v44, v48
 v_add_f32 v52, v52, v56
 s_waitcnt vmcnt(6)
 v_mfma_f32_16x16x32_bf16 v[192:195], v[144:147], v[64:67], v[192:195]
 s_add_u32 s87, s78, 0x3000
 buffer_load_dwordx4 a[236:239], v2, s[4:7], s87 offen offset:2048 sc1
 v_mfma_f32_16x16x32_bf16 v[196:199], v[148:151], v[64:67], v[196:199]
 v_add_f32 v45, v45, v49
 v_add_f32 v53, v53, v57
 v_mfma_f32_16x16x32_bf16 v[200:203], v[152:155], v[64:67], v[200:203]
 v_add_f32 v46, v46, v50
 v_add_f32 v54, v54, v58
 v_mfma_f32_16x16x32_bf16 v[124:127], v[156:159], v[64:67], v[124:127]
 s_waitcnt vmcnt(6)
 v_add_f32 v47, v47, v51
 v_add_f32 v55, v55, v59
 v_mfma_f32_16x16x32_bf16 v[192:195], v[160:163], v[68:71], v[192:195]
 v_add_f32 v44, v44, v52
 v_mfma_f32_16x16x32_bf16 v[196:199], v[164:167], v[68:71], v[196:199]
 v_add_f32 v45, v45, v53
 v_add_f32 v46, v46, v54
 v_mfma_f32_16x16x32_bf16 v[200:203], v[168:171], v[68:71], v[200:203]
 v_add_f32 v47, v47, v55
 v_add_f32 v100, v100, v44
 v_mfma_f32_16x16x32_bf16 v[124:127], v[172:175], v[68:71], v[124:127]
 s_waitcnt vmcnt(5)
 v_add_f32 v101, v101, v45
 v_mfma_f32_16x16x32_bf16 v[192:195], v[176:179], v[112:115], v[192:195]
 v_add_f32 v102, v102, v46
 v_add_f32 v103, v103, v47
 v_mfma_f32_16x16x32_bf16 v[196:199], v[180:183], v[112:115], v[196:199]
 v_cvt_pk_bf16_f32 v18, v100, v101
 v_cvt_pk_bf16_f32 v19, v102, v103
 v_mfma_f32_16x16x32_bf16 v[200:203], v[184:187], v[112:115], v[200:203]
 buffer_store_dwordx2 v[18:19], v12, s[4:7], s71 offen
 v_mfma_f32_16x16x32_bf16 v[124:127], v[188:191], v[112:115], v[124:127]
 v_add_f32 v108, v100, v101
 v_mul_f32 v109, v100, v100
 v_add_f32 v108, v108, v102
 v_fmac_f32 v109, v101, v101
 v_add_f32 v108, v108, v103
 v_fmac_f32 v109, v102, v102
 v_fmac_f32 v109, v103, v103
 v_add_f32_dpp v108, v108, v108 row_ror:8 row_mask:0xf bank_mask:0xf
 ds_write_b128 v9, v[192:195]
 ds_write_b128 v10, v[196:199]
 ds_write_b128 v9, v[200:203] offset:128
 ds_write_b128 v10, v[124:127] offset:128
 v_add_f32_dpp v108, v109, v109 row_ror:8 row_mask:0xf bank_mask:0xc
 s_nop 1
 v_add_f32_dpp v108, v108, v108 row_half_mirror row_mask:0xf bank_mask:0xf
 s_nop 1
 v_add_f32_dpp v108, v108, v108 quad_perm:[1,0,3,2] row_mask:0xf bank_mask:0xf
 s_nop 1
 v_add_f32_dpp v108, v108, v108 quad_perm:[2,3,0,1] row_mask:0xf bank_mask:0xf
 buffer_store_dword v108, v14, s[4:7], s72 offen offset:1024
 s_waitcnt vmcnt(3)
 v_cmp_gt_u32 vcc, 2, v3
 s_nop 0
 s_cbranch_vccnz .Lps_18
.Lpb_19:
 s_add_u32 s85, s73, 0x8000
 buffer_load_dwordx4 v[216:219], v2, s[4:7], s85 offen sc1
 buffer_load_dwordx4 v[220:223], v2, s[4:7], s85 offen offset:1024 sc1
 s_waitcnt lgkmcnt(0)
 s_barrier
 ds_read_b128 v[60:63], v11
 ds_read_b128 v[64:67], v11 offset:4096
 ds_read_b128 v[68:71], v11 offset:8192
 ds_read_b128 v[112:115], v11 offset:12288
 buffer_load_dwordx4 v[224:227], v2, s[4:7], s85 offen offset:2048 sc1
 buffer_load_dwordx4 v[228:231], v2, s[4:7], s85 offen offset:3072 sc1
 s_add_u32 s85, s73, 0x9000
 buffer_load_dwordx4 v[232:235], v2, s[4:7], s85 offen sc1
 buffer_load_dwordx4 v[236:239], v2, s[4:7], s85 offen offset:1024 sc1
 buffer_load_dwordx4 v[240:243], v2, s[4:7], s85 offen offset:2048 sc1
 buffer_load_dwordx4 v[244:247], v2, s[4:7], s85 offen offset:3072 sc1
 ds_read_b128 v[184:187], v2
 ds_read_b128 v[188:191], v2 offset:1024
 ds_read_b128 v[192:195], v2 offset:2048
 ds_read_b128 v[196:199], v2 offset:3072
 ds_read_b128 v[200:203], v2 offset:4096
 ds_read_b128 v[204:207], v2 offset:5120
 s_add_u32 s91, s71, 0x0
 v_lshlrev_b32 v104, 16, v16
 v_and_b32 v105, 0xffff0000, v16
 v_lshlrev_b32 v106, 16, v17
 v_and_b32 v107, 0xffff0000, v17
 s_waitcnt lgkmcnt(8)
 v_pk_add_f32 v[60:61], v[60:61], v[64:65]
 s_waitcnt lgkmcnt(6)
 v_pk_add_f32 v[68:69], v[68:69], v[112:113]
 v_pk_add_f32 v[62:63], v[62:63], v[66:67]
 v_pk_add_f32 v[70:71], v[70:71], v[114:115]
 v_pk_add_f32 v[60:61], v[60:61], v[68:69]
 v_pk_add_f32 v[62:63], v[62:63], v[70:71]
 v_pk_add_f32 v[104:105], v[104:105], v[60:61]
 v_pk_add_f32 v[106:107], v[106:107], v[62:63]
 v_cvt_pk_bf16_f32 v16, v104, v105
 v_cvt_pk_bf16_f32 v17, v106, v107
 buffer_store_dwordx2 v[16:17], v12, s[4:7], s91 offen offset:1024
 v_add_f32 v110, v104, v105
 v_mul_f32 v111, v104, v104
 v_add_f32 v110, v110, v106
 v_fmac_f32 v111, v105, v105
 v_add_f32 v110, v110, v107
 v_fmac_f32 v111, v106, v106
 v_fmac_f32 v111, v107, v107
 v_add_f32_dpp v110, v110, v110 row_ror:8 row_mask:0xf bank_mask:0xf
 s_nop 0
 v_add_f32_dpp v110, v111, v111 row_ror:8 row_mask:0xf bank_mask:0xc
 s_nop 1
 v_add_f32_dpp v110, v110, v110 row_half_mirror row_mask:0xf bank_mask:0xf
 s_nop 1
 v_add_f32_dpp v110, v110, v110 quad_perm:[1,0,3,2] row_mask:0xf bank_mask:0xf
 s_nop 1
 v_add_f32_dpp v110, v110, v110 quad_perm:[2,3,0,1] row_mask:0xf bank_mask:0xf
 buffer_store_dword v110, v14, s[4:7], s72 offen
 ds_read_b128 v[208:211], v2 offset:6144
 s_waitcnt vmcnt(9) lgkmcnt(1)
 v_mfma_f32_16x16x32_bf16 v[128:131], v[184:187], v[216:219], 0
 s_add_u32 s85, s73, 0xa000
 buffer_load_dwordx4 v[248:251], v2, s[4:7], s85 offen sc1
 s_waitcnt vmcnt(9)
 v_mfma_f32_16x16x32_bf16 v[156:159], v[184:187], v[220:223], 0
 ds_read_b128 v[212:215], v2 offset:7168
 v_mfma_f32_16x16x32_bf16 v[132:135], v[188:191], v[216:219], 0
 v_mfma_f32_16x16x32_bf16 v[160:163], v[188:191], v[220:223], 0
 ds_read_b128 v[184:187], v2 offset:8192
 v_mfma_f32_16x16x32_bf16 v[136:139], v[192:195], v[216:219], 0
 buffer_load_dwordx4 v[30:33], v2, s[4:7], s74 offen offset:3072 sc1
 v_mfma_f32_16x16x32_bf16 v[164:167], v[192:195], v[220:223], 0
 ds_read_b128 v[188:191], v2 offset:9216
 v_mfma_f32_16x16x32_bf16 v[140:143], v[196:199], v[216:219], 0
 v_mfma_f32_16x16x32_bf16 v[168:171], v[196:199], v[220:223], 0
 ds_read_b128 v[192:195], v2 offset:10240
 v_mfma_f32_16x16x32_bf16 v[144:147], v[200:203], v[216:219], 0
 buffer_load_dwordx4 v[252:255], v2, s[4:7], s85 offen offset:1024 sc1
 v_mfma_f32_16x16x32_bf16 v[172:175], v[200:203], v[220:223], 0
 ds_read_b128 v[196:199], v2 offset:11264
 v_mfma_f32_16x16x32_bf16 v[148:151], v[204:207], v[216:219], 0
 v_mfma_f32_16x16x32_bf16 v[176:179], v[204:207], v[220:223], 0
 s_waitcnt lgkmcnt(4)
 buffer_load_dwordx4 v[34:37], v2, s[4:7], s74 offen offset:2048 sc1
 v_mfma_f32_16x16x32_bf16 v[152:155], v[208:211], v[216:219], 0
 ds_read_b128 v[200:203], v2 offset:12288
 v_mfma_f32_16x16x32_bf16 v[180:183], v[208:211], v[220:223], 0
 s_waitcnt vmcnt(11)
 ds_read_b128 v[204:207], v2 offset:13312
 v_mfma_f32_16x16x32_bf16 v[128:131], v[212:215], v[224:227], v[128:131]
 s_waitcnt vmcnt(10)
 buffer_load_dwordx4 v[216:219], v2, s[4:7], s85 offen offset:2048 sc1
 v_mfma_f32_16x16x32_bf16 v[156:159], v[212:215], v[228:231], v[156:159]
 s_waitcnt lgkmcnt(4)
 ds_read_b128 v[208:211], v2 offset:14336
 v_mfma_f32_16x16x32_bf16 v[132:135], v[184:187], v[224:227], v[132:135]
 v_mfma_f32_16x16x32_bf16 v[160:163], v[184:187], v[228:231], v[160:163]
 s_mul_i32 s89, s50, 28672
 ds_read_b128 v[212:215], v2 offset:15360
 v_mfma_f32_16x16x32_bf16 v[136:139], v[188:191], v[224:227], v[136:139]
 s_add_u32 m0, s16, 86016
 s_add_u32 s89, s89, s16
 s_add_u32 s89, s89, 0x700000
 buffer_load_dwordx4 v2, s[4:7], s89 offen sc1 lds
 v_mfma_f32_16x16x32_bf16 v[164:167], v[188:191], v[228:231], v[164:167]
 s_waitcnt lgkmcnt(4)
 ds_read_b128 v[184:187], v2 offset:16384
 v_mfma_f32_16x16x32_bf16 v[140:143], v[192:195], v[224:227], v[140:143]
 v_mfma_f32_16x16x32_bf16 v[168:171], v[192:195], v[228:231], v[168:171]
 ds_read_b128 v[188:191], v2 offset:17408
 v_mfma_f32_16x16x32_bf16 v[144:147], v[196:199], v[224:227], v[144:147]
 buffer_load_dwordx4 v[220:223], v2, s[4:7], s85 offen offset:3072 sc1
 v_mfma_f32_16x16x32_bf16 v[172:175], v[196:199], v[228:231], v[172:175]
 s_waitcnt lgkmcnt(4)
 ds_read_b128 v[192:195], v2 offset:18432
 v_mfma_f32_16x16x32_bf16 v[148:151], v[200:203], v[224:227], v[148:151]
 v_mfma_f32_16x16x32_bf16 v[176:179], v[200:203], v[228:231], v[176:179]
 buffer_load_dwordx4 v[72:75], v29, s[4:7], s79 offen sc1
 ds_read_b128 v[196:199], v2 offset:19456
 v_mfma_f32_16x16x32_bf16 v[152:155], v[204:207], v[224:227], v[152:155]
 v_mfma_f32_16x16x32_bf16 v[180:183], v[204:207], v[228:231], v[180:183]
 s_waitcnt vmcnt(13) lgkmcnt(4)
 v_mfma_f32_16x16x32_bf16 v[128:131], v[208:211], v[232:235], v[128:131]
 s_add_u32 s85, s73, 0xb000
 ds_read_b128 v[200:203], v2 offset:20480
 buffer_load_dwordx4 v[224:227], v2, s[4:7], s85 offen sc1
 s_waitcnt vmcnt(13)
 v_mfma_f32_16x16x32_bf16 v[156:159], v[208:211], v[236:239], v[156:159]
 s_lshl_b32 s87, s50, 2
 ds_read_b128 v[204:207], v2 offset:21504
 v_mfma_f32_16x16x32_bf16 v[132:135], v[212:215], v[232:235], v[132:135]
 s_waitcnt vmcnt(9)
 v_mov_b32 v5, 4
 buffer_store_dword v5, off, s[4:7], s67 offset:1024
 s_add_u32 s87, s87, s48
 s_lshl_b32 s87, s87, 9
 v_and_b32 v5, 12, v6
 v_lshl_add_u32 v5, v5, 5, s87
 v_min_u32 v5, .Lfast_end-interleave_layers__sliding_local_dilated__geglu_ffn__prompt_kernel-4, v5
 v_mfma_f32_16x16x32_bf16 v[160:163], v[212:215], v[236:239], v[160:163]
 s_waitcnt lgkmcnt(3)
 global_load_dword v0, v5, s[82:83]
 v_mfma_f32_16x16x32_bf16 v[136:139], v[184:187], v[232:235], v[136:139]
 ds_read_b128 v[208:211], v2 offset:22528
 buffer_load_dwordx4 v2, s[4:7], s89 offen offset:1024 sc1 lds
 v_mfma_f32_16x16x32_bf16 v[164:167], v[184:187], v[236:239], v[164:167]
 ds_read_b128 v[212:215], v2 offset:23552
 v_mfma_f32_16x16x32_bf16 v[140:143], v[188:191], v[232:235], v[140:143]
 v_mfma_f32_16x16x32_bf16 v[168:171], v[188:191], v[236:239], v[168:171]
 v_mfma_f32_16x16x32_bf16 v[144:147], v[192:195], v[232:235], v[144:147]
 s_waitcnt vmcnt(10)
 ds_read_b128 v[184:187], v2 offset:24576
 buffer_load_dwordx4 v[228:231], v2, s[4:7], s85 offen offset:1024 sc1
 v_add_f32 v38, v30, v32
 v_mfma_f32_16x16x32_bf16 v[172:175], v[192:195], v[236:239], v[172:175]
 s_waitcnt lgkmcnt(3)
 ds_read_b128 v[188:191], v2 offset:25600
 v_add_f32 v44, v31, v33
 v_mfma_f32_16x16x32_bf16 v[148:151], v[196:199], v[232:235], v[148:151]
 buffer_load_dwordx4 v[76:79], v29, s[4:7], s79 offen offset:64 sc1
 ds_read_b128 v[192:195], v2 offset:26624
 v_mfma_f32_16x16x32_bf16 v[176:179], v[196:199], v[236:239], v[176:179]
 v_permlane32_swap_b32 v38, v44
 v_mfma_f32_16x16x32_bf16 v[152:155], v[200:203], v[232:235], v[152:155]
 v_add_f32 v38, v38, v44
 v_mov_b32 v24, v38
 v_mfma_f32_16x16x32_bf16 v[180:183], v[200:203], v[236:239], v[180:183]
 ds_read_b128 v[196:199], v2 offset:27648
 v_permlane16_swap_b32 v38, v24
 v_mfma_f32_16x16x32_bf16 v[128:131], v[204:207], v[240:243], v[128:131]
 buffer_load_dwordx4 v[232:235], v2, s[4:7], s85 offen offset:2048 sc1
 v_mfma_f32_16x16x32_bf16 v[156:159], v[204:207], v[244:247], v[156:159]
 s_waitcnt lgkmcnt(3)
 ds_read_b128 v[200:203], v2 offset:28672
 v_add_f32 v38, v38, v24
 v_mfma_f32_16x16x32_bf16 v[132:135], v[208:211], v[240:243], v[132:135]
 v_mov_b32 v44, v38
 v_mfma_f32_16x16x32_bf16 v[160:163], v[208:211], v[244:247], v[160:163]
 ds_read_b128 v[204:207], v2 offset:29696
 v_permlane32_swap_b32 v38, v44
 v_mul_f32 v38, s84, v38
 v_mfma_f32_16x16x32_bf16 v[136:139], v[212:215], v[240:243], v[136:139]
 buffer_load_dwordx4 v2, s[4:7], s89 offen offset:2048 sc1 lds
 v_mul_f32 v44, s84, v44
 v_mfma_f32_16x16x32_bf16 v[164:167], v[212:215], v[244:247], v[164:167]
 ds_read_b128 v[208:211], v2 offset:30720
 v_fmac_f32 v44, v38, v38
 v_mfma_f32_16x16x32_bf16 v[140:143], v[184:187], v[240:243], v[140:143]
 v_min_f32 v44, 0, v44
 v_mfma_f32_16x16x32_bf16 v[168:171], v[184:187], v[244:247], v[168:171]
 s_waitcnt lgkmcnt(3)
 ds_read_b128 v[212:215], v2 offset:31744
 v_sub_f32 v44, 0x3727c5ac, v44
 v_mfma_f32_16x16x32_bf16 v[144:147], v[188:191], v[240:243], v[144:147]
 buffer_load_dwordx4 v[236:239], v2, s[4:7], s85 offen offset:3072 sc1
 v_rsq_f32 v24, v44
 v_mfma_f32_16x16x32_bf16 v[172:175], v[188:191], v[244:247], v[172:175]
 ds_read_b128 v[184:187], v2 offset:32768
 v_mfma_f32_16x16x32_bf16 v[148:151], v[192:195], v[240:243], v[148:151]
 v_mul_f32 v40, 0xc0135761, v24
 v_mul_f32 v25, v24, v24
 v_mfma_f32_16x16x32_bf16 v[176:179], v[192:195], v[244:247], v[176:179]
 buffer_load_dwordx4 v[80:83], v29, s[4:7], s79 offen offset:128 sc1
 ds_read_b128 v[188:191], v2 offset:33792
 v_mfma_f32_16x16x32_bf16 v[152:155], v[196:199], v[240:243], v[152:155]
 s_waitcnt lgkmcnt(3)
 v_mul_f32 v25, v25, v24
 v_mul_f32 v42, 0xbdd2d3e8, v25
 v_mfma_f32_16x16x32_bf16 v[180:183], v[196:199], v[244:247], v[180:183]
 s_waitcnt vmcnt(14)
 ds_read_b128 v[192:195], v2 offset:34816
 v_add_f32 v39, v34, v36
 v_mfma_f32_16x16x32_bf16 v[128:131], v[200:203], v[248:251], v[128:131]
 s_add_u32 s85, s73, 0xc000
 buffer_load_dwordx4 v[240:243], v2, s[4:7], s85 offen sc1
 v_add_f32 v45, v35, v37
 v_mfma_f32_16x16x32_bf16 v[156:159], v[200:203], v[252:255], v[156:159]
 ds_read_b128 v[196:199], v2 offset:35840
 v_permlane32_swap_b32 v39, v45
 v_mfma_f32_16x16x32_bf16 v[132:135], v[204:207], v[248:251], v[132:135]
 buffer_load_dword v3, v6, s[4:7], s65 offen sc1
 v_add_f32 v39, v39, v45
 v_mfma_f32_16x16x32_bf16 v[160:163], v[204:207], v[252:255], v[160:163]
 ds_read_b128 v[200:203], v2 offset:36864
 v_mfma_f32_16x16x32_bf16 v[136:139], v[208:211], v[248:251], v[136:139]
 buffer_load_dwordx4 v2, s[4:7], s89 offen offset:3072 sc1 lds
 v_mov_b32 v24, v39
 v_mfma_f32_16x16x32_bf16 v[164:167], v[208:211], v[252:255], v[164:167]
 s_waitcnt lgkmcnt(3)
 ds_read_b128 v[204:207], v2 offset:37888
 v_permlane16_swap_b32 v39, v24
 v_mfma_f32_16x16x32_bf16 v[140:143], v[212:215], v[248:251], v[140:143]
 v_add_f32 v39, v39, v24
 v_mov_b32 v45, v39
 v_mfma_f32_16x16x32_bf16 v[168:171], v[212:215], v[252:255], v[168:171]
 ds_read_b128 v[208:211], v2 offset:38912
 v_permlane32_swap_b32 v39, v45
 v_mfma_f32_16x16x32_bf16 v[144:147], v[184:187], v[248:251], v[144:147]
 buffer_load_dwordx4 v[244:247], v2, s[4:7], s85 offen offset:1024 sc1
 v_mul_f32 v39, s84, v39
 v_mfma_f32_16x16x32_bf16 v[172:175], v[184:187], v[252:255], v[172:175]
 ds_read_b128 v[212:215], v2 offset:39936
 v_mul_f32 v45, s84, v45
 v_mfma_f32_16x16x32_bf16 v[148:151], v[188:191], v[248:251], v[148:151]
 v_fmac_f32 v45, v39, v39
 v_min_f32 v45, 0, v45
 v_mfma_f32_16x16x32_bf16 v[176:179], v[188:191], v[252:255], v[176:179]
 s_waitcnt lgkmcnt(3)
 buffer_load_dwordx4 v[84:87], v29, s[4:7], s79 offen offset:192 sc1
 v_mfma_f32_16x16x32_bf16 v[152:155], v[192:195], v[248:251], v[152:155]
 ds_read_b128 v[184:187], v2 offset:40960
 v_sub_f32 v45, 0x3727c5ac, v45
 v_mfma_f32_16x16x32_bf16 v[180:183], v[192:195], v[252:255], v[180:183]
 s_waitcnt vmcnt(18)
 ds_read_b128 v[188:191], v2 offset:41984
 v_rsq_f32 v24, v45
 v_mfma_f32_16x16x32_bf16 v[128:131], v[196:199], v[216:219], v[128:131]
 s_waitcnt vmcnt(16)
 buffer_load_dwordx4 v[248:251], v2, s[4:7], s85 offen offset:2048 sc1
 v_mfma_f32_16x16x32_bf16 v[156:159], v[196:199], v[220:223], v[156:159]
 ds_read_b128 v[192:195], v2 offset:43008
 v_mul_f32 v41, 0xc0135761, v24
 v_mfma_f32_16x16x32_bf16 v[132:135], v[200:203], v[216:219], v[132:135]
 v_mul_f32 v25, v24, v24
 v_mfma_f32_16x16x32_bf16 v[160:163], v[200:203], v[220:223], v[160:163]
 s_waitcnt lgkmcnt(3)
 ds_read_b128 v[196:199], v2 offset:44032
 v_mul_f32 v25, v25, v24
 v_mfma_f32_16x16x32_bf16 v[136:139], v[204:207], v[216:219], v[136:139]
 s_add_u32 m0, s16, 90112
 s_mul_i32 s89, s50, 28672
 s_add_u32 s89, s89, s16
 s_add_u32 s89, s89, 0x701000
 v_mfma_f32_16x16x32_bf16 v[164:167], v[204:207], v[220:223], v[164:167]
 buffer_load_dwordx4 v2, s[4:7], s89 offen sc1 lds
 ds_read_b128 v[200:203], v2 offset:45056
 v_mfma_f32_16x16x32_bf16 v[140:143], v[208:211], v[216:219], v[140:143]
 v_mul_f32 v43, 0xbdd2d3e8, v25
 v_mfma_f32_16x16x32_bf16 v[168:171], v[208:211], v[220:223], v[168:171]
 ds_read_b128 v[204:207], v2 offset:46080
 v_mfma_f32_16x16x32_bf16 v[144:147], v[212:215], v[216:219], v[144:147]
 buffer_load_dwordx4 v[252:255], v2, s[4:7], s85 offen offset:3072 sc1
 v_mfma_f32_16x16x32_bf16 v[172:175], v[212:215], v[220:223], v[172:175]
 s_waitcnt lgkmcnt(3)
 ds_read_b128 v[208:211], v2 offset:47104
 v_cmp_gt_u32 vcc, 32, v1
 s_nop 1
 v_cndmask_b32 v46, v41, v40, vcc
 v_mfma_f32_16x16x32_bf16 v[148:151], v[184:187], v[216:219], v[148:151]
 v_cndmask_b32 v47, v43, v42, vcc
 v_cndmask_b32 v48, v45, v44, vcc
 v_mfma_f32_16x16x32_bf16 v[176:179], v[184:187], v[220:223], v[176:179]
 buffer_load_dwordx4 v[88:91], v29, s[4:7], s79 offen offset:256 sc1
 ds_read_b128 v[212:215], v2 offset:48128
 v_mfma_f32_16x16x32_bf16 v[152:155], v[188:191], v[216:219], v[152:155]
 v_mfma_f32_16x16x32_bf16 v[180:183], v[188:191], v[220:223], v[180:183]
 s_waitcnt vmcnt(18)
 v_mfma_f32_16x16x32_bf16 v[128:131], v[192:195], v[224:227], v[128:131]
 s_add_u32 s85, s73, 0xd000
 ds_read_b128 v[184:187], v2 offset:49152
 buffer_load_dwordx4 v[216:219], v2, s[4:7], s85 offen sc1
 s_waitcnt vmcnt(15)
 v_mfma_f32_16x16x32_bf16 v[156:159], v[192:195], v[228:231], v[156:159]
 s_waitcnt lgkmcnt(3)
 ds_read_b128 v[188:191], v2 offset:50176
 v_mfma_f32_16x16x32_bf16 v[132:135], v[196:199], v[224:227], v[132:135]
 v_mfma_f32_16x16x32_bf16 v[160:163], v[196:199], v[228:231], v[160:163]
 ds_read_b128 v[192:195], v2 offset:51200
 v_mfma_f32_16x16x32_bf16 v[136:139], v[200:203], v[224:227], v[136:139]
 buffer_load_dwordx4 v2, s[4:7], s89 offen offset:1024 sc1 lds
 v_mfma_f32_16x16x32_bf16 v[164:167], v[200:203], v[228:231], v[164:167]
 ds_read_b128 v[196:199], v2 offset:52224
 v_mfma_f32_16x16x32_bf16 v[140:143], v[204:207], v[224:227], v[140:143]
 v_fmac_f32 v128, v72, v38
 v_fmac_f32 v129, v73, v38
 v_mfma_f32_16x16x32_bf16 v[168:171], v[204:207], v[228:231], v[168:171]
 s_waitcnt lgkmcnt(3)
 ds_read_b128 v[200:203], v2 offset:53248
 v_fmac_f32 v130, v74, v38
 v_fmac_f32 v131, v75, v38
 v_mfma_f32_16x16x32_bf16 v[144:147], v[208:211], v[224:227], v[144:147]
 buffer_load_dwordx4 v[220:223], v2, s[4:7], s85 offen offset:1024 sc1
 v_fmac_f32 v156, v72, v39
 v_fmac_f32 v157, v73, v39
 v_mfma_f32_16x16x32_bf16 v[172:175], v[208:211], v[228:231], v[172:175]
 ds_read_b128 v[204:207], v2 offset:54272
 v_fmac_f32 v158, v74, v39
 v_mfma_f32_16x16x32_bf16 v[148:151], v[212:215], v[224:227], v[148:151]
 v_fmac_f32 v159, v75, v39
 v_mfma_f32_16x16x32_bf16 v[176:179], v[212:215], v[228:231], v[176:179]
 buffer_load_dwordx4 v2, s[4:7], s89 offen offset:2048 sc1 lds
 ds_read_b128 v[208:211], v2 offset:55296
 v_mfma_f32_16x16x32_bf16 v[152:155], v[184:187], v[224:227], v[152:155]
 v_mfma_f32_16x16x32_bf16 v[180:183], v[184:187], v[228:231], v[180:183]
 s_waitcnt vmcnt(16) lgkmcnt(3)
 ds_read_b128 v[212:215], v2 offset:56320
 v_mfma_f32_16x16x32_bf16 v[128:131], v[188:191], v[232:235], v[128:131]
 s_waitcnt vmcnt(14)
 buffer_load_dwordx4 v[224:227], v2, s[4:7], s85 offen offset:2048 sc1
 v_mfma_f32_16x16x32_bf16 v[156:159], v[188:191], v[236:239], v[156:159]
 ds_read_b128 v[184:187], v26
 v_mfma_f32_16x16x32_bf16 v[132:135], v[192:195], v[232:235], v[132:135]
 v_mfma_f32_16x16x32_bf16 v[160:163], v[192:195], v[236:239], v[160:163]
 s_waitcnt vmcnt(12)
 v_cmp_gt_u32 vcc, 4, v3
 s_nop 0
 s_cbranch_vccnz .Lps_20
.Lpb_21:
 v_mfma_f32_16x16x32_bf16 v[136:139], v[196:199], v[232:235], v[136:139]
 s_waitcnt lgkmcnt(2)
 ds_read_b128 v[188:191], v26 offset:1024
 buffer_load_dwordx4 v[30:33], v2, s[4:7], s74 offen offset:1024 sc1
 v_mfma_f32_16x16x32_bf16 v[164:167], v[196:199], v[236:239], v[164:167]
 s_lshl_b32 s87, s48, 7
 s_add_u32 s87, s87, s61
 s_cmp_eq_u32 s50, 0
 s_cselect_b32 s87, s87, 0x2000000
 v_mov_b32 v5, 1
 v_mfma_f32_16x16x32_bf16 v[140:143], v[200:203], v[232:235], v[140:143]
 buffer_store_dword v5, v6, s[4:7], s87 offen offset:2560 sc1
 v_mfma_f32_16x16x32_bf16 v[168:171], v[200:203], v[236:239], v[168:171]
 ds_read_b128 v[192:195], v26 offset:2048
 ds_read_b128 v[196:199], v26 offset:3072
 buffer_load_dwordx4 v[228:231], v2, s[4:7], s85 offen offset:3072 sc1
 v_mfma_f32_16x16x32_bf16 v[144:147], v[204:207], v[232:235], v[144:147]
 v_fmac_f32 v132, v76, v38
 v_fmac_f32 v133, v77, v38
 v_mfma_f32_16x16x32_bf16 v[172:175], v[204:207], v[236:239], v[172:175]
 ds_read_b128 v[200:203], v26 offset:4096
 v_fmac_f32 v134, v78, v38
 v_fmac_f32 v135, v79, v38
 v_mfma_f32_16x16x32_bf16 v[148:151], v[208:211], v[232:235], v[148:151]
 v_fmac_f32 v160, v76, v39
 v_fmac_f32 v161, v77, v39
 v_mfma_f32_16x16x32_bf16 v[176:179], v[208:211], v[236:239], v[176:179]
 s_waitcnt lgkmcnt(3)
 buffer_load_dwordx4 v[34:37], v2, s[4:7], s74 offen sc1
 ds_read_b128 v[204:207], v26 offset:5120
 v_mfma_f32_16x16x32_bf16 v[152:155], v[212:215], v[232:235], v[152:155]
 v_fmac_f32 v162, v78, v39
 v_fmac_f32 v163, v79, v39
 v_mfma_f32_16x16x32_bf16 v[180:183], v[212:215], v[236:239], v[180:183]
 s_waitcnt vmcnt(14)
 ds_read_b128 v[208:211], v26 offset:6144
 v_mfma_f32_16x16x32_bf16 v[128:131], v[184:187], v[240:243], v[128:131]
 s_add_u32 s85, s73, 0xe000
 buffer_load_dwordx4 v[232:235], v2, s[4:7], s85 offen sc1
 v_mfma_f32_16x16x32_bf16 v[156:159], v[184:187], v[244:247], v[156:159]
 ds_read_b128 v[212:215], v26 offset:7168
 v_mfma_f32_16x16x32_bf16 v[132:135], v[188:191], v[240:243], v[132:135]
 v_mfma_f32_16x16x32_bf16 v[160:163], v[188:191], v[244:247], v[160:163]
 s_waitcnt lgkmcnt(3)
 ds_read_b128 v[184:187], v26 offset:8192
 v_mfma_f32_16x16x32_bf16 v[136:139], v[192:195], v[240:243], v[136:139]
 buffer_load_dwordx4 v[92:95], v29, s[4:7], s79 offen offset:320 sc1
 v_mfma_f32_16x16x32_bf16 v[164:167], v[192:195], v[244:247], v[164:167]
 ds_read_b128 v[188:191], v26 offset:9216
 v_mfma_f32_16x16x32_bf16 v[140:143], v[196:199], v[240:243], v[140:143]
 v_mfma_f32_16x16x32_bf16 v[168:171], v[196:199], v[244:247], v[168:171]
 s_mov_b32 s87, 0x0
 ds_read_b128 v[192:195], v26 offset:10240
 v_mfma_f32_16x16x32_bf16 v[144:147], v[200:203], v[240:243], v[144:147]
 s_mov_b64 exec, 0xfff0000
 buffer_load_dword v0, v8, s[4:7], s87 offen
 s_mov_b64 exec, -1
 buffer_load_dwordx4 v[236:239], v2, s[4:7], s85 offen offset:1024 sc1
 v_mfma_f32_16x16x32_bf16 v[172:175], v[200:203], v[244:247], v[172:175]
 s_waitcnt lgkmcnt(4)
 ds_read_b128 v[196:199], v26 offset:11264
 v_mfma_f32_16x16x32_bf16 v[148:151], v[204:207], v[240:243], v[148:151]
 v_fmac_f32 v136, v80, v38
 v_fmac_f32 v137, v81, v38
 v_mfma_f32_16x16x32_bf16 v[176:179], v[204:207], v[244:247], v[176:179]
 buffer_load_dwordx4 v[96:99], v29, s[4:7], s79 offen offset:384 sc1
 ds_read_b128 v[200:203], v26 offset:12288
 v_fmac_f32 v138, v82, v38
 v_mfma_f32_16x16x32_bf16 v[152:155], v[208:211], v[240:243], v[152:155]
 v_fmac_f32 v139, v83, v38
 v_fmac_f32 v164, v80, v39
 v_fmac_f32 v165, v81, v39
 v_mfma_f32_16x16x32_bf16 v[180:183], v[208:211], v[244:247], v[180:183]
 s_waitcnt vmcnt(17) lgkmcnt(3)
 ds_read_b128 v[204:207], v26 offset:13312
 v_fmac_f32 v166, v82, v39
 v_fmac_f32 v167, v83, v39
 v_mfma_f32_16x16x32_bf16 v[128:131], v[212:215], v[248:251], v[128:131]
 s_waitcnt vmcnt(15)
 buffer_load_dwordx4 v[240:243], v2, s[4:7], s85 offen offset:2048 sc1
 v_fmac_f32 v168, v84, v39
 v_fmac_f32 v169, v85, v39
 v_mfma_f32_16x16x32_bf16 v[156:159], v[212:215], v[252:255], v[156:159]
 ds_read_b128 v[208:211], v26 offset:14336
 v_fmac_f32 v170, v86, v39
 v_mfma_f32_16x16x32_bf16 v[132:135], v[184:187], v[248:251], v[132:135]
 v_fmac_f32 v171, v87, v39
 v_mfma_f32_16x16x32_bf16 v[160:163], v[184:187], v[252:255], v[160:163]
 ds_read_b128 v[212:215], v26 offset:15360
 v_mfma_f32_16x16x32_bf16 v[136:139], v[188:191], v[248:251], v[136:139]
 s_add_u32 s91, s78, 0x4000
 buffer_load_dwordx4 a[240:243], v2, s[4:7], s91 offen sc1
 v_mfma_f32_16x16x32_bf16 v[164:167], v[188:191], v[252:255], v[164:167]
 s_waitcnt lgkmcnt(3)
 ds_read_b128 v[184:187], v26 offset:16384
 v_mfma_f32_16x16x32_bf16 v[140:143], v[192:195], v[248:251], v[140:143]
 v_mfma_f32_16x16x32_bf16 v[168:171], v[192:195], v[252:255], v[168:171]
 ds_read_b128 v[188:191], v26 offset:17408
 v_mfma_f32_16x16x32_bf16 v[144:147], v[196:199], v[248:251], v[144:147]
 buffer_load_dwordx4 v[244:247], v2, s[4:7], s85 offen offset:3072 sc1
 v_mfma_f32_16x16x32_bf16 v[172:175], v[196:199], v[252:255], v[172:175]
 ds_read_b128 v[192:195], v26 offset:18432
 v_mfma_f32_16x16x32_bf16 v[148:151], v[200:203], v[248:251], v[148:151]
 s_waitcnt vmcnt(11)
 v_add_f32 v49, v30, v32
 v_add_f32 v54, v31, v33
 v_mfma_f32_16x16x32_bf16 v[176:179], v[200:203], v[252:255], v[176:179]
 s_add_u32 s91, s78, 0x4000
 buffer_load_dwordx4 a[244:247], v2, s[4:7], s91 offen offset:1024 sc1
 ds_read_b128 v[196:199], v26 offset:19456
 v_permlane32_swap_b32 v49, v54
 s_waitcnt lgkmcnt(4)
 v_mfma_f32_16x16x32_bf16 v[152:155], v[204:207], v[248:251], v[152:155]
 v_fmac_f32 v140, v84, v38
 v_fmac_f32 v141, v85, v38
 v_add_f32 v49, v49, v54
 v_mfma_f32_16x16x32_bf16 v[180:183], v[204:207], v[252:255], v[180:183]
 ds_read_b128 v[200:203], v26 offset:20480
 v_fmac_f32 v142, v86, v38
 v_fmac_f32 v143, v87, v38
 v_mfma_f32_16x16x32_bf16 v[128:131], v[208:211], v[216:219], v[128:131]
 s_add_u32 s85, s73, 0xf000
 buffer_load_dwordx4 v[248:251], v2, s[4:7], s85 offen sc1
 v_fmac_f32 v144, v88, v38
 v_fmac_f32 v145, v89, v38
 v_mfma_f32_16x16x32_bf16 v[156:159], v[208:211], v[220:223], v[156:159]
 ds_read_b128 v[204:207], v26 offset:21504
 v_fmac_f32 v146, v90, v38
 v_fmac_f32 v147, v91, v38
 v_mfma_f32_16x16x32_bf16 v[132:135], v[212:215], v[216:219], v[132:135]
 v_fmac_f32 v172, v88, v39
 v_fmac_f32 v173, v89, v39
 v_mfma_f32_16x16x32_bf16 v[160:163], v[212:215], v[220:223], v[160:163]
 s_waitcnt lgkmcnt(2)
 ds_read_b128 v[208:211], v26 offset:22528
 v_fmac_f32 v174, v90, v39
 v_fmac_f32 v175, v91, v39
 v_mfma_f32_16x16x32_bf16 v[136:139], v[184:187], v[216:219], v[136:139]
 s_add_u32 s91, s78, 0x4000
 buffer_load_dwordx4 a[248:251], v2, s[4:7], s91 offen offset:2048 sc1
 v_mfma_f32_16x16x32_bf16 v[164:167], v[184:187], v[220:223], v[164:167]
 ds_read_b128 v[212:215], v26 offset:23552
 v_mov_b32 v24, v49
 v_mfma_f32_16x16x32_bf16 v[140:143], v[188:191], v[216:219], v[140:143]
 ds_read_b128 v[184:187], v26 offset:24576
 v_mfma_f32_16x16x32_bf16 v[168:171], v[188:191], v[220:223], v[168:171]
 v_permlane16_swap_b32 v49, v24
 v_add_f32 v49, v49, v24
 v_mfma_f32_16x16x32_bf16 v[144:147], v[192:195], v[216:219], v[144:147]
 buffer_load_dwordx4 v[252:255], v2, s[4:7], s85 offen offset:1024 sc1
 v_mov_b32 v54, v49
 v_mfma_f32_16x16x32_bf16 v[172:175], v[192:195], v[220:223], v[172:175]
 ds_read_b128 v[188:191], v26 offset:25600
 v_permlane32_swap_b32 v49, v54
 v_mul_f32 v49, s84, v49
 v_mfma_f32_16x16x32_bf16 v[148:151], v[196:199], v[216:219], v[148:151]
 s_barrier
 v_mul_f32 v54, s84, v54
 v_fmac_f32 v54, v49, v49
 v_mfma_f32_16x16x32_bf16 v[176:179], v[196:199], v[220:223], v[176:179]
 s_add_u32 s91, s78, 0x5000
 buffer_load_dwordx4 a[252:255], v2, s[4:7], s91 offen sc1
 ds_read_b128 v[192:195], v26 offset:26624
 s_waitcnt lgkmcnt(4)
 v_mfma_f32_16x16x32_bf16 v[152:155], v[200:203], v[216:219], v[152:155]
 v_min_f32 v54, 0, v54
 v_sub_f32 v54, 0x3727c5ac, v54
 v_mfma_f32_16x16x32_bf16 v[180:183], v[200:203], v[220:223], v[180:183]
 ds_read_b128 v[196:199], v26 offset:27648
 v_rsq_f32 v24, v54
 v_mfma_f32_16x16x32_bf16 v[128:131], v[204:207], v[224:227], v[128:131]
 s_waitcnt vmcnt(14)
 buffer_load_dwordx4 v[216:219], v2, s[4:7], s85 offen offset:2048 sc1
 v_mul_f32 v50, 0xc0135761, v24
 v_mul_f32 v25, v24, v24
 v_mfma_f32_16x16x32_bf16 v[156:159], v[204:207], v[228:231], v[156:159]
 ds_read_b128 v[200:203], v26 offset:28672
 v_mul_f32 v25, v25, v24
 v_mul_f32 v52, 0xbdd2d3e8, v25
 v_mfma_f32_16x16x32_bf16 v[132:135], v[208:211], v[224:227], v[132:135]
 s_waitcnt vmcnt(12)
 v_fmac_f32 v148, v92, v38
 v_fmac_f32 v149, v93, v38
 v_mfma_f32_16x16x32_bf16 v[160:163], v[208:211], v[228:231], v[160:163]
 s_waitcnt lgkmcnt(2)
 ds_read_b128 v[204:207], v26 offset:29696
 v_fmac_f32 v150, v94, v38
 v_fmac_f32 v151, v95, v38
 v_mfma_f32_16x16x32_bf16 v[136:139], v[212:215], v[224:227], v[136:139]
 s_add_u32 m0, s80, 16384
 s_add_u32 s91, s78, 0xc00
 buffer_load_dwordx4 v2, s[4:7], s91 offen sc1 lds
 v_fmac_f32 v176, v92, v39
 v_fmac_f32 v177, v93, v39
 v_mfma_f32_16x16x32_bf16 v[164:167], v[212:215], v[228:231], v[164:167]
 ds_read_b128 v[208:211], v26 offset:30720
 v_fmac_f32 v178, v94, v39
 v_mfma_f32_16x16x32_bf16 v[140:143], v[184:187], v[224:227], v[140:143]
 v_fmac_f32 v179, v95, v39
 v_add_f32 v59, v34, v36
 v_mfma_f32_16x16x32_bf16 v[168:171], v[184:187], v[228:231], v[168:171]
 ds_read_b128 v[212:215], v26 offset:31744
 v_add_f32 v55, v35, v37
 v_mfma_f32_16x16x32_bf16 v[144:147], v[188:191], v[224:227], v[144:147]
 buffer_load_dwordx4 v[220:223], v2, s[4:7], s85 offen offset:3072 sc1
 v_permlane32_swap_b32 v59, v55
 v_add_f32 v59, v59, v55
 v_mfma_f32_16x16x32_bf16 v[172:175], v[188:191], v[228:231], v[172:175]
 ds_read_b128 v[184:187], v26 offset:32768
 v_mov_b32 v24, v59
 v_mfma_f32_16x16x32_bf16 v[148:151], v[192:195], v[224:227], v[148:151]
 s_add_u32 s91, s78, 0x1c00
 v_mfma_f32_16x16x32_bf16 v[176:179], v[192:195], v[228:231], v[176:179]
 s_add_u32 m0, s80, 17408
 s_nop 0
 buffer_load_dwordx4 v2, s[4:7], s91 offen sc1 lds
 ds_read_b128 v[188:191], v26 offset:33792
 v_permlane16_swap_b32 v59, v24
 s_waitcnt lgkmcnt(4)
 v_mfma_f32_16x16x32_bf16 v[152:155], v[196:199], v[224:227], v[152:155]
 v_add_f32 v59, v59, v24
 v_mov_b32 v55, v59
 v_mfma_f32_16x16x32_bf16 v[180:183], v[196:199], v[228:231], v[180:183]
 s_waitcnt vmcnt(13)
 ds_read_b128 v[192:195], v26 offset:34816
 v_permlane32_swap_b32 v59, v55
 v_mul_f32 v59, s84, v59
 v_mfma_f32_16x16x32_bf16 v[128:131], v[200:203], v[232:235], v[128:131]
 s_add_u32 s85, s73, 0x0
 buffer_load_dwordx4 v[224:227], v2, s[4:7], s85 offen sc1
 v_mul_f32 v55, s84, v55
 v_fmac_f32 v55, v59, v59
 v_mfma_f32_16x16x32_bf16 v[156:159], v[200:203], v[236:239], v[156:159]
 s_mov_b32 s87, 0x400000
 ds_read_b128 v[196:199], v26 offset:35840
 v_min_f32 v55, 0, v55
 v_mfma_f32_16x16x32_bf16 v[132:135], v[204:207], v[232:235], v[132:135]
 s_mov_b64 exec, 0x3fff
 buffer_load_dword v0, v8, s[4:7], s87 offen
 s_mov_b64 exec, -1
 v_sub_f32 v55, 0x3727c5ac, v55
 v_mfma_f32_16x16x32_bf16 v[160:163], v[204:207], v[236:239], v[160:163]
 s_waitcnt lgkmcnt(2)
 ds_read_b128 v[200:203], v26 offset:36864
 v_rsq_f32 v24, v55
 v_mfma_f32_16x16x32_bf16 v[136:139], v[208:211], v[232:235], v[136:139]
 s_waitcnt vmcnt(14)
 v_fmac_f32 v152, v96, v38
 v_fmac_f32 v153, v97, v38
 v_mfma_f32_16x16x32_bf16 v[164:167], v[208:211], v[236:239], v[164:167]
 ds_read_b128 v[204:207], v26 offset:37888
 v_fmac_f32 v154, v98, v38
 v_fmac_f32 v155, v99, v38
 v_mfma_f32_16x16x32_bf16 v[140:143], v[212:215], v[232:235], v[140:143]
 v_fmac_f32 v180, v96, v39
 v_fmac_f32 v181, v97, v39
 v_mfma_f32_16x16x32_bf16 v[168:171], v[212:215], v[236:239], v[168:171]
 ds_read_b128 v[208:211], v26 offset:38912
 v_fmac_f32 v182, v98, v39
 v_fmac_f32 v183, v99, v39
 v_mfma_f32_16x16x32_bf16 v[144:147], v[184:187], v[232:235], v[144:147]
 buffer_load_dwordx4 v[228:231], v2, s[4:7], s85 offen offset:1024 sc1
 v_mul_f32 v51, 0xc0135761, v24
 v_mfma_f32_16x16x32_bf16 v[172:175], v[184:187], v[236:239], v[172:175]
 ds_read_b128 v[212:215], v26 offset:39936
 v_mul_f32 v25, v24, v24
 v_mfma_f32_16x16x32_bf16 v[148:151], v[188:191], v[232:235], v[148:151]
 s_add_u32 s91, s78, 0x2c00
 v_mul_f32 v25, v25, v24
 v_mul_f32 v53, 0xbdd2d3e8, v25
 v_mfma_f32_16x16x32_bf16 v[176:179], v[188:191], v[236:239], v[176:179]
 s_add_u32 m0, s80, 18432
 s_nop 0
 buffer_load_dwordx4 v2, s[4:7], s91 offen sc1 lds
 ds_read_b128 v[184:187], v26 offset:40960
 s_waitcnt lgkmcnt(4)
 v_mfma_f32_16x16x32_bf16 v[152:155], v[192:195], v[232:235], v[152:155]
 v_cmp_gt_u32 vcc, 32, v1
 s_nop 1
 v_cndmask_b32 v56, v51, v50, vcc
 v_cndmask_b32 v57, v53, v52, vcc
 v_cndmask_b32 v58, v55, v54, vcc
 v_mfma_f32_16x16x32_bf16 v[180:183], v[192:195], v[236:239], v[180:183]
 s_waitcnt vmcnt(15)
 ds_read_b128 v[188:191], v26 offset:41984
 v_mfma_f32_16x16x32_bf16 v[128:131], v[196:199], v[240:243], v[128:131]
 s_waitcnt vmcnt(13)
 buffer_load_dwordx4 v[232:235], v2, s[4:7], s85 offen offset:2048 sc1
 v_mfma_f32_16x16x32_bf16 v[156:159], v[196:199], v[244:247], v[156:159]
 ds_read_b128 v[192:195], v26 offset:43008
 v_mul_f32 v100, v72, v59
 v_mul_f32 v72, v72, v49
 v_mfma_f32_16x16x32_bf16 v[132:135], v[200:203], v[240:243], v[132:135]
 v_mul_f32 v101, v73, v59
 v_mul_f32 v73, v73, v49
 v_mfma_f32_16x16x32_bf16 v[160:163], v[200:203], v[244:247], v[160:163]
 s_waitcnt lgkmcnt(2)
 ds_read_b128 v[196:199], v26 offset:44032
 v_mul_f32 v102, v74, v59
 v_mul_f32 v74, v74, v49
 v_mfma_f32_16x16x32_bf16 v[136:139], v[204:207], v[240:243], v[136:139]
 s_add_u32 m0, s80, 19456
 s_add_u32 s91, s78, 0x3c00
 buffer_load_dwordx4 v2, s[4:7], s91 offen sc1 lds
 v_mfma_f32_16x16x32_bf16 v[164:167], v[204:207], v[244:247], v[164:167]
 ds_read_b128 v[200:203], v26 offset:45056
 v_mul_f32 v103, v75, v59
 v_mul_f32 v75, v75, v49
 v_mfma_f32_16x16x32_bf16 v[140:143], v[208:211], v[240:243], v[140:143]
 v_mul_f32 v104, v76, v59
 v_mul_f32 v76, v76, v49
 v_mfma_f32_16x16x32_bf16 v[168:171], v[208:211], v[244:247], v[168:171]
 ds_read_b128 v[204:207], v26 offset:46080
 v_mul_f32 v105, v77, v59
 v_mul_f32 v77, v77, v49
 v_mfma_f32_16x16x32_bf16 v[144:147], v[212:215], v[240:243], v[144:147]
 buffer_load_dwordx4 v[236:239], v2, s[4:7], s85 offen offset:3072 sc1
 v_mul_f32 v106, v78, v59
 v_mfma_f32_16x16x32_bf16 v[172:175], v[212:215], v[244:247], v[172:175]
 ds_read_b128 v[208:211], v26 offset:47104
 v_mul_f32 v78, v78, v49
 v_mul_f32 v107, v79, v59
 v_mfma_f32_16x16x32_bf16 v[148:151], v[184:187], v[240:243], v[148:151]
 s_add_u32 s91, s78, 0x4c00
 v_mul_f32 v79, v79, v49
 v_mul_f32 v108, v80, v59
 v_mfma_f32_16x16x32_bf16 v[176:179], v[184:187], v[244:247], v[176:179]
 s_add_u32 m0, s80, 32768
 s_nop 0
 buffer_load_dwordx4 v2, s[4:7], s91 offen sc1 lds
 ds_read_b128 v[212:215], v26 offset:48128
 s_waitcnt lgkmcnt(3)
 v_mfma_f32_16x16x32_bf16 v[152:155], v[188:191], v[240:243], v[152:155]
 v_mul_f32 v80, v80, v49
 v_mul_f32 v109, v81, v59
 v_mul_f32 v81, v81, v49
 v_mfma_f32_16x16x32_bf16 v[180:183], v[188:191], v[244:247], v[180:183]
 s_waitcnt vmcnt(15)
 ds_read_b128 v[184:187], v26 offset:49152
 v_mul_f32 v110, v82, v59
 v_mfma_f32_16x16x32_bf16 v[128:131], v[192:195], v[248:251], v[128:131]
 s_add_u32 s85, s73, 0x1000
 buffer_load_dwordx4 v[240:243], v2, s[4:7], s85 offen sc1
 v_mul_f32 v82, v82, v49
 s_waitcnt vmcnt(14)
 v_mfma_f32_16x16x32_bf16 v[156:159], v[192:195], v[252:255], v[156:159]
 ds_read_b128 v[188:191], v26 offset:50176
 v_mul_f32 v111, v83, v59
 v_mul_f32 v83, v83, v49
 v_mfma_f32_16x16x32_bf16 v[132:135], v[196:199], v[248:251], v[132:135]
 v_mul_f32 v112, v84, v59
 v_mul_f32 v84, v84, v49
 v_mfma_f32_16x16x32_bf16 v[160:163], v[196:199], v[252:255], v[160:163]
 s_add_u32 s91, s78, 0x5c00
 ds_read_b128 v[192:195], v26 offset:51200
 v_mul_f32 v113, v85, v59
 v_mul_f32 v85, v85, v49
 v_mfma_f32_16x16x32_bf16 v[136:139], v[200:203], v[248:251], v[136:139]
 s_add_u32 m0, s80, 33792
 s_nop 0
 buffer_load_dwordx4 v2, s[4:7], s91 offen sc1 lds
 s_mov_b64 exec, 0xfffc000
 s_mov_b32 s87, 0x400000
 buffer_load_dword v0, v8, s[4:7], s87 offen
 s_mov_b64 exec, -1
 v_mfma_f32_16x16x32_bf16 v[164:167], v[200:203], v[252:255], v[164:167]
 s_waitcnt lgkmcnt(2)
 ds_read_b128 v[196:199], v26 offset:52224
 v_mfma_f32_16x16x32_bf16 v[140:143], v[204:207], v[248:251], v[140:143]
 v_mul_f32 v114, v86, v59
 v_mul_f32 v86, v86, v49
 v_mfma_f32_16x16x32_bf16 v[168:171], v[204:207], v[252:255], v[168:171]
 ds_read_b128 v[200:203], v26 offset:53248
 v_mul_f32 v115, v87, v59
 v_mul_f32 v87, v87, v49
 v_mfma_f32_16x16x32_bf16 v[144:147], v[208:211], v[248:251], v[144:147]
 buffer_load_dwordx4 v[244:247], v2, s[4:7], s85 offen offset:1024 sc1
 v_mul_f32 v116, v88, v59
 v_mfma_f32_16x16x32_bf16 v[172:175], v[208:211], v[252:255], v[172:175]
 ds_read_b128 v[204:207], v26 offset:54272
 v_mul_f32 v88, v88, v49
 v_mfma_f32_16x16x32_bf16 v[148:151], v[212:215], v[248:251], v[148:151]
 s_add_u32 s91, s78, 0x6c00
 v_mul_f32 v117, v89, v59
 v_mul_f32 v89, v89, v49
 v_mul_f32 v118, v90, v59
 v_mfma_f32_16x16x32_bf16 v[176:179], v[212:215], v[252:255], v[176:179]
 s_add_u32 m0, s80, 34816
 s_nop 0
 buffer_load_dwordx4 v2, s[4:7], s91 offen sc1 lds
 ds_read_b128 v[208:211], v26 offset:55296
 v_mfma_f32_16x16x32_bf16 v[152:155], v[184:187], v[248:251], v[152:155]
 v_mul_f32 v90, v90, v49
 v_mul_f32 v119, v91, v59
 v_mfma_f32_16x16x32_bf16 v[180:183], v[184:187], v[252:255], v[180:183]
 s_waitcnt vmcnt(16) lgkmcnt(3)
 ds_read_b128 v[212:215], v26 offset:56320
 v_mul_f32 v91, v91, v49
 v_mfma_f32_16x16x32_bf16 v[128:131], v[188:191], v[216:219], v[128:131]
 s_waitcnt vmcnt(14)
 buffer_load_dwordx4 v[248:251], v2, s[4:7], s85 offen offset:2048 sc1
 v_mul_f32 v120, v92, v59
 v_mfma_f32_16x16x32_bf16 v[156:159], v[188:191], v[220:223], v[156:159]
 ds_read_b128 v[184:187], v2
 v_mul_f32 v92, v92, v49
 v_mul_f32 v121, v93, v59
 v_mfma_f32_16x16x32_bf16 v[132:135], v[192:195], v[216:219], v[132:135]
 v_mul_f32 v93, v93, v49
 v_mul_f32 v122, v94, v59
 v_mfma_f32_16x16x32_bf16 v[160:163], v[192:195], v[220:223], v[160:163]
 s_add_u32 s91, s78, 0x7c00
 ds_read_b128 v[188:191], v2 offset:1024
 v_mul_f32 v94, v94, v49
 v_mfma_f32_16x16x32_bf16 v[136:139], v[196:199], v[216:219], v[136:139]
 s_add_u32 m0, s80, 35840
 s_nop 0
 buffer_load_dwordx4 v2, s[4:7], s91 offen sc1 lds
 v_mul_f32 v123, v95, v59
 v_mfma_f32_16x16x32_bf16 v[164:167], v[196:199], v[220:223], v[164:167]
 s_waitcnt lgkmcnt(2)
 ds_read_b128 v[192:195], v2 offset:2048
 v_mul_f32 v95, v95, v49
 v_mfma_f32_16x16x32_bf16 v[140:143], v[200:203], v[216:219], v[140:143]
 v_mul_f32 v124, v96, v59
 v_mul_f32 v96, v96, v49
 v_mfma_f32_16x16x32_bf16 v[168:171], v[200:203], v[220:223], v[168:171]
 ds_read_b128 v[196:199], v2 offset:3072
 v_mul_f32 v125, v97, v59
 v_mfma_f32_16x16x32_bf16 v[144:147], v[204:207], v[216:219], v[144:147]
 buffer_load_dwordx4 v[252:255], v2, s[4:7], s85 offen offset:3072 sc1
 v_mul_f32 v97, v97, v49
 v_mfma_f32_16x16x32_bf16 v[172:175], v[204:207], v[220:223], v[172:175]
 ds_read_b128 v[200:203], v2 offset:4096
 v_mul_f32 v126, v98, v59
 v_mfma_f32_16x16x32_bf16 v[148:151], v[208:211], v[216:219], v[148:151]
 v_mul_f32 v98, v98, v49
 v_mul_f32 v127, v99, v59
 v_mfma_f32_16x16x32_bf16 v[176:179], v[208:211], v[220:223], v[176:179]
 ds_read_b128 v[204:207], v2 offset:5120
 v_mul_f32 v99, v99, v49
 v_mfma_f32_16x16x32_bf16 v[152:155], v[212:215], v[216:219], v[152:155]
 v_mfma_f32_16x16x32_bf16 v[180:183], v[212:215], v[220:223], v[180:183]
 s_waitcnt vmcnt(15) lgkmcnt(3)
 v_mfma_f32_16x16x32_bf16 v[72:75], v[184:187], v[224:227], v[72:75]
 s_add_u32 s85, s73, 0x2000
 ds_read_b128 v[208:211], v2 offset:6144
 buffer_load_dwordx4 v[216:219], v2, s[4:7], s85 offen sc1
 s_waitcnt vmcnt(14)
 v_mfma_f32_16x16x32_bf16 v[100:103], v[184:187], v[228:231], v[100:103]
 ds_read_b128 v[212:215], v2 offset:7168
 v_mfma_f32_16x16x32_bf16 v[76:79], v[188:191], v[224:227], v[76:79]
 v_mfma_f32_16x16x32_bf16 v[104:107], v[188:191], v[228:231], v[104:107]
 s_add_u32 s91, s78, 0x9800
 v_mfma_f32_16x16x32_bf16 v[80:83], v[192:195], v[224:227], v[80:83]
 s_add_u32 m0, s80, 0
 ds_read_b128 v[184:187], v2 offset:8192
 buffer_load_dwordx4 v2, s[4:7], s91 offen sc1 lds
 v_permlane32_swap_b32 v152, v180
 v_mfma_f32_16x16x32_bf16 v[108:111], v[192:195], v[228:231], v[108:111]
 s_waitcnt lgkmcnt(3)
 ds_read_b128 v[188:191], v2 offset:9216
 v_permlane32_swap_b32 v153, v181
 v_permlane32_swap_b32 v154, v182
 v_mfma_f32_16x16x32_bf16 v[84:87], v[196:199], v[224:227], v[84:87]
 s_add_u32 s90, s75, 0x0
 v_permlane32_swap_b32 v155, v183
 v_mul_f32 v60, v152, v152
 v_mfma_f32_16x16x32_bf16 v[112:115], v[196:199], v[228:231], v[112:115]
 ds_read_b128 v[192:195], v2 offset:10240
 v_mul_f32 v61, v153, v153
 v_mfma_f32_16x16x32_bf16 v[88:91], v[200:203], v[224:227], v[88:91]
 buffer_load_dwordx4 v[220:223], v2, s[4:7], s85 offen offset:1024 sc1
 v_mul_f32 v62, v154, v154
 v_mfma_f32_16x16x32_bf16 v[116:119], v[200:203], v[228:231], v[116:119]
 ds_read_b128 v[196:199], v2 offset:11264
 v_mul_f32 v63, v155, v155
 v_fma_f32 v60, v60, v47, v46
 v_mfma_f32_16x16x32_bf16 v[92:95], v[204:207], v[224:227], v[92:95]
 v_fma_f32 v61, v61, v47, v46
 v_fma_f32 v62, v62, v47, v46
 v_mfma_f32_16x16x32_bf16 v[120:123], v[204:207], v[228:231], v[120:123]
 s_waitcnt lgkmcnt(2)
 ds_read_b128 v[200:203], v2 offset:12288
 v_fma_f32 v63, v63, v47, v46
 v_mfma_f32_16x16x32_bf16 v[96:99], v[208:211], v[224:227], v[96:99]
 v_mul_f32 v60, v60, v152
 v_mul_f32 v61, v61, v153
 v_mfma_f32_16x16x32_bf16 v[124:127], v[208:211], v[228:231], v[124:127]
 s_waitcnt vmcnt(14)
 ds_read_b128 v[204:207], v2 offset:13312
 v_mul_f32 v62, v62, v154
 v_mul_f32 v63, v63, v155
 v_mfma_f32_16x16x32_bf16 v[72:75], v[212:215], v[232:235], v[72:75]
 s_waitcnt vmcnt(12)
 buffer_load_dwordx4 v[224:227], v2, s[4:7], s85 offen offset:2048 sc1
 v_exp_f32 v60, v60
 v_mfma_f32_16x16x32_bf16 v[100:103], v[212:215], v[236:239], v[100:103]
 ds_read_b128 v[208:211], v2 offset:14336
 v_mul_f32 v64, v152, v180
 v_mfma_f32_16x16x32_bf16 v[76:79], v[184:187], v[232:235], v[76:79]
 v_exp_f32 v61, v61
 v_mfma_f32_16x16x32_bf16 v[104:107], v[184:187], v[236:239], v[104:107]
 s_add_u32 s91, s78, 0x9c00
 ds_read_b128 v[212:215], v2 offset:15360
 v_mul_f32 v65, v153, v181
 v_mfma_f32_16x16x32_bf16 v[80:83], v[188:191], v[232:235], v[80:83]
 s_add_u32 m0, s80, 1024
 s_nop 0
 buffer_load_dwordx4 v2, s[4:7], s91 offen sc1 lds
 v_mfma_f32_16x16x32_bf16 v[108:111], v[188:191], v[236:239], v[108:111]
 s_waitcnt lgkmcnt(2)
 ds_read_b128 v[184:187], v2 offset:16384
 v_exp_f32 v62, v62
 v_mfma_f32_16x16x32_bf16 v[84:87], v[192:195], v[232:235], v[84:87]
 v_mul_f32 v66, v154, v182
 v_exp_f32 v63, v63
 v_mfma_f32_16x16x32_bf16 v[112:115], v[192:195], v[236:239], v[112:115]
 ds_read_b128 v[188:191], v2 offset:17408
 buffer_load_dwordx4 v[228:231], v2, s[4:7], s85 offen offset:3072 sc1
 v_mfma_f32_16x16x32_bf16 v[88:91], v[196:199], v[232:235], v[88:91]
 v_mul_f32 v67, v155, v183
 v_fma_f32 v60, v60, v48, v48
 v_mfma_f32_16x16x32_bf16 v[116:119], v[196:199], v[236:239], v[116:119]
 ds_read_b128 v[192:195], v2 offset:18432
 v_rcp_f32 v60, v60
 v_mfma_f32_16x16x32_bf16 v[92:95], v[200:203], v[232:235], v[92:95]
 v_fma_f32 v61, v61, v48, v48
 v_mfma_f32_16x16x32_bf16 v[120:123], v[200:203], v[236:239], v[120:123]
 ds_read_b128 v[196:199], v2 offset:19456
 v_rcp_f32 v61, v61
 v_mfma_f32_16x16x32_bf16 v[96:99], v[204:207], v[232:235], v[96:99]
 v_fma_f32 v62, v62, v48, v48
 v_mfma_f32_16x16x32_bf16 v[124:127], v[204:207], v[236:239], v[124:127]
 s_waitcnt vmcnt(13) lgkmcnt(3)
 ds_read_b128 v[200:203], v2 offset:20480
 v_rcp_f32 v62, v62
 v_mfma_f32_16x16x32_bf16 v[72:75], v[208:211], v[240:243], v[72:75]
 s_add_u32 s85, s73, 0x3000
 buffer_load_dwordx4 v[232:235], v2, s[4:7], s85 offen sc1
 v_fma_f32 v63, v63, v48, v48
 s_waitcnt vmcnt(11)
 v_mfma_f32_16x16x32_bf16 v[100:103], v[208:211], v[244:247], v[100:103]
 ds_read_b128 v[204:207], v2 offset:21504
 v_rcp_f32 v63, v63
 v_mfma_f32_16x16x32_bf16 v[76:79], v[212:215], v[240:243], v[76:79]
 v_mul_f32 v60, v60, v64
 v_mfma_f32_16x16x32_bf16 v[104:107], v[212:215], v[244:247], v[104:107]
 s_add_u32 s91, s78, 0xa000
 ds_read_b128 v[208:211], v2 offset:22528
 v_mul_f32 v61, v61, v65
 v_mul_f32 v62, v62, v66
 v_mfma_f32_16x16x32_bf16 v[80:83], v[184:187], v[240:243], v[80:83]
 s_add_u32 m0, s80, 2048
 s_nop 0
 buffer_load_dwordx4 v2, s[4:7], s91 offen sc1 lds
 v_mfma_f32_16x16x32_bf16 v[108:111], v[184:187], v[244:247], v[108:111]
 s_waitcnt lgkmcnt(2)
 ds_read_b128 v[212:215], v2 offset:23552
 v_mul_f32 v63, v63, v67
 v_cvt_pk_bf16_f32 v68, v60, v61
 v_cvt_pk_bf16_f32 v69, v62, v63
 v_mfma_f32_16x16x32_bf16 v[84:87], v[188:191], v[240:243], v[84:87]
 buffer_store_dwordx2 v[68:69], v28, s[4:7], s90 offen offset:1536
 v_mfma_f32_16x16x32_bf16 v[112:115], v[188:191], v[244:247], v[112:115]
 s_add_u32 s91, s78, 0x7000
 ds_read_b128 v[184:187], v2 offset:24576
 buffer_load_dwordx4 v[152:155], v2, s[4:7], s91 offen offset:1024 sc1
 buffer_load_dwordx4 v[236:239], v2, s[4:7], s85 offen offset:1024 sc1
 v_mfma_f32_16x16x32_bf16 v[88:91], v[192:195], v[240:243], v[88:91]
 s_add_u32 s90, s75, 0xe000
 v_mul_f32 v60, v128, v128
 v_mfma_f32_16x16x32_bf16 v[116:119], v[192:195], v[244:247], v[116:119]
 ds_read_b128 v[188:191], v2 offset:25600
 v_mul_f32 v61, v129, v129
 v_mfma_f32_16x16x32_bf16 v[92:95], v[196:199], v[240:243], v[92:95]
 v_mul_f32 v62, v130, v130
 v_mul_f32 v63, v131, v131
 v_fma_f32 v60, v60, v42, v40
 v_mfma_f32_16x16x32_bf16 v[120:123], v[196:199], v[244:247], v[120:123]
 ds_read_b128 v[192:195], v2 offset:26624
 v_fma_f32 v61, v61, v42, v40
 v_mfma_f32_16x16x32_bf16 v[96:99], v[200:203], v[240:243], v[96:99]
 v_fma_f32 v62, v62, v42, v40
 v_fma_f32 v63, v63, v42, v40
 v_mfma_f32_16x16x32_bf16 v[124:127], v[200:203], v[244:247], v[124:127]
 s_waitcnt vmcnt(13) lgkmcnt(3)
 ds_read_b128 v[196:199], v2 offset:27648
 v_mul_f32 v60, v60, v128
 v_mfma_f32_16x16x32_bf16 v[72:75], v[204:207], v[248:251], v[72:75]
 s_waitcnt vmcnt(11)
 buffer_load_dwordx4 v[240:243], v2, s[4:7], s85 offen offset:2048 sc1
 v_mul_f32 v61, v61, v129
 v_mul_f32 v62, v62, v130
 v_mfma_f32_16x16x32_bf16 v[100:103], v[204:207], v[252:255], v[100:103]
 ds_read_b128 v[200:203], v2 offset:28672
 v_mul_f32 v63, v63, v131
 v_mfma_f32_16x16x32_bf16 v[76:79], v[208:211], v[248:251], v[76:79]
 v_exp_f32 v60, v60
 v_mfma_f32_16x16x32_bf16 v[104:107], v[208:211], v[252:255], v[104:107]
 s_add_u32 s91, s78, 0xa400
 ds_read_b128 v[204:207], v2 offset:29696
 v_mul_f32 v64, v128, v132
 v_mfma_f32_16x16x32_bf16 v[80:83], v[212:215], v[248:251], v[80:83]
 s_add_u32 m0, s80, 3072
 s_nop 0
 buffer_load_dwordx4 v2, s[4:7], s91 offen sc1 lds
 v_exp_f32 v61, v61
 v_mfma_f32_16x16x32_bf16 v[108:111], v[212:215], v[252:255], v[108:111]
 s_waitcnt lgkmcnt(2)
 ds_read_b128 v[208:211], v2 offset:30720
 v_mul_f32 v65, v129, v133
 v_mfma_f32_16x16x32_bf16 v[84:87], v[184:187], v[248:251], v[84:87]
 v_exp_f32 v62, v62
 v_mfma_f32_16x16x32_bf16 v[112:115], v[184:187], v[252:255], v[112:115]
 s_add_u32 s91, s78, 0x9000
 ds_read_b128 v[212:215], v2 offset:31744
 buffer_load_dwordx4 v[180:183], v2, s[4:7], s91 offen offset:1024 sc1
 v_mfma_f32_16x16x32_bf16 v[88:91], v[188:191], v[248:251], v[88:91]
 buffer_load_dwordx4 v[244:247], v2, s[4:7], s85 offen offset:3072 sc1
 v_mul_f32 v66, v130, v134
 v_mfma_f32_16x16x32_bf16 v[116:119], v[188:191], v[252:255], v[116:119]
 ds_read_b128 v[184:187], v2 offset:32768
 v_exp_f32 v63, v63
 v_mfma_f32_16x16x32_bf16 v[92:95], v[192:195], v[248:251], v[92:95]
 v_mul_f32 v67, v131, v135
 v_fma_f32 v60, v60, v44, v44
 v_mfma_f32_16x16x32_bf16 v[120:123], v[192:195], v[252:255], v[120:123]
 ds_read_b128 v[188:191], v2 offset:33792
 v_mfma_f32_16x16x32_bf16 v[96:99], v[196:199], v[248:251], v[96:99]
 v_rcp_f32 v60, v60
 v_fma_f32 v61, v61, v44, v44
 v_mfma_f32_16x16x32_bf16 v[124:127], v[196:199], v[252:255], v[124:127]
 s_waitcnt vmcnt(14) lgkmcnt(3)
 ds_read_b128 v[192:195], v2 offset:34816
 v_rcp_f32 v61, v61
 v_mfma_f32_16x16x32_bf16 v[72:75], v[200:203], v[216:219], v[72:75]
 s_add_u32 s85, s73, 0x4000
 buffer_load_dwordx4 v[248:251], v2, s[4:7], s85 offen sc1
 s_waitcnt vmcnt(13)
 v_mfma_f32_16x16x32_bf16 v[100:103], v[200:203], v[220:223], v[100:103]
 ds_read_b128 v[196:199], v2 offset:35840
 v_fma_f32 v62, v62, v44, v44
 v_mfma_f32_16x16x32_bf16 v[76:79], v[204:207], v[216:219], v[76:79]
 v_rcp_f32 v62, v62
 v_fma_f32 v63, v63, v44, v44
 v_mfma_f32_16x16x32_bf16 v[104:107], v[204:207], v[220:223], v[104:107]
 ds_read_b128 v[200:203], v2 offset:36864
 v_mfma_f32_16x16x32_bf16 v[80:83], v[208:211], v[216:219], v[80:83]
 v_rcp_f32 v63, v63
 v_mul_f32 v60, v60, v64
 v_mfma_f32_16x16x32_bf16 v[108:111], v[208:211], v[220:223], v[108:111]
 s_waitcnt lgkmcnt(2)
 ds_read_b128 v[204:207], v2 offset:37888
 v_mul_f32 v61, v61, v65
 v_mfma_f32_16x16x32_bf16 v[84:87], v[212:215], v[216:219], v[84:87]
 v_mul_f32 v62, v62, v66
 v_mul_f32 v63, v63, v67
 v_mfma_f32_16x16x32_bf16 v[112:115], v[212:215], v[220:223], v[112:115]
 ds_read_b128 v[208:211], v2 offset:38912
 v_cvt_pk_bf16_f32 v34, v60, v61
 v_cvt_pk_bf16_f32 v35, v62, v63
 v_mfma_f32_16x16x32_bf16 v[88:91], v[184:187], v[216:219], v[88:91]
 s_add_u32 s91, s78, 0x5000
 buffer_load_dwordx4 v[252:255], v2, s[4:7], s85 offen offset:1024 sc1
 buffer_load_dwordx4 v[128:131], v2, s[4:7], s91 offen offset:1024 sc1
 v_mfma_f32_16x16x32_bf16 v[116:119], v[184:187], v[220:223], v[116:119]
 ds_read_b128 v[212:215], v2 offset:39936
 v_mul_f32 v60, v136, v136
 v_mfma_f32_16x16x32_bf16 v[92:95], v[188:191], v[216:219], v[92:95]
 v_mul_f32 v61, v137, v137
 v_mul_f32 v62, v138, v138
 v_mfma_f32_16x16x32_bf16 v[120:123], v[188:191], v[220:223], v[120:123]
 ds_read_b128 v[184:187], v2 offset:40960
 v_mul_f32 v63, v139, v139
 v_mfma_f32_16x16x32_bf16 v[96:99], v[192:195], v[216:219], v[96:99]
 v_fma_f32 v60, v60, v42, v40
 v_fma_f32 v61, v61, v42, v40
 v_fma_f32 v62, v62, v42, v40
 v_mfma_f32_16x16x32_bf16 v[124:127], v[192:195], v[220:223], v[124:127]
 s_waitcnt vmcnt(14) lgkmcnt(3)
 ds_read_b128 v[188:191], v2 offset:41984
 v_fma_f32 v63, v63, v42, v40
 v_mfma_f32_16x16x32_bf16 v[72:75], v[196:199], v[224:227], v[72:75]
 s_waitcnt vmcnt(12)
 buffer_load_dwordx4 v[216:219], v2, s[4:7], s85 offen offset:2048 sc1
 v_mul_f32 v60, v60, v136
 v_mfma_f32_16x16x32_bf16 v[100:103], v[196:199], v[228:231], v[100:103]
 ds_read_b128 v[192:195], v2 offset:43008
 v_mul_f32 v61, v61, v137
 v_mfma_f32_16x16x32_bf16 v[76:79], v[200:203], v[224:227], v[76:79]
 v_mul_f32 v62, v62, v138
 v_mul_f32 v63, v63, v139
 v_mfma_f32_16x16x32_bf16 v[104:107], v[200:203], v[228:231], v[104:107]
 ds_read_b128 v[196:199], v2 offset:44032
 v_exp_f32 v60, v60
 v_mfma_f32_16x16x32_bf16 v[80:83], v[204:207], v[224:227], v[80:83]
 v_mul_f32 v64, v136, v140
 v_exp_f32 v61, v61
 v_mfma_f32_16x16x32_bf16 v[108:111], v[204:207], v[228:231], v[108:111]
 s_waitcnt lgkmcnt(2)
 ds_read_b128 v[200:203], v2 offset:45056
 v_mul_f32 v65, v137, v141
 v_mfma_f32_16x16x32_bf16 v[84:87], v[208:211], v[224:227], v[84:87]
 v_exp_f32 v62, v62
 v_mfma_f32_16x16x32_bf16 v[112:115], v[208:211], v[228:231], v[112:115]
 ds_read_b128 v[204:207], v2 offset:46080
 v_mul_f32 v66, v138, v142
 v_mfma_f32_16x16x32_bf16 v[88:91], v[212:215], v[224:227], v[88:91]
 s_add_u32 s91, s78, 0x5000
 buffer_load_dwordx4 v[220:223], v2, s[4:7], s85 offen offset:3072 sc1
 buffer_load_dwordx4 v[132:135], v2, s[4:7], s91 offen offset:2048 sc1
 v_mfma_f32_16x16x32_bf16 v[116:119], v[212:215], v[228:231], v[116:119]
 ds_read_b128 v[208:211], v2 offset:47104
 v_exp_f32 v63, v63
 v_mfma_f32_16x16x32_bf16 v[92:95], v[184:187], v[224:227], v[92:95]
 v_mul_f32 v67, v139, v143
 v_mfma_f32_16x16x32_bf16 v[120:123], v[184:187], v[228:231], v[120:123]
 ds_read_b128 v[212:215], v2 offset:48128
 v_fma_f32 v60, v60, v44, v44
 v_mfma_f32_16x16x32_bf16 v[96:99], v[188:191], v[224:227], v[96:99]
 v_rcp_f32 v60, v60
 v_mfma_f32_16x16x32_bf16 v[124:127], v[188:191], v[228:231], v[124:127]
 s_waitcnt vmcnt(14) lgkmcnt(3)
 v_fma_f32 v61, v61, v44, v44
 v_mfma_f32_16x16x32_bf16 v[72:75], v[192:195], v[232:235], v[72:75]
 s_add_u32 s85, s73, 0x5000
 ds_read_b128 v[184:187], v2 offset:49152
 buffer_load_dwordx4 v[224:227], v2, s[4:7], s85 offen sc1
 v_rcp_f32 v61, v61
 s_waitcnt vmcnt(11)
 v_mfma_f32_16x16x32_bf16 v[100:103], v[192:195], v[236:239], v[100:103]
 ds_read_b128 v[188:191], v2 offset:50176
 v_fma_f32 v62, v62, v44, v44
 v_mfma_f32_16x16x32_bf16 v[76:79], v[196:199], v[232:235], v[76:79]
 v_rcp_f32 v62, v62
 v_mfma_f32_16x16x32_bf16 v[104:107], v[196:199], v[236:239], v[104:107]
 ds_read_b128 v[192:195], v2 offset:51200
 v_fma_f32 v63, v63, v44, v44
 v_mfma_f32_16x16x32_bf16 v[80:83], v[200:203], v[232:235], v[80:83]
 v_rcp_f32 v63, v63
 v_mfma_f32_16x16x32_bf16 v[108:111], v[200:203], v[236:239], v[108:111]
 s_waitcnt lgkmcnt(2)
 ds_read_b128 v[196:199], v2 offset:52224
 v_mul_f32 v60, v60, v64
 v_mul_f32 v61, v61, v65
 v_mfma_f32_16x16x32_bf16 v[84:87], v[204:207], v[232:235], v[84:87]
 v_mul_f32 v62, v62, v66
 v_mul_f32 v63, v63, v67
 v_mfma_f32_16x16x32_bf16 v[112:115], v[204:207], v[236:239], v[112:115]
 ds_read_b128 v[200:203], v2 offset:53248
 v_cvt_pk_bf16_f32 v36, v60, v61
 v_mfma_f32_16x16x32_bf16 v[88:91], v[208:211], v[232:235], v[88:91]
 buffer_load_dwordx4 v[228:231], v2, s[4:7], s85 offen offset:1024 sc1
 v_cvt_pk_bf16_f32 v37, v62, v63
 v_mfma_f32_16x16x32_bf16 v[116:119], v[208:211], v[236:239], v[116:119]
 ds_read_b128 v[204:207], v2 offset:54272
 buffer_store_dwordx4 v[34:37], v2, s[4:7], s90 offen
 v_mfma_f32_16x16x32_bf16 v[92:95], v[212:215], v[232:235], v[92:95]
 s_add_u32 s91, s78, 0x6000
 buffer_load_dwordx4 v[136:139], v2, s[4:7], s91 offen sc1
 v_mul_f32 v60, v144, v144
 v_mul_f32 v61, v145, v145
 v_mfma_f32_16x16x32_bf16 v[120:123], v[212:215], v[236:239], v[120:123]
 ds_read_b128 v[208:211], v2 offset:55296
 v_mul_f32 v62, v146, v146
 v_mfma_f32_16x16x32_bf16 v[96:99], v[184:187], v[232:235], v[96:99]
 v_mul_f32 v63, v147, v147
 v_fma_f32 v60, v60, v42, v40
 v_mfma_f32_16x16x32_bf16 v[124:127], v[184:187], v[236:239], v[124:127]
 s_waitcnt vmcnt(13) lgkmcnt(3)
 ds_read_b128 v[212:215], v2 offset:56320
 v_fma_f32 v61, v61, v42, v40
 v_mfma_f32_16x16x32_bf16 v[72:75], v[188:191], v[240:243], v[72:75]
 s_waitcnt vmcnt(10)
 buffer_load_dwordx4 v[232:235], v2, s[4:7], s85 offen offset:2048 sc1
 v_fma_f32 v62, v62, v42, v40
 v_mfma_f32_16x16x32_bf16 v[100:103], v[188:191], v[244:247], v[100:103]
 ds_read_b128 v[184:187], v26
 v_fma_f32 v63, v63, v42, v40
 v_mul_f32 v60, v60, v144
 v_mfma_f32_16x16x32_bf16 v[76:79], v[192:195], v[240:243], v[76:79]
 v_mul_f32 v61, v61, v145
 v_mul_f32 v62, v62, v146
 v_mfma_f32_16x16x32_bf16 v[104:107], v[192:195], v[244:247], v[104:107]
 ds_read_b128 v[188:191], v26 offset:1024
 v_mul_f32 v63, v63, v147
 v_mfma_f32_16x16x32_bf16 v[80:83], v[196:199], v[240:243], v[80:83]
 v_exp_f32 v60, v60
 v_mfma_f32_16x16x32_bf16 v[108:111], v[196:199], v[244:247], v[108:111]
 s_waitcnt lgkmcnt(2)
 ds_read_b128 v[192:195], v26 offset:2048
 v_mul_f32 v64, v144, v148
 v_mfma_f32_16x16x32_bf16 v[84:87], v[200:203], v[240:243], v[84:87]
 v_exp_f32 v61, v61
 v_mul_f32 v65, v145, v149
 v_mfma_f32_16x16x32_bf16 v[112:115], v[200:203], v[244:247], v[112:115]
 ds_read_b128 v[196:199], v26 offset:3072
 buffer_load_dwordx4 v[236:239], v2, s[4:7], s85 offen offset:3072 sc1
 v_mfma_f32_16x16x32_bf16 v[88:91], v[204:207], v[240:243], v[88:91]
 v_exp_f32 v62, v62
 v_mfma_f32_16x16x32_bf16 v[116:119], v[204:207], v[244:247], v[116:119]
 ds_read_b128 v[200:203], v26 offset:4096
 v_mul_f32 v66, v146, v150
 v_mfma_f32_16x16x32_bf16 v[92:95], v[208:211], v[240:243], v[92:95]
 s_add_u32 s91, s78, 0x6000
 buffer_load_dwordx4 v[140:143], v2, s[4:7], s91 offen offset:1024 sc1
 v_mfma_f32_16x16x32_bf16 v[120:123], v[208:211], v[244:247], v[120:123]
 ds_read_b128 v[204:207], v26 offset:5120
 v_exp_f32 v63, v63
 v_mfma_f32_16x16x32_bf16 v[96:99], v[212:215], v[240:243], v[96:99]
 v_mul_f32 v67, v147, v151
 v_fma_f32 v60, v60, v44, v44
 v_mfma_f32_16x16x32_bf16 v[124:127], v[212:215], v[244:247], v[124:127]
 s_waitcnt vmcnt(12) lgkmcnt(3)
 ds_read_b128 v[208:211], v26 offset:6144
 v_rcp_f32 v60, v60
 v_mfma_f32_16x16x32_bf16 v[72:75], v[184:187], v[248:251], v[72:75]
 s_add_u32 s85, s73, 0x6000
 buffer_load_dwordx4 v[240:243], v2, s[4:7], s85 offen sc1
 s_waitcnt vmcnt(12)
 v_mfma_f32_16x16x32_bf16 v[100:103], v[184:187], v[252:255], v[100:103]
 ds_read_b128 v[212:215], v26 offset:7168
 v_fma_f32 v61, v61, v44, v44
 v_mfma_f32_16x16x32_bf16 v[76:79], v[188:191], v[248:251], v[76:79]
 v_rcp_f32 v61, v61
 v_fma_f32 v62, v62, v44, v44
 v_mfma_f32_16x16x32_bf16 v[104:107], v[188:191], v[252:255], v[104:107]
 ds_read_b128 v[184:187], v26 offset:8192
 v_mfma_f32_16x16x32_bf16 v[80:83], v[192:195], v[248:251], v[80:83]
 v_rcp_f32 v62, v62
 v_fma_f32 v63, v63, v44, v44
 v_mfma_f32_16x16x32_bf16 v[108:111], v[192:195], v[252:255], v[108:111]
 s_waitcnt lgkmcnt(3)
 ds_read_b128 v[188:191], v26 offset:9216
 v_mfma_f32_16x16x32_bf16 v[84:87], v[196:199], v[248:251], v[84:87]
 v_rcp_f32 v63, v63
 v_mul_f32 v60, v60, v64
 v_mfma_f32_16x16x32_bf16 v[112:115], v[196:199], v[252:255], v[112:115]
 ds_read_b128 v[192:195], v26 offset:10240
 v_mul_f32 v61, v61, v65
 v_mfma_f32_16x16x32_bf16 v[88:91], v[200:203], v[248:251], v[88:91]
 buffer_load_dwordx4 v[244:247], v2, s[4:7], s85 offen offset:1024 sc1
 v_mul_f32 v62, v62, v66
 v_mfma_f32_16x16x32_bf16 v[116:119], v[200:203], v[252:255], v[116:119]
 ds_read_b128 v[196:199], v26 offset:11264
 v_mul_f32 v63, v63, v67
 v_mfma_f32_16x16x32_bf16 v[92:95], v[204:207], v[248:251], v[92:95]
 s_waitcnt lgkmcnt(3)
 v_cvt_pk_bf16_f32 v70, v60, v61
 v_cvt_pk_bf16_f32 v71, v62, v63
 v_mfma_f32_16x16x32_bf16 v[120:123], v[204:207], v[252:255], v[120:123]
 s_add_u32 s91, s78, 0x6000
 buffer_store_dwordx2 v[70:71], v27, s[4:7], s90 offen offset:1024
 v_mfma_f32_16x16x32_bf16 v[96:99], v[208:211], v[248:251], v[96:99]
 s_add_u32 s90, s75, 0x0
 ds_read_b128 v[200:203], v26 offset:12288
 buffer_load_dwordx4 v[144:147], v2, s[4:7], s91 offen offset:2048 sc1
 v_mul_f32 v60, v156, v156
 v_mfma_f32_16x16x32_bf16 v[124:127], v[208:211], v[252:255], v[124:127]
 s_waitcnt vmcnt(13)
 ds_read_b128 v[204:207], v26 offset:13312
 v_mul_f32 v61, v157, v157
 v_mul_f32 v62, v158, v158
 v_mfma_f32_16x16x32_bf16 v[72:75], v[212:215], v[216:219], v[72:75]
 s_waitcnt vmcnt(12)
 buffer_load_dwordx4 v[248:251], v2, s[4:7], s85 offen offset:2048 sc1
 v_mul_f32 v63, v159, v159
 v_mfma_f32_16x16x32_bf16 v[100:103], v[212:215], v[220:223], v[100:103]
 ds_read_b128 v[208:211], v26 offset:14336
 v_fma_f32 v60, v60, v43, v41
 v_mfma_f32_16x16x32_bf16 v[76:79], v[184:187], v[216:219], v[76:79]
 v_fma_f32 v61, v61, v43, v41
 v_fma_f32 v62, v62, v43, v41
 v_mfma_f32_16x16x32_bf16 v[104:107], v[184:187], v[220:223], v[104:107]
 s_waitcnt lgkmcnt(2)
 ds_read_b128 v[212:215], v26 offset:15360
 v_fma_f32 v63, v63, v43, v41
 v_mfma_f32_16x16x32_bf16 v[80:83], v[188:191], v[216:219], v[80:83]
 v_mul_f32 v60, v60, v156
 v_mul_f32 v61, v61, v157
 v_mfma_f32_16x16x32_bf16 v[108:111], v[188:191], v[220:223], v[108:111]
 ds_read_b128 v[184:187], v26 offset:16384
 v_mul_f32 v62, v62, v158
 v_mul_f32 v63, v63, v159
 v_mfma_f32_16x16x32_bf16 v[84:87], v[192:195], v[216:219], v[84:87]
 v_exp_f32 v60, v60
 v_mfma_f32_16x16x32_bf16 v[112:115], v[192:195], v[220:223], v[112:115]
 ds_read_b128 v[188:191], v26 offset:17408
 v_mul_f32 v64, v156, v160
 v_mfma_f32_16x16x32_bf16 v[88:91], v[196:199], v[216:219], v[88:91]
 buffer_load_dwordx4 v[252:255], v2, s[4:7], s85 offen offset:3072 sc1
 v_exp_f32 v61, v61
 v_mfma_f32_16x16x32_bf16 v[116:119], v[196:199], v[220:223], v[116:119]
 ds_read_b128 v[192:195], v26 offset:18432
 v_mul_f32 v65, v157, v161
 v_mfma_f32_16x16x32_bf16 v[92:95], v[200:203], v[216:219], v[92:95]
 v_exp_f32 v62, v62
 v_mfma_f32_16x16x32_bf16 v[120:123], v[200:203], v[220:223], v[120:123]
 s_waitcnt lgkmcnt(3)
 v_mfma_f32_16x16x32_bf16 v[96:99], v[204:207], v[216:219], v[96:99]
 s_add_u32 s91, s78, 0x7000
 ds_read_b128 v[196:199], v26 offset:19456
 buffer_load_dwordx4 v[148:151], v2, s[4:7], s91 offen sc1
 v_mul_f32 v66, v158, v162
 v_mfma_f32_16x16x32_bf16 v[124:127], v[204:207], v[220:223], v[124:127]
 s_waitcnt vmcnt(13)
 ds_read_b128 v[200:203], v26 offset:20480
 v_exp_f32 v63, v63
 v_mfma_f32_16x16x32_bf16 v[72:75], v[208:211], v[224:227], v[72:75]
 s_add_u32 s85, s73, 0x7000
 buffer_load_dwordx4 v[216:219], v2, s[4:7], s85 offen sc1
 s_waitcnt vmcnt(13)
 v_mfma_f32_16x16x32_bf16 v[100:103], v[208:211], v[228:231], v[100:103]
 ds_read_b128 v[204:207], v26 offset:21504
 v_mul_f32 v67, v159, v163
 v_fma_f32 v60, v60, v45, v45
 v_mfma_f32_16x16x32_bf16 v[76:79], v[212:215], v[224:227], v[76:79]
 v_rcp_f32 v60, v60
 v_mfma_f32_16x16x32_bf16 v[104:107], v[212:215], v[228:231], v[104:107]
 s_waitcnt lgkmcnt(2)
 ds_read_b128 v[208:211], v26 offset:22528
 v_fma_f32 v61, v61, v45, v45
 v_mfma_f32_16x16x32_bf16 v[80:83], v[184:187], v[224:227], v[80:83]
 v_rcp_f32 v61, v61
 v_mfma_f32_16x16x32_bf16 v[108:111], v[184:187], v[228:231], v[108:111]
 ds_read_b128 v[212:215], v26 offset:23552
 v_fma_f32 v62, v62, v45, v45
 v_mfma_f32_16x16x32_bf16 v[84:87], v[188:191], v[224:227], v[84:87]
 v_rcp_f32 v62, v62
 v_mfma_f32_16x16x32_bf16 v[112:115], v[188:191], v[228:231], v[112:115]
 ds_read_b128 v[184:187], v26 offset:24576
 v_fma_f32 v63, v63, v45, v45
 v_mfma_f32_16x16x32_bf16 v[88:91], v[192:195], v[224:227], v[88:91]
 buffer_load_dwordx4 v[220:223], v2, s[4:7], s85 offen offset:1024 sc1
 v_rcp_f32 v63, v63
 v_mfma_f32_16x16x32_bf16 v[116:119], v[192:195], v[228:231], v[116:119]
 ds_read_b128 v[188:191], v26 offset:25600
 v_mul_f32 v60, v60, v64
 v_and_b32 v30, 12, v6
 v_lshlrev_b32 v30, 5, v30
 v_lshrrev_b32 v31, 4, v6
 v_lshl_add_u32 v30, v31, 12, v30
 v_mfma_f32_16x16x32_bf16 v[92:95], v[196:199], v[224:227], v[92:95]
 s_mov_b32 s86, 0x8b0000
 buffer_load_dword v3, v30, s[4:7], s86 offen offset:2560 sc1
 v_mul_f32 v61, v61, v65
 v_mul_f32 v62, v62, v66
 v_mfma_f32_16x16x32_bf16 v[120:123], v[196:199], v[228:231], v[120:123]
 s_waitcnt lgkmcnt(2)
 ds_read_b128 v[192:195], v26 offset:26624
 v_mul_f32 v63, v63, v67
 v_mfma_f32_16x16x32_bf16 v[96:99], v[200:203], v[224:227], v[96:99]
 s_waitcnt vmcnt(12)
 v_cvt_pk_bf16_f32 v34, v60, v61
 v_cvt_pk_bf16_f32 v35, v62, v63
 v_mfma_f32_16x16x32_bf16 v[124:127], v[200:203], v[228:231], v[124:127]
 s_add_u32 s91, s78, 0x7000
 ds_read_b128 v[196:199], v26 offset:27648
 buffer_load_dwordx4 v[156:159], v2, s[4:7], s91 offen offset:2048 sc1
 v_mfma_f32_16x16x32_bf16 v[72:75], v[204:207], v[232:235], v[72:75]
 s_waitcnt vmcnt(12)
 buffer_load_dwordx4 v[224:227], v2, s[4:7], s85 offen offset:2048 sc1
 v_mfma_f32_16x16x32_bf16 v[100:103], v[204:207], v[236:239], v[100:103]
 s_waitcnt vmcnt(9)
 ds_read_b128 v[200:203], v26 offset:28672
 v_mov_b32 v5, 1
 v_mfma_f32_16x16x32_bf16 v[76:79], v[208:211], v[232:235], v[76:79]
 buffer_store_dword v5, off, s[4:7], s68
 v_mul_f32 v60, v164, v164
 v_mfma_f32_16x16x32_bf16 v[104:107], v[208:211], v[236:239], v[104:107]
 ds_read_b128 v[204:207], v26 offset:29696
 v_mul_f32 v61, v165, v165
 v_mfma_f32_16x16x32_bf16 v[80:83], v[212:215], v[232:235], v[80:83]
 v_mul_f32 v62, v166, v166
 v_mul_f32 v63, v167, v167
 v_mfma_f32_16x16x32_bf16 v[108:111], v[212:215], v[236:239], v[108:111]
 s_waitcnt lgkmcnt(3)
 ds_read_b128 v[208:211], v26 offset:30720
 v_fma_f32 v60, v60, v43, v41
 v_mfma_f32_16x16x32_bf16 v[84:87], v[184:187], v[232:235], v[84:87]
 v_fma_f32 v61, v61, v43, v41
 v_fma_f32 v62, v62, v43, v41
 v_mfma_f32_16x16x32_bf16 v[112:115], v[184:187], v[236:239], v[112:115]
 ds_read_b128 v[212:215], v26 offset:31744
 v_fma_f32 v63, v63, v43, v41
 v_mfma_f32_16x16x32_bf16 v[88:91], v[188:191], v[232:235], v[88:91]
 buffer_load_dwordx4 v[228:231], v2, s[4:7], s85 offen offset:3072 sc1
 v_mul_f32 v60, v60, v164
 v_mul_f32 v61, v61, v165
 v_mfma_f32_16x16x32_bf16 v[116:119], v[188:191], v[236:239], v[116:119]
 ds_read_b128 v[184:187], v26 offset:32768
 v_mul_f32 v62, v62, v166
 v_mfma_f32_16x16x32_bf16 v[92:95], v[192:195], v[232:235], v[92:95]
 v_mul_f32 v63, v63, v167
 v_mfma_f32_16x16x32_bf16 v[120:123], v[192:195], v[236:239], v[120:123]
 s_waitcnt lgkmcnt(3)
 ds_read_b128 v[188:191], v26 offset:33792
 v_exp_f32 v60, v60
 v_mfma_f32_16x16x32_bf16 v[96:99], v[196:199], v[232:235], v[96:99]
 v_mul_f32 v64, v164, v168
 v_mfma_f32_16x16x32_bf16 v[124:127], v[196:199], v[236:239], v[124:127]
 ds_read_b128 v[192:195], v26 offset:34816
 v_exp_f32 v61, v61
 v_mfma_f32_16x16x32_bf16 v[72:75], v[200:203], v[240:243], v[72:75]
 v_mul_f32 v65, v165, v169
 v_mfma_f32_16x16x32_bf16 v[100:103], v[200:203], v[244:247], v[100:103]
 s_add_u32 s91, s78, 0xc000
 buffer_load_dwordx4 v[232:235], v2, s[4:7], s91 offen offset:2048 sc1
 ds_read_b128 v[196:199], v26 offset:35840
 v_exp_f32 v62, v62
 v_mfma_f32_16x16x32_bf16 v[76:79], v[204:207], v[240:243], v[76:79]
 s_lshl_b32 s87, s50, 2
 s_add_u32 s87, s87, s48
 s_lshl_b32 s87, s87, 9
 v_and_b32 v5, 12, v6
 v_lshl_add_u32 v5, v5, 5, s87
 v_min_u32 v5, .Lfast_end-interleave_layers__sliding_local_dilated__geglu_ffn__prompt_kernel-4, v5
 global_load_dword v0, v5, s[82:83]
 v_mul_f32 v66, v166, v170
 v_mfma_f32_16x16x32_bf16 v[104:107], v[204:207], v[244:247], v[104:107]
 s_waitcnt lgkmcnt(2)
 s_add_u32 s91, s78, 0x8000
 buffer_load_dwordx4 v[160:163], v2, s[4:7], s91 offen sc1
 ds_read_b128 v[200:203], v26 offset:36864
 v_mfma_f32_16x16x32_bf16 v[80:83], v[208:211], v[240:243], v[80:83]
 v_exp_f32 v63, v63
 v_mul_f32 v67, v167, v171
 v_mfma_f32_16x16x32_bf16 v[108:111], v[208:211], v[244:247], v[108:111]
 ds_read_b128 v[204:207], v26 offset:37888
 v_fma_f32 v60, v60, v45, v45
 v_mfma_f32_16x16x32_bf16 v[84:87], v[212:215], v[240:243], v[84:87]
 v_rcp_f32 v60, v60
 v_mfma_f32_16x16x32_bf16 v[112:115], v[212:215], v[244:247], v[112:115]
 ds_read_b128 v[208:211], v26 offset:38912
 v_fma_f32 v61, v61, v45, v45
 v_mfma_f32_16x16x32_bf16 v[88:91], v[184:187], v[240:243], v[88:91]
 s_add_u32 s91, s78, 0xc000
 buffer_load_dwordx4 v[236:239], v2, s[4:7], s91 offen offset:3072 sc1
 v_rcp_f32 v61, v61
 v_mfma_f32_16x16x32_bf16 v[116:119], v[184:187], v[244:247], v[116:119]
 ds_read_b128 v[212:215], v26 offset:39936
 v_fma_f32 v62, v62, v45, v45
 v_mfma_f32_16x16x32_bf16 v[92:95], v[188:191], v[240:243], v[92:95]
 v_rcp_f32 v62, v62
 v_mfma_f32_16x16x32_bf16 v[120:123], v[188:191], v[244:247], v[120:123]
 s_waitcnt lgkmcnt(3)
 ds_read_b128 v[184:187], v26 offset:40960
 v_fma_f32 v63, v63, v45, v45
 v_mfma_f32_16x16x32_bf16 v[96:99], v[192:195], v[240:243], v[96:99]
 v_rcp_f32 v63, v63
 v_mfma_f32_16x16x32_bf16 v[124:127], v[192:195], v[244:247], v[124:127]
 s_waitcnt vmcnt(13)
 ds_read_b128 v[188:191], v26 offset:41984
 v_mul_f32 v60, v60, v64
 v_mfma_f32_16x16x32_bf16 v[72:75], v[196:199], v[248:251], v[72:75]
 s_waitcnt vmcnt(12)
 v_mul_f32 v61, v61, v65
 v_mul_f32 v62, v62, v66
 v_mfma_f32_16x16x32_bf16 v[100:103], v[196:199], v[252:255], v[100:103]
 s_add_u32 s91, s78, 0xd000
 buffer_load_dwordx4 v[240:243], v2, s[4:7], s91 offen sc1
 ds_read_b128 v[192:195], v26 offset:43008
 v_mfma_f32_16x16x32_bf16 v[76:79], v[200:203], v[248:251], v[76:79]
 v_mul_f32 v63, v63, v67
 v_cvt_pk_bf16_f32 v36, v60, v61
 v_cvt_pk_bf16_f32 v37, v62, v63
 v_mfma_f32_16x16x32_bf16 v[104:107], v[200:203], v[252:255], v[104:107]
 s_waitcnt lgkmcnt(2)
 ds_read_b128 v[196:199], v26 offset:44032
 buffer_store_dwordx4 v[34:37], v2, s[4:7], s90 offen
 v_mfma_f32_16x16x32_bf16 v[80:83], v[204:207], v[248:251], v[80:83]
 s_add_u32 s91, s78, 0x8000
 buffer_load_dwordx4 v[164:167], v2, s[4:7], s91 offen offset:1024 sc1
 v_mul_f32 v60, v172, v172
 v_mfma_f32_16x16x32_bf16 v[108:111], v[204:207], v[252:255], v[108:111]
 ds_read_b128 v[200:203], v26 offset:45056
 v_mul_f32 v61, v173, v173
 v_mfma_f32_16x16x32_bf16 v[84:87], v[208:211], v[248:251], v[84:87]
 v_mul_f32 v62, v174, v174
 v_mul_f32 v63, v175, v175
 v_mfma_f32_16x16x32_bf16 v[112:115], v[208:211], v[252:255], v[112:115]
 ds_read_b128 v[204:207], v26 offset:46080
 v_fma_f32 v60, v60, v43, v41
 v_mfma_f32_16x16x32_bf16 v[88:91], v[212:215], v[248:251], v[88:91]
 s_add_u32 s91, s78, 0xd000
 buffer_load_dwordx4 v[244:247], v2, s[4:7], s91 offen offset:1024 sc1
 v_fma_f32 v61, v61, v43, v41
 v_fma_f32 v62, v62, v43, v41
 v_mfma_f32_16x16x32_bf16 v[116:119], v[212:215], v[252:255], v[116:119]
 ds_read_b128 v[208:211], v26 offset:47104
 v_fma_f32 v63, v63, v43, v41
 v_mfma_f32_16x16x32_bf16 v[92:95], v[184:187], v[248:251], v[92:95]
 v_mul_f32 v60, v60, v172
 v_mul_f32 v61, v61, v173
 v_mfma_f32_16x16x32_bf16 v[120:123], v[184:187], v[252:255], v[120:123]
 s_waitcnt lgkmcnt(3)
 ds_read_b128 v[212:215], v26 offset:48128
 v_mul_f32 v62, v62, v174
 v_mfma_f32_16x16x32_bf16 v[96:99], v[188:191], v[248:251], v[96:99]
 v_mul_f32 v63, v63, v175
 v_exp_f32 v60, v60
 v_mfma_f32_16x16x32_bf16 v[124:127], v[188:191], v[252:255], v[124:127]
 s_waitcnt vmcnt(14)
 ds_read_b128 v[184:187], v26 offset:49152
 v_mfma_f32_16x16x32_bf16 v[72:75], v[192:195], v[216:219], v[72:75]
 s_waitcnt vmcnt(13)
 v_mul_f32 v64, v172, v176
 v_mfma_f32_16x16x32_bf16 v[100:103], v[192:195], v[220:223], v[100:103]
 s_add_u32 s91, s78, 0xd000
 buffer_load_dwordx4 v[248:251], v2, s[4:7], s91 offen offset:2048 sc1
 ds_read_b128 v[188:191], v26 offset:50176
 v_mfma_f32_16x16x32_bf16 v[76:79], v[196:199], v[216:219], v[76:79]
 v_exp_f32 v61, v61
 v_mul_f32 v65, v173, v177
 v_mfma_f32_16x16x32_bf16 v[104:107], v[196:199], v[220:223], v[104:107]
 s_waitcnt lgkmcnt(2)
 ds_read_b128 v[192:195], v26 offset:51200
 v_exp_f32 v62, v62
 v_mfma_f32_16x16x32_bf16 v[80:83], v[200:203], v[216:219], v[80:83]
 v_mul_f32 v66, v174, v178
 v_mfma_f32_16x16x32_bf16 v[108:111], v[200:203], v[220:223], v[108:111]
 s_add_u32 s91, s78, 0x8000
 ds_read_b128 v[196:199], v26 offset:52224
 buffer_load_dwordx4 v[168:171], v2, s[4:7], s91 offen offset:2048 sc1
 v_mfma_f32_16x16x32_bf16 v[84:87], v[204:207], v[216:219], v[84:87]
 v_exp_f32 v63, v63
 v_mfma_f32_16x16x32_bf16 v[112:115], v[204:207], v[220:223], v[112:115]
 ds_read_b128 v[200:203], v26 offset:53248
 v_mul_f32 v67, v175, v179
 v_mfma_f32_16x16x32_bf16 v[88:91], v[208:211], v[216:219], v[88:91]
 s_add_u32 s91, s78, 0xd000
 buffer_load_dwordx4 v[252:255], v2, s[4:7], s91 offen offset:3072 sc1
 v_fma_f32 v60, v60, v45, v45
 v_mfma_f32_16x16x32_bf16 v[116:119], v[208:211], v[220:223], v[116:119]
 ds_read_b128 v[204:207], v26 offset:54272
 v_rcp_f32 v60, v60
 v_mfma_f32_16x16x32_bf16 v[92:95], v[212:215], v[216:219], v[92:95]
 v_fma_f32 v61, v61, v45, v45
 v_mfma_f32_16x16x32_bf16 v[120:123], v[212:215], v[220:223], v[120:123]
 s_waitcnt lgkmcnt(3)
 ds_read_b128 v[208:211], v26 offset:55296
 v_rcp_f32 v61, v61
 v_mfma_f32_16x16x32_bf16 v[96:99], v[184:187], v[216:219], v[96:99]
 v_fma_f32 v62, v62, v45, v45
 v_mfma_f32_16x16x32_bf16 v[124:127], v[184:187], v[220:223], v[124:127]
 s_waitcnt vmcnt(12)
 ds_read_b128 v[212:215], v26 offset:56320
 v_rcp_f32 v62, v62
 v_cmp_gt_u32 vcc, 1, v3
 v_mfma_f32_16x16x32_bf16 v[72:75], v[188:191], v[224:227], v[72:75]
 s_cbranch_vccnz .Lps_22
.Lpb_23:
 v_fma_f32 v63, v63, v45, v45
 s_waitcnt vmcnt(11)
 v_mfma_f32_16x16x32_bf16 v[100:103], v[188:191], v[228:231], v[100:103]
 s_add_u32 s91, s78, 0xb000
 buffer_load_dwordx4 v[216:219], v2, s[4:7], s91 offen offset:2048 sc1
 v_mfma_f32_16x16x32_bf16 v[76:79], v[192:195], v[224:227], v[76:79]
 v_rcp_f32 v63, v63
 v_mul_f32 v60, v60, v64
 v_mfma_f32_16x16x32_bf16 v[104:107], v[192:195], v[228:231], v[104:107]
 s_waitcnt lgkmcnt(1)
 v_mul_f32 v61, v61, v65
 v_mul_f32 v62, v62, v66
 v_mfma_f32_16x16x32_bf16 v[80:83], v[196:199], v[224:227], v[80:83]
 v_mul_f32 v63, v63, v67
 v_cvt_pk_bf16_f32 v70, v60, v61
 v_cvt_pk_bf16_f32 v71, v62, v63
 v_mfma_f32_16x16x32_bf16 v[108:111], v[196:199], v[228:231], v[108:111]
 buffer_store_dwordx2 v[70:71], v27, s[4:7], s90 offen offset:1024
 v_mfma_f32_16x16x32_bf16 v[84:87], v[200:203], v[224:227], v[84:87]
 s_add_u32 s91, s78, 0x8000
 buffer_load_dword v3, v7, s[4:7], s66 offen sc1
 buffer_load_dwordx4 v[172:175], v2, s[4:7], s91 offen offset:3072 sc1
 v_mfma_f32_16x16x32_bf16 v[112:115], v[200:203], v[228:231], v[112:115]
 s_add_u32 s91, s78, 0x9000
 buffer_load_dwordx4 v[176:179], v2, s[4:7], s91 offen sc1
 v_mfma_f32_16x16x32_bf16 v[88:91], v[204:207], v[224:227], v[88:91]
 s_add_u32 s91, s78, 0xb000
 buffer_load_dwordx4 v[220:223], v2, s[4:7], s91 offen offset:3072 sc1
 v_mfma_f32_16x16x32_bf16 v[116:119], v[204:207], v[228:231], v[116:119]
 v_mfma_f32_16x16x32_bf16 v[92:95], v[208:211], v[224:227], v[92:95]
 v_mfma_f32_16x16x32_bf16 v[120:123], v[208:211], v[228:231], v[120:123]
 s_waitcnt lgkmcnt(0)
 v_mfma_f32_16x16x32_bf16 v[96:99], v[212:215], v[224:227], v[96:99]
 s_add_u32 s90, s75, 0x400000
 v_mfma_f32_16x16x32_bf16 v[124:127], v[212:215], v[228:231], v[124:127]
 s_add_u32 s91, s78, 0xa000
 v_add_u32 v24, s80, v2
 ds_read_b128 v[184:187], v24
 ds_read_b128 v[188:191], v24 offset:1024
 ds_read_b128 v[192:195], v24 offset:2048
 ds_read_b128 v[196:199], v24 offset:3072
 buffer_load_dwordx4 v[200:203], v2, s[4:7], s91 offen offset:2048 sc1
 s_nop 0
 v_permlane32_swap_b32 v96, v124
 v_permlane32_swap_b32 v97, v125
 v_permlane32_swap_b32 v98, v126
 v_permlane32_swap_b32 v99, v127
 v_pk_mul_f32 v[60:61], v[96:97], v[96:97]
 v_pk_mul_f32 v[62:63], v[98:99], v[98:99]
 v_pk_fma_f32 v[60:61], v[60:61], v[56:57], v[56:57] op_sel:[0,1,0] op_sel_hi:[1,1,0]
 v_pk_fma_f32 v[62:63], v[62:63], v[56:57], v[56:57] op_sel:[0,1,0] op_sel_hi:[1,1,0]
 v_pk_mul_f32 v[60:61], v[60:61], v[96:97]
 v_pk_mul_f32 v[62:63], v[62:63], v[98:99]
 v_exp_f32 v60, v60
 v_exp_f32 v61, v61
 v_exp_f32 v62, v62
 v_exp_f32 v63, v63
 s_add_u32 s91, s78, 0xa000
 buffer_load_dwordx4 v[204:207], v2, s[4:7], s91 offen offset:3072 sc1
 v_pk_mul_f32 v[64:65], v[96:97], v[124:125]
 v_pk_mul_f32 v[66:67], v[98:99], v[126:127]
 v_pk_fma_f32 v[60:61], v[60:61], v[58:59], v[58:59] op_sel:[0,0,0] op_sel_hi:[1,0,0]
 v_pk_fma_f32 v[62:63], v[62:63], v[58:59], v[58:59] op_sel:[0,0,0] op_sel_hi:[1,0,0]
 v_rcp_f32 v60, v60
 v_rcp_f32 v61, v61
 v_rcp_f32 v62, v62
 v_rcp_f32 v63, v63
 v_pk_mul_f32 v[60:61], v[60:61], v[64:65]
 s_add_u32 s91, s78, 0xb000
 buffer_load_dwordx4 v[208:211], v2, s[4:7], s91 offen sc1
 v_pk_mul_f32 v[62:63], v[62:63], v[66:67]
 v_cvt_pk_bf16_f32 v68, v60, v61
 v_cvt_pk_bf16_f32 v69, v62, v63
 buffer_store_dwordx2 v[68:69], v28, s[4:7], s90 offen offset:1536
 s_add_u32 s90, s75, 0x40e000
 v_pk_mul_f32 v[60:61], v[72:73], v[72:73]
 v_pk_mul_f32 v[62:63], v[74:75], v[74:75]
 v_pk_fma_f32 v[60:61], v[60:61], v[52:53], v[50:51] op_sel:[0,0,0] op_sel_hi:[1,0,0]
 v_pk_fma_f32 v[62:63], v[62:63], v[52:53], v[50:51] op_sel:[0,0,0] op_sel_hi:[1,0,0]
 v_pk_mul_f32 v[60:61], v[60:61], v[72:73]
 v_pk_mul_f32 v[62:63], v[62:63], v[74:75]
 v_exp_f32 v60, v60
 v_exp_f32 v61, v61
 s_add_u32 s91, s78, 0xb000
 buffer_load_dwordx4 v[212:215], v2, s[4:7], s91 offen offset:1024 sc1
 v_exp_f32 v62, v62
 v_exp_f32 v63, v63
 v_pk_mul_f32 v[64:65], v[72:73], v[76:77]
 v_pk_mul_f32 v[66:67], v[74:75], v[78:79]
 v_pk_fma_f32 v[60:61], v[60:61], v[54:55], v[54:55] op_sel:[0,0,0] op_sel_hi:[1,0,0]
 v_pk_fma_f32 v[62:63], v[62:63], v[54:55], v[54:55] op_sel:[0,0,0] op_sel_hi:[1,0,0]
 v_rcp_f32 v60, v60
 v_rcp_f32 v61, v61
 v_rcp_f32 v62, v62
 s_add_u32 s91, s78, 0xc000
 buffer_load_dwordx4 v[224:227], v2, s[4:7], s91 offen sc1
 v_rcp_f32 v63, v63
 v_pk_mul_f32 v[60:61], v[60:61], v[64:65]
 v_pk_mul_f32 v[62:63], v[62:63], v[66:67]
 v_cvt_pk_bf16_f32 v34, v60, v61
 v_cvt_pk_bf16_f32 v35, v62, v63
 v_pk_mul_f32 v[60:61], v[80:81], v[80:81]
 v_pk_mul_f32 v[62:63], v[82:83], v[82:83]
 v_pk_fma_f32 v[60:61], v[60:61], v[52:53], v[50:51] op_sel:[0,0,0] op_sel_hi:[1,0,0]
 v_pk_fma_f32 v[62:63], v[62:63], v[52:53], v[50:51] op_sel:[0,0,0] op_sel_hi:[1,0,0]
 v_pk_mul_f32 v[60:61], v[60:61], v[80:81]
 v_pk_mul_f32 v[62:63], v[62:63], v[82:83]
 v_exp_f32 v60, v60
 s_add_u32 s91, s78, 0xc000
 buffer_load_dwordx4 v[228:231], v2, s[4:7], s91 offen offset:1024 sc1
 v_exp_f32 v61, v61
 v_exp_f32 v62, v62
 v_exp_f32 v63, v63
 v_pk_mul_f32 v[64:65], v[80:81], v[84:85]
 v_pk_mul_f32 v[66:67], v[82:83], v[86:87]
 v_pk_fma_f32 v[60:61], v[60:61], v[54:55], v[54:55] op_sel:[0,0,0] op_sel_hi:[1,0,0]
 v_pk_fma_f32 v[62:63], v[62:63], v[54:55], v[54:55] op_sel:[0,0,0] op_sel_hi:[1,0,0]
 v_rcp_f32 v60, v60
 v_rcp_f32 v61, v61
 v_rcp_f32 v62, v62
 v_rcp_f32 v63, v63
 v_pk_mul_f32 v[60:61], v[60:61], v[64:65]
 v_pk_mul_f32 v[62:63], v[62:63], v[66:67]
 v_cvt_pk_bf16_f32 v36, v60, v61
 v_cvt_pk_bf16_f32 v37, v62, v63
 buffer_store_dwordx4 v[34:37], v2, s[4:7], s90 offen
 v_pk_mul_f32 v[60:61], v[88:89], v[88:89]
 v_pk_mul_f32 v[62:63], v[90:91], v[90:91]
 v_pk_fma_f32 v[60:61], v[60:61], v[52:53], v[50:51] op_sel:[0,0,0] op_sel_hi:[1,0,0]
 v_pk_fma_f32 v[62:63], v[62:63], v[52:53], v[50:51] op_sel:[0,0,0] op_sel_hi:[1,0,0]
 v_pk_mul_f32 v[60:61], v[60:61], v[88:89]
 v_pk_mul_f32 v[62:63], v[62:63], v[90:91]
 v_exp_f32 v60, v60
 v_exp_f32 v61, v61
 v_exp_f32 v62, v62
 v_exp_f32 v63, v63
 v_mov_b32 v5, 2
 s_waitcnt vmcnt(12)
 buffer_store_dword v5, off, s[4:7], s68
 s_waitcnt vmcnt(12)
 v_cmp_gt_u32 vcc, 1, v3
 s_nop 0
 s_cbranch_vccnz .Lps_24
.Lpb_25:
 s_add_u32 s85, s76, 0xe000
 buffer_load_dwordx4 v[72:75], v2, s[4:7], s85 offen sc1
 v_pk_mul_f32 v[64:65], v[88:89], v[92:93]
 v_pk_mul_f32 v[66:67], v[90:91], v[94:95]
 v_pk_fma_f32 v[60:61], v[60:61], v[54:55], v[54:55] op_sel:[0,0,0] op_sel_hi:[1,0,0]
 v_pk_fma_f32 v[62:63], v[62:63], v[54:55], v[54:55] op_sel:[0,0,0] op_sel_hi:[1,0,0]
 v_rcp_f32 v60, v60
 v_rcp_f32 v61, v61
 v_rcp_f32 v62, v62
 v_rcp_f32 v63, v63
 v_pk_mul_f32 v[60:61], v[60:61], v[64:65]
 buffer_load_dwordx4 v[76:79], v2, s[4:7], s85 offen offset:1024 sc1
 v_pk_mul_f32 v[62:63], v[62:63], v[66:67]
 v_cvt_pk_bf16_f32 v70, v60, v61
 v_cvt_pk_bf16_f32 v71, v62, v63
 buffer_store_dwordx2 v[70:71], v27, s[4:7], s90 offen offset:1024
 s_add_u32 s90, s75, 0x400000
 v_pk_mul_f32 v[60:61], v[100:101], v[100:101]
 v_pk_mul_f32 v[62:63], v[102:103], v[102:103]
 v_pk_fma_f32 v[60:61], v[60:61], v[52:53], v[50:51] op_sel:[0,1,1] op_sel_hi:[1,1,1]
 v_pk_fma_f32 v[62:63], v[62:63], v[52:53], v[50:51] op_sel:[0,1,1] op_sel_hi:[1,1,1]
 v_pk_mul_f32 v[60:61], v[60:61], v[100:101]
 v_pk_mul_f32 v[62:63], v[62:63], v[102:103]
 v_exp_f32 v60, v60
 v_exp_f32 v61, v61
 buffer_load_dwordx4 v[80:83], v2, s[4:7], s85 offen offset:2048 sc1
 v_exp_f32 v62, v62
 v_exp_f32 v63, v63
 v_pk_mul_f32 v[64:65], v[100:101], v[104:105]
 v_pk_mul_f32 v[66:67], v[102:103], v[106:107]
 v_pk_fma_f32 v[60:61], v[60:61], v[54:55], v[54:55] op_sel:[0,1,1] op_sel_hi:[1,1,1]
 v_pk_fma_f32 v[62:63], v[62:63], v[54:55], v[54:55] op_sel:[0,1,1] op_sel_hi:[1,1,1]
 v_rcp_f32 v60, v60
 v_rcp_f32 v61, v61
 v_rcp_f32 v62, v62
 buffer_load_dwordx4 v[84:87], v2, s[4:7], s85 offen offset:3072 sc1
 v_rcp_f32 v63, v63
 v_pk_mul_f32 v[60:61], v[60:61], v[64:65]
 v_pk_mul_f32 v[62:63], v[62:63], v[66:67]
 v_cvt_pk_bf16_f32 v34, v60, v61
 v_cvt_pk_bf16_f32 v35, v62, v63
 v_pk_mul_f32 v[60:61], v[108:109], v[108:109]
 v_pk_mul_f32 v[62:63], v[110:111], v[110:111]
 v_pk_fma_f32 v[60:61], v[60:61], v[52:53], v[50:51] op_sel:[0,1,1] op_sel_hi:[1,1,1]
 v_pk_fma_f32 v[62:63], v[62:63], v[52:53], v[50:51] op_sel:[0,1,1] op_sel_hi:[1,1,1]
 v_pk_mul_f32 v[60:61], v[60:61], v[108:109]
 v_pk_mul_f32 v[62:63], v[62:63], v[110:111]
 v_exp_f32 v60, v60
 s_add_u32 s85, s76, 0xf000
 buffer_load_dwordx4 v[88:91], v2, s[4:7], s85 offen sc1
 v_exp_f32 v61, v61
 v_exp_f32 v62, v62
 v_exp_f32 v63, v63
 v_pk_mul_f32 v[64:65], v[108:109], v[112:113]
 v_pk_mul_f32 v[66:67], v[110:111], v[114:115]
 v_pk_fma_f32 v[60:61], v[60:61], v[54:55], v[54:55] op_sel:[0,1,1] op_sel_hi:[1,1,1]
 v_pk_fma_f32 v[62:63], v[62:63], v[54:55], v[54:55] op_sel:[0,1,1] op_sel_hi:[1,1,1]
 v_rcp_f32 v60, v60
 v_rcp_f32 v61, v61
 buffer_load_dwordx4 v[92:95], v2, s[4:7], s85 offen offset:1024 sc1
 v_rcp_f32 v62, v62
 v_rcp_f32 v63, v63
 v_pk_mul_f32 v[60:61], v[60:61], v[64:65]
 v_pk_mul_f32 v[62:63], v[62:63], v[66:67]
 v_cvt_pk_bf16_f32 v36, v60, v61
 v_cvt_pk_bf16_f32 v37, v62, v63
 buffer_store_dwordx4 v[34:37], v2, s[4:7], s90 offen
 v_mov_b32 v5, 3
 s_waitcnt vmcnt(5)
 buffer_store_dword v5, off, s[4:7], s68
 v_pk_mul_f32 v[60:61], v[116:117], v[116:117]
 v_pk_mul_f32 v[62:63], v[118:119], v[118:119]
 v_pk_fma_f32 v[60:61], v[60:61], v[52:53], v[50:51] op_sel:[0,1,1] op_sel_hi:[1,1,1]
 v_pk_fma_f32 v[62:63], v[62:63], v[52:53], v[50:51] op_sel:[0,1,1] op_sel_hi:[1,1,1]
 buffer_load_dwordx4 v[96:99], v2, s[4:7], s85 offen offset:2048 sc1
 v_pk_mul_f32 v[60:61], v[60:61], v[116:117]
 v_pk_mul_f32 v[62:63], v[62:63], v[118:119]
 v_exp_f32 v60, v60
 v_exp_f32 v61, v61
 v_exp_f32 v62, v62
 v_exp_f32 v63, v63
 v_pk_mul_f32 v[64:65], v[116:117], v[120:121]
 v_pk_mul_f32 v[66:67], v[118:119], v[122:123]
 v_pk_fma_f32 v[60:61], v[60:61], v[54:55], v[54:55] op_sel:[0,1,1] op_sel_hi:[1,1,1]
 buffer_load_dwordx4 v[100:103], v2, s[4:7], s85 offen offset:3072 sc1
 v_pk_fma_f32 v[62:63], v[62:63], v[54:55], v[54:55] op_sel:[0,1,1] op_sel_hi:[1,1,1]
 v_rcp_f32 v60, v60
 v_rcp_f32 v61, v61
 v_rcp_f32 v62, v62
 v_rcp_f32 v63, v63
 v_pk_mul_f32 v[60:61], v[60:61], v[64:65]
 v_pk_mul_f32 v[62:63], v[62:63], v[66:67]
 v_cvt_pk_bf16_f32 v70, v60, v61
 v_cvt_pk_bf16_f32 v71, v62, v63
 buffer_store_dwordx2 v[70:71], v27, s[4:7], s90 offen offset:1024
 v_add_u32 v24, s80, v2
 v_and_b32 v8, 0x3ff, v13
 v_lshrrev_b32 v5, 11, v13
 v_lshl_add_u32 v8, v5, 10, v8
 ds_read_b128 v[36:39], v24 offset:16384
 v_mfma_f32_16x16x32_bf16 v[112:115], a[192:195], v[72:75], 0
 s_add_u32 s85, s76, 0x10000
 buffer_load_dwordx4 v[104:107], v2, s[4:7], s85 offen sc1
 v_mfma_f32_16x16x32_bf16 v[116:119], a[196:199], v[72:75], 0
 buffer_load_dword v3, v7, s[4:7], s66 offen sc1
 ds_read_b128 v[40:43], v24 offset:17408
 v_mfma_f32_16x16x32_bf16 v[120:123], a[200:203], v[72:75], 0
 s_waitcnt lgkmcnt(1)
 v_mfma_f32_16x16x32_bf16 v[124:127], v[36:39], v[72:75], 0
 v_mfma_f32_16x16x32_bf16 v[112:115], a[204:207], v[76:79], v[112:115]
 buffer_load_dwordx4 v[72:75], v2, s[4:7], s85 offen offset:1024 sc1
 v_mfma_f32_16x16x32_bf16 v[116:119], a[208:211], v[76:79], v[116:119]
 ds_read_b128 v[36:39], v24 offset:18432
 v_mfma_f32_16x16x32_bf16 v[120:123], a[212:215], v[76:79], v[120:123]
 s_waitcnt lgkmcnt(1)
 v_mfma_f32_16x16x32_bf16 v[124:127], v[40:43], v[76:79], v[124:127]
 s_waitcnt vmcnt(11)
 v_mfma_f32_16x16x32_bf16 v[112:115], a[216:219], v[80:83], v[112:115]
 buffer_load_dwordx4 v[76:79], v2, s[4:7], s85 offen offset:2048 sc1
 v_mfma_f32_16x16x32_bf16 v[116:119], a[220:223], v[80:83], v[116:119]
 ds_read_b128 v[40:43], v24 offset:19456
 v_mfma_f32_16x16x32_bf16 v[120:123], a[224:227], v[80:83], v[120:123]
 s_waitcnt lgkmcnt(1)
 v_mfma_f32_16x16x32_bf16 v[124:127], v[36:39], v[80:83], v[124:127]
 s_waitcnt vmcnt(11)
 v_mfma_f32_16x16x32_bf16 v[112:115], a[228:231], v[84:87], v[112:115]
 buffer_load_dwordx4 v[80:83], v2, s[4:7], s85 offen offset:3072 sc1
 v_mfma_f32_16x16x32_bf16 v[116:119], a[232:235], v[84:87], v[116:119]
 ds_read_b128 v[36:39], v24 offset:32768
 v_mfma_f32_16x16x32_bf16 v[120:123], a[236:239], v[84:87], v[120:123]
 s_waitcnt lgkmcnt(1)
 v_mfma_f32_16x16x32_bf16 v[124:127], v[40:43], v[84:87], v[124:127]
 s_waitcnt vmcnt(11)
 v_mfma_f32_16x16x32_bf16 v[112:115], a[240:243], v[88:91], v[112:115]
 s_add_u32 s85, s76, 0x11000
 buffer_load_dwordx4 v[84:87], v2, s[4:7], s85 offen sc1
 v_mfma_f32_16x16x32_bf16 v[116:119], a[244:247], v[88:91], v[116:119]
 ds_read_b128 v[40:43], v24 offset:33792
 v_mfma_f32_16x16x32_bf16 v[120:123], a[248:251], v[88:91], v[120:123]
 s_waitcnt lgkmcnt(1)
 v_mfma_f32_16x16x32_bf16 v[124:127], v[36:39], v[88:91], v[124:127]
 s_waitcnt vmcnt(11)
 v_mfma_f32_16x16x32_bf16 v[112:115], a[252:255], v[92:95], v[112:115]
 buffer_load_dwordx4 v[88:91], v2, s[4:7], s85 offen offset:1024 sc1
 v_mfma_f32_16x16x32_bf16 v[116:119], v[128:131], v[92:95], v[116:119]
 ds_read_b128 v[36:39], v24 offset:34816
 v_mfma_f32_16x16x32_bf16 v[120:123], v[132:135], v[92:95], v[120:123]
 s_waitcnt lgkmcnt(1)
 v_mfma_f32_16x16x32_bf16 v[124:127], v[40:43], v[92:95], v[124:127]
 s_waitcnt vmcnt(9)
 v_mfma_f32_16x16x32_bf16 v[112:115], v[136:139], v[96:99], v[112:115]
 s_waitcnt vmcnt(5)
 v_cmp_gt_u32 vcc, 2, v3
 s_nop 0
 s_cbranch_vccnz .Lps_26
.Lpb_27:
 s_add_u32 s85, s76, 0x0
 v_mfma_f32_16x16x32_bf16 v[116:119], v[140:143], v[96:99], v[116:119]
 buffer_load_dwordx4 v[92:95], v2, s[4:7], s85 offen sc1
 ds_read_b128 v[40:43], v24 offset:35840
 v_mfma_f32_16x16x32_bf16 v[120:123], v[144:147], v[96:99], v[120:123]
 s_waitcnt lgkmcnt(1)
 v_mfma_f32_16x16x32_bf16 v[124:127], v[36:39], v[96:99], v[124:127]
 v_mov_b32 v5, 4
 v_mfma_f32_16x16x32_bf16 v[112:115], v[148:151], v[100:103], v[112:115]
 buffer_store_dword v5, off, s[4:7], s68
 v_mfma_f32_16x16x32_bf16 v[116:119], v[152:155], v[100:103], v[116:119]
 buffer_load_dwordx4 v[96:99], v2, s[4:7], s85 offen offset:1024 sc1
 v_mfma_f32_16x16x32_bf16 v[120:123], v[156:159], v[100:103], v[120:123]
 s_waitcnt lgkmcnt(0)
 v_mfma_f32_16x16x32_bf16 v[124:127], v[40:43], v[100:103], v[124:127]
 v_mfma_f32_16x16x32_bf16 v[112:115], v[160:163], v[104:107], v[112:115]
 buffer_load_dwordx4 v[100:103], v2, s[4:7], s85 offen offset:2048 sc1
 v_mfma_f32_16x16x32_bf16 v[116:119], v[164:167], v[104:107], v[116:119]
 v_mfma_f32_16x16x32_bf16 v[120:123], v[168:171], v[104:107], v[120:123]
 v_mfma_f32_16x16x32_bf16 v[124:127], v[172:175], v[104:107], v[124:127]
 s_waitcnt vmcnt(8)
 v_mfma_f32_16x16x32_bf16 v[112:115], v[176:179], v[72:75], v[112:115]
 buffer_load_dwordx4 v[104:107], v2, s[4:7], s85 offen offset:3072 sc1
 v_mfma_f32_16x16x32_bf16 v[116:119], v[180:183], v[72:75], v[116:119]
 v_mfma_f32_16x16x32_bf16 v[120:123], v[184:187], v[72:75], v[120:123]
 v_mfma_f32_16x16x32_bf16 v[124:127], v[188:191], v[72:75], v[124:127]
 s_waitcnt vmcnt(8)
 v_mfma_f32_16x16x32_bf16 v[112:115], v[192:195], v[76:79], v[112:115]
 s_add_u32 s85, s76, 0x1000
 buffer_load_dwordx4 v[72:75], v2, s[4:7], s85 offen sc1
 v_mfma_f32_16x16x32_bf16 v[116:119], v[196:199], v[76:79], v[116:119]
 v_mfma_f32_16x16x32_bf16 v[120:123], v[200:203], v[76:79], v[120:123]
 v_mfma_f32_16x16x32_bf16 v[124:127], v[204:207], v[76:79], v[124:127]
 s_waitcnt vmcnt(8)
 v_mfma_f32_16x16x32_bf16 v[112:115], v[208:211], v[80:83], v[112:115]
 buffer_load_dwordx4 v[76:79], v2, s[4:7], s85 offen offset:1024 sc1
 v_mfma_f32_16x16x32_bf16 v[116:119], v[212:215], v[80:83], v[116:119]
 v_mfma_f32_16x16x32_bf16 v[120:123], v[216:219], v[80:83], v[120:123]
 v_mfma_f32_16x16x32_bf16 v[124:127], v[220:223], v[80:83], v[124:127]
 s_waitcnt vmcnt(8)
 v_mfma_f32_16x16x32_bf16 v[112:115], v[224:227], v[84:87], v[112:115]
 buffer_load_dwordx4 v[80:83], v2, s[4:7], s85 offen offset:2048 sc1
 buffer_load_dword v3, v7, s[4:7], s66 offen sc1
 v_mfma_f32_16x16x32_bf16 v[116:119], v[228:231], v[84:87], v[116:119]
 ds_read_b128 v[36:39], v24 offset:16384
 v_mfma_f32_16x16x32_bf16 v[120:123], v[232:235], v[84:87], v[120:123]
 s_barrier
 v_mfma_f32_16x16x32_bf16 v[124:127], v[236:239], v[84:87], v[124:127]
 s_waitcnt vmcnt(9)
 v_mfma_f32_16x16x32_bf16 v[112:115], v[240:243], v[88:91], v[112:115]
 buffer_load_dwordx4 v[84:87], v2, s[4:7], s85 offen offset:3072 sc1
 v_mfma_f32_16x16x32_bf16 v[116:119], v[244:247], v[88:91], v[116:119]
 v_mfma_f32_16x16x32_bf16 v[120:123], v[248:251], v[88:91], v[120:123]
 v_mfma_f32_16x16x32_bf16 v[124:127], v[252:255], v[88:91], v[124:127]
 s_waitcnt vmcnt(9)
 v_mfma_f32_16x16x32_bf16 v[60:63], a[192:195], v[92:95], 0
 s_add_u32 s85, s76, 0x2000
 buffer_load_dwordx4 v[88:91], v2, s[4:7], s85 offen sc1
 v_mfma_f32_16x16x32_bf16 v[64:67], a[196:199], v[92:95], 0
 ds_read_b128 v[40:43], v24 offset:17408
 v_mfma_f32_16x16x32_bf16 v[68:71], a[200:203], v[92:95], 0
 s_waitcnt lgkmcnt(1)
 v_mfma_f32_16x16x32_bf16 v[108:111], v[36:39], v[92:95], 0
 s_waitcnt vmcnt(8)
 v_mfma_f32_16x16x32_bf16 v[60:63], a[204:207], v[96:99], v[60:63]
 buffer_load_dwordx4 v[92:95], v2, s[4:7], s85 offen offset:1024 sc1
 v_mfma_f32_16x16x32_bf16 v[64:67], a[208:211], v[96:99], v[64:67]
 ds_write_b128 v9, v[112:115]
 v_mfma_f32_16x16x32_bf16 v[68:71], a[212:215], v[96:99], v[68:71]
 s_waitcnt lgkmcnt(1)
 ds_read_b128 v[36:39], v24 offset:18432
 v_mfma_f32_16x16x32_bf16 v[108:111], v[40:43], v[96:99], v[108:111]
 s_waitcnt vmcnt(8)
 ds_write_b128 v10, v[116:119]
 v_mfma_f32_16x16x32_bf16 v[60:63], a[216:219], v[100:103], v[60:63]
 buffer_load_dwordx4 v[96:99], v2, s[4:7], s85 offen offset:2048 sc1
 v_mfma_f32_16x16x32_bf16 v[64:67], a[220:223], v[100:103], v[64:67]
 ds_write_b128 v9, v[120:123] offset:128
 v_mfma_f32_16x16x32_bf16 v[68:71], a[224:227], v[100:103], v[68:71]
 s_waitcnt lgkmcnt(2)
 ds_read_b128 v[40:43], v24 offset:19456
 v_mfma_f32_16x16x32_bf16 v[108:111], v[36:39], v[100:103], v[108:111]
 s_waitcnt vmcnt(8)
 ds_write_b128 v10, v[124:127] offset:128
 v_mfma_f32_16x16x32_bf16 v[60:63], a[228:231], v[104:107], v[60:63]
 buffer_load_dwordx4 v[100:103], v2, s[4:7], s85 offen offset:3072 sc1
 v_mfma_f32_16x16x32_bf16 v[64:67], a[232:235], v[104:107], v[64:67]
 ds_read_b128 v[36:39], v24 offset:32768
 v_mfma_f32_16x16x32_bf16 v[68:71], a[236:239], v[104:107], v[68:71]
 s_waitcnt lgkmcnt(2)
 v_mfma_f32_16x16x32_bf16 v[108:111], v[40:43], v[104:107], v[108:111]
 s_waitcnt vmcnt(8)
 v_mfma_f32_16x16x32_bf16 v[60:63], a[240:243], v[72:75], v[60:63]
 s_add_u32 s85, s76, 0x3000
 buffer_load_dwordx4 v[104:107], v2, s[4:7], s85 offen sc1
 v_mfma_f32_16x16x32_bf16 v[64:67], a[244:247], v[72:75], v[64:67]
 ds_read_b128 v[40:43], v24 offset:33792
 v_mfma_f32_16x16x32_bf16 v[68:71], a[248:251], v[72:75], v[68:71]
 s_waitcnt lgkmcnt(1)
 v_mfma_f32_16x16x32_bf16 v[108:111], v[36:39], v[72:75], v[108:111]
 s_waitcnt vmcnt(8)
 v_mfma_f32_16x16x32_bf16 v[60:63], a[252:255], v[76:79], v[60:63]
 s_barrier
 buffer_load_dwordx4 v[72:75], v2, s[4:7], s85 offen offset:1024 sc1
 v_mfma_f32_16x16x32_bf16 v[64:67], v[128:131], v[76:79], v[64:67]
 ds_read_b128 v[44:47], v11
 ds_read_b128 v[36:39], v24 offset:34816
 v_mfma_f32_16x16x32_bf16 v[68:71], v[132:135], v[76:79], v[68:71]
 s_waitcnt lgkmcnt(2)
 ds_read_b128 v[48:51], v11 offset:4096
 v_mfma_f32_16x16x32_bf16 v[108:111], v[40:43], v[76:79], v[108:111]
 s_waitcnt vmcnt(8)
 ds_read_b128 v[52:55], v11 offset:8192
 v_mfma_f32_16x16x32_bf16 v[60:63], v[136:139], v[80:83], v[60:63]
 s_waitcnt vmcnt(7)
 ds_read_b128 v[56:59], v11 offset:12288
 v_cmp_gt_u32 vcc, 3, v3
 s_nop 0
 s_cbranch_vccnz .Lps_28
.Lpb_29:
 v_mfma_f32_16x16x32_bf16 v[64:67], v[140:143], v[80:83], v[64:67]
 s_add_u32 s85, s76, 0x40e000
 buffer_load_dwordx4 v[76:79], v2, s[4:7], s85 offen sc1
 v_mfma_f32_16x16x32_bf16 v[68:71], v[144:147], v[80:83], v[68:71]
 s_waitcnt lgkmcnt(3)
 ds_read_b128 v[40:43], v24 offset:35840
 v_mfma_f32_16x16x32_bf16 v[108:111], v[36:39], v[80:83], v[108:111]
 s_waitcnt vmcnt(7)
 v_mfma_f32_16x16x32_bf16 v[60:63], v[148:151], v[84:87], v[60:63]
 buffer_load_dwordx4 v[80:83], v2, s[4:7], s85 offen offset:1024 sc1
 v_mfma_f32_16x16x32_bf16 v[64:67], v[152:155], v[84:87], v[64:67]
 s_add_u32 s90, s71, 0xc000
 v_lshlrev_b32 v32, 16, v22
 v_and_b32 v33, 0xffff0000, v22
 v_mfma_f32_16x16x32_bf16 v[68:71], v[156:159], v[84:87], v[68:71]
 s_waitcnt lgkmcnt(0)
 v_lshlrev_b32 v34, 16, v23
 v_and_b32 v35, 0xffff0000, v23
 v_mfma_f32_16x16x32_bf16 v[108:111], v[40:43], v[84:87], v[108:111]
 s_waitcnt vmcnt(7)
 v_add_f32 v44, v44, v48
 v_add_f32 v52, v52, v56
 v_mfma_f32_16x16x32_bf16 v[60:63], v[160:163], v[88:91], v[60:63]
 buffer_load_dwordx4 v[84:87], v2, s[4:7], s85 offen offset:2048 sc1
 v_add_f32 v45, v45, v49
 v_add_f32 v53, v53, v57
 v_mfma_f32_16x16x32_bf16 v[64:67], v[164:167], v[88:91], v[64:67]
 v_add_f32 v46, v46, v50
 v_add_f32 v54, v54, v58
 v_mfma_f32_16x16x32_bf16 v[68:71], v[168:171], v[88:91], v[68:71]
 v_add_f32 v47, v47, v51
 v_add_f32 v55, v55, v59
 v_mfma_f32_16x16x32_bf16 v[108:111], v[172:175], v[88:91], v[108:111]
 s_waitcnt vmcnt(7)
 v_add_f32 v44, v44, v52
 v_add_f32 v45, v45, v53
 v_mfma_f32_16x16x32_bf16 v[60:63], v[176:179], v[92:95], v[60:63]
 buffer_load_dwordx4 v[88:91], v2, s[4:7], s85 offen offset:3072 sc1
 v_add_f32 v46, v46, v54
 v_mfma_f32_16x16x32_bf16 v[64:67], v[180:183], v[92:95], v[64:67]
 v_add_f32 v47, v47, v55
 v_add_f32 v32, v32, v44
 v_mfma_f32_16x16x32_bf16 v[68:71], v[184:187], v[92:95], v[68:71]
 v_add_f32 v33, v33, v45
 v_add_f32 v34, v34, v46
 v_add_f32 v35, v35, v47
 v_mfma_f32_16x16x32_bf16 v[108:111], v[188:191], v[92:95], v[108:111]
 s_waitcnt vmcnt(7)
 v_cvt_pk_bf16_f32 v22, v32, v33
 v_cvt_pk_bf16_f32 v23, v34, v35
 v_mfma_f32_16x16x32_bf16 v[60:63], v[192:195], v[96:99], v[60:63]
 s_add_u32 s85, s76, 0x40f000
 buffer_load_dwordx4 v[92:95], v2, s[4:7], s85 offen sc1
 v_mfma_f32_16x16x32_bf16 v[64:67], v[196:199], v[96:99], v[64:67]
 buffer_store_dwordx2 v[22:23], v8, s[4:7], s90 offen
 v_add_f32 v28, v32, v33
 v_mfma_f32_16x16x32_bf16 v[68:71], v[200:203], v[96:99], v[68:71]
 v_mul_f32 v29, v32, v32
 v_add_f32 v28, v28, v34
 v_fmac_f32 v29, v33, v33
 v_mfma_f32_16x16x32_bf16 v[108:111], v[204:207], v[96:99], v[108:111]
 s_waitcnt vmcnt(8)
 v_add_f32 v28, v28, v35
 v_fmac_f32 v29, v34, v34
 v_mfma_f32_16x16x32_bf16 v[60:63], v[208:211], v[100:103], v[60:63]
 buffer_load_dwordx4 v[96:99], v2, s[4:7], s85 offen offset:1024 sc1
 v_fmac_f32 v29, v35, v35
 v_mfma_f32_16x16x32_bf16 v[64:67], v[212:215], v[100:103], v[64:67]
 v_add_f32_dpp v28, v28, v28 row_ror:8 row_mask:0xf bank_mask:0xf
 v_mfma_f32_16x16x32_bf16 v[68:71], v[216:219], v[100:103], v[68:71]
 v_add_f32_dpp v28, v29, v29 row_ror:8 row_mask:0xf bank_mask:0xc
 v_mfma_f32_16x16x32_bf16 v[108:111], v[220:223], v[100:103], v[108:111]
 s_waitcnt vmcnt(8)
 buffer_load_dwordx4 v[100:103], v2, s[4:7], s85 offen offset:2048 sc1
 v_mfma_f32_16x16x32_bf16 v[60:63], v[224:227], v[104:107], v[60:63]
 buffer_load_dword v3, v7, s[4:7], s66 offen sc1
 v_add_f32_dpp v28, v28, v28 row_half_mirror row_mask:0xf bank_mask:0xf
 v_mfma_f32_16x16x32_bf16 v[64:67], v[228:231], v[104:107], v[64:67]
 ds_read_b128 v[36:39], v24 offset:16384
 v_add_f32_dpp v28, v28, v28 quad_perm:[1,0,3,2] row_mask:0xf bank_mask:0xf
 v_mfma_f32_16x16x32_bf16 v[68:71], v[232:235], v[104:107], v[68:71]
 s_waitcnt vmcnt(9)
 v_add_f32_dpp v28, v28, v28 quad_perm:[2,3,0,1] row_mask:0xf bank_mask:0xf
 buffer_store_dword v28, v14, s[4:7], s59 offen offset:3072
 v_mfma_f32_16x16x32_bf16 v[108:111], v[236:239], v[104:107], v[108:111]
 s_lshl_b32 s91, s49, 2
 v_mov_b32 v27, v28
 s_add_u32 s91, s91, s51
 s_lshl_b32 s88, s91, 14
 s_add_u32 s88, s88, 0x600000
 v_mfma_f32_16x16x32_bf16 v[60:63], v[240:243], v[72:75], v[60:63]
 s_cmp_eq_u32 s51, 3
 s_cselect_b32 s90, 0x2000000, s88
 buffer_store_dwordx2 v[22:23], v8, s[4:7], s90 offen
 v_mfma_f32_16x16x32_bf16 v[64:67], v[244:247], v[72:75], v[64:67]
 buffer_load_dwordx4 v[104:107], v2, s[4:7], s85 offen offset:3072 sc1
 v_mfma_f32_16x16x32_bf16 v[68:71], v[248:251], v[72:75], v[68:71]
 v_mfma_f32_16x16x32_bf16 v[108:111], v[252:255], v[72:75], v[108:111]
 s_barrier
 s_waitcnt vmcnt(11)
 v_mfma_f32_16x16x32_bf16 v[112:115], a[192:195], v[76:79], 0
 s_add_u32 s85, s76, 0x410000
 buffer_load_dwordx4 v[72:75], v2, s[4:7], s85 offen sc1
 v_mfma_f32_16x16x32_bf16 v[116:119], a[196:199], v[76:79], 0
 ds_read_b128 v[40:43], v24 offset:17408
 v_mfma_f32_16x16x32_bf16 v[120:123], a[200:203], v[76:79], 0
 s_waitcnt lgkmcnt(1)
 v_mfma_f32_16x16x32_bf16 v[124:127], v[36:39], v[76:79], 0
 s_waitcnt vmcnt(11)
 v_mfma_f32_16x16x32_bf16 v[112:115], a[204:207], v[80:83], v[112:115]
 buffer_load_dwordx4 v[76:79], v2, s[4:7], s85 offen offset:1024 sc1
 v_mfma_f32_16x16x32_bf16 v[116:119], a[208:211], v[80:83], v[116:119]
 ds_write_b128 v9, v[60:63]
 v_mfma_f32_16x16x32_bf16 v[120:123], a[212:215], v[80:83], v[120:123]
 s_waitcnt lgkmcnt(1)
 ds_read_b128 v[36:39], v24 offset:18432
 v_mfma_f32_16x16x32_bf16 v[124:127], v[40:43], v[80:83], v[124:127]
 s_waitcnt vmcnt(11)
 ds_write_b128 v10, v[64:67]
 v_mfma_f32_16x16x32_bf16 v[112:115], a[216:219], v[84:87], v[112:115]
 buffer_load_dwordx4 v[80:83], v2, s[4:7], s85 offen offset:2048 sc1
 v_mfma_f32_16x16x32_bf16 v[116:119], a[220:223], v[84:87], v[116:119]
 ds_write_b128 v9, v[68:71] offset:128
 v_mfma_f32_16x16x32_bf16 v[120:123], a[224:227], v[84:87], v[120:123]
 s_waitcnt lgkmcnt(2)
 ds_read_b128 v[40:43], v24 offset:19456
 v_mfma_f32_16x16x32_bf16 v[124:127], v[36:39], v[84:87], v[124:127]
 s_waitcnt vmcnt(11)
 ds_write_b128 v10, v[108:111] offset:128
 v_mfma_f32_16x16x32_bf16 v[112:115], a[228:231], v[88:91], v[112:115]
 buffer_load_dwordx4 v[84:87], v2, s[4:7], s85 offen offset:3072 sc1
 v_mfma_f32_16x16x32_bf16 v[116:119], a[232:235], v[88:91], v[116:119]
 ds_read_b128 v[36:39], v24 offset:32768
 v_mfma_f32_16x16x32_bf16 v[120:123], a[236:239], v[88:91], v[120:123]
 s_waitcnt lgkmcnt(2)
 v_mfma_f32_16x16x32_bf16 v[124:127], v[40:43], v[88:91], v[124:127]
 s_waitcnt vmcnt(11)
 v_mfma_f32_16x16x32_bf16 v[112:115], a[240:243], v[92:95], v[112:115]
 s_waitcnt vmcnt(5)
 v_mov_b32 v5, 1
 v_mfma_f32_16x16x32_bf16 v[116:119], a[244:247], v[92:95], v[116:119]
 s_add_u32 s85, s76, 0x411000
 buffer_store_dword v5, off, s[4:7], s67
 buffer_load_dwordx4 v[88:91], v2, s[4:7], s85 offen sc1
 v_mfma_f32_16x16x32_bf16 v[120:123], a[248:251], v[92:95], v[120:123]
 s_waitcnt lgkmcnt(0)
 ds_read_b128 v[40:43], v24 offset:33792
 v_mfma_f32_16x16x32_bf16 v[124:127], v[36:39], v[92:95], v[124:127]
 v_mfma_f32_16x16x32_bf16 v[112:115], a[252:255], v[96:99], v[112:115]
 s_barrier
 buffer_load_dwordx4 v[92:95], v2, s[4:7], s85 offen offset:1024 sc1
 v_mfma_f32_16x16x32_bf16 v[116:119], v[128:131], v[96:99], v[116:119]
 ds_read_b128 v[44:47], v11
 ds_read_b128 v[36:39], v24 offset:34816
 v_mfma_f32_16x16x32_bf16 v[120:123], v[132:135], v[96:99], v[120:123]
 s_waitcnt lgkmcnt(2)
 ds_read_b128 v[48:51], v11 offset:4096
 ds_read_b128 v[52:55], v11 offset:8192
 v_mfma_f32_16x16x32_bf16 v[124:127], v[40:43], v[96:99], v[124:127]
 ds_read_b128 v[56:59], v11 offset:12288
 v_cmp_gt_u32 vcc, 4, v3
 v_mfma_f32_16x16x32_bf16 v[112:115], v[136:139], v[100:103], v[112:115]
 s_cbranch_vccnz .Lps_30
.Lpb_31:
 s_add_u32 s85, s76, 0x400000
 buffer_load_dwordx4 v[96:99], v2, s[4:7], s85 offen sc1
 v_mfma_f32_16x16x32_bf16 v[116:119], v[140:143], v[100:103], v[116:119]
 ds_read_b128 v[40:43], v24 offset:35840
 v_mfma_f32_16x16x32_bf16 v[120:123], v[144:147], v[100:103], v[120:123]
 s_waitcnt lgkmcnt(4)
 v_mfma_f32_16x16x32_bf16 v[124:127], v[36:39], v[100:103], v[124:127]
 s_waitcnt vmcnt(8)
 v_mfma_f32_16x16x32_bf16 v[112:115], v[148:151], v[104:107], v[112:115]
 buffer_load_dwordx4 v[100:103], v2, s[4:7], s85 offen offset:1024 sc1
 v_mfma_f32_16x16x32_bf16 v[116:119], v[152:155], v[104:107], v[116:119]
 s_add_u32 s90, s71, 0x8000
 v_lshlrev_b32 v32, 16, v20
 v_and_b32 v33, 0xffff0000, v20
 v_mfma_f32_16x16x32_bf16 v[120:123], v[156:159], v[104:107], v[120:123]
 s_waitcnt lgkmcnt(0)
 v_lshlrev_b32 v34, 16, v21
 v_and_b32 v35, 0xffff0000, v21
 v_mfma_f32_16x16x32_bf16 v[124:127], v[40:43], v[104:107], v[124:127]
 s_waitcnt vmcnt(8)
 v_add_f32 v44, v44, v48
 v_add_f32 v52, v52, v56
 v_mfma_f32_16x16x32_bf16 v[112:115], v[160:163], v[72:75], v[112:115]
 buffer_load_dwordx4 v[104:107], v2, s[4:7], s85 offen offset:2048 sc1
 v_add_f32 v45, v45, v49
 v_mfma_f32_16x16x32_bf16 v[116:119], v[164:167], v[72:75], v[116:119]
 v_add_f32 v53, v53, v57
 v_add_f32 v46, v46, v50
 v_mfma_f32_16x16x32_bf16 v[120:123], v[168:171], v[72:75], v[120:123]
 v_add_f32 v54, v54, v58
 v_add_f32 v47, v47, v51
 v_mfma_f32_16x16x32_bf16 v[124:127], v[172:175], v[72:75], v[124:127]
 s_waitcnt vmcnt(8)
 v_add_f32 v55, v55, v59
 v_add_f32 v44, v44, v52
 v_mfma_f32_16x16x32_bf16 v[112:115], v[176:179], v[76:79], v[112:115]
 buffer_load_dwordx4 v[72:75], v2, s[4:7], s85 offen offset:3072 sc1
 v_add_f32 v45, v45, v53
 v_mfma_f32_16x16x32_bf16 v[116:119], v[180:183], v[76:79], v[116:119]
 v_add_f32 v46, v46, v54
 v_add_f32 v47, v47, v55
 v_mfma_f32_16x16x32_bf16 v[120:123], v[184:187], v[76:79], v[120:123]
 v_add_f32 v32, v32, v44
 v_add_f32 v33, v33, v45
 v_mfma_f32_16x16x32_bf16 v[124:127], v[188:191], v[76:79], v[124:127]
 s_waitcnt vmcnt(8)
 v_add_f32 v34, v34, v46
 v_add_f32 v35, v35, v47
 v_mfma_f32_16x16x32_bf16 v[112:115], v[192:195], v[80:83], v[112:115]
 s_add_u32 s85, s76, 0x401000
 buffer_load_dwordx4 v[76:79], v2, s[4:7], s85 offen sc1
 v_mfma_f32_16x16x32_bf16 v[116:119], v[196:199], v[80:83], v[116:119]
 v_cvt_pk_bf16_f32 v20, v32, v33
 v_cvt_pk_bf16_f32 v21, v34, v35
 v_mfma_f32_16x16x32_bf16 v[120:123], v[200:203], v[80:83], v[120:123]
 buffer_store_dwordx2 v[20:21], v8, s[4:7], s90 offen
 v_mfma_f32_16x16x32_bf16 v[124:127], v[204:207], v[80:83], v[124:127]
 s_waitcnt vmcnt(9)
 v_add_f32 v28, v32, v33
 v_mul_f32 v29, v32, v32
 v_add_f32 v28, v28, v34
 v_mfma_f32_16x16x32_bf16 v[112:115], v[208:211], v[84:87], v[112:115]
 buffer_load_dword v3, v6, s[4:7], s63 offen sc1
 buffer_load_dwordx4 v[80:83], v2, s[4:7], s85 offen offset:1024 sc1
 v_mfma_f32_16x16x32_bf16 v[116:119], v[212:215], v[84:87], v[116:119]
 v_fmac_f32 v29, v33, v33
 v_add_f32 v28, v28, v35
 v_mfma_f32_16x16x32_bf16 v[120:123], v[216:219], v[84:87], v[120:123]
 v_fmac_f32 v29, v34, v34
 v_fmac_f32 v29, v35, v35
 v_mfma_f32_16x16x32_bf16 v[124:127], v[220:223], v[84:87], v[124:127]
 s_waitcnt vmcnt(9)
 v_add_f32_dpp v28, v28, v28 row_ror:8 row_mask:0xf bank_mask:0xf
 v_mfma_f32_16x16x32_bf16 v[112:115], v[224:227], v[88:91], v[112:115]
 buffer_load_dwordx4 v[84:87], v2, s[4:7], s85 offen offset:2048 sc1
 v_add_f32_dpp v28, v29, v29 row_ror:8 row_mask:0xf bank_mask:0xc
 v_mfma_f32_16x16x32_bf16 v[116:119], v[228:231], v[88:91], v[116:119]
 ds_read_b128 v[36:39], v24 offset:16384
 v_add_f32_dpp v28, v28, v28 row_half_mirror row_mask:0xf bank_mask:0xf
 v_mfma_f32_16x16x32_bf16 v[120:123], v[232:235], v[88:91], v[120:123]
 v_mfma_f32_16x16x32_bf16 v[124:127], v[236:239], v[88:91], v[124:127]
 s_waitcnt vmcnt(9)
 v_add_f32_dpp v28, v28, v28 quad_perm:[1,0,3,2] row_mask:0xf bank_mask:0xf
 s_nop 1
 v_add_f32_dpp v28, v28, v28 quad_perm:[2,3,0,1] row_mask:0xf bank_mask:0xf
 v_mfma_f32_16x16x32_bf16 v[112:115], v[240:243], v[92:95], v[112:115]
 buffer_store_dword v28, v14, s[4:7], s59 offen offset:2048
 v_mfma_f32_16x16x32_bf16 v[116:119], v[244:247], v[92:95], v[116:119]
 buffer_load_dwordx4 v[88:91], v2, s[4:7], s85 offen offset:3072 sc1
 v_mfma_f32_16x16x32_bf16 v[120:123], v[248:251], v[92:95], v[120:123]
 v_mfma_f32_16x16x32_bf16 v[124:127], v[252:255], v[92:95], v[124:127]
 s_barrier
 s_waitcnt vmcnt(10)
 v_mfma_f32_16x16x32_bf16 v[60:63], a[192:195], v[96:99], 0
 s_add_u32 s85, s76, 0x402000
 buffer_load_dwordx4 v[92:95], v2, s[4:7], s85 offen sc1
 v_mfma_f32_16x16x32_bf16 v[64:67], a[196:199], v[96:99], 0
 ds_read_b128 v[40:43], v24 offset:17408
 v_mfma_f32_16x16x32_bf16 v[68:71], a[200:203], v[96:99], 0
 s_waitcnt lgkmcnt(1)
 v_mfma_f32_16x16x32_bf16 v[108:111], v[36:39], v[96:99], 0
 s_waitcnt vmcnt(10)
 v_mfma_f32_16x16x32_bf16 v[60:63], a[204:207], v[100:103], v[60:63]
 buffer_load_dwordx4 v[96:99], v2, s[4:7], s85 offen offset:1024 sc1
 v_mfma_f32_16x16x32_bf16 v[64:67], a[208:211], v[100:103], v[64:67]
 ds_write_b128 v9, v[112:115]
 v_mfma_f32_16x16x32_bf16 v[68:71], a[212:215], v[100:103], v[68:71]
 s_waitcnt lgkmcnt(1)
 ds_read_b128 v[36:39], v24 offset:18432
 v_mfma_f32_16x16x32_bf16 v[108:111], v[40:43], v[100:103], v[108:111]
 s_waitcnt vmcnt(10)
 ds_write_b128 v10, v[116:119]
 v_mfma_f32_16x16x32_bf16 v[60:63], a[216:219], v[104:107], v[60:63]
 buffer_load_dwordx4 v[100:103], v2, s[4:7], s85 offen offset:2048 sc1
 v_mfma_f32_16x16x32_bf16 v[64:67], a[220:223], v[104:107], v[64:67]
 ds_write_b128 v9, v[120:123] offset:128
 v_mfma_f32_16x16x32_bf16 v[68:71], a[224:227], v[104:107], v[68:71]
 s_waitcnt lgkmcnt(2)
 ds_read_b128 v[40:43], v24 offset:19456
 v_mfma_f32_16x16x32_bf16 v[108:111], v[36:39], v[104:107], v[108:111]
 s_waitcnt vmcnt(10)
 ds_write_b128 v10, v[124:127] offset:128
 v_mfma_f32_16x16x32_bf16 v[60:63], a[228:231], v[72:75], v[60:63]
 buffer_load_dwordx4 v[104:107], v2, s[4:7], s85 offen offset:3072 sc1
 v_mfma_f32_16x16x32_bf16 v[64:67], a[232:235], v[72:75], v[64:67]
 ds_read_b128 v[36:39], v24 offset:32768
 v_mfma_f32_16x16x32_bf16 v[68:71], a[236:239], v[72:75], v[68:71]
 s_waitcnt lgkmcnt(2)
 v_mfma_f32_16x16x32_bf16 v[108:111], v[40:43], v[72:75], v[108:111]
 s_lshl_b32 s57, s48, 12
 s_add_u32 s57, s57, s71
 s_add_u32 s89, s57, 0xc000
 s_waitcnt vmcnt(8)
 v_cmp_gt_u32 vcc, 1, v3
 s_nop 0
 s_cbranch_vccnz .Lps_32
.Lpb_33:
 s_waitcnt lgkmcnt(0)
 v_mfma_f32_16x16x32_bf16 v[60:63], a[240:243], v[76:79], v[60:63]
 s_waitcnt vmcnt(5)
 v_mov_b32 v5, 2
 buffer_store_dword v5, off, s[4:7], s67
 s_add_u32 m0, s80, 16384
 v_xor_b32 v25, 16, v15
 v_mfma_f32_16x16x32_bf16 v[64:67], a[244:247], v[76:79], v[64:67]
 s_add_u32 s85, s76, 0x403000
 buffer_load_dwordx4 v15, s[4:7], s89 offen sc1 lds
 v_mfma_f32_16x16x32_bf16 v[68:71], a[248:251], v[76:79], v[68:71]
 buffer_load_dwordx4 v[72:75], v2, s[4:7], s85 offen sc1
 ds_read_b128 v[40:43], v24 offset:33792
 v_mfma_f32_16x16x32_bf16 v[108:111], v[36:39], v[76:79], v[108:111]
 buffer_load_dwordx4 v25, s[4:7], s89 offen offset:1024 sc1 lds
 v_xor_b32 v26, 32, v15
 v_mfma_f32_16x16x32_bf16 v[60:63], a[252:255], v[80:83], v[60:63]
 s_barrier
 buffer_load_dwordx4 v[76:79], v2, s[4:7], s85 offen offset:1024 sc1
 v_mfma_f32_16x16x32_bf16 v[64:67], v[128:131], v[80:83], v[64:67]
 ds_read_b128 v[44:47], v11
 ds_read_b128 v[36:39], v24 offset:34816
 v_mfma_f32_16x16x32_bf16 v[68:71], v[132:135], v[80:83], v[68:71]
 s_waitcnt lgkmcnt(2)
 ds_read_b128 v[48:51], v11 offset:4096
 buffer_load_dwordx4 v26, s[4:7], s89 offen offset:2048 sc1 lds
 v_xor_b32 v25, 48, v15
 v_mfma_f32_16x16x32_bf16 v[108:111], v[40:43], v[80:83], v[108:111]
 ds_read_b128 v[52:55], v11 offset:8192
 v_mfma_f32_16x16x32_bf16 v[60:63], v[136:139], v[84:87], v[60:63]
 ds_read_b128 v[56:59], v11 offset:12288
 v_mfma_f32_16x16x32_bf16 v[64:67], v[140:143], v[84:87], v[64:67]
 buffer_load_dwordx4 v25, s[4:7], s89 offen offset:3072 sc1 lds
 ds_read_b128 v[40:43], v24 offset:35840
 v_mfma_f32_16x16x32_bf16 v[68:71], v[144:147], v[84:87], v[68:71]
 s_waitcnt lgkmcnt(4)
 v_mfma_f32_16x16x32_bf16 v[108:111], v[36:39], v[84:87], v[108:111]
 s_waitcnt vmcnt(11)
 v_mfma_f32_16x16x32_bf16 v[60:63], v[148:151], v[88:91], v[60:63]
 v_mfma_f32_16x16x32_bf16 v[64:67], v[152:155], v[88:91], v[64:67]
 s_add_u32 s90, s71, 0x4000
 v_lshlrev_b32 v32, 16, v18
 v_and_b32 v33, 0xffff0000, v18
 v_mfma_f32_16x16x32_bf16 v[68:71], v[156:159], v[88:91], v[68:71]
 s_waitcnt lgkmcnt(0)
 v_lshlrev_b32 v34, 16, v19
 v_and_b32 v35, 0xffff0000, v19
 v_mfma_f32_16x16x32_bf16 v[108:111], v[40:43], v[88:91], v[108:111]
 s_waitcnt vmcnt(10)
 v_add_f32 v44, v44, v48
 v_add_f32 v52, v52, v56
 v_add_f32 v45, v45, v49
 v_mfma_f32_16x16x32_bf16 v[60:63], v[160:163], v[92:95], v[60:63]
 v_add_f32 v53, v53, v57
 v_add_f32 v46, v46, v50
 v_mfma_f32_16x16x32_bf16 v[64:67], v[164:167], v[92:95], v[64:67]
 v_add_f32 v54, v54, v58
 v_add_f32 v47, v47, v51
 v_mfma_f32_16x16x32_bf16 v[68:71], v[168:171], v[92:95], v[68:71]
 v_add_f32 v55, v55, v59
 v_add_f32 v44, v44, v52
 v_add_f32 v45, v45, v53
 v_mfma_f32_16x16x32_bf16 v[108:111], v[172:175], v[92:95], v[108:111]
 s_waitcnt vmcnt(9)
 v_add_f32 v46, v46, v54
 v_add_f32 v47, v47, v55
 v_mfma_f32_16x16x32_bf16 v[60:63], v[176:179], v[96:99], v[60:63]
 v_add_f32 v32, v32, v44
 v_add_f32 v33, v33, v45
 v_add_f32 v34, v34, v46
 v_mfma_f32_16x16x32_bf16 v[64:67], v[180:183], v[96:99], v[64:67]
 v_add_f32 v35, v35, v47
 v_cvt_pk_bf16_f32 v18, v32, v33
 v_cvt_pk_bf16_f32 v19, v34, v35
 v_mfma_f32_16x16x32_bf16 v[68:71], v[184:187], v[96:99], v[68:71]
 buffer_store_dwordx2 v[18:19], v8, s[4:7], s90 offen
 v_mfma_f32_16x16x32_bf16 v[108:111], v[188:191], v[96:99], v[108:111]
 s_waitcnt vmcnt(9)
 v_add_f32 v28, v32, v33
 v_mul_f32 v29, v32, v32
 v_mfma_f32_16x16x32_bf16 v[60:63], v[192:195], v[100:103], v[60:63]
 v_add_f32 v28, v28, v34
 v_fmac_f32 v29, v33, v33
 v_mfma_f32_16x16x32_bf16 v[64:67], v[196:199], v[100:103], v[64:67]
 v_add_f32 v28, v28, v35
 v_fmac_f32 v29, v34, v34
 v_mfma_f32_16x16x32_bf16 v[68:71], v[200:203], v[100:103], v[68:71]
 v_fmac_f32 v29, v35, v35
 v_add_f32_dpp v28, v28, v28 row_ror:8 row_mask:0xf bank_mask:0xf
 v_mfma_f32_16x16x32_bf16 v[108:111], v[204:207], v[100:103], v[108:111]
 s_waitcnt vmcnt(8)
 v_add_f32_dpp v28, v29, v29 row_ror:8 row_mask:0xf bank_mask:0xc
 v_mfma_f32_16x16x32_bf16 v[60:63], v[208:211], v[104:107], v[60:63]
 buffer_load_dword v3, v6, s[4:7], s63 offen sc1
 v_add_f32_dpp v28, v28, v28 row_half_mirror row_mask:0xf bank_mask:0xf
 v_mfma_f32_16x16x32_bf16 v[64:67], v[212:215], v[104:107], v[64:67]
 s_nop 0
 v_add_f32_dpp v28, v28, v28 quad_perm:[1,0,3,2] row_mask:0xf bank_mask:0xf
 s_nop 1
 v_add_f32_dpp v28, v28, v28 quad_perm:[2,3,0,1] row_mask:0xf bank_mask:0xf
 v_mfma_f32_16x16x32_bf16 v[68:71], v[216:219], v[104:107], v[68:71]
 buffer_store_dword v28, v14, s[4:7], s59 offen offset:1024
 v_mfma_f32_16x16x32_bf16 v[108:111], v[220:223], v[104:107], v[108:111]
 s_waitcnt vmcnt(7)
 v_mfma_f32_16x16x32_bf16 v[60:63], v[224:227], v[72:75], v[60:63]
 s_lshl_b32 s87, s91, 10
 s_add_u32 s87, s87, 0x8a0000
 v_mfma_f32_16x16x32_bf16 v[64:67], v[228:231], v[72:75], v[64:67]
 s_cmp_eq_u32 s51, 3
 s_cselect_b32 s86, s88, 0x2000000
 buffer_store_dwordx2 v[22:23], v8, s[4:7], s86 offen sc1
 v_mfma_f32_16x16x32_bf16 v[68:71], v[232:235], v[72:75], v[68:71]
 s_cselect_b32 s87, s87, 0x2000000
 buffer_store_dword v27, v14, s[4:7], s87 offen sc1
 v_mfma_f32_16x16x32_bf16 v[108:111], v[236:239], v[72:75], v[108:111]
 s_waitcnt vmcnt(7)
 s_cselect_b32 s91, s67, 0x2000000
 v_mfma_f32_16x16x32_bf16 v[60:63], v[240:243], v[76:79], v[60:63]
 v_mfma_f32_16x16x32_bf16 v[64:67], v[244:247], v[76:79], v[64:67]
 v_mfma_f32_16x16x32_bf16 v[68:71], v[248:251], v[76:79], v[68:71]
 v_mfma_f32_16x16x32_bf16 v[108:111], v[252:255], v[76:79], v[108:111]
 s_waitcnt vmcnt(5)
 s_barrier
 s_lshl_b32 s58, s48, 12
 s_add_u32 s58, s58, s88
 s_sub_u32 s58, s58, 16384
 s_cmp_eq_u32 s55, 1
 s_cselect_b32 s58, s57, s58
.Lloop:
 v_and_b32 v24, 15, v1
 v_lshrrev_b32 v25, 4, v1
 v_xor_b32 v26, v25, v24
 v_lshlrev_b32 v26, 4, v26
 v_lshl_add_u32 v26, v24, 10, v26
 v_add_u32 v30, 114688, v26
 v_xor_b32 v31, 64, v30
 v_xor_b32 v32, 128, v30
 v_xor_b32 v33, 192, v30
 ds_read_b128 v[216:219], v30 offset:16384
 ds_read_b128 v[220:223], v31 offset:16384
 ds_read_b128 v[224:227], v32 offset:16384
 ds_read_b128 v[228:231], v33 offset:16384
 ds_write_b128 v9, v[60:63]
 ds_write_b128 v10, v[64:67]
 ds_write_b128 v9, v[68:71] offset:128
 ds_write_b128 v10, v[108:111] offset:128
 buffer_load_dwordx4 v[208:211], v2, s[4:7], s59 offen offset:3072 sc1
 ds_read_b128 v[232:235], v30 offset:16640
 s_waitcnt lgkmcnt(8)
 v_mfma_f32_16x16x32_bf16 v[112:115], a[0:3], v[216:219], 0
 v_mfma_f32_16x16x32_bf16 v[116:119], a[64:67], v[216:219], 0
 s_waitcnt vmcnt(4)
 v_cmp_gt_u32 vcc, 2, v3
 v_mfma_f32_16x16x32_bf16 v[120:123], a[128:131], v[216:219], 0
 s_add_u32 s87, s57, 0x8000
 s_cbranch_vccnz .Lps_36
.Lpb_37:
 s_add_u32 m0, s80, 32768
 s_nop 0
 buffer_load_dwordx4 v15, s[4:7], s87 offen sc1 lds
 ds_read_b128 v[236:239], v31 offset:16640
 v_xor_b32 v27, 16, v15
 s_waitcnt lgkmcnt(8)
 v_mfma_f32_16x16x32_bf16 v[112:115], a[4:7], v[220:223], v[112:115]
 v_mfma_f32_16x16x32_bf16 v[116:119], a[68:71], v[220:223], v[116:119]
 v_mfma_f32_16x16x32_bf16 v[120:123], a[132:135], v[220:223], v[120:123]
 s_waitcnt lgkmcnt(6)
 buffer_load_dwordx4 v27, s[4:7], s87 offen offset:1024 sc1 lds
 ds_read_b128 v[216:219], v32 offset:16640
 v_mfma_f32_16x16x32_bf16 v[112:115], a[8:11], v[224:227], v[112:115]
 s_waitcnt vmcnt(5)
 v_xor_b32 v28, 32, v15
 v_mov_b32 v5, 3
 v_mfma_f32_16x16x32_bf16 v[116:119], a[72:75], v[224:227], v[116:119]
 buffer_store_dword v5, off, s[4:7], s67
 v_mfma_f32_16x16x32_bf16 v[120:123], a[136:139], v[224:227], v[120:123]
 s_waitcnt lgkmcnt(2)
 buffer_load_dwordx4 v28, s[4:7], s87 offen offset:2048 sc1 lds
 v_xor_b32 v27, 48, v15
 v_mfma_f32_16x16x32_bf16 v[112:115], a[12:15], v[228:231], v[112:115]
 s_barrier
 ds_read_b128 v[220:223], v33 offset:16640
 ds_read_b128 v[44:47], v11
 v_mfma_f32_16x16x32_bf16 v[116:119], a[76:79], v[228:231], v[116:119]
 ds_read_b128 v[48:51], v11 offset:4096
 buffer_load_dwordx4 v27, s[4:7], s87 offen offset:3072 sc1 lds
 v_mfma_f32_16x16x32_bf16 v[120:123], a[140:143], v[228:231], v[120:123]
 ds_read_b128 v[52:55], v11 offset:8192
 ds_read_b128 v[224:227], v30 offset:16896
 v_mfma_f32_16x16x32_bf16 v[112:115], a[16:19], v[232:235], v[112:115]
 ds_read_b128 v[56:59], v11 offset:12288
 v_mfma_f32_16x16x32_bf16 v[116:119], a[80:83], v[232:235], v[116:119]
 s_waitcnt lgkmcnt(6)
 v_lshlrev_b32 v29, 4, v25
 v_mfma_f32_16x16x32_bf16 v[120:123], a[144:147], v[232:235], v[120:123]
 s_lshl_b32 s90, s48, 8
 s_add_u32 s90, s90, s79
 buffer_load_dwordx4 v[192:195], v29, s[4:7], s90 offen offset:512 sc1
 v_mfma_f32_16x16x32_bf16 v[112:115], a[20:23], v[236:239], v[112:115]
 ds_read_b128 v[228:231], v31 offset:16896
 v_mfma_f32_16x16x32_bf16 v[116:119], a[84:87], v[236:239], v[116:119]
 buffer_load_dwordx4 v[196:199], v29, s[4:7], s90 offen offset:576 sc1
 v_mfma_f32_16x16x32_bf16 v[120:123], a[148:151], v[236:239], v[120:123]
 ds_read_b128 v[232:235], v32 offset:16896
 v_lshlrev_b32 v36, 16, v16
 v_mfma_f32_16x16x32_bf16 v[112:115], a[24:27], v[216:219], v[112:115]
 s_waitcnt lgkmcnt(2)
 v_and_b32 v37, 0xffff0000, v16
 v_lshlrev_b32 v38, 16, v17
 v_and_b32 v39, 0xffff0000, v17
 v_mfma_f32_16x16x32_bf16 v[116:119], a[88:91], v[216:219], v[116:119]
 s_waitcnt lgkmcnt(4)
 v_add_f32 v44, v44, v48
 v_add_f32 v52, v52, v56
 v_add_f32 v45, v45, v49
 v_mfma_f32_16x16x32_bf16 v[120:123], a[152:155], v[216:219], v[120:123]
 buffer_load_dwordx4 v[200:203], v29, s[4:7], s90 offen offset:640 sc1
 ds_read_b128 v[236:239], v33 offset:16896
 v_add_f32 v53, v53, v57
 v_mfma_f32_16x16x32_bf16 v[112:115], a[28:31], v[220:223], v[112:115]
 v_add_f32 v46, v46, v50
 v_add_f32 v54, v54, v58
 v_add_f32 v47, v47, v51
 v_mfma_f32_16x16x32_bf16 v[116:119], a[92:95], v[220:223], v[116:119]
 v_add_f32 v55, v55, v59
 v_add_f32 v44, v44, v52
 v_add_f32 v45, v45, v53
 v_mfma_f32_16x16x32_bf16 v[120:123], a[156:159], v[220:223], v[120:123]
 ds_read_b128 v[216:219], v30 offset:17152
 v_add_f32 v46, v46, v54
 v_add_f32 v47, v47, v55
 v_mfma_f32_16x16x32_bf16 v[112:115], a[32:35], v[224:227], v[112:115]
 v_add_f32 v36, v36, v44
 v_add_f32 v37, v37, v45
 v_add_f32 v38, v38, v46
 v_mfma_f32_16x16x32_bf16 v[116:119], a[96:99], v[224:227], v[116:119]
 v_add_f32 v39, v39, v47
 v_cvt_pk_bf16_f32 v16, v36, v37
 v_cvt_pk_bf16_f32 v17, v38, v39
 v_mfma_f32_16x16x32_bf16 v[120:123], a[160:163], v[224:227], v[120:123]
 s_waitcnt lgkmcnt(1)
 ds_read_b128 v[220:223], v31 offset:17152
 buffer_store_dwordx2 v[16:17], v8, s[4:7], s71 offen
 v_mfma_f32_16x16x32_bf16 v[112:115], a[36:39], v[228:231], v[112:115]
 v_add_f32 v40, v36, v37
 v_mul_f32 v41, v36, v36
 v_add_f32 v40, v40, v38
 v_mfma_f32_16x16x32_bf16 v[116:119], a[100:103], v[228:231], v[116:119]
 buffer_load_dword v3, v6, s[4:7], s63 offen sc1
 v_fmac_f32 v41, v37, v37
 v_add_f32 v40, v40, v39
 v_mfma_f32_16x16x32_bf16 v[120:123], a[164:167], v[228:231], v[120:123]
 ds_read_b128 v[224:227], v32 offset:17152
 v_fmac_f32 v41, v38, v38
 v_mfma_f32_16x16x32_bf16 v[112:115], a[40:43], v[232:235], v[112:115]
 v_fmac_f32 v41, v39, v39
 v_add_f32_dpp v40, v40, v40 row_ror:8 row_mask:0xf bank_mask:0xf
 v_mfma_f32_16x16x32_bf16 v[116:119], a[104:107], v[232:235], v[116:119]
 v_add_f32_dpp v40, v41, v41 row_ror:8 row_mask:0xf bank_mask:0xc
 v_mfma_f32_16x16x32_bf16 v[120:123], a[168:171], v[232:235], v[120:123]
 ds_read_b128 v[228:231], v33 offset:17152
 v_add_f32_dpp v40, v40, v40 row_half_mirror row_mask:0xf bank_mask:0xf
 s_nop 1
 v_add_f32_dpp v40, v40, v40 quad_perm:[1,0,3,2] row_mask:0xf bank_mask:0xf
 s_nop 1
 v_add_f32_dpp v40, v40, v40 quad_perm:[2,3,0,1] row_mask:0xf bank_mask:0xf
 v_mfma_f32_16x16x32_bf16 v[112:115], a[44:47], v[236:239], v[112:115]
 buffer_store_dword v40, v14, s[4:7], s59 offen
 v_mfma_f32_16x16x32_bf16 v[116:119], a[108:111], v[236:239], v[116:119]
 s_waitcnt vmcnt(11)
 buffer_load_dwordx4 v[204:207], v2, s[4:7], s59 offen offset:2048 sc1
 v_add_f32 v35, v208, v210
 v_add_f32 v36, v209, v211
 v_mfma_f32_16x16x32_bf16 v[120:123], a[172:175], v[236:239], v[120:123]
 s_waitcnt lgkmcnt(1)
 v_lshlrev_b32 v94, 2, v25
 v_permlane32_swap_b32 v35, v36
 v_add_f32 v35, v35, v36
 v_mfma_f32_16x16x32_bf16 v[112:115], a[48:51], v[216:219], v[112:115]
 v_sub_u32 v94, v94, v24
 v_mov_b32 v26, v35
 v_mov_b32 v95, 0x3f80
 v_sub_u32 v42, 0, v94
 v_mfma_f32_16x16x32_bf16 v[116:119], a[112:115], v[216:219], v[116:119]
 v_lshlrev_b32 v43, 4, v42
 v_permlane16_swap_b32 v35, v26
 v_lshlrev_b32 v92, v43, v95
 v_mfma_f32_16x16x32_bf16 v[120:123], a[176:179], v[216:219], v[120:123]
 s_waitcnt vmcnt(7) lgkmcnt(0)
 s_barrier
 ds_read_b128 v[232:235], v30 offset:32768
 ds_read_b128 v[236:239], v31 offset:32768
 v_mfma_f32_16x16x32_bf16 v[112:115], a[52:55], v[220:223], v[112:115]
 v_add_f32 v35, v35, v26
 v_lshrrev_b32 v42, 1, v42
 v_mov_b32 v36, v35
 v_mfma_f32_16x16x32_bf16 v[116:119], a[116:119], v[220:223], v[116:119]
 v_min_u32 v42, 1, v42
 v_add_u32 v42, -1, v42
 v_and_b32 v92, v92, v42
 v_mfma_f32_16x16x32_bf16 v[120:123], a[180:183], v[220:223], v[120:123]
 ds_read_b128 v[216:219], v32 offset:32768
 v_permlane32_swap_b32 v35, v36
 v_mfma_f32_16x16x32_bf16 v[112:115], a[56:59], v[224:227], v[112:115]
 v_sub_u32 v42, -2, v94
 v_mul_f32 v35, s84, v35
 v_lshlrev_b32 v43, 4, v42
 v_mul_f32 v36, s84, v36
 v_mfma_f32_16x16x32_bf16 v[116:119], a[120:123], v[224:227], v[116:119]
 v_lshlrev_b32 v93, v43, v95
 v_fmac_f32 v36, v35, v35
 v_lshrrev_b32 v42, 1, v42
 v_mov_b32 v5, 1
 v_mfma_f32_16x16x32_bf16 v[120:123], a[184:187], v[224:227], v[120:123]
 buffer_store_dword v5, off, s[4:7], s91 offset:2048 sc1
 v_mfma_f32_16x16x32_bf16 v[112:115], a[60:63], v[228:231], v[112:115]
 ds_read_b128 v[220:223], v33 offset:32768
 v_min_f32 v36, 0, v36
 v_min_u32 v42, 1, v42
 v_mfma_f32_16x16x32_bf16 v[116:119], a[124:127], v[228:231], v[116:119]
 v_sub_f32 v36, 0x3727c5ac, v36
 v_add_u32 v42, -1, v42
 v_mfma_f32_16x16x32_bf16 v[120:123], a[188:191], v[228:231], v[120:123]
 s_waitcnt lgkmcnt(1)
 ds_read_b128 v[224:227], v30 offset:33024
 v_rsq_f32 v37, v36
 v_and_b32 v93, v93, v42
 v_mfma_f32_16x16x32_bf16 v[240:243], a[0:3], v[232:235], 0
 v_mov_b32 v64, 0x3f803f80
 v_mov_b32 v65, 0x3f803f80
 v_mov_b32 v66, 0x3f803f80
 v_mfma_f32_16x16x32_bf16 v[244:247], a[64:67], v[232:235], 0
 v_mov_b32 v67, 0x3f803f80
 v_lshrrev_b32 v52, 1, v25
 v_lshlrev_b32 v34, 8, v52
 v_mfma_f32_16x16x32_bf16 v[248:251], a[128:131], v[232:235], 0
 s_mov_b32 s95, 0xff800000
 ds_read_b128 v[228:231], v31 offset:33024
 v_lshl_add_u32 v34, v24, 4, v34
 v_and_b32 v52, 1, v25
 v_mfma_f32_16x16x32_bf16 v[240:243], a[4:7], v[236:239], v[240:243]
 s_mul_i32 s94, s55, 0xff800000
 v_lshl_add_u32 v34, v52, 3, v34
 v_add_u32 v96, -9, v94
 v_mfma_f32_16x16x32_bf16 v[244:247], a[68:71], v[236:239], v[244:247]
 s_waitcnt vmcnt(3)
 v_ashrrev_i32 v96, 31, v96
 v_and_b32 v96, s95, v96
 v_or_b32 v60, s94, v96
 v_cmp_gt_u32 vcc, 3, v3
 v_mfma_f32_16x16x32_bf16 v[248:251], a[132:135], v[236:239], v[248:251]
 s_add_u32 s87, s57, 0x4000
 s_cbranch_vccnz .Lps_38
.Lpb_39:
 s_add_u32 m0, s80, 0
 v_xor_b32 v27, 16, v15
 v_mfma_f32_16x16x32_bf16 v[240:243], a[8:11], v[216:219], v[240:243]
 buffer_load_dwordx4 v15, s[4:7], s87 offen sc1 lds
 ds_read_b128 v[232:235], v32 offset:33024
 v_add_u32 v53, 7, v94
 v_mfma_f32_16x16x32_bf16 v[244:247], a[72:75], v[216:219], v[244:247]
 v_fmac_f32 v120, v200, v35
 v_sub_u32 v56, 0, v94
 v_fmac_f32 v121, v201, v35
 v_mfma_f32_16x16x32_bf16 v[248:251], a[136:139], v[216:219], v[248:251]
 s_waitcnt lgkmcnt(1)
 buffer_load_dwordx4 v27, s[4:7], s87 offen offset:1024 sc1 lds
 ds_read_b128 v[236:239], v33 offset:33024
 v_mfma_f32_16x16x32_bf16 v[240:243], a[12:15], v[220:223], v[240:243]
 v_xor_b32 v28, 32, v15
 v_or_b32 v56, v56, v53
 v_fmac_f32 v122, v202, v35
 v_mfma_f32_16x16x32_bf16 v[244:247], a[76:79], v[220:223], v[244:247]
 s_waitcnt vmcnt(4)
 v_ashrrev_i32 v56, 31, v56
 v_mov_b32 v5, 4
 v_mfma_f32_16x16x32_bf16 v[248:251], a[140:143], v[220:223], v[248:251]
 buffer_store_dword v5, off, s[4:7], s67
 buffer_load_dwordx4 v28, s[4:7], s87 offen offset:2048 sc1 lds
 v_mfma_f32_16x16x32_bf16 v[240:243], a[16:19], v[224:227], v[240:243]
 ds_read_b128 v[216:219], v30 offset:33280
 v_xor_b32 v27, 48, v15
 v_fmac_f32 v123, v203, v35
 v_and_b32 v56, s95, v56
 v_mfma_f32_16x16x32_bf16 v[244:247], a[80:83], v[224:227], v[244:247]
 v_mul_f32 v120, v120, v37
 v_add_u32 v97, -8, v94
 v_mul_f32 v121, v121, v37
 v_mfma_f32_16x16x32_bf16 v[248:251], a[144:147], v[224:227], v[248:251]
 buffer_load_dwordx4 v27, s[4:7], s87 offen offset:3072 sc1 lds
 ds_read_b128 v[220:223], v31 offset:33280
 v_ashrrev_i32 v97, 31, v97
 v_mfma_f32_16x16x32_bf16 v[240:243], a[20:23], v[228:231], v[240:243]
 v_mul_f32 v122, v122, v37
 v_and_b32 v97, s95, v97
 v_mul_f32 v123, v123, v37
 v_mfma_f32_16x16x32_bf16 v[244:247], a[84:87], v[228:231], v[244:247]
 v_or_b32 v61, s94, v97
 v_cvt_pk_bf16_f32 v40, v120, v121
 v_add_u32 v53, 8, v94
 v_mfma_f32_16x16x32_bf16 v[248:251], a[148:151], v[228:231], v[248:251]
 s_waitcnt lgkmcnt(1)
 ds_read_b128 v[224:227], v32 offset:33280
 v_cvt_pk_bf16_f32 v41, v122, v123
 v_sub_u32 v57, -1, v94
 v_mfma_f32_16x16x32_bf16 v[240:243], a[24:27], v[232:235], v[240:243]
 s_add_u32 s91, s77, 0x0
 buffer_load_dwordx4 v[212:215], v2, s[4:7], s59 offen offset:1024 sc1
 buffer_load_dwordx4 v[128:131], v2, s[4:7], s91 offen sc1
 v_mfma_f32_16x16x32_bf16 v[244:247], a[88:91], v[232:235], v[244:247]
 s_waitcnt vmcnt(8)
 v_add_f32 v124, v204, v206
 v_fmac_f32 v116, v196, v35
 v_or_b32 v57, v57, v53
 v_mfma_f32_16x16x32_bf16 v[248:251], a[152:155], v[232:235], v[248:251]
 ds_read_b128 v[228:231], v33 offset:33280
 v_add_f32 v36, v205, v207
 v_mfma_f32_16x16x32_bf16 v[240:243], a[28:31], v[236:239], v[240:243]
 v_fmac_f32 v117, v197, v35
 v_ashrrev_i32 v57, 31, v57
 v_mfma_f32_16x16x16_bf16 v[120:123], v[40:41], v[92:93], 0
 buffer_load_dwordx4 v[132:135], v2, s[4:7], s91 offen offset:1024 sc1
 v_mfma_f32_16x16x32_bf16 v[244:247], a[92:95], v[236:239], v[244:247]
 v_and_b32 v57, s95, v57
 v_add_u32 v98, -7, v94
 v_mfma_f32_16x16x32_bf16 v[248:251], a[156:159], v[236:239], v[248:251]
 ds_read_b128 v[232:235], v30 offset:33536
 v_permlane32_swap_b32 v124, v36
 v_mfma_f32_16x16x32_bf16 v[240:243], a[32:35], v[216:219], v[240:243]
 v_fmac_f32 v118, v198, v35
 v_ashrrev_i32 v98, 31, v98
 v_add_f32 v124, v124, v36
 v_mfma_f32_16x16x32_bf16 v[244:247], a[96:99], v[216:219], v[244:247]
 v_fmac_f32 v119, v199, v35
 v_and_b32 v98, s95, v98
 v_mov_b32 v26, v124
 v_mfma_f32_16x16x32_bf16 v[248:251], a[160:163], v[216:219], v[248:251]
 s_waitcnt lgkmcnt(1)
 buffer_load_dwordx4 v[136:139], v2, s[4:7], s91 offen offset:2048 sc1
 ds_read_b128 v[236:239], v31 offset:33536
 v_mul_f32 v116, v116, v37
 v_mfma_f32_16x16x32_bf16 v[240:243], a[36:39], v[220:223], v[240:243]
 v_or_b32 v62, s94, v98
 v_mul_f32 v117, v117, v37
 v_add_u32 v53, 9, v94
 v_mfma_f32_16x16x32_bf16 v[244:247], a[100:103], v[220:223], v[244:247]
 v_mul_f32 v118, v118, v37
 v_sub_u32 v58, -2, v94
 v_mfma_f32_16x16x32_bf16 v[248:251], a[164:167], v[220:223], v[248:251]
 ds_read_b128 v[216:219], v32 offset:33536
 v_permlane16_swap_b32 v124, v26
 v_mul_f32 v119, v119, v37
 v_mfma_f32_16x16x32_bf16 v[240:243], a[40:43], v[224:227], v[240:243]
 buffer_load_dwordx4 v[140:143], v2, s[4:7], s91 offen offset:3072 sc1
 buffer_load_dword v3, v6, s[4:7], s63 offen sc1
 v_or_b32 v58, v58, v53
 v_mfma_f32_16x16x32_bf16 v[244:247], a[104:107], v[224:227], v[244:247]
 v_add_f32 v124, v124, v26
 v_cvt_pk_bf16_f32 v80, v116, v117
 v_ashrrev_i32 v58, 31, v58
 v_mfma_f32_16x16x32_bf16 v[248:251], a[168:171], v[224:227], v[248:251]
 ds_read_b128 v[220:223], v33 offset:33536
 v_mov_b32 v36, v124
 v_mfma_f32_16x16x32_bf16 v[240:243], a[44:47], v[228:231], v[240:243]
 v_cvt_pk_bf16_f32 v81, v118, v119
 v_and_b32 v58, s95, v58
 v_fmac_f32 v112, v192, v35
 v_mfma_f32_16x16x32_bf16 v[244:247], a[108:111], v[228:231], v[244:247]
 s_add_u32 s91, s77, 0x1000
 buffer_load_dwordx4 v[144:147], v2, s[4:7], s91 offen sc1
 v_add_u32 v99, -6, v94
 v_mfma_f32_16x16x32_bf16 v[248:251], a[172:175], v[228:231], v[248:251]
 s_waitcnt lgkmcnt(1)
 v_fmac_f32 v113, v193, v35
 v_ashrrev_i32 v99, 31, v99
 v_permlane32_swap_b32 v124, v36
 v_mfma_f32_16x16x32_bf16 v[240:243], a[48:51], v[232:235], v[240:243]
 v_fmac_f32 v114, v194, v35
 v_and_b32 v99, s95, v99
 v_mul_f32 v124, s84, v124
 v_mfma_f32_16x16x32_bf16 v[244:247], a[112:115], v[232:235], v[244:247]
 v_fmac_f32 v115, v195, v35
 v_or_b32 v63, s94, v99
 v_mfma_f32_16x16x32_bf16 v[248:251], a[176:179], v[232:235], v[248:251]
 s_waitcnt vmcnt(7) lgkmcnt(0)
 buffer_load_dwordx4 v[148:151], v2, s[4:7], s91 offen offset:1024 sc1
 v_mfma_f32_16x16x32_bf16 v[240:243], a[52:55], v[236:239], v[240:243]
 s_barrier
 ds_read_b128 v[224:227], v30
 ds_read_b128 v[228:231], v31
 v_mul_f32 v36, s84, v36
 v_mfma_f32_16x16x32_bf16 v[244:247], a[116:119], v[236:239], v[244:247]
 v_cvt_pk_bf16_f32 v68, v112, v113
 v_add_u32 v53, 10, v94
 v_fmac_f32 v36, v124, v124
 v_mfma_f32_16x16x32_bf16 v[248:251], a[180:183], v[236:239], v[248:251]
 ds_read_b128 v[232:235], v32
 v_cvt_pk_bf16_f32 v69, v114, v115
 v_mfma_f32_16x16x32_bf16 v[240:243], a[56:59], v[216:219], v[240:243]
 buffer_load_dwordx4 v[152:155], v2, s[4:7], s91 offen offset:2048 sc1
 v_sub_u32 v59, -3, v94
 v_mfma_f32_16x16x32_bf16 v[244:247], a[120:123], v[216:219], v[244:247]
 v_min_f32 v36, 0, v36
 v_mul_f32 v38, 0x3eb8aa3b, v37
 v_or_b32 v59, v59, v53
 v_mfma_f32_16x16x32_bf16 v[248:251], a[184:187], v[216:219], v[248:251]
 ds_read_b128 v[236:239], v33
 v_sub_f32 v36, 0x3727c5ac, v36
 v_mfma_f32_16x16x32_bf16 v[240:243], a[60:63], v[220:223], v[240:243]
 v_cvt_pk_bf16_f32 v90, v120, v121
 v_ashrrev_i32 v59, 31, v59
 v_mfma_f32_16x16x32_bf16 v[244:247], a[124:127], v[220:223], v[244:247]
 buffer_load_dwordx4 v[156:159], v2, s[4:7], s91 offen offset:3072 sc1
 v_rsq_f32 v125, v36
 v_mfma_f32_16x16x32_bf16 v[248:251], a[188:191], v[220:223], v[248:251]
 s_waitcnt lgkmcnt(1)
 ds_read_b128 v[216:219], v30 offset:256
 v_cvt_pk_bf16_f32 v91, v122, v123
 v_and_b32 v59, s95, v59
 v_mfma_f32_16x16x32_bf16 v[112:115], a[0:3], v[224:227], 0
 s_waitcnt vmcnt(9)
 v_add_f32 v35, v212, v214
 v_add_f32 v36, v213, v215
 v_mfma_f32_16x16x32_bf16 v[116:119], a[64:67], v[224:227], 0
 ds_read_b128 v[220:223], v31 offset:256
 v_permlane32_swap_b32 v35, v36
 v_mfma_f32_16x16x32_bf16 v[120:123], a[128:131], v[224:227], 0
 v_fmac_f32 v248, v200, v124
 v_fmac_f32 v249, v201, v124
 v_mfma_f32_16x16x32_bf16 v[112:115], a[4:7], v[228:231], v[112:115]
 v_fmac_f32 v250, v202, v124
 v_fmac_f32 v251, v203, v124
 v_mul_f32 v248, v248, v125
 v_mfma_f32_16x16x32_bf16 v[116:119], a[68:71], v[228:231], v[116:119]
 v_mul_f32 v249, v249, v125
 v_mul_f32 v250, v250, v125
 v_mul_f32 v251, v251, v125
 v_mfma_f32_16x16x32_bf16 v[120:123], a[132:135], v[228:231], v[120:123]
 ds_read_b128 v[224:227], v32 offset:256
 v_cvt_pk_bf16_f32 v40, v248, v249
 v_cvt_pk_bf16_f32 v41, v250, v251
 v_mfma_f32_16x16x32_bf16 v[112:115], a[8:11], v[232:235], v[112:115]
 v_fmac_f32 v244, v196, v124
 v_fmac_f32 v245, v197, v124
 v_mfma_f32_16x16x16_bf16 v[248:251], v[40:41], v[92:93], 0
 s_waitcnt vmcnt(4)
 v_cmp_gt_u32 vcc, 4, v3
 v_mfma_f32_16x16x32_bf16 v[116:119], a[72:75], v[232:235], v[116:119]
 s_add_u32 s87, s57, 0x0
 s_cbranch_vccnz .Lps_40
.Lpb_41:
 s_add_u32 m0, s80, 16384
 v_xor_b32 v27, 16, v15
 v_mfma_f32_16x16x32_bf16 v[120:123], a[136:139], v[232:235], v[120:123]
 s_waitcnt lgkmcnt(1)
 buffer_load_dwordx4 v15, s[4:7], s87 offen sc1 lds
 ds_read_b128 v[228:231], v33 offset:256
 v_fmac_f32 v246, v198, v124
 v_mfma_f32_16x16x32_bf16 v[112:115], a[12:15], v[236:239], v[112:115]
 v_fmac_f32 v247, v199, v124
 v_mul_f32 v244, v244, v125
 v_mul_f32 v245, v245, v125
 v_mfma_f32_16x16x32_bf16 v[116:119], a[76:79], v[236:239], v[116:119]
 buffer_load_dwordx4 v27, s[4:7], s87 offen offset:1024 sc1 lds
 v_xor_b32 v28, 32, v15
 v_mul_f32 v246, v246, v125
 v_mfma_f32_16x16x32_bf16 v[120:123], a[140:143], v[236:239], v[120:123]
 ds_read_b128 v[232:235], v30 offset:512
 v_mul_f32 v247, v247, v125
 v_mfma_f32_16x16x32_bf16 v[112:115], a[16:19], v[216:219], v[112:115]
 v_cvt_pk_bf16_f32 v78, v244, v245
 v_cvt_pk_bf16_f32 v79, v246, v247
 v_mfma_f32_16x16x16_bf16 v[104:107], v[80:81], v[68:69], v[56:59]
 v_add_f32 v35, v35, v36
 v_mfma_f32_16x16x32_bf16 v[116:119], a[80:83], v[216:219], v[116:119]
 buffer_load_dwordx4 v28, s[4:7], s87 offen offset:2048 sc1 lds
 v_xor_b32 v27, 48, v15
 v_mfma_f32_16x16x32_bf16 v[120:123], a[144:147], v[216:219], v[120:123]
 ds_read_b128 v[236:239], v31 offset:512
 v_mfma_f32_16x16x16_bf16 v[100:103], v[78:79], v[68:69], v[96:99]
 v_fmac_f32 v240, v192, v124
 v_fmac_f32 v241, v193, v124
 v_mfma_f32_16x16x32_bf16 v[112:115], a[20:23], v[220:223], v[112:115]
 v_fmac_f32 v242, v194, v124
 v_fmac_f32 v243, v195, v124
 v_mfma_f32_16x16x32_bf16 v[116:119], a[84:87], v[220:223], v[116:119]
 buffer_load_dwordx4 v27, s[4:7], s87 offen offset:3072 sc1 lds
 v_cvt_pk_bf16_f32 v70, v240, v241
 v_cvt_pk_bf16_f32 v71, v242, v243
 v_mfma_f32_16x16x32_bf16 v[120:123], a[148:151], v[220:223], v[120:123]
 s_waitcnt lgkmcnt(1)
 ds_read_b128 v[216:219], v32 offset:512
 v_mul_f32 v39, 0x3eb8aa3b, v125
 v_cvt_pk_bf16_f32 v88, v248, v249
 v_mfma_f32_16x16x32_bf16 v[112:115], a[24:27], v[224:227], v[112:115]
 v_cvt_pk_bf16_f32 v89, v250, v251
 v_max3_f32 v24, v104, v105, v106
 v_max3_f32 v24, v24, v107, v100
 v_mfma_f32_16x16x32_bf16 v[116:119], a[88:91], v[224:227], v[116:119]
 v_max3_f32 v24, v24, v101, v102
 v_max_f32 v24, v24, v103
 v_mov_b32 v25, v24
 v_mfma_f32_16x16x32_bf16 v[120:123], a[152:155], v[224:227], v[120:123]
 buffer_load_dwordx4 v[208:211], v2, s[4:7], s59 offen sc1
 buffer_load_dword v3, v6, s[4:7], s62 offen sc1
 ds_read_b128 v[220:223], v33 offset:512
 v_permlane32_swap_b32 v24, v25
 v_mfma_f32_16x16x32_bf16 v[112:115], a[28:31], v[228:231], v[112:115]
 v_max_f32 v24, v24, v25
 v_mov_b32 v25, v24
 v_mov_b32 v26, v35
 v_mfma_f32_16x16x32_bf16 v[116:119], a[92:95], v[228:231], v[116:119]
 v_permlane16_swap_b32 v24, v25
 v_max_f32 v24, v24, v25
 v_mul_f32 v24, v24, v38
 v_mfma_f32_16x16x32_bf16 v[120:123], a[156:159], v[228:231], v[120:123]
 s_add_u32 s91, s77, 0x2000
 buffer_load_dwordx4 v[160:163], v2, s[4:7], s91 offen sc1
 ds_read_b128 v[224:227], v30 offset:768
 v_mfma_f32_16x16x32_bf16 v[112:115], a[32:35], v[232:235], v[112:115]
 v_fma_f32 v100, v100, v38, -v24
 v_exp_f32 v100, v100
 v_fma_f32 v101, v101, v38, -v24
 v_mfma_f32_16x16x32_bf16 v[116:119], a[96:99], v[232:235], v[116:119]
 v_exp_f32 v101, v101
 v_fma_f32 v102, v102, v38, -v24
 v_mfma_f32_16x16x32_bf16 v[120:123], a[160:163], v[232:235], v[120:123]
 s_waitcnt lgkmcnt(1)
 ds_read_b128 v[228:231], v31 offset:768
 v_exp_f32 v102, v102
 v_mfma_f32_16x16x32_bf16 v[112:115], a[36:39], v[236:239], v[112:115]
 buffer_load_dwordx4 v[164:167], v2, s[4:7], s91 offen offset:1024 sc1
 v_fma_f32 v103, v103, v38, -v24
 v_mfma_f32_16x16x32_bf16 v[116:119], a[100:103], v[236:239], v[116:119]
 v_exp_f32 v103, v103
 v_fma_f32 v104, v104, v38, -v24
 v_cvt_pk_bf16_f32 v108, v100, v101
 v_mfma_f32_16x16x32_bf16 v[120:123], a[164:167], v[236:239], v[120:123]
 ds_read_b128 v[232:235], v32 offset:768
 v_exp_f32 v104, v104
 v_mfma_f32_16x16x32_bf16 v[112:115], a[40:43], v[216:219], v[112:115]
 v_fma_f32 v105, v105, v38, -v24
 v_exp_f32 v105, v105
 v_mfma_f32_16x16x32_bf16 v[116:119], a[104:107], v[216:219], v[116:119]
 v_fma_f32 v106, v106, v38, -v24
 v_cvt_pk_bf16_f32 v109, v102, v103
 v_mfma_f32_16x16x32_bf16 v[120:123], a[168:171], v[216:219], v[120:123]
 buffer_load_dwordx4 v[168:171], v2, s[4:7], s91 offen offset:2048 sc1
 ds_read_b128 v[236:239], v33 offset:768
 v_exp_f32 v106, v106
 v_mfma_f32_16x16x32_bf16 v[112:115], a[44:47], v[220:223], v[112:115]
 v_fma_f32 v107, v107, v38, -v24
 v_exp_f32 v107, v107
 v_mfma_f32_16x16x32_bf16 v[116:119], a[108:111], v[220:223], v[116:119]
 s_add_u32 s90, s69, 0xc000
 v_cvt_pk_bf16_f32 v110, v104, v105
 v_cvt_pk_bf16_f32 v111, v106, v107
 v_mfma_f32_16x16x32_bf16 v[120:123], a[172:175], v[220:223], v[120:123]
 v_permlane16_swap_b32 v35, v26
 v_mfma_f32_16x16x32_bf16 v[48:51], v[64:67], v[108:111], 0
 s_waitcnt lgkmcnt(1)
 v_mfma_f32_16x16x32_bf16 v[112:115], a[48:51], v[224:227], v[112:115]
 v_mfma_f32_16x16x32_bf16 v[44:47], v[88:91], v[108:111], 0
 v_add_f32 v35, v35, v26
 v_mfma_f32_16x16x32_bf16 v[116:119], a[112:115], v[224:227], v[116:119]
 buffer_load_dwordx4 v[172:175], v2, s[4:7], s91 offen offset:3072 sc1
 v_mov_b32 v36, v35
 v_mfma_f32_16x16x32_bf16 v[120:123], a[176:179], v[224:227], v[120:123]
 s_waitcnt vmcnt(6) lgkmcnt(0)
 s_barrier
 ds_read_b128 v[216:219], v30 offset:16384
 ds_read_b128 v[220:223], v31 offset:16384
 v_mfma_f32_16x16x32_bf16 v[112:115], a[52:55], v[228:231], v[112:115]
 v_rcp_f32 v24, v48
 v_permlane32_swap_b32 v35, v36
 v_mfma_f32_16x16x32_bf16 v[116:119], a[116:119], v[228:231], v[116:119]
 v_mul_f32 v52, v44, v24
 v_mul_f32 v35, s84, v35
 v_mul_f32 v53, v45, v24
 v_mfma_f32_16x16x32_bf16 v[120:123], a[180:183], v[228:231], v[120:123]
 ds_read_b128 v[224:227], v32 offset:16384
 v_mul_f32 v36, s84, v36
 v_mul_f32 v54, v46, v24
 v_mfma_f32_16x16x32_bf16 v[112:115], a[56:59], v[232:235], v[112:115]
 s_add_u32 s91, s77, 0x3000
 buffer_load_dwordx4 v[176:179], v2, s[4:7], s91 offen sc1
 v_fmac_f32 v36, v35, v35
 v_mfma_f32_16x16x32_bf16 v[116:119], a[120:123], v[232:235], v[116:119]
 v_mul_f32 v55, v47, v24
 v_min_f32 v36, 0, v36
 v_cvt_pk_bf16_f32 v42, v52, v53
 v_mfma_f32_16x16x32_bf16 v[120:123], a[184:187], v[232:235], v[120:123]
 ds_read_b128 v[228:231], v33 offset:16384
 v_sub_f32 v36, 0x3727c5ac, v36
 v_mfma_f32_16x16x32_bf16 v[112:115], a[60:63], v[236:239], v[112:115]
 v_cvt_pk_bf16_f32 v43, v54, v55
 v_rsq_f32 v37, v36
 v_mfma_f32_16x16x32_bf16 v[116:119], a[124:127], v[236:239], v[116:119]
 s_waitcnt vmcnt(5)
 v_cmp_gt_u32 vcc, 1, v3
 s_nop 0
 s_cbranch_vccnz .Lps_34
.Lpb_35:
 s_add_u32 m0, s80, 32768
 v_xor_b32 v27, 16, v15
 v_mfma_f32_16x16x32_bf16 v[120:123], a[188:191], v[236:239], v[120:123]
 s_waitcnt lgkmcnt(1)
 buffer_load_dwordx4 v15, s[4:7], s58 offen sc1 lds
 buffer_store_dwordx2 v[42:43], v34, s[4:7], s90 offen
 v_mfma_f32_16x16x32_bf16 v[240:243], a[0:3], v[216:219], 0
 ds_read_b128 v[232:235], v30 offset:16640
 v_add_f32 v124, v208, v210
 v_add_f32 v36, v209, v211
 v_mfma_f32_16x16x32_bf16 v[244:247], a[64:67], v[216:219], 0
 buffer_load_dwordx4 v27, s[4:7], s58 offen offset:1024 sc1 lds
 v_xor_b32 v28, 32, v15
 v_permlane32_swap_b32 v124, v36
 v_fmac_f32 v120, v200, v35
 v_mfma_f32_16x16x32_bf16 v[248:251], a[128:131], v[216:219], 0
 ds_read_b128 v[236:239], v31 offset:16640
 v_fmac_f32 v121, v201, v35
 v_fmac_f32 v122, v202, v35
 v_fmac_f32 v123, v203, v35
 v_mfma_f32_16x16x32_bf16 v[240:243], a[4:7], v[220:223], v[240:243]
 v_mul_f32 v120, v120, v37
 v_mul_f32 v121, v121, v37
 v_mul_f32 v122, v122, v37
 v_mul_f32 v123, v123, v37
 v_mfma_f32_16x16x32_bf16 v[244:247], a[68:71], v[220:223], v[244:247]
 buffer_load_dwordx4 v28, s[4:7], s58 offen offset:2048 sc1 lds
 v_xor_b32 v27, 48, v15
 v_cvt_pk_bf16_f32 v40, v120, v121
 v_mfma_f32_16x16x32_bf16 v[248:251], a[132:135], v[220:223], v[248:251]
 ds_read_b128 v[216:219], v32 offset:16640
 v_cvt_pk_bf16_f32 v41, v122, v123
 v_mfma_f32_16x16x32_bf16 v[240:243], a[8:11], v[224:227], v[240:243]
 v_fmac_f32 v116, v196, v35
 v_fmac_f32 v117, v197, v35
 v_mfma_f32_16x16x16_bf16 v[120:123], v[40:41], v[92:93], 0
 v_fmac_f32 v118, v198, v35
 v_mfma_f32_16x16x32_bf16 v[244:247], a[72:75], v[224:227], v[244:247]
 buffer_load_dwordx4 v27, s[4:7], s58 offen offset:3072 sc1 lds
 v_fmac_f32 v119, v199, v35
 v_mul_f32 v116, v116, v37
 v_mul_f32 v117, v117, v37
 v_mfma_f32_16x16x32_bf16 v[248:251], a[136:139], v[224:227], v[248:251]
 s_waitcnt lgkmcnt(1)
 ds_read_b128 v[220:223], v33 offset:16640
 v_mul_f32 v118, v118, v37
 v_mul_f32 v119, v119, v37
 v_mfma_f32_16x16x32_bf16 v[240:243], a[12:15], v[228:231], v[240:243]
 v_cvt_pk_bf16_f32 v76, v116, v117
 v_cvt_pk_bf16_f32 v77, v118, v119
 v_mfma_f32_16x16x16_bf16 v[104:107], v[78:79], v[70:71], v[56:59]
 v_mfma_f32_16x16x32_bf16 v[244:247], a[76:79], v[228:231], v[244:247]
 v_mfma_f32_16x16x16_bf16 v[100:103], v[76:77], v[70:71], v[96:99]
 v_fmac_f32 v112, v192, v35
 v_fmac_f32 v113, v193, v35
 v_mfma_f32_16x16x32_bf16 v[248:251], a[140:143], v[228:231], v[248:251]
 buffer_load_dwordx4 v[204:207], v2, s[4:7], s60 offen sc1
 ds_read_b128 v[224:227], v30 offset:16896
 v_fmac_f32 v114, v194, v35
 v_mfma_f32_16x16x32_bf16 v[240:243], a[16:19], v[232:235], v[240:243]
 v_fmac_f32 v115, v195, v35
 v_cvt_pk_bf16_f32 v68, v112, v113
 v_cvt_pk_bf16_f32 v69, v114, v115
 v_mul_f32 v38, 0x3eb8aa3b, v37
 v_mfma_f32_16x16x32_bf16 v[244:247], a[80:83], v[232:235], v[244:247]
 v_cvt_pk_bf16_f32 v86, v120, v121
 v_cvt_pk_bf16_f32 v87, v122, v123
 v_max3_f32 v24, v104, v105, v106
 v_mfma_f32_16x16x32_bf16 v[248:251], a[144:147], v[232:235], v[248:251]
 ds_read_b128 v[228:231], v31 offset:16896
 v_max3_f32 v24, v24, v107, v100
 v_max3_f32 v24, v24, v101, v102
 v_max_f32 v24, v24, v103
 v_mfma_f32_16x16x32_bf16 v[240:243], a[20:23], v[236:239], v[240:243]
 buffer_load_dwordx4 v[180:183], v2, s[4:7], s91 offen offset:1024 sc1
 v_mov_b32 v25, v24
 v_add_f32 v124, v124, v36
 v_mov_b32 v26, v124
 v_mfma_f32_16x16x32_bf16 v[244:247], a[84:87], v[236:239], v[244:247]
 v_permlane32_swap_b32 v24, v25
 v_max_f32 v24, v24, v25
 v_mov_b32 v25, v24
 v_mfma_f32_16x16x32_bf16 v[248:251], a[148:151], v[236:239], v[248:251]
 s_waitcnt lgkmcnt(1)
 ds_read_b128 v[232:235], v32 offset:16896
 v_permlane16_swap_b32 v24, v25
 v_max_f32 v24, v24, v25
 v_mfma_f32_16x16x32_bf16 v[240:243], a[24:27], v[216:219], v[240:243]
 v_mul_f32 v24, v24, v39
 v_fma_f32 v100, v100, v39, -v24
 v_exp_f32 v100, v100
 v_mfma_f32_16x16x32_bf16 v[244:247], a[88:91], v[216:219], v[244:247]
 v_fma_f32 v101, v101, v39, -v24
 v_exp_f32 v101, v101
 v_mfma_f32_16x16x32_bf16 v[248:251], a[152:155], v[216:219], v[248:251]
 ds_read_b128 v[236:239], v33 offset:16896
 v_fma_f32 v102, v102, v39, -v24
 v_exp_f32 v102, v102
 v_mfma_f32_16x16x32_bf16 v[240:243], a[28:31], v[220:223], v[240:243]
 s_waitcnt vmcnt(5)
 buffer_load_dwordx4 v[184:187], v2, s[4:7], s91 offen offset:2048 sc1
 v_mov_b32 v5, 5
 v_mfma_f32_16x16x32_bf16 v[244:247], a[92:95], v[220:223], v[244:247]
 buffer_store_dword v5, off, s[4:7], s67 offset:512
 v_fma_f32 v103, v103, v39, -v24
 v_exp_f32 v103, v103
 v_mfma_f32_16x16x32_bf16 v[248:251], a[156:159], v[220:223], v[248:251]
 s_lshl_b32 s86, s50, 2
 s_add_u32 s86, s86, s48
 s_lshl_b32 s86, s86, 9
 v_and_b32 v5, 12, v6
 v_lshl_add_u32 v5, v5, 5, s86
 v_min_u32 v5, .Lfast_end-interleave_layers__sliding_local_dilated__geglu_ffn__prompt_kernel-4, v5
 v_mfma_f32_16x16x32_bf16 v[240:243], a[32:35], v[224:227], v[240:243]
 global_load_dword v0, v5, s[82:83]
 ds_read_b128 v[216:219], v30 offset:17152
 v_fma_f32 v104, v104, v39, -v24
 v_cvt_pk_bf16_f32 v108, v100, v101
 v_mfma_f32_16x16x32_bf16 v[244:247], a[96:99], v[224:227], v[244:247]
 v_exp_f32 v104, v104
 v_fma_f32 v105, v105, v39, -v24
 v_mfma_f32_16x16x32_bf16 v[248:251], a[160:163], v[224:227], v[248:251]
 s_waitcnt lgkmcnt(1)
 ds_read_b128 v[220:223], v31 offset:17152
 v_exp_f32 v105, v105
 v_mfma_f32_16x16x32_bf16 v[240:243], a[36:39], v[228:231], v[240:243]
 buffer_load_dwordx4 v[188:191], v2, s[4:7], s91 offen offset:3072 sc1
 v_fma_f32 v106, v106, v39, -v24
 v_cvt_pk_bf16_f32 v109, v102, v103
 v_mfma_f32_16x16x32_bf16 v[244:247], a[100:103], v[228:231], v[244:247]
 v_exp_f32 v106, v106
 v_fma_f32 v107, v107, v39, -v24
 v_mfma_f32_16x16x32_bf16 v[248:251], a[164:167], v[228:231], v[248:251]
 ds_read_b128 v[224:227], v32 offset:17152
 v_exp_f32 v107, v107
 v_cvt_pk_bf16_f32 v110, v104, v105
 v_mfma_f32_16x16x32_bf16 v[240:243], a[40:43], v[232:235], v[240:243]
 s_add_u32 s90, s69, 0x8000
 v_cvt_pk_bf16_f32 v111, v106, v107
 v_permlane16_swap_b32 v124, v26
 v_mfma_f32_16x16x32_bf16 v[244:247], a[104:107], v[232:235], v[244:247]
 v_add_f32 v124, v124, v26
 v_mfma_f32_16x16x32_bf16 v[48:51], v[64:67], v[108:111], 0
 v_mfma_f32_16x16x32_bf16 v[248:251], a[168:171], v[232:235], v[248:251]
 ds_read_b128 v[228:231], v33 offset:17152
 v_mfma_f32_16x16x32_bf16 v[44:47], v[86:89], v[108:111], 0
 v_mov_b32 v36, v124
 v_mfma_f32_16x16x32_bf16 v[240:243], a[44:47], v[236:239], v[240:243]
 v_mfma_f32_16x16x32_bf16 v[244:247], a[108:111], v[236:239], v[244:247]
 v_permlane32_swap_b32 v124, v36
 v_mul_f32 v124, s84, v124
 v_mul_f32 v36, s84, v36
 v_mfma_f32_16x16x32_bf16 v[248:251], a[172:175], v[236:239], v[248:251]
 s_waitcnt lgkmcnt(1)
 v_fmac_f32 v36, v124, v124
 v_rcp_f32 v24, v48
 v_min_f32 v36, 0, v36
 v_mfma_f32_16x16x32_bf16 v[240:243], a[48:51], v[216:219], v[240:243]
 v_mul_f32 v52, v44, v24
 v_mul_f32 v53, v45, v24
 v_mul_f32 v54, v46, v24
 v_mul_f32 v55, v47, v24
 v_mfma_f32_16x16x32_bf16 v[244:247], a[112:115], v[216:219], v[244:247]
 v_cvt_pk_bf16_f32 v42, v52, v53
 v_sub_f32 v36, 0x3727c5ac, v36
 v_cvt_pk_bf16_f32 v43, v54, v55
 v_mfma_f32_16x16x32_bf16 v[248:251], a[176:179], v[216:219], v[248:251]
 s_waitcnt vmcnt(6) lgkmcnt(0)
 s_barrier
 ds_read_b128 v[232:235], v30 offset:32768
 ds_read_b128 v[236:239], v31 offset:32768
 v_mfma_f32_16x16x32_bf16 v[240:243], a[52:55], v[220:223], v[240:243]
 buffer_store_dwordx2 v[42:43], v34, s[4:7], s90 offen
 v_mfma_f32_16x16x32_bf16 v[244:247], a[116:119], v[220:223], v[244:247]
 v_rsq_f32 v125, v36
 v_mfma_f32_16x16x32_bf16 v[248:251], a[180:183], v[220:223], v[248:251]
 ds_read_b128 v[216:219], v32 offset:32768
 v_mfma_f32_16x16x32_bf16 v[240:243], a[56:59], v[224:227], v[240:243]
 buffer_load_dword v3, v7, s[4:7], s64 offen sc1
 v_mfma_f32_16x16x32_bf16 v[244:247], a[120:123], v[224:227], v[244:247]
 v_mfma_f32_16x16x32_bf16 v[248:251], a[184:187], v[224:227], v[248:251]
 ds_read_b128 v[220:223], v33 offset:32768
 v_mfma_f32_16x16x32_bf16 v[240:243], a[60:63], v[228:231], v[240:243]
 v_mfma_f32_16x16x32_bf16 v[244:247], a[124:127], v[228:231], v[244:247]
 v_mfma_f32_16x16x32_bf16 v[248:251], a[188:191], v[228:231], v[248:251]
 s_waitcnt lgkmcnt(3)
 ds_read_b128 v[224:227], v30 offset:33024
 v_mfma_f32_16x16x32_bf16 v[116:119], a[64:67], v[232:235], 0
 s_waitcnt vmcnt(7)
 v_add_f32 v35, v204, v206
 v_add_f32 v36, v205, v207
 v_mfma_f32_16x16x32_bf16 v[120:123], a[128:131], v[232:235], 0
 s_add_u32 s89, s78, 0x0
 buffer_load_dwordx4 a[0:3], v2, s[4:7], s89 offen offset:3072 sc1
 ds_read_b128 v[228:231], v31 offset:33024
 v_fmac_f32 v248, v200, v124
 v_fmac_f32 v249, v201, v124
 v_fmac_f32 v250, v202, v124
 s_waitcnt lgkmcnt(3)
 v_mfma_f32_16x16x32_bf16 v[116:119], a[68:71], v[236:239], v[116:119]
 v_fmac_f32 v251, v203, v124
 v_mul_f32 v248, v248, v125
 v_mul_f32 v249, v249, v125
 v_mul_f32 v250, v250, v125
 v_mfma_f32_16x16x32_bf16 v[120:123], a[132:135], v[236:239], v[120:123]
 s_add_u32 s89, s78, 0x1000
 buffer_load_dwordx4 a[4:7], v2, s[4:7], s89 offen offset:3072 sc1
 ds_read_b128 v[232:235], v32 offset:33024
 v_mul_f32 v251, v251, v125
 v_mfma_f32_16x16x32_bf16 v[116:119], a[72:75], v[216:219], v[116:119]
 v_cvt_pk_bf16_f32 v40, v248, v249
 v_cvt_pk_bf16_f32 v41, v250, v251
 v_fmac_f32 v244, v196, v124
 v_fmac_f32 v245, v197, v124
 v_mfma_f32_16x16x16_bf16 v[248:251], v[40:41], v[92:93], 0
 v_mfma_f32_16x16x32_bf16 v[120:123], a[136:139], v[216:219], v[120:123]
 s_waitcnt lgkmcnt(1)
 ds_read_b128 v[236:239], v33 offset:33024
 v_fmac_f32 v246, v198, v124
 v_fmac_f32 v247, v199, v124
 v_mul_f32 v244, v244, v125
 v_mfma_f32_16x16x32_bf16 v[116:119], a[76:79], v[220:223], v[116:119]
 s_add_u32 s89, s78, 0x2000
 buffer_load_dwordx4 a[8:11], v2, s[4:7], s89 offen offset:3072 sc1
 v_mul_f32 v245, v245, v125
 v_mul_f32 v246, v246, v125
 v_mul_f32 v247, v247, v125
 v_cvt_pk_bf16_f32 v74, v244, v245
 v_mfma_f32_16x16x32_bf16 v[120:123], a[140:143], v[220:223], v[120:123]
 ds_read_b128 v[216:219], v30 offset:33280
 v_cvt_pk_bf16_f32 v75, v246, v247
 v_mfma_f32_16x16x16_bf16 v[104:107], v[76:77], v[68:69], v[56:59]
 v_mfma_f32_16x16x32_bf16 v[116:119], a[80:83], v[224:227], v[116:119]
 s_add_u32 s89, s78, 0x3000
 buffer_load_dwordx4 a[12:15], v2, s[4:7], s89 offen offset:3072 sc1
 v_mfma_f32_16x16x16_bf16 v[100:103], v[74:75], v[68:69], v[96:99]
 v_fmac_f32 v240, v192, v124
 v_mfma_f32_16x16x32_bf16 v[120:123], a[144:147], v[224:227], v[120:123]
 s_waitcnt vmcnt(5)
 v_mov_b32 v5, 6
 buffer_store_dword v5, off, s[4:7], s67 offset:512
 v_mfma_f32_16x16x32_bf16 v[116:119], a[84:87], v[228:231], v[116:119]
 s_waitcnt lgkmcnt(0)
 ds_read_b128 v[220:223], v31 offset:33280
 v_fmac_f32 v241, v193, v124
 v_fmac_f32 v242, v194, v124
 v_fmac_f32 v243, v195, v124
 v_cvt_pk_bf16_f32 v70, v240, v241
 v_cvt_pk_bf16_f32 v71, v242, v243
 v_mfma_f32_16x16x32_bf16 v[120:123], a[148:151], v[228:231], v[120:123]
 s_add_u32 s89, s78, 0x4000
 buffer_load_dwordx4 a[16:19], v2, s[4:7], s89 offen offset:3072 sc1
 ds_read_b128 v[224:227], v32 offset:33280
 v_mul_f32 v39, 0x3eb8aa3b, v125
 v_cvt_pk_bf16_f32 v84, v248, v249
 v_mfma_f32_16x16x32_bf16 v[116:119], a[88:91], v[232:235], v[116:119]
 v_cvt_pk_bf16_f32 v85, v250, v251
 v_max3_f32 v24, v104, v105, v106
 v_max3_f32 v24, v24, v107, v100
 v_max3_f32 v24, v24, v101, v102
 v_mfma_f32_16x16x32_bf16 v[120:123], a[152:155], v[232:235], v[120:123]
 ds_read_b128 v[228:231], v33 offset:33280
 v_max_f32 v24, v24, v103
 v_mov_b32 v25, v24
 v_permlane32_swap_b32 v35, v36
 v_add_f32 v35, v35, v36
 v_mfma_f32_16x16x32_bf16 v[116:119], a[92:95], v[236:239], v[116:119]
 s_add_u32 s89, s78, 0x5000
 buffer_load_dwordx4 a[20:23], v2, s[4:7], s89 offen offset:1024 sc1
 v_permlane32_swap_b32 v24, v25
 v_mfma_f32_16x16x32_bf16 v[120:123], a[156:159], v[236:239], v[120:123]
 s_add_u32 s85, s70, 0xc000
 v_max_f32 v24, v24, v25
 v_mov_b32 v25, v24
 s_waitcnt vmcnt(7)
 v_cmp_gt_u32 vcc, 5, v3
 s_nop 0
 s_cbranch_vccnz .Lps_42
.Lpb_43:
 v_mfma_f32_16x16x32_bf16 v[116:119], a[96:99], v[216:219], v[116:119]
 ds_read_b128 v[232:235], v30 offset:33536
 v_permlane16_swap_b32 v24, v25
 v_max_f32 v24, v24, v25
 v_mul_f32 v24, v24, v38
 v_fma_f32 v100, v100, v38, -v24
 v_exp_f32 v100, v100
 v_mfma_f32_16x16x32_bf16 v[120:123], a[160:163], v[216:219], v[120:123]
 s_waitcnt lgkmcnt(1)
 buffer_load_dwordx4 v[212:215], v2, s[4:7], s85 offen sc1
 ds_read_b128 v[236:239], v31 offset:33536
 v_fma_f32 v101, v101, v38, -v24
 v_mfma_f32_16x16x32_bf16 v[116:119], a[100:103], v[220:223], v[116:119]
 v_exp_f32 v101, v101
 v_fma_f32 v102, v102, v38, -v24
 v_exp_f32 v102, v102
 v_mfma_f32_16x16x32_bf16 v[120:123], a[164:167], v[220:223], v[120:123]
 ds_read_b128 v[216:219], v32 offset:33536
 v_fma_f32 v103, v103, v38, -v24
 v_exp_f32 v103, v103
 v_mfma_f32_16x16x32_bf16 v[116:119], a[104:107], v[224:227], v[116:119]
 buffer_load_dwordx4 v[124:127], v2, s[4:7], s85 offen offset:1024 sc1
 v_fma_f32 v104, v104, v38, -v24
 v_cvt_pk_bf16_f32 v108, v100, v101
 v_exp_f32 v104, v104
 v_mfma_f32_16x16x32_bf16 v[120:123], a[168:171], v[224:227], v[120:123]
 ds_read_b128 v[220:223], v33 offset:33536
 v_fma_f32 v105, v105, v38, -v24
 v_exp_f32 v105, v105
 v_mfma_f32_16x16x32_bf16 v[116:119], a[108:111], v[228:231], v[116:119]
 v_fma_f32 v106, v106, v38, -v24
 v_cvt_pk_bf16_f32 v109, v102, v103
 v_exp_f32 v106, v106
 v_mfma_f32_16x16x32_bf16 v[120:123], a[172:175], v[228:231], v[120:123]
 s_waitcnt lgkmcnt(2)
 buffer_load_dwordx4 v[252:255], v2, s[4:7], s85 offen offset:2048 sc1
 buffer_load_dword v3, v7, s[4:7], s64 offen sc1
 v_fma_f32 v107, v107, v38, -v24
 v_mfma_f32_16x16x32_bf16 v[116:119], a[112:115], v[232:235], v[116:119]
 s_add_u32 s90, s69, 0x4000
 v_exp_f32 v107, v107
 v_cvt_pk_bf16_f32 v110, v104, v105
 v_cvt_pk_bf16_f32 v111, v106, v107
 v_mfma_f32_16x16x32_bf16 v[120:123], a[176:179], v[232:235], v[120:123]
 v_mov_b32 v26, v35
 v_mfma_f32_16x16x32_bf16 v[48:51], v[64:67], v[108:111], 0
 v_mfma_f32_16x16x32_bf16 v[44:47], v[84:87], v[108:111], 0
 buffer_load_dwordx4 v[240:243], v2, s[4:7], s85 offen offset:3072 sc1
 v_mfma_f32_16x16x32_bf16 v[116:119], a[116:119], v[236:239], v[116:119]
 v_permlane16_swap_b32 v35, v26
 v_mfma_f32_16x16x32_bf16 v[120:123], a[180:183], v[236:239], v[120:123]
 s_waitcnt lgkmcnt(0)
 v_add_f32 v35, v35, v26
 v_mov_b32 v36, v35
 v_rcp_f32 v24, v48
 v_mfma_f32_16x16x32_bf16 v[116:119], a[120:123], v[216:219], v[116:119]
 v_permlane32_swap_b32 v35, v36
 v_mul_f32 v52, v44, v24
 v_mul_f32 v35, s84, v35
 v_mfma_f32_16x16x32_bf16 v[120:123], a[184:187], v[216:219], v[120:123]
 v_mul_f32 v53, v45, v24
 v_mul_f32 v36, s84, v36
 v_mul_f32 v54, v46, v24
 v_fmac_f32 v36, v35, v35
 v_mfma_f32_16x16x32_bf16 v[116:119], a[124:127], v[220:223], v[116:119]
 s_waitcnt vmcnt(1)
 v_mul_f32 v55, v47, v24
 v_min_f32 v36, 0, v36
 v_cvt_pk_bf16_f32 v42, v52, v53
 v_sub_f32 v36, 0x3727c5ac, v36
 v_cvt_pk_bf16_f32 v43, v54, v55
 v_rsq_f32 v37, v36
 v_mfma_f32_16x16x32_bf16 v[120:123], a[188:191], v[220:223], v[120:123]
 s_add_u32 s85, s70, 0x8000
 buffer_store_dwordx2 v[42:43], v34, s[4:7], s90 offen
 v_cmp_gt_u32 vcc, 6, v3
 s_nop 0
 s_cbranch_vccnz .Lps_44
.Lpb_45:
 v_mfma_f32_16x16x32_bf16 v[244:247], v[128:131], v[212:215], 0
 buffer_load_dwordx4 v[216:219], v2, s[4:7], s85 offen sc1
 v_mfma_f32_16x16x32_bf16 v[248:251], v[132:135], v[212:215], 0
 buffer_load_dwordx4 v[220:223], v2, s[4:7], s85 offen offset:1024 sc1
 v_mfma_f32_16x16x32_bf16 v[232:235], v[136:139], v[212:215], 0
 buffer_load_dwordx4 v[224:227], v2, s[4:7], s85 offen offset:2048 sc1
 v_fmac_f32 v120, v200, v35
 v_mfma_f32_16x16x32_bf16 v[236:239], v[140:143], v[212:215], 0
 v_fmac_f32 v121, v201, v35
 v_fmac_f32 v122, v202, v35
 v_fmac_f32 v123, v203, v35
 v_mfma_f32_16x16x32_bf16 v[244:247], v[144:147], v[124:127], v[244:247]
 v_mul_f32 v120, v120, v37
 v_mul_f32 v121, v121, v37
 v_mul_f32 v122, v122, v37
 v_mfma_f32_16x16x32_bf16 v[248:251], v[148:151], v[124:127], v[248:251]
 buffer_load_dwordx4 v[228:231], v2, s[4:7], s85 offen offset:3072 sc1
 v_mul_f32 v123, v123, v37
 v_cvt_pk_bf16_f32 v40, v120, v121
 v_mfma_f32_16x16x32_bf16 v[232:235], v[152:155], v[124:127], v[232:235]
 v_cvt_pk_bf16_f32 v41, v122, v123
 v_fmac_f32 v116, v196, v35
 v_fmac_f32 v117, v197, v35
 v_mfma_f32_16x16x16_bf16 v[120:123], v[40:41], v[92:93], 0
 v_fmac_f32 v118, v198, v35
 v_mfma_f32_16x16x32_bf16 v[236:239], v[156:159], v[124:127], v[236:239]
 v_fmac_f32 v119, v199, v35
 v_mul_f32 v116, v116, v37
 v_mfma_f32_16x16x32_bf16 v[244:247], v[160:163], v[252:255], v[244:247]
 s_add_u32 s89, s78, 0x5000
 buffer_load_dwordx4 a[24:27], v2, s[4:7], s89 offen offset:2048 sc1
 v_mul_f32 v117, v117, v37
 v_mfma_f32_16x16x32_bf16 v[248:251], v[164:167], v[252:255], v[248:251]
 s_waitcnt vmcnt(5)
 v_mul_f32 v118, v118, v37
 v_mov_b32 v5, 7
 v_mfma_f32_16x16x32_bf16 v[232:235], v[168:171], v[252:255], v[232:235]
 buffer_store_dword v5, off, s[4:7], s67 offset:512
 v_mfma_f32_16x16x16_bf16 v[104:107], v[74:75], v[70:71], v[56:59]
 v_mul_f32 v119, v119, v37
 v_cvt_pk_bf16_f32 v72, v116, v117
 v_cvt_pk_bf16_f32 v73, v118, v119
 v_mfma_f32_16x16x32_bf16 v[236:239], v[172:175], v[252:255], v[236:239]
 s_add_u32 s89, s78, 0x5000
 buffer_load_dwordx4 a[28:31], v2, s[4:7], s89 offen offset:3072 sc1
 v_mfma_f32_16x16x32_bf16 v[244:247], v[176:179], v[240:243], v[244:247]
 v_mfma_f32_16x16x16_bf16 v[100:103], v[72:73], v[70:71], v[60:63]
 v_cvt_pk_bf16_f32 v82, v120, v121
 v_cvt_pk_bf16_f32 v83, v122, v123
 v_mfma_f32_16x16x32_bf16 v[248:251], v[180:183], v[240:243], v[248:251]
 v_mfma_f32_16x16x32_bf16 v[232:235], v[184:187], v[240:243], v[232:235]
 s_add_u32 s89, s78, 0x6000
 buffer_load_dwordx4 a[32:35], v2, s[4:7], s89 offen sc1
 v_mfma_f32_16x16x32_bf16 v[236:239], v[188:191], v[240:243], v[236:239]
 s_waitcnt vmcnt(7)
 v_max3_f32 v24, v104, v105, v106
 v_max3_f32 v24, v24, v107, v100
 v_max3_f32 v24, v24, v101, v102
 v_mfma_f32_16x16x32_bf16 v[96:99], v[128:131], v[216:219], 0
 v_max_f32 v24, v24, v103
 v_mov_b32 v25, v24
 v_mfma_f32_16x16x32_bf16 v[192:195], v[132:135], v[216:219], 0
 s_add_u32 s89, s78, 0x6000
 buffer_load_dwordx4 a[36:39], v2, s[4:7], s89 offen offset:1024 sc1
 v_permlane32_swap_b32 v24, v25
 v_mfma_f32_16x16x32_bf16 v[196:199], v[136:139], v[216:219], 0
 v_max_f32 v24, v24, v25
 v_mov_b32 v25, v24
 v_mfma_f32_16x16x32_bf16 v[200:203], v[140:143], v[216:219], 0
 s_waitcnt vmcnt(7)
 v_permlane16_swap_b32 v24, v25
 v_max_f32 v24, v24, v25
 v_mul_f32 v24, v24, v39
 v_fma_f32 v100, v100, v39, -v24
 v_mfma_f32_16x16x32_bf16 v[96:99], v[144:147], v[220:223], v[96:99]
 s_add_u32 s89, s78, 0x6000
 buffer_load_dwordx4 a[40:43], v2, s[4:7], s89 offen offset:2048 sc1
 v_exp_f32 v100, v100
 v_fma_f32 v101, v101, v39, -v24
 v_mfma_f32_16x16x32_bf16 v[192:195], v[148:151], v[220:223], v[192:195]
 ds_write_b128 v9, v[244:247]
 v_exp_f32 v101, v101
 v_mfma_f32_16x16x32_bf16 v[196:199], v[152:155], v[220:223], v[196:199]
 v_fma_f32 v102, v102, v39, -v24
 v_exp_f32 v102, v102
 v_fma_f32 v103, v103, v39, -v24
 v_exp_f32 v103, v103
 v_mfma_f32_16x16x32_bf16 v[200:203], v[156:159], v[220:223], v[200:203]
 s_waitcnt vmcnt(7)
 v_fma_f32 v104, v104, v39, -v24
 v_cvt_pk_bf16_f32 v108, v100, v101
 v_exp_f32 v104, v104
 v_mfma_f32_16x16x32_bf16 v[96:99], v[160:163], v[224:227], v[96:99]
 buffer_load_dword v3, v7, s[4:7], s64 offen sc1
 ds_write_b128 v10, v[248:251]
 v_mfma_f32_16x16x32_bf16 v[192:195], v[164:167], v[224:227], v[192:195]
 v_fma_f32 v105, v105, v39, -v24
 v_exp_f32 v105, v105
 v_fma_f32 v106, v106, v39, -v24
 v_cvt_pk_bf16_f32 v109, v102, v103
 v_mfma_f32_16x16x32_bf16 v[196:199], v[168:171], v[224:227], v[196:199]
 s_waitcnt vmcnt(7)
 v_exp_f32 v106, v106
 v_fma_f32 v107, v107, v39, -v24
 v_exp_f32 v107, v107
 v_mfma_f32_16x16x32_bf16 v[200:203], v[172:175], v[224:227], v[200:203]
 s_add_u32 s90, s69, 0x0
 ds_write_b128 v9, v[232:235] offset:128
 v_cvt_pk_bf16_f32 v110, v104, v105
 v_cvt_pk_bf16_f32 v111, v106, v107
 v_mfma_f32_16x16x32_bf16 v[96:99], v[176:179], v[228:231], v[96:99]
 v_mfma_f32_16x16x32_bf16 v[192:195], v[180:183], v[228:231], v[192:195]
 v_mfma_f32_16x16x32_bf16 v[48:51], v[64:67], v[108:111], 0
 v_mfma_f32_16x16x32_bf16 v[44:47], v[82:85], v[108:111], 0
 v_mfma_f32_16x16x32_bf16 v[196:199], v[184:187], v[228:231], v[196:199]
 ds_write_b128 v10, v[236:239] offset:128
 v_mfma_f32_16x16x32_bf16 v[200:203], v[188:191], v[228:231], v[200:203]
 s_add_u32 s89, s78, 0x6000
 s_nop 2
 v_rcp_f32 v24, v48
 s_nop 0
 v_mul_f32 v52, v44, v24
 v_mul_f32 v53, v45, v24
 v_mul_f32 v54, v46, v24
 v_mul_f32 v55, v47, v24
 v_cvt_pk_bf16_f32 v42, v52, v53
 v_cvt_pk_bf16_f32 v43, v54, v55
 buffer_store_dwordx2 v[42:43], v34, s[4:7], s90 offen
 ds_write_b128 v9, v[96:99] offset:16384
 ds_write_b128 v10, v[192:195] offset:16384
 ds_write_b128 v9, v[196:199] offset:16512
 ds_write_b128 v10, v[200:203] offset:16512
 buffer_load_dwordx4 a[44:47], v2, s[4:7], s89 offen offset:3072 sc1
 v_add_u32 v26, 57344, v2
 v_and_b32 v24, 15, v1
 v_lshrrev_b32 v25, 4, v1
 v_lshlrev_b32 v29, 4, v25
 s_add_u32 s89, s78, 0x7000
 buffer_load_dwordx4 a[48:51], v2, s[4:7], s89 offen sc1
 v_and_b32 v28, 1, v25
 v_lshlrev_b32 v28, 3, v28
 v_lshl_add_u32 v28, v24, 4, v28
 v_lshrrev_b32 v25, 1, v25
 s_add_u32 s89, s78, 0x7000
 buffer_load_dwordx4 a[52:55], v2, s[4:7], s89 offen offset:1024 sc1
 v_lshl_add_u32 v27, v25, 8, v28
 v_xor_b32 v25, 1, v25
 v_mul_u32_u24 v25, 57344, v25
 v_add_u32 v28, v28, v25
 s_waitcnt lgkmcnt(0)
 s_barrier
 ds_read_b128 v[212:215], v11
 ds_read_b128 v[124:127], v11 offset:4096
 ds_read_b128 v[252:255], v11 offset:8192
 ds_read_b128 v[240:243], v11 offset:12288
 ds_read_b128 v[216:219], v11 offset:16384
 ds_read_b128 v[220:223], v11 offset:20480
 ds_read_b128 v[224:227], v11 offset:24576
 ds_read_b128 v[228:231], v11 offset:28672
 s_add_u32 s85, s70, 0x4000
 s_waitcnt vmcnt(4)
 v_cmp_gt_u32 vcc, 7, v3
 s_nop 0
 s_cbranch_vccnz .Lps_46
.Lpb_47:
 buffer_load_dwordx4 v[44:47], v2, s[4:7], s85 offen sc1
 buffer_load_dwordx4 v[48:51], v2, s[4:7], s85 offen offset:1024 sc1
 v_mov_b32 v5, 8
 s_waitcnt vmcnt(5)
 buffer_store_dword v5, off, s[4:7], s67 offset:512
 buffer_load_dwordx4 v[52:55], v2, s[4:7], s85 offen offset:2048 sc1
 s_add_u32 s90, s71, 0x8000
 s_add_u32 s91, s71, 0x8000
 v_lshlrev_b32 v100, 16, v22
 v_lshlrev_b32 v104, 16, v20
 v_and_b32 v101, 0xffff0000, v22
 v_and_b32 v105, 0xffff0000, v20
 v_lshlrev_b32 v102, 16, v23
 v_lshlrev_b32 v106, 16, v21
 v_and_b32 v103, 0xffff0000, v23
 v_and_b32 v107, 0xffff0000, v21
 s_waitcnt lgkmcnt(6)
 v_pk_add_f32 v[212:213], v[212:213], v[124:125]
 s_waitcnt lgkmcnt(2)
 v_pk_add_f32 v[216:217], v[216:217], v[220:221]
 v_pk_add_f32 v[252:253], v[252:253], v[240:241]
 s_waitcnt lgkmcnt(0)
 v_pk_add_f32 v[224:225], v[224:225], v[228:229]
 v_pk_add_f32 v[214:215], v[214:215], v[126:127]
 v_pk_add_f32 v[218:219], v[218:219], v[222:223]
 buffer_load_dwordx4 v[56:59], v2, s[4:7], s85 offen offset:3072 sc1
 v_pk_add_f32 v[254:255], v[254:255], v[242:243]
 v_pk_add_f32 v[226:227], v[226:227], v[230:231]
 v_pk_add_f32 v[212:213], v[212:213], v[252:253]
 v_pk_add_f32 v[216:217], v[216:217], v[224:225]
 v_pk_add_f32 v[214:215], v[214:215], v[254:255]
 v_pk_add_f32 v[218:219], v[218:219], v[226:227]
 v_pk_add_f32 v[100:101], v[100:101], v[212:213]
 v_pk_add_f32 v[104:105], v[104:105], v[216:217]
 v_pk_add_f32 v[102:103], v[102:103], v[214:215]
 v_pk_add_f32 v[106:107], v[106:107], v[218:219]
 v_cvt_pk_bf16_f32 v22, v100, v101
 v_cvt_pk_bf16_f32 v20, v104, v105
 v_cvt_pk_bf16_f32 v23, v102, v103
 v_cvt_pk_bf16_f32 v21, v106, v107
 buffer_store_dwordx2 v[22:23], v12, s[4:7], s90 offen nt
 buffer_store_dwordx2 v[20:21], v12, s[4:7], s91 offen offset:1024 nt
 v_add_f32 v108, v100, v101
 v_add_f32 v110, v104, v105
 v_mul_f32 v109, v100, v100
 v_mul_f32 v111, v104, v104
 v_add_f32 v108, v108, v102
 v_add_f32 v110, v110, v106
 v_fmac_f32 v109, v101, v101
 v_fmac_f32 v111, v105, v105
 v_add_f32 v108, v108, v103
 v_add_f32 v110, v110, v107
 v_fmac_f32 v109, v102, v102
 v_fmac_f32 v111, v106, v106
 v_fmac_f32 v109, v103, v103
 v_fmac_f32 v111, v107, v107
 v_add_f32_dpp v108, v108, v108 row_ror:8 row_mask:0xf bank_mask:0xf
 v_add_f32_dpp v110, v110, v110 row_ror:8 row_mask:0xf bank_mask:0xf
 v_add_f32_dpp v108, v109, v109 row_ror:8 row_mask:0xf bank_mask:0xc
 v_add_f32_dpp v110, v111, v111 row_ror:8 row_mask:0xf bank_mask:0xc
 s_nop 0
 v_add_f32_dpp v108, v108, v108 row_half_mirror row_mask:0xf bank_mask:0xf
 v_add_f32_dpp v110, v110, v110 row_half_mirror row_mask:0xf bank_mask:0xf
 s_nop 0
 v_add_f32_dpp v108, v108, v108 quad_perm:[1,0,3,2] row_mask:0xf bank_mask:0xf
 v_add_f32_dpp v110, v110, v110 quad_perm:[1,0,3,2] row_mask:0xf bank_mask:0xf
 s_nop 0
 v_add_f32_dpp v108, v108, v108 quad_perm:[2,3,0,1] row_mask:0xf bank_mask:0xf
 v_add_f32_dpp v110, v110, v110 quad_perm:[2,3,0,1] row_mask:0xf bank_mask:0xf
 buffer_store_dword v108, v14, s[4:7], s72 offen offset:3072
 buffer_store_dword v110, v14, s[4:7], s72 offen offset:2048
 buffer_load_dword v3, v7, s[4:7], s64 offen sc1
 s_waitcnt vmcnt(9)
 v_mfma_f32_16x16x32_bf16 v[116:119], v[128:131], v[44:47], 0
 v_mfma_f32_16x16x32_bf16 v[120:123], v[132:135], v[44:47], 0
 v_mfma_f32_16x16x32_bf16 v[204:207], v[136:139], v[44:47], 0
 s_add_u32 s89, s78, 0x7000
 buffer_load_dwordx4 a[56:59], v2, s[4:7], s89 offen offset:2048 sc1
 v_mfma_f32_16x16x32_bf16 v[208:211], v[140:143], v[44:47], 0
 s_waitcnt vmcnt(9)
 v_mfma_f32_16x16x32_bf16 v[116:119], v[144:147], v[48:51], v[116:119]
 v_mfma_f32_16x16x32_bf16 v[120:123], v[148:151], v[48:51], v[120:123]
 v_mfma_f32_16x16x32_bf16 v[204:207], v[152:155], v[48:51], v[204:207]
 s_add_u32 s89, s78, 0x7000
 buffer_load_dwordx4 a[60:63], v2, s[4:7], s89 offen offset:3072 sc1
 v_mfma_f32_16x16x32_bf16 v[208:211], v[156:159], v[48:51], v[208:211]
 s_waitcnt vmcnt(8)
 v_mfma_f32_16x16x32_bf16 v[116:119], v[160:163], v[52:55], v[116:119]
 v_mfma_f32_16x16x32_bf16 v[120:123], v[164:167], v[52:55], v[120:123]
 v_mfma_f32_16x16x32_bf16 v[204:207], v[168:171], v[52:55], v[204:207]
 s_add_u32 s89, s78, 0x8000
 buffer_load_dwordx4 a[64:67], v2, s[4:7], s89 offen sc1
 v_mfma_f32_16x16x32_bf16 v[208:211], v[172:175], v[52:55], v[208:211]
 s_waitcnt vmcnt(8)
 v_mfma_f32_16x16x32_bf16 v[116:119], v[176:179], v[56:59], v[116:119]
 v_mfma_f32_16x16x32_bf16 v[120:123], v[180:183], v[56:59], v[120:123]
 v_mfma_f32_16x16x32_bf16 v[204:207], v[184:187], v[56:59], v[204:207]
 s_add_u32 s89, s78, 0x8000
 buffer_load_dwordx4 a[68:71], v2, s[4:7], s89 offen offset:1024 sc1
 v_mfma_f32_16x16x32_bf16 v[208:211], v[188:191], v[56:59], v[208:211]
 s_waitcnt vmcnt(5)
 v_mov_b32 v5, 6
 buffer_store_dword v5, off, s[4:7], s67 offset:1024
 s_add_u32 s85, s70, 0x0
 s_waitcnt vmcnt(5)
 v_cmp_gt_u32 vcc, 8, v3
 s_nop 0
 s_cbranch_vccnz .Lps_48
.Lpb_49:
 buffer_load_dwordx4 v[60:63], v2, s[4:7], s85 offen sc1
 buffer_load_dwordx4 v[64:67], v2, s[4:7], s85 offen offset:1024 sc1
 buffer_load_dwordx4 v[68:71], v2, s[4:7], s85 offen offset:2048 sc1
 buffer_load_dwordx4 v[112:115], v2, s[4:7], s85 offen offset:3072 sc1
 ds_write_b128 v9, v[116:119] offset:32768
 ds_write_b128 v10, v[120:123] offset:32768
 ds_write_b128 v9, v[204:207] offset:32896
 ds_write_b128 v10, v[208:211] offset:32896
 s_add_u32 s89, s78, 0x8000
 buffer_load_dwordx4 a[72:75], v2, s[4:7], s89 offen offset:2048 sc1
 s_add_u32 s89, s78, 0x8000
 buffer_load_dwordx4 a[76:79], v2, s[4:7], s89 offen offset:3072 sc1
 s_add_u32 s89, s78, 0x9000
 buffer_load_dwordx4 a[80:83], v2, s[4:7], s89 offen sc1
 s_waitcnt lgkmcnt(0)
 s_barrier
 ds_read_b128 v[44:47], v11 offset:32768
 ds_read_b128 v[48:51], v11 offset:36864
 ds_read_b128 v[52:55], v11 offset:40960
 ds_read_b128 v[56:59], v11 offset:45056
 s_waitcnt vmcnt(6)
 v_mfma_f32_16x16x32_bf16 v[192:195], v[128:131], v[60:63], 0
 v_lshlrev_b32 v100, 16, v18
 v_and_b32 v101, 0xffff0000, v18
 v_mfma_f32_16x16x32_bf16 v[196:199], v[132:135], v[60:63], 0
 v_lshlrev_b32 v102, 16, v19
 v_and_b32 v103, 0xffff0000, v19
 v_mfma_f32_16x16x32_bf16 v[200:203], v[136:139], v[60:63], 0
 s_waitcnt lgkmcnt(2)
 buffer_load_dword v3, v6, s[4:7], s65 offen sc1
 v_add_f32 v44, v44, v48
 v_mfma_f32_16x16x32_bf16 v[124:127], v[140:143], v[60:63], 0
 s_waitcnt lgkmcnt(0)
 v_add_f32 v52, v52, v56
 v_add_f32 v45, v45, v49
 s_waitcnt vmcnt(6)
 v_mfma_f32_16x16x32_bf16 v[192:195], v[144:147], v[64:67], v[192:195]
 s_add_u32 s89, s78, 0x9000
 buffer_load_dwordx4 a[84:87], v2, s[4:7], s89 offen offset:1024 sc1
 v_add_f32 v53, v53, v57
 v_mfma_f32_16x16x32_bf16 v[196:199], v[148:151], v[64:67], v[196:199]
 v_add_f32 v46, v46, v50
 v_add_f32 v54, v54, v58
 v_mfma_f32_16x16x32_bf16 v[200:203], v[152:155], v[64:67], v[200:203]
 s_waitcnt vmcnt(6)
 v_add_f32 v47, v47, v51
 v_add_f32 v55, v55, v59
 v_mfma_f32_16x16x32_bf16 v[124:127], v[156:159], v[64:67], v[124:127]
 s_add_u32 s89, s78, 0x9000
 buffer_load_dwordx4 a[88:91], v2, s[4:7], s89 offen offset:2048 sc1
 v_add_f32 v44, v44, v52
 v_mfma_f32_16x16x32_bf16 v[192:195], v[160:163], v[68:71], v[192:195]
 v_add_f32 v45, v45, v53
 v_add_f32 v46, v46, v54
 v_mfma_f32_16x16x32_bf16 v[196:199], v[164:167], v[68:71], v[196:199]
 v_add_f32 v47, v47, v55
 v_add_f32 v100, v100, v44
 v_mfma_f32_16x16x32_bf16 v[200:203], v[168:171], v[68:71], v[200:203]
 s_add_u32 s89, s78, 0x9000
 buffer_load_dwordx4 a[92:95], v2, s[4:7], s89 offen offset:3072 sc1
 v_add_f32 v101, v101, v45
 v_mfma_f32_16x16x32_bf16 v[124:127], v[172:175], v[68:71], v[124:127]
 s_waitcnt vmcnt(7)
 v_add_f32 v102, v102, v46
 v_add_f32 v103, v103, v47
 v_mfma_f32_16x16x32_bf16 v[192:195], v[176:179], v[112:115], v[192:195]
 v_cvt_pk_bf16_f32 v18, v100, v101
 v_cvt_pk_bf16_f32 v19, v102, v103
 v_mfma_f32_16x16x32_bf16 v[196:199], v[180:183], v[112:115], v[196:199]
 s_add_u32 s89, s78, 0xa000
 buffer_load_dwordx4 a[96:99], v2, s[4:7], s89 offen sc1
 v_mfma_f32_16x16x32_bf16 v[200:203], v[184:187], v[112:115], v[200:203]
 buffer_store_dwordx2 v[18:19], v12, s[4:7], s71 offen nt
 v_add_f32 v108, v100, v101
 v_mfma_f32_16x16x32_bf16 v[124:127], v[188:191], v[112:115], v[124:127]
 s_add_u32 s89, s78, 0xa000
 buffer_load_dwordx4 a[100:103], v2, s[4:7], s89 offen offset:1024 sc1
 ds_write_b128 v9, v[192:195]
 ds_write_b128 v10, v[196:199]
 s_nop 0
 ds_write_b128 v9, v[200:203] offset:128
 s_nop 1
 ds_write_b128 v10, v[124:127] offset:128
 v_mul_f32 v109, v100, v100
 v_add_f32 v108, v108, v102
 v_fmac_f32 v109, v101, v101
 v_add_f32 v108, v108, v103
 v_fmac_f32 v109, v102, v102
 v_fmac_f32 v109, v103, v103
 v_add_f32_dpp v108, v108, v108 row_ror:8 row_mask:0xf bank_mask:0xf
 s_nop 0
 v_add_f32_dpp v108, v109, v109 row_ror:8 row_mask:0xf bank_mask:0xc
 s_nop 1
 v_add_f32_dpp v108, v108, v108 row_half_mirror row_mask:0xf bank_mask:0xf
 s_nop 1
 v_add_f32_dpp v108, v108, v108 quad_perm:[1,0,3,2] row_mask:0xf bank_mask:0xf
 s_nop 1
 v_add_f32_dpp v108, v108, v108 quad_perm:[2,3,0,1] row_mask:0xf bank_mask:0xf
 buffer_store_dword v108, v14, s[4:7], s72 offen offset:1024
 s_waitcnt vmcnt(7)
 v_cmp_gt_u32 vcc, 6, v3
 s_nop 0
 s_cbranch_vccnz .Lps_50
.Lpb_51:
 s_add_u32 s85, s73, 0x8000
 buffer_load_dwordx4 v[216:219], v2, s[4:7], s85 offen sc1
 buffer_load_dwordx4 v[220:223], v2, s[4:7], s85 offen offset:1024 sc1
 s_waitcnt lgkmcnt(0)
 s_barrier
 ds_read_b128 v[60:63], v11
 ds_read_b128 v[64:67], v11 offset:4096
 ds_read_b128 v[68:71], v11 offset:8192
 ds_read_b128 v[112:115], v11 offset:12288
 buffer_load_dwordx4 v[224:227], v2, s[4:7], s85 offen offset:2048 sc1
 buffer_load_dwordx4 v[228:231], v2, s[4:7], s85 offen offset:3072 sc1
 s_add_u32 s85, s73, 0x9000
 buffer_load_dwordx4 v[232:235], v2, s[4:7], s85 offen sc1
 buffer_load_dwordx4 v[236:239], v2, s[4:7], s85 offen offset:1024 sc1
 buffer_load_dwordx4 v[240:243], v2, s[4:7], s85 offen offset:2048 sc1
 buffer_load_dwordx4 v[244:247], v2, s[4:7], s85 offen offset:3072 sc1
 ds_read_b128 v[184:187], v2
 ds_read_b128 v[188:191], v2 offset:1024
 ds_read_b128 v[192:195], v2 offset:2048
 ds_read_b128 v[196:199], v2 offset:3072
 ds_read_b128 v[200:203], v2 offset:4096
 ds_read_b128 v[204:207], v2 offset:5120
 s_add_u32 s91, s71, 0x0
 v_lshlrev_b32 v104, 16, v16
 v_and_b32 v105, 0xffff0000, v16
 v_lshlrev_b32 v106, 16, v17
 v_and_b32 v107, 0xffff0000, v17
 s_waitcnt lgkmcnt(8)
 v_pk_add_f32 v[60:61], v[60:61], v[64:65]
 s_waitcnt lgkmcnt(6)
 v_pk_add_f32 v[68:69], v[68:69], v[112:113]
 v_pk_add_f32 v[62:63], v[62:63], v[66:67]
 v_pk_add_f32 v[70:71], v[70:71], v[114:115]
 v_pk_add_f32 v[60:61], v[60:61], v[68:69]
 v_pk_add_f32 v[62:63], v[62:63], v[70:71]
 v_pk_add_f32 v[104:105], v[104:105], v[60:61]
 v_pk_add_f32 v[106:107], v[106:107], v[62:63]
 v_cvt_pk_bf16_f32 v16, v104, v105
 v_cvt_pk_bf16_f32 v17, v106, v107
 buffer_store_dwordx2 v[16:17], v12, s[4:7], s91 offen offset:1024 nt
 v_add_f32 v110, v104, v105
 v_mul_f32 v111, v104, v104
 v_add_f32 v110, v110, v106
 v_fmac_f32 v111, v105, v105
 v_add_f32 v110, v110, v107
 v_fmac_f32 v111, v106, v106
 v_fmac_f32 v111, v107, v107
 v_add_f32_dpp v110, v110, v110 row_ror:8 row_mask:0xf bank_mask:0xf
 s_nop 0
 v_add_f32_dpp v110, v111, v111 row_ror:8 row_mask:0xf bank_mask:0xc
 s_nop 1
 v_add_f32_dpp v110, v110, v110 row_half_mirror row_mask:0xf bank_mask:0xf
 s_nop 1
 v_add_f32_dpp v110, v110, v110 quad_perm:[1,0,3,2] row_mask:0xf bank_mask:0xf
 s_nop 1
 v_add_f32_dpp v110, v110, v110 quad_perm:[2,3,0,1] row_mask:0xf bank_mask:0xf
 buffer_store_dword v110, v14, s[4:7], s72 offen
 ds_read_b128 v[208:211], v2 offset:6144
 s_waitcnt vmcnt(9) lgkmcnt(1)
 v_mfma_f32_16x16x32_bf16 v[128:131], v[184:187], v[216:219], 0
 s_add_u32 s85, s73, 0xa000
 buffer_load_dwordx4 v[248:251], v2, s[4:7], s85 offen sc1
 s_waitcnt vmcnt(9)
 v_mfma_f32_16x16x32_bf16 v[156:159], v[184:187], v[220:223], 0
 ds_read_b128 v[212:215], v2 offset:7168
 v_mfma_f32_16x16x32_bf16 v[132:135], v[188:191], v[216:219], 0
 v_mfma_f32_16x16x32_bf16 v[160:163], v[188:191], v[220:223], 0
 ds_read_b128 v[184:187], v2 offset:8192
 v_mfma_f32_16x16x32_bf16 v[136:139], v[192:195], v[216:219], 0
 buffer_load_dwordx4 v[30:33], v2, s[4:7], s74 offen offset:3072 sc1
 v_mfma_f32_16x16x32_bf16 v[164:167], v[192:195], v[220:223], 0
 ds_read_b128 v[188:191], v2 offset:9216
 v_mfma_f32_16x16x32_bf16 v[140:143], v[196:199], v[216:219], 0
 v_mfma_f32_16x16x32_bf16 v[168:171], v[196:199], v[220:223], 0
 ds_read_b128 v[192:195], v2 offset:10240
 v_mfma_f32_16x16x32_bf16 v[144:147], v[200:203], v[216:219], 0
 buffer_load_dwordx4 v[252:255], v2, s[4:7], s85 offen offset:1024 sc1
 v_mfma_f32_16x16x32_bf16 v[172:175], v[200:203], v[220:223], 0
 ds_read_b128 v[196:199], v2 offset:11264
 v_mfma_f32_16x16x32_bf16 v[148:151], v[204:207], v[216:219], 0
 v_mfma_f32_16x16x32_bf16 v[176:179], v[204:207], v[220:223], 0
 s_waitcnt lgkmcnt(4)
 buffer_load_dwordx4 v[34:37], v2, s[4:7], s74 offen offset:2048 sc1
 v_mfma_f32_16x16x32_bf16 v[152:155], v[208:211], v[216:219], 0
 ds_read_b128 v[200:203], v2 offset:12288
 v_mfma_f32_16x16x32_bf16 v[180:183], v[208:211], v[220:223], 0
 s_waitcnt vmcnt(11)
 ds_read_b128 v[204:207], v2 offset:13312
 v_mfma_f32_16x16x32_bf16 v[128:131], v[212:215], v[224:227], v[128:131]
 s_waitcnt vmcnt(10)
 buffer_load_dwordx4 v[216:219], v2, s[4:7], s85 offen offset:2048 sc1
 v_mfma_f32_16x16x32_bf16 v[156:159], v[212:215], v[228:231], v[156:159]
 s_waitcnt lgkmcnt(4)
 ds_read_b128 v[208:211], v2 offset:14336
 v_mfma_f32_16x16x32_bf16 v[132:135], v[184:187], v[224:227], v[132:135]
 v_mfma_f32_16x16x32_bf16 v[160:163], v[184:187], v[228:231], v[160:163]
 ds_read_b128 v[212:215], v2 offset:15360
 v_mfma_f32_16x16x32_bf16 v[136:139], v[188:191], v[224:227], v[136:139]
 buffer_load_dwordx4 v[72:75], v29, s[4:7], s79 offen sc1
 v_mfma_f32_16x16x32_bf16 v[164:167], v[188:191], v[228:231], v[164:167]
 s_waitcnt lgkmcnt(4)
 ds_read_b128 v[184:187], v2 offset:16384
 v_mfma_f32_16x16x32_bf16 v[140:143], v[192:195], v[224:227], v[140:143]
 v_mfma_f32_16x16x32_bf16 v[168:171], v[192:195], v[228:231], v[168:171]
 ds_read_b128 v[188:191], v2 offset:17408
 v_mfma_f32_16x16x32_bf16 v[144:147], v[196:199], v[224:227], v[144:147]
 buffer_load_dwordx4 v[220:223], v2, s[4:7], s85 offen offset:3072 sc1
 v_mfma_f32_16x16x32_bf16 v[172:175], v[196:199], v[228:231], v[172:175]
 s_waitcnt lgkmcnt(4)
 ds_read_b128 v[192:195], v2 offset:18432
 v_mfma_f32_16x16x32_bf16 v[148:151], v[200:203], v[224:227], v[148:151]
 v_mfma_f32_16x16x32_bf16 v[176:179], v[200:203], v[228:231], v[176:179]
 buffer_load_dwordx4 v[76:79], v29, s[4:7], s79 offen offset:64 sc1
 ds_read_b128 v[196:199], v2 offset:19456
 v_mfma_f32_16x16x32_bf16 v[152:155], v[204:207], v[224:227], v[152:155]
 v_mfma_f32_16x16x32_bf16 v[180:183], v[204:207], v[228:231], v[180:183]
 s_waitcnt vmcnt(13) lgkmcnt(4)
 v_mfma_f32_16x16x32_bf16 v[128:131], v[208:211], v[232:235], v[128:131]
 s_add_u32 s85, s73, 0xb000
 ds_read_b128 v[200:203], v2 offset:20480
 buffer_load_dwordx4 v[224:227], v2, s[4:7], s85 offen sc1
 s_waitcnt vmcnt(13)
 v_mfma_f32_16x16x32_bf16 v[156:159], v[208:211], v[236:239], v[156:159]
 s_lshl_b32 s87, s50, 2
 ds_read_b128 v[204:207], v2 offset:21504
 v_mfma_f32_16x16x32_bf16 v[132:135], v[212:215], v[232:235], v[132:135]
 s_waitcnt vmcnt(9)
 v_mov_b32 v5, 8
 buffer_store_dword v5, off, s[4:7], s67 offset:1024
 s_add_u32 s87, s87, s48
 s_lshl_b32 s87, s87, 9
 v_and_b32 v5, 12, v6
 v_lshl_add_u32 v5, v5, 5, s87
 v_min_u32 v5, .Lfast_end-interleave_layers__sliding_local_dilated__geglu_ffn__prompt_kernel-4, v5
 v_mfma_f32_16x16x32_bf16 v[160:163], v[212:215], v[236:239], v[160:163]
 s_waitcnt lgkmcnt(3)
 global_load_dword v0, v5, s[82:83]
 v_mfma_f32_16x16x32_bf16 v[136:139], v[184:187], v[232:235], v[136:139]
 ds_read_b128 v[208:211], v2 offset:22528
 buffer_load_dwordx4 v[80:83], v29, s[4:7], s79 offen offset:128 sc1
 v_mfma_f32_16x16x32_bf16 v[164:167], v[184:187], v[236:239], v[164:167]
 ds_read_b128 v[212:215], v2 offset:23552
 v_mfma_f32_16x16x32_bf16 v[140:143], v[188:191], v[232:235], v[140:143]
 v_mfma_f32_16x16x32_bf16 v[168:171], v[188:191], v[236:239], v[168:171]
 v_mfma_f32_16x16x32_bf16 v[144:147], v[192:195], v[232:235], v[144:147]
 s_waitcnt vmcnt(10)
 ds_read_b128 v[184:187], v2 offset:24576
 buffer_load_dwordx4 v[228:231], v2, s[4:7], s85 offen offset:1024 sc1
 v_add_f32 v38, v30, v32
 v_mfma_f32_16x16x32_bf16 v[172:175], v[192:195], v[236:239], v[172:175]
 s_waitcnt lgkmcnt(3)
 ds_read_b128 v[188:191], v2 offset:25600
 v_add_f32 v44, v31, v33
 v_mfma_f32_16x16x32_bf16 v[148:151], v[196:199], v[232:235], v[148:151]
 buffer_load_dwordx4 v[84:87], v29, s[4:7], s79 offen offset:192 sc1
 ds_read_b128 v[192:195], v2 offset:26624
 v_mfma_f32_16x16x32_bf16 v[176:179], v[196:199], v[236:239], v[176:179]
 v_permlane32_swap_b32 v38, v44
 v_mfma_f32_16x16x32_bf16 v[152:155], v[200:203], v[232:235], v[152:155]
 v_add_f32 v38, v38, v44
 v_mfma_f32_16x16x32_bf16 v[180:183], v[200:203], v[236:239], v[180:183]
 ds_read_b128 v[196:199], v2 offset:27648
 v_mov_b32 v24, v38
 v_mfma_f32_16x16x32_bf16 v[128:131], v[204:207], v[240:243], v[128:131]
 buffer_load_dwordx4 v[232:235], v2, s[4:7], s85 offen offset:2048 sc1
 v_permlane16_swap_b32 v38, v24
 v_mfma_f32_16x16x32_bf16 v[156:159], v[204:207], v[244:247], v[156:159]
 s_waitcnt lgkmcnt(3)
 ds_read_b128 v[200:203], v2 offset:28672
 v_add_f32 v38, v38, v24
 v_mfma_f32_16x16x32_bf16 v[132:135], v[208:211], v[240:243], v[132:135]
 v_mov_b32 v44, v38
 v_mfma_f32_16x16x32_bf16 v[160:163], v[208:211], v[244:247], v[160:163]
 ds_read_b128 v[204:207], v2 offset:29696
 v_permlane32_swap_b32 v38, v44
 v_mul_f32 v38, s84, v38
 v_mfma_f32_16x16x32_bf16 v[136:139], v[212:215], v[240:243], v[136:139]
 buffer_load_dwordx4 v[88:91], v29, s[4:7], s79 offen offset:256 sc1
 v_mfma_f32_16x16x32_bf16 v[164:167], v[212:215], v[244:247], v[164:167]
 ds_read_b128 v[208:211], v2 offset:30720
 v_mul_f32 v44, s84, v44
 v_mfma_f32_16x16x32_bf16 v[140:143], v[184:187], v[240:243], v[140:143]
 v_fmac_f32 v44, v38, v38
 v_min_f32 v44, 0, v44
 v_mfma_f32_16x16x32_bf16 v[168:171], v[184:187], v[244:247], v[168:171]
 s_waitcnt lgkmcnt(3)
 ds_read_b128 v[212:215], v2 offset:31744
 v_sub_f32 v44, 0x3727c5ac, v44
 v_mfma_f32_16x16x32_bf16 v[144:147], v[188:191], v[240:243], v[144:147]
 buffer_load_dwordx4 v[236:239], v2, s[4:7], s85 offen offset:3072 sc1
 ds_read_b128 v[184:187], v2 offset:32768
 v_mfma_f32_16x16x32_bf16 v[172:175], v[188:191], v[244:247], v[172:175]
 v_rsq_f32 v24, v44
 v_mfma_f32_16x16x32_bf16 v[148:151], v[192:195], v[240:243], v[148:151]
 v_mul_f32 v40, 0xc0135761, v24
 v_mfma_f32_16x16x32_bf16 v[176:179], v[192:195], v[244:247], v[176:179]
 buffer_load_dwordx4 v[92:95], v29, s[4:7], s79 offen offset:320 sc1
 ds_read_b128 v[188:191], v2 offset:33792
 v_mfma_f32_16x16x32_bf16 v[152:155], v[196:199], v[240:243], v[152:155]
 v_mul_f32 v25, v24, v24
 v_mul_f32 v25, v25, v24
 v_mfma_f32_16x16x32_bf16 v[180:183], v[196:199], v[244:247], v[180:183]
 s_waitcnt lgkmcnt(3)
 ds_read_b128 v[192:195], v2 offset:34816
 v_mul_f32 v42, 0xbdd2d3e8, v25
 v_mfma_f32_16x16x32_bf16 v[128:131], v[200:203], v[248:251], v[128:131]
 s_add_u32 s85, s73, 0xc000
 buffer_load_dwordx4 v[240:243], v2, s[4:7], s85 offen sc1
 s_waitcnt vmcnt(15)
 v_add_f32 v39, v34, v36
 v_mfma_f32_16x16x32_bf16 v[156:159], v[200:203], v[252:255], v[156:159]
 ds_read_b128 v[196:199], v2 offset:35840
 v_mfma_f32_16x16x32_bf16 v[132:135], v[204:207], v[248:251], v[132:135]
 v_add_f32 v45, v35, v37
 v_mfma_f32_16x16x32_bf16 v[160:163], v[204:207], v[252:255], v[160:163]
 ds_read_b128 v[200:203], v2 offset:36864
 v_permlane32_swap_b32 v39, v45
 v_mfma_f32_16x16x32_bf16 v[136:139], v[208:211], v[248:251], v[136:139]
 buffer_load_dwordx4 v[96:99], v29, s[4:7], s79 offen offset:384 sc1
 v_add_f32 v39, v39, v45
 v_mfma_f32_16x16x32_bf16 v[164:167], v[208:211], v[252:255], v[164:167]
 s_waitcnt lgkmcnt(3)
 ds_read_b128 v[204:207], v2 offset:37888
 v_mov_b32 v24, v39
 v_mfma_f32_16x16x32_bf16 v[140:143], v[212:215], v[248:251], v[140:143]
 ds_read_b128 v[208:211], v2 offset:38912
 v_mfma_f32_16x16x32_bf16 v[168:171], v[212:215], v[252:255], v[168:171]
 v_permlane16_swap_b32 v39, v24
 v_add_f32 v39, v39, v24
 v_mfma_f32_16x16x32_bf16 v[144:147], v[184:187], v[248:251], v[144:147]
 buffer_load_dwordx4 v[244:247], v2, s[4:7], s85 offen offset:1024 sc1
 v_mfma_f32_16x16x32_bf16 v[172:175], v[184:187], v[252:255], v[172:175]
 ds_read_b128 v[212:215], v2 offset:39936
 v_mov_b32 v45, v39
 v_mfma_f32_16x16x32_bf16 v[148:151], v[188:191], v[248:251], v[148:151]
 s_waitcnt lgkmcnt(3)
 buffer_load_dword v3, v6, s[4:7], s65 offen sc1
 v_permlane32_swap_b32 v39, v45
 v_mfma_f32_16x16x32_bf16 v[176:179], v[188:191], v[252:255], v[176:179]
 s_add_u32 s91, s78, 0xa000
 buffer_load_dwordx4 a[104:107], v2, s[4:7], s91 offen offset:2048 sc1
 ds_read_b128 v[184:187], v2 offset:40960
 v_mfma_f32_16x16x32_bf16 v[152:155], v[192:195], v[248:251], v[152:155]
 v_mul_f32 v39, s84, v39
 v_mul_f32 v45, s84, v45
 v_mfma_f32_16x16x32_bf16 v[180:183], v[192:195], v[252:255], v[180:183]
 s_waitcnt vmcnt(18)
 ds_read_b128 v[188:191], v2 offset:41984
 v_fmac_f32 v45, v39, v39
 v_mfma_f32_16x16x32_bf16 v[128:131], v[196:199], v[216:219], v[128:131]
 s_waitcnt vmcnt(16)
 buffer_load_dwordx4 v[248:251], v2, s[4:7], s85 offen offset:2048 sc1
 v_mfma_f32_16x16x32_bf16 v[156:159], v[196:199], v[220:223], v[156:159]
 ds_read_b128 v[192:195], v2 offset:43008
 v_min_f32 v45, 0, v45
 v_mfma_f32_16x16x32_bf16 v[132:135], v[200:203], v[216:219], v[132:135]
 v_sub_f32 v45, 0x3727c5ac, v45
 v_rsq_f32 v24, v45
 v_mfma_f32_16x16x32_bf16 v[160:163], v[200:203], v[220:223], v[160:163]
 s_waitcnt lgkmcnt(3)
 ds_read_b128 v[196:199], v2 offset:44032
 v_mfma_f32_16x16x32_bf16 v[136:139], v[204:207], v[216:219], v[136:139]
 v_mul_f32 v41, 0xc0135761, v24
 v_mfma_f32_16x16x32_bf16 v[164:167], v[204:207], v[220:223], v[164:167]
 ds_read_b128 v[200:203], v2 offset:45056
 v_mul_f32 v25, v24, v24
 v_mfma_f32_16x16x32_bf16 v[140:143], v[208:211], v[216:219], v[140:143]
 v_mul_f32 v25, v25, v24
 v_mul_f32 v43, 0xbdd2d3e8, v25
 v_mfma_f32_16x16x32_bf16 v[168:171], v[208:211], v[220:223], v[168:171]
 ds_read_b128 v[204:207], v2 offset:46080
 v_mfma_f32_16x16x32_bf16 v[144:147], v[212:215], v[216:219], v[144:147]
 buffer_load_dwordx4 v[252:255], v2, s[4:7], s85 offen offset:3072 sc1
 v_mfma_f32_16x16x32_bf16 v[172:175], v[212:215], v[220:223], v[172:175]
 s_waitcnt lgkmcnt(3)
 ds_read_b128 v[208:211], v2 offset:47104
 v_cmp_gt_u32 vcc, 32, v1
 v_mfma_f32_16x16x32_bf16 v[148:151], v[184:187], v[216:219], v[148:151]
 s_nop 0
 v_cndmask_b32 v46, v41, v40, vcc
 v_cndmask_b32 v47, v43, v42, vcc
 v_cndmask_b32 v48, v45, v44, vcc
 v_mfma_f32_16x16x32_bf16 v[176:179], v[184:187], v[220:223], v[176:179]
 ds_read_b128 v[212:215], v2 offset:48128
 v_mfma_f32_16x16x32_bf16 v[152:155], v[188:191], v[216:219], v[152:155]
 v_mfma_f32_16x16x32_bf16 v[180:183], v[188:191], v[220:223], v[180:183]
 s_waitcnt vmcnt(16)
 v_mfma_f32_16x16x32_bf16 v[128:131], v[192:195], v[224:227], v[128:131]
 s_add_u32 s85, s73, 0xd000
 ds_read_b128 v[184:187], v2 offset:49152
 buffer_load_dwordx4 v[216:219], v2, s[4:7], s85 offen sc1
 s_waitcnt vmcnt(13)
 v_mfma_f32_16x16x32_bf16 v[156:159], v[192:195], v[228:231], v[156:159]
 s_waitcnt lgkmcnt(3)
 ds_read_b128 v[188:191], v2 offset:50176
 v_mfma_f32_16x16x32_bf16 v[132:135], v[196:199], v[224:227], v[132:135]
 v_mfma_f32_16x16x32_bf16 v[160:163], v[196:199], v[228:231], v[160:163]
 ds_read_b128 v[192:195], v2 offset:51200
 v_mfma_f32_16x16x32_bf16 v[136:139], v[200:203], v[224:227], v[136:139]
 s_add_u32 s91, s78, 0xa000
 buffer_load_dwordx4 a[108:111], v2, s[4:7], s91 offen offset:3072 sc1
 v_mfma_f32_16x16x32_bf16 v[164:167], v[200:203], v[228:231], v[164:167]
 ds_read_b128 v[196:199], v2 offset:52224
 v_mfma_f32_16x16x32_bf16 v[140:143], v[204:207], v[224:227], v[140:143]
 v_fmac_f32 v128, v72, v38
 v_fmac_f32 v129, v73, v38
 v_mfma_f32_16x16x32_bf16 v[168:171], v[204:207], v[228:231], v[168:171]
 s_waitcnt lgkmcnt(3)
 ds_read_b128 v[200:203], v2 offset:53248
 v_fmac_f32 v130, v74, v38
 v_fmac_f32 v131, v75, v38
 v_mfma_f32_16x16x32_bf16 v[144:147], v[208:211], v[224:227], v[144:147]
 buffer_load_dwordx4 v[220:223], v2, s[4:7], s85 offen offset:1024 sc1
 v_fmac_f32 v156, v72, v39
 v_fmac_f32 v157, v73, v39
 v_mfma_f32_16x16x32_bf16 v[172:175], v[208:211], v[228:231], v[172:175]
 ds_read_b128 v[204:207], v2 offset:54272
 v_fmac_f32 v158, v74, v39
 v_mfma_f32_16x16x32_bf16 v[148:151], v[212:215], v[224:227], v[148:151]
 v_fmac_f32 v159, v75, v39
 v_mfma_f32_16x16x32_bf16 v[176:179], v[212:215], v[228:231], v[176:179]
 ds_read_b128 v[208:211], v2 offset:55296
 v_mfma_f32_16x16x32_bf16 v[152:155], v[184:187], v[224:227], v[152:155]
 v_mfma_f32_16x16x32_bf16 v[180:183], v[184:187], v[228:231], v[180:183]
 s_waitcnt vmcnt(13) lgkmcnt(3)
 ds_read_b128 v[212:215], v2 offset:56320
 v_mfma_f32_16x16x32_bf16 v[128:131], v[188:191], v[232:235], v[128:131]
 s_waitcnt vmcnt(11)
 buffer_load_dwordx4 v[224:227], v2, s[4:7], s85 offen offset:2048 sc1
 v_mfma_f32_16x16x32_bf16 v[156:159], v[188:191], v[236:239], v[156:159]
 ds_read_b128 v[184:187], v26
 v_mfma_f32_16x16x32_bf16 v[132:135], v[192:195], v[232:235], v[132:135]
 v_mfma_f32_16x16x32_bf16 v[160:163], v[192:195], v[236:239], v[160:163]
 s_waitcnt vmcnt(7)
 v_cmp_gt_u32 vcc, 8, v3
 s_nop 0
 s_cbranch_vccnz .Lps_52
.Lpb_53:
 v_mfma_f32_16x16x32_bf16 v[136:139], v[196:199], v[232:235], v[136:139]
 ds_read_b128 v[188:191], v26 offset:1024
 buffer_load_dwordx4 v[30:33], v2, s[4:7], s74 offen offset:1024 sc1
 v_mfma_f32_16x16x32_bf16 v[164:167], v[196:199], v[236:239], v[164:167]
 s_waitcnt lgkmcnt(4)
 ds_read_b128 v[192:195], v26 offset:2048
 v_mfma_f32_16x16x32_bf16 v[140:143], v[200:203], v[232:235], v[140:143]
 v_mfma_f32_16x16x32_bf16 v[168:171], v[200:203], v[236:239], v[168:171]
 ds_read_b128 v[196:199], v26 offset:3072
 buffer_load_dwordx4 v[228:231], v2, s[4:7], s85 offen offset:3072 sc1
 v_mfma_f32_16x16x32_bf16 v[144:147], v[204:207], v[232:235], v[144:147]
 v_fmac_f32 v132, v76, v38
 v_fmac_f32 v133, v77, v38
 v_mfma_f32_16x16x32_bf16 v[172:175], v[204:207], v[236:239], v[172:175]
 s_waitcnt lgkmcnt(3)
 ds_read_b128 v[200:203], v26 offset:4096
 v_fmac_f32 v134, v78, v38
 v_fmac_f32 v135, v79, v38
 v_mfma_f32_16x16x32_bf16 v[148:151], v[208:211], v[232:235], v[148:151]
 v_fmac_f32 v160, v76, v39
 v_fmac_f32 v161, v77, v39
 v_mfma_f32_16x16x32_bf16 v[176:179], v[208:211], v[236:239], v[176:179]
 buffer_load_dwordx4 v[34:37], v2, s[4:7], s74 offen sc1
 ds_read_b128 v[204:207], v26 offset:5120
 v_mfma_f32_16x16x32_bf16 v[152:155], v[212:215], v[232:235], v[152:155]
 v_fmac_f32 v162, v78, v39
 v_fmac_f32 v163, v79, v39
 v_mfma_f32_16x16x32_bf16 v[180:183], v[212:215], v[236:239], v[180:183]
 ds_read_b128 v[208:211], v26 offset:6144
 v_mfma_f32_16x16x32_bf16 v[128:131], v[184:187], v[240:243], v[128:131]
 s_add_u32 s85, s73, 0xe000
 buffer_load_dwordx4 v[232:235], v2, s[4:7], s85 offen sc1
 v_mfma_f32_16x16x32_bf16 v[156:159], v[184:187], v[244:247], v[156:159]
 s_waitcnt lgkmcnt(3)
 ds_read_b128 v[212:215], v26 offset:7168
 v_mfma_f32_16x16x32_bf16 v[132:135], v[188:191], v[240:243], v[132:135]
 v_mfma_f32_16x16x32_bf16 v[160:163], v[188:191], v[244:247], v[160:163]
 ds_read_b128 v[184:187], v26 offset:8192
 v_mfma_f32_16x16x32_bf16 v[136:139], v[192:195], v[240:243], v[136:139]
 v_mfma_f32_16x16x32_bf16 v[164:167], v[192:195], v[244:247], v[164:167]
 ds_read_b128 v[188:191], v26 offset:9216
 v_mfma_f32_16x16x32_bf16 v[140:143], v[196:199], v[240:243], v[140:143]
 v_mfma_f32_16x16x32_bf16 v[168:171], v[196:199], v[244:247], v[168:171]
 s_waitcnt lgkmcnt(5)
 ds_read_b128 v[192:195], v26 offset:10240
 v_mfma_f32_16x16x32_bf16 v[144:147], v[200:203], v[240:243], v[144:147]
 buffer_load_dwordx4 v[236:239], v2, s[4:7], s85 offen offset:1024 sc1
 v_mfma_f32_16x16x32_bf16 v[172:175], v[200:203], v[244:247], v[172:175]
 s_waitcnt lgkmcnt(4)
 ds_read_b128 v[196:199], v26 offset:11264
 v_mfma_f32_16x16x32_bf16 v[148:151], v[204:207], v[240:243], v[148:151]
 v_fmac_f32 v136, v80, v38
 v_fmac_f32 v137, v81, v38
 v_mfma_f32_16x16x32_bf16 v[176:179], v[204:207], v[244:247], v[176:179]
 s_add_u32 s91, s78, 0xb000
 buffer_load_dwordx4 a[112:115], v2, s[4:7], s91 offen sc1
 ds_read_b128 v[200:203], v26 offset:12288
 v_fmac_f32 v138, v82, v38
 v_mfma_f32_16x16x32_bf16 v[152:155], v[208:211], v[240:243], v[152:155]
 v_fmac_f32 v139, v83, v38
 v_fmac_f32 v164, v80, v39
 v_fmac_f32 v165, v81, v39
 v_mfma_f32_16x16x32_bf16 v[180:183], v[208:211], v[244:247], v[180:183]
 s_waitcnt vmcnt(11) lgkmcnt(3)
 ds_read_b128 v[204:207], v26 offset:13312
 v_fmac_f32 v166, v82, v39
 v_fmac_f32 v167, v83, v39
 v_mfma_f32_16x16x32_bf16 v[128:131], v[212:215], v[248:251], v[128:131]
 s_waitcnt vmcnt(10)
 buffer_load_dwordx4 v[240:243], v2, s[4:7], s85 offen offset:2048 sc1
 v_fmac_f32 v168, v84, v39
 v_fmac_f32 v169, v85, v39
 v_mfma_f32_16x16x32_bf16 v[156:159], v[212:215], v[252:255], v[156:159]
 ds_read_b128 v[208:211], v26 offset:14336
 v_fmac_f32 v170, v86, v39
 v_mfma_f32_16x16x32_bf16 v[132:135], v[184:187], v[248:251], v[132:135]
 v_fmac_f32 v171, v87, v39
 v_mfma_f32_16x16x32_bf16 v[160:163], v[184:187], v[252:255], v[160:163]
 ds_read_b128 v[212:215], v26 offset:15360
 v_mfma_f32_16x16x32_bf16 v[136:139], v[188:191], v[248:251], v[136:139]
 v_mfma_f32_16x16x32_bf16 v[164:167], v[188:191], v[252:255], v[164:167]
 s_waitcnt lgkmcnt(3)
 ds_read_b128 v[184:187], v26 offset:16384
 v_mfma_f32_16x16x32_bf16 v[140:143], v[192:195], v[248:251], v[140:143]
 v_mfma_f32_16x16x32_bf16 v[168:171], v[192:195], v[252:255], v[168:171]
 ds_read_b128 v[188:191], v26 offset:17408
 v_mfma_f32_16x16x32_bf16 v[144:147], v[196:199], v[248:251], v[144:147]
 buffer_load_dwordx4 v[244:247], v2, s[4:7], s85 offen offset:3072 sc1
 v_mfma_f32_16x16x32_bf16 v[172:175], v[196:199], v[252:255], v[172:175]
 ds_read_b128 v[192:195], v26 offset:18432
 v_mfma_f32_16x16x32_bf16 v[148:151], v[200:203], v[248:251], v[148:151]
 s_waitcnt vmcnt(7)
 v_add_f32 v49, v30, v32
 v_add_f32 v54, v31, v33
 v_mfma_f32_16x16x32_bf16 v[176:179], v[200:203], v[252:255], v[176:179]
 s_waitcnt lgkmcnt(4)
 ds_read_b128 v[196:199], v26 offset:19456
 v_permlane32_swap_b32 v49, v54
 v_mfma_f32_16x16x32_bf16 v[152:155], v[204:207], v[248:251], v[152:155]
 v_add_f32 v49, v49, v54
 v_fmac_f32 v140, v84, v38
 v_fmac_f32 v141, v85, v38
 v_mfma_f32_16x16x32_bf16 v[180:183], v[204:207], v[252:255], v[180:183]
 ds_read_b128 v[200:203], v26 offset:20480
 v_fmac_f32 v142, v86, v38
 v_fmac_f32 v143, v87, v38
 v_mfma_f32_16x16x32_bf16 v[128:131], v[208:211], v[216:219], v[128:131]
 s_add_u32 s85, s73, 0xf000
 buffer_load_dwordx4 v[248:251], v2, s[4:7], s85 offen sc1
 v_fmac_f32 v144, v88, v38
 v_fmac_f32 v145, v89, v38
 v_mfma_f32_16x16x32_bf16 v[156:159], v[208:211], v[220:223], v[156:159]
 s_waitcnt lgkmcnt(2)
 ds_read_b128 v[204:207], v26 offset:21504
 v_fmac_f32 v146, v90, v38
 v_fmac_f32 v147, v91, v38
 v_mfma_f32_16x16x32_bf16 v[132:135], v[212:215], v[216:219], v[132:135]
 v_fmac_f32 v172, v88, v39
 v_fmac_f32 v173, v89, v39
 v_mfma_f32_16x16x32_bf16 v[160:163], v[212:215], v[220:223], v[160:163]
 ds_read_b128 v[208:211], v26 offset:22528
 v_fmac_f32 v174, v90, v39
 v_fmac_f32 v175, v91, v39
 v_mfma_f32_16x16x32_bf16 v[136:139], v[184:187], v[216:219], v[136:139]
 s_add_u32 s91, s78, 0xb000
 buffer_load_dwordx4 a[116:119], v2, s[4:7], s91 offen offset:1024 sc1
 v_mfma_f32_16x16x32_bf16 v[164:167], v[184:187], v[220:223], v[164:167]
 ds_read_b128 v[212:215], v26 offset:23552
 v_mfma_f32_16x16x32_bf16 v[140:143], v[188:191], v[216:219], v[140:143]
 v_mov_b32 v24, v49
 v_mfma_f32_16x16x32_bf16 v[168:171], v[188:191], v[220:223], v[168:171]
 ds_read_b128 v[184:187], v26 offset:24576
 v_permlane16_swap_b32 v49, v24
 v_add_f32 v49, v49, v24
 v_mfma_f32_16x16x32_bf16 v[144:147], v[192:195], v[216:219], v[144:147]
 buffer_load_dwordx4 v[252:255], v2, s[4:7], s85 offen offset:1024 sc1
 v_mov_b32 v54, v49
 v_mfma_f32_16x16x32_bf16 v[172:175], v[192:195], v[220:223], v[172:175]
 s_waitcnt lgkmcnt(3)
 ds_read_b128 v[188:191], v26 offset:25600
 v_permlane32_swap_b32 v49, v54
 v_mfma_f32_16x16x32_bf16 v[148:151], v[196:199], v[216:219], v[148:151]
 v_mul_f32 v49, s84, v49
 v_mul_f32 v54, s84, v54
 v_fmac_f32 v54, v49, v49
 v_mfma_f32_16x16x32_bf16 v[176:179], v[196:199], v[220:223], v[176:179]
 ds_read_b128 v[192:195], v26 offset:26624
 v_min_f32 v54, 0, v54
 v_sub_f32 v54, 0x3727c5ac, v54
 v_mfma_f32_16x16x32_bf16 v[152:155], v[200:203], v[216:219], v[152:155]
 v_rsq_f32 v24, v54
 v_mfma_f32_16x16x32_bf16 v[180:183], v[200:203], v[220:223], v[180:183]
 ds_read_b128 v[196:199], v26 offset:27648
 v_mul_f32 v50, 0xc0135761, v24
 v_mul_f32 v25, v24, v24
 v_mfma_f32_16x16x32_bf16 v[128:131], v[204:207], v[224:227], v[128:131]
 s_waitcnt vmcnt(9)
 buffer_load_dwordx4 v[216:219], v2, s[4:7], s85 offen offset:2048 sc1
 v_mul_f32 v25, v25, v24
 v_mfma_f32_16x16x32_bf16 v[156:159], v[204:207], v[228:231], v[156:159]
 s_waitcnt lgkmcnt(2)
 ds_read_b128 v[200:203], v26 offset:28672
 v_mul_f32 v52, 0xbdd2d3e8, v25
 v_mfma_f32_16x16x32_bf16 v[132:135], v[208:211], v[224:227], v[132:135]
 s_waitcnt vmcnt(9)
 v_fmac_f32 v148, v92, v38
 v_fmac_f32 v149, v93, v38
 v_add_f32 v59, v34, v36
 v_mfma_f32_16x16x32_bf16 v[160:163], v[208:211], v[228:231], v[160:163]
 ds_read_b128 v[204:207], v26 offset:29696
 v_fmac_f32 v150, v94, v38
 v_fmac_f32 v151, v95, v38
 v_mfma_f32_16x16x32_bf16 v[136:139], v[212:215], v[224:227], v[136:139]
 v_fmac_f32 v176, v92, v39
 v_fmac_f32 v177, v93, v39
 v_mfma_f32_16x16x32_bf16 v[164:167], v[212:215], v[228:231], v[164:167]
 ds_read_b128 v[208:211], v26 offset:30720
 v_fmac_f32 v178, v94, v39
 v_mfma_f32_16x16x32_bf16 v[140:143], v[184:187], v[224:227], v[140:143]
 v_fmac_f32 v179, v95, v39
 v_add_f32 v55, v35, v37
 v_mfma_f32_16x16x32_bf16 v[168:171], v[184:187], v[228:231], v[168:171]
 ds_read_b128 v[212:215], v26 offset:31744
 v_permlane32_swap_b32 v59, v55
 v_mfma_f32_16x16x32_bf16 v[144:147], v[188:191], v[224:227], v[144:147]
 buffer_load_dwordx4 v[220:223], v2, s[4:7], s85 offen offset:3072 sc1
 v_add_f32 v59, v59, v55
 v_mov_b32 v24, v59
 v_mfma_f32_16x16x32_bf16 v[172:175], v[188:191], v[228:231], v[172:175]
 s_waitcnt lgkmcnt(3)
 ds_read_b128 v[184:187], v26 offset:32768
 v_permlane16_swap_b32 v59, v24
 v_mfma_f32_16x16x32_bf16 v[148:151], v[192:195], v[224:227], v[148:151]
 v_add_f32 v59, v59, v24
 v_mov_b32 v55, v59
 v_mfma_f32_16x16x32_bf16 v[176:179], v[192:195], v[228:231], v[176:179]
 s_add_u32 s91, s78, 0xb000
 buffer_load_dwordx4 a[120:123], v2, s[4:7], s91 offen offset:2048 sc1
 ds_read_b128 v[188:191], v26 offset:33792
 v_mfma_f32_16x16x32_bf16 v[152:155], v[196:199], v[224:227], v[152:155]
 v_permlane32_swap_b32 v59, v55
 v_mul_f32 v59, s84, v59
 v_mul_f32 v55, s84, v55
 v_mfma_f32_16x16x32_bf16 v[180:183], v[196:199], v[228:231], v[180:183]
 s_waitcnt vmcnt(10)
 ds_read_b128 v[192:195], v26 offset:34816
 v_fmac_f32 v55, v59, v59
 v_mfma_f32_16x16x32_bf16 v[128:131], v[200:203], v[232:235], v[128:131]
 s_add_u32 s85, s73, 0x0
 buffer_load_dwordx4 v[224:227], v2, s[4:7], s85 offen sc1
 v_min_f32 v55, 0, v55
 s_waitcnt vmcnt(10)
 v_mfma_f32_16x16x32_bf16 v[156:159], v[200:203], v[236:239], v[156:159]
 s_waitcnt lgkmcnt(2)
 ds_read_b128 v[196:199], v26 offset:35840
 v_sub_f32 v55, 0x3727c5ac, v55
 v_mfma_f32_16x16x32_bf16 v[132:135], v[204:207], v[232:235], v[132:135]
 v_rsq_f32 v24, v55
 v_mfma_f32_16x16x32_bf16 v[160:163], v[204:207], v[236:239], v[160:163]
 ds_read_b128 v[200:203], v26 offset:36864
 v_mul_f32 v51, 0xc0135761, v24
 v_mul_f32 v25, v24, v24
 v_mfma_f32_16x16x32_bf16 v[136:139], v[208:211], v[232:235], v[136:139]
 v_fmac_f32 v152, v96, v38
 v_fmac_f32 v153, v97, v38
 v_mfma_f32_16x16x32_bf16 v[164:167], v[208:211], v[236:239], v[164:167]
 ds_read_b128 v[204:207], v26 offset:37888
 v_fmac_f32 v154, v98, v38
 v_fmac_f32 v155, v99, v38
 v_mfma_f32_16x16x32_bf16 v[140:143], v[212:215], v[232:235], v[140:143]
 v_fmac_f32 v180, v96, v39
 v_fmac_f32 v181, v97, v39
 v_mfma_f32_16x16x32_bf16 v[168:171], v[212:215], v[236:239], v[168:171]
 ds_read_b128 v[208:211], v26 offset:38912
 v_fmac_f32 v182, v98, v39
 v_fmac_f32 v183, v99, v39
 v_mfma_f32_16x16x32_bf16 v[144:147], v[184:187], v[232:235], v[144:147]
 buffer_load_dwordx4 v[228:231], v2, s[4:7], s85 offen offset:1024 sc1
 v_mfma_f32_16x16x32_bf16 v[172:175], v[184:187], v[236:239], v[172:175]
 s_waitcnt lgkmcnt(3)
 ds_read_b128 v[212:215], v26 offset:39936
 v_mfma_f32_16x16x32_bf16 v[148:151], v[188:191], v[232:235], v[148:151]
 v_mul_f32 v25, v25, v24
 v_mul_f32 v53, 0xbdd2d3e8, v25
 v_mfma_f32_16x16x32_bf16 v[176:179], v[188:191], v[236:239], v[176:179]
 ds_read_b128 v[184:187], v26 offset:40960
 v_cmp_gt_u32 vcc, 32, v1
 v_mfma_f32_16x16x32_bf16 v[152:155], v[192:195], v[232:235], v[152:155]
 s_nop 0
 v_cndmask_b32 v56, v51, v50, vcc
 v_cndmask_b32 v57, v53, v52, vcc
 v_cndmask_b32 v58, v55, v54, vcc
 v_mfma_f32_16x16x32_bf16 v[180:183], v[192:195], v[236:239], v[180:183]
 s_waitcnt vmcnt(9)
 ds_read_b128 v[188:191], v26 offset:41984
 v_mfma_f32_16x16x32_bf16 v[128:131], v[196:199], v[240:243], v[128:131]
 s_waitcnt vmcnt(8)
 buffer_load_dwordx4 v[232:235], v2, s[4:7], s85 offen offset:2048 sc1
 v_mfma_f32_16x16x32_bf16 v[156:159], v[196:199], v[244:247], v[156:159]
 s_waitcnt lgkmcnt(3)
 ds_read_b128 v[192:195], v26 offset:43008
 v_mul_f32 v100, v72, v59
 v_mfma_f32_16x16x32_bf16 v[132:135], v[200:203], v[240:243], v[132:135]
 v_mul_f32 v72, v72, v49
 v_mul_f32 v101, v73, v59
 v_mul_f32 v73, v73, v49
 v_mfma_f32_16x16x32_bf16 v[160:163], v[200:203], v[244:247], v[160:163]
 ds_read_b128 v[196:199], v26 offset:44032
 v_mul_f32 v102, v74, v59
 v_mfma_f32_16x16x32_bf16 v[136:139], v[204:207], v[240:243], v[136:139]
 s_add_u32 s91, s78, 0xb000
 buffer_load_dwordx4 a[124:127], v2, s[4:7], s91 offen offset:3072 sc1
 v_mul_f32 v74, v74, v49
 v_mfma_f32_16x16x32_bf16 v[164:167], v[204:207], v[244:247], v[164:167]
 ds_read_b128 v[200:203], v26 offset:45056
 v_mul_f32 v103, v75, v59
 v_mfma_f32_16x16x32_bf16 v[140:143], v[208:211], v[240:243], v[140:143]
 v_mul_f32 v75, v75, v49
 v_mul_f32 v104, v76, v59
 v_mul_f32 v76, v76, v49
 v_mfma_f32_16x16x32_bf16 v[168:171], v[208:211], v[244:247], v[168:171]
 s_waitcnt lgkmcnt(2)
 ds_read_b128 v[204:207], v26 offset:46080
 v_mul_f32 v105, v77, v59
 v_mfma_f32_16x16x32_bf16 v[144:147], v[212:215], v[240:243], v[144:147]
 buffer_load_dwordx4 v[236:239], v2, s[4:7], s85 offen offset:3072 sc1
 v_mul_f32 v77, v77, v49
 v_mfma_f32_16x16x32_bf16 v[172:175], v[212:215], v[244:247], v[172:175]
 ds_read_b128 v[208:211], v26 offset:47104
 v_mul_f32 v106, v78, v59
 v_mfma_f32_16x16x32_bf16 v[148:151], v[184:187], v[240:243], v[148:151]
 v_mul_f32 v78, v78, v49
 v_mul_f32 v107, v79, v59
 v_mul_f32 v79, v79, v49
 v_mfma_f32_16x16x32_bf16 v[176:179], v[184:187], v[244:247], v[176:179]
 ds_read_b128 v[212:215], v26 offset:48128
 v_mul_f32 v108, v80, v59
 v_mfma_f32_16x16x32_bf16 v[152:155], v[188:191], v[240:243], v[152:155]
 v_mul_f32 v80, v80, v49
 v_mul_f32 v109, v81, v59
 v_mfma_f32_16x16x32_bf16 v[180:183], v[188:191], v[244:247], v[180:183]
 s_waitcnt vmcnt(10)
 ds_read_b128 v[184:187], v26 offset:49152
 v_mul_f32 v81, v81, v49
 v_mfma_f32_16x16x32_bf16 v[128:131], v[192:195], v[248:251], v[128:131]
 s_add_u32 s85, s73, 0x1000
 buffer_load_dwordx4 v[240:243], v2, s[4:7], s85 offen sc1
 v_mul_f32 v110, v82, v59
 s_waitcnt vmcnt(9)
 v_mfma_f32_16x16x32_bf16 v[156:159], v[192:195], v[252:255], v[156:159]
 s_waitcnt lgkmcnt(2)
 ds_read_b128 v[188:191], v26 offset:50176
 v_mul_f32 v82, v82, v49
 v_mul_f32 v111, v83, v59
 v_mfma_f32_16x16x32_bf16 v[132:135], v[196:199], v[248:251], v[132:135]
 v_mul_f32 v83, v83, v49
 v_mul_f32 v112, v84, v59
 v_mfma_f32_16x16x32_bf16 v[160:163], v[196:199], v[252:255], v[160:163]
 ds_read_b128 v[192:195], v26 offset:51200
 v_mul_f32 v84, v84, v49
 v_mfma_f32_16x16x32_bf16 v[136:139], v[200:203], v[248:251], v[136:139]
 v_mul_f32 v113, v85, v59
 v_mul_f32 v85, v85, v49
 v_mfma_f32_16x16x32_bf16 v[164:167], v[200:203], v[252:255], v[164:167]
 ds_read_b128 v[196:199], v26 offset:52224
 v_mul_f32 v114, v86, v59
 v_mul_f32 v86, v86, v49
 v_mfma_f32_16x16x32_bf16 v[140:143], v[204:207], v[248:251], v[140:143]
 v_mul_f32 v115, v87, v59
 v_mul_f32 v87, v87, v49
 v_mfma_f32_16x16x32_bf16 v[168:171], v[204:207], v[252:255], v[168:171]
 ds_read_b128 v[200:203], v26 offset:53248
 v_mul_f32 v116, v88, v59
 v_mfma_f32_16x16x32_bf16 v[144:147], v[208:211], v[248:251], v[144:147]
 buffer_load_dwordx4 v[244:247], v2, s[4:7], s85 offen offset:1024 sc1
 v_mul_f32 v88, v88, v49
 v_mfma_f32_16x16x32_bf16 v[172:175], v[208:211], v[252:255], v[172:175]
 s_waitcnt lgkmcnt(3)
 ds_read_b128 v[204:207], v26 offset:54272
 v_mul_f32 v117, v89, v59
 v_mfma_f32_16x16x32_bf16 v[148:151], v[212:215], v[248:251], v[148:151]
 v_mul_f32 v89, v89, v49
 v_mul_f32 v118, v90, v59
 v_mfma_f32_16x16x32_bf16 v[176:179], v[212:215], v[252:255], v[176:179]
 s_add_u32 s91, s78, 0xc000
 buffer_load_dwordx4 a[128:131], v2, s[4:7], s91 offen sc1
 ds_read_b128 v[208:211], v26 offset:55296
 v_mfma_f32_16x16x32_bf16 v[152:155], v[184:187], v[248:251], v[152:155]
 v_mul_f32 v90, v90, v49
 v_mul_f32 v119, v91, v59
 v_mul_f32 v91, v91, v49
 v_mfma_f32_16x16x32_bf16 v[180:183], v[184:187], v[252:255], v[180:183]
 s_waitcnt vmcnt(10)
 ds_read_b128 v[212:215], v26 offset:56320
 v_mul_f32 v120, v92, v59
 v_mfma_f32_16x16x32_bf16 v[128:131], v[188:191], v[216:219], v[128:131]
 s_waitcnt vmcnt(9)
 buffer_load_dwordx4 v[248:251], v2, s[4:7], s85 offen offset:2048 sc1
 v_mul_f32 v92, v92, v49
 v_mfma_f32_16x16x32_bf16 v[156:159], v[188:191], v[220:223], v[156:159]
 s_waitcnt lgkmcnt(2)
 ds_read_b128 v[184:187], v2
 v_mul_f32 v121, v93, v59
 v_mfma_f32_16x16x32_bf16 v[132:135], v[192:195], v[216:219], v[132:135]
 v_mul_f32 v93, v93, v49
 v_mul_f32 v122, v94, v59
 v_mfma_f32_16x16x32_bf16 v[160:163], v[192:195], v[220:223], v[160:163]
 ds_read_b128 v[188:191], v2 offset:1024
 v_mul_f32 v94, v94, v49
 v_mfma_f32_16x16x32_bf16 v[136:139], v[196:199], v[216:219], v[136:139]
 v_mul_f32 v123, v95, v59
 v_mul_f32 v95, v95, v49
 v_mfma_f32_16x16x32_bf16 v[164:167], v[196:199], v[220:223], v[164:167]
 ds_read_b128 v[192:195], v2 offset:2048
 v_mul_f32 v124, v96, v59
 v_mfma_f32_16x16x32_bf16 v[140:143], v[200:203], v[216:219], v[140:143]
 v_mul_f32 v96, v96, v49
 v_mul_f32 v125, v97, v59
 v_mfma_f32_16x16x32_bf16 v[168:171], v[200:203], v[220:223], v[168:171]
 ds_read_b128 v[196:199], v2 offset:3072
 v_mul_f32 v97, v97, v49
 v_mfma_f32_16x16x32_bf16 v[144:147], v[204:207], v[216:219], v[144:147]
 buffer_load_dwordx4 v[252:255], v2, s[4:7], s85 offen offset:3072 sc1
 v_mul_f32 v126, v98, v59
 v_mfma_f32_16x16x32_bf16 v[172:175], v[204:207], v[220:223], v[172:175]
 s_waitcnt lgkmcnt(3)
 ds_read_b128 v[200:203], v2 offset:4096
 v_mul_f32 v98, v98, v49
 v_mfma_f32_16x16x32_bf16 v[148:151], v[208:211], v[216:219], v[148:151]
 v_mul_f32 v127, v99, v59
 v_mul_f32 v99, v99, v49
 v_mfma_f32_16x16x32_bf16 v[176:179], v[208:211], v[220:223], v[176:179]
 ds_read_b128 v[204:207], v2 offset:5120
 v_mfma_f32_16x16x32_bf16 v[152:155], v[212:215], v[216:219], v[152:155]
 v_mfma_f32_16x16x32_bf16 v[180:183], v[212:215], v[220:223], v[180:183]
 s_waitcnt vmcnt(9)
 v_mfma_f32_16x16x32_bf16 v[72:75], v[184:187], v[224:227], v[72:75]
 s_add_u32 s85, s73, 0x2000
 ds_read_b128 v[208:211], v2 offset:6144
 buffer_load_dwordx4 v[216:219], v2, s[4:7], s85 offen sc1
 s_waitcnt vmcnt(9)
 v_mfma_f32_16x16x32_bf16 v[100:103], v[184:187], v[228:231], v[100:103]
 s_waitcnt lgkmcnt(3)
 ds_read_b128 v[212:215], v2 offset:7168
 v_mfma_f32_16x16x32_bf16 v[76:79], v[188:191], v[224:227], v[76:79]
 v_mfma_f32_16x16x32_bf16 v[104:107], v[188:191], v[228:231], v[104:107]
 v_mfma_f32_16x16x32_bf16 v[80:83], v[192:195], v[224:227], v[80:83]
 s_add_u32 s91, s78, 0xc000
 ds_read_b128 v[184:187], v2 offset:8192
 buffer_load_dwordx4 a[132:135], v2, s[4:7], s91 offen offset:1024 sc1
 v_permlane32_swap_b32 v152, v180
 v_permlane32_swap_b32 v153, v181
 v_mfma_f32_16x16x32_bf16 v[108:111], v[192:195], v[228:231], v[108:111]
 ds_read_b128 v[188:191], v2 offset:9216
 v_permlane32_swap_b32 v154, v182
 v_mfma_f32_16x16x32_bf16 v[84:87], v[196:199], v[224:227], v[84:87]
 s_add_u32 s90, s75, 0x0
 v_permlane32_swap_b32 v155, v183
 v_mul_f32 v60, v152, v152
 v_mfma_f32_16x16x32_bf16 v[112:115], v[196:199], v[228:231], v[112:115]
 s_waitcnt lgkmcnt(3)
 ds_read_b128 v[192:195], v2 offset:10240
 v_mul_f32 v61, v153, v153
 v_mfma_f32_16x16x32_bf16 v[88:91], v[200:203], v[224:227], v[88:91]
 buffer_load_dwordx4 v[220:223], v2, s[4:7], s85 offen offset:1024 sc1
 v_mul_f32 v62, v154, v154
 v_mfma_f32_16x16x32_bf16 v[116:119], v[200:203], v[228:231], v[116:119]
 ds_read_b128 v[196:199], v2 offset:11264
 v_mul_f32 v63, v155, v155
 v_fma_f32 v60, v60, v47, v46
 v_mfma_f32_16x16x32_bf16 v[92:95], v[204:207], v[224:227], v[92:95]
 v_fma_f32 v61, v61, v47, v46
 v_fma_f32 v62, v62, v47, v46
 v_mfma_f32_16x16x32_bf16 v[120:123], v[204:207], v[228:231], v[120:123]
 ds_read_b128 v[200:203], v2 offset:12288
 v_fma_f32 v63, v63, v47, v46
 v_mfma_f32_16x16x32_bf16 v[96:99], v[208:211], v[224:227], v[96:99]
 v_mul_f32 v60, v60, v152
 v_mul_f32 v61, v61, v153
 v_mfma_f32_16x16x32_bf16 v[124:127], v[208:211], v[228:231], v[124:127]
 s_waitcnt vmcnt(10) lgkmcnt(2)
 ds_read_b128 v[204:207], v2 offset:13312
 v_mul_f32 v62, v62, v154
 v_mul_f32 v63, v63, v155
 v_mfma_f32_16x16x32_bf16 v[72:75], v[212:215], v[232:235], v[72:75]
 s_waitcnt vmcnt(8)
 buffer_load_dwordx4 v[224:227], v2, s[4:7], s85 offen offset:2048 sc1
 v_exp_f32 v60, v60
 v_mfma_f32_16x16x32_bf16 v[100:103], v[212:215], v[236:239], v[100:103]
 ds_read_b128 v[208:211], v2 offset:14336
 v_mul_f32 v64, v152, v180
 v_mfma_f32_16x16x32_bf16 v[76:79], v[184:187], v[232:235], v[76:79]
 v_exp_f32 v61, v61
 v_mfma_f32_16x16x32_bf16 v[104:107], v[184:187], v[236:239], v[104:107]
 ds_read_b128 v[212:215], v2 offset:15360
 v_mul_f32 v65, v153, v181
 v_mfma_f32_16x16x32_bf16 v[80:83], v[188:191], v[232:235], v[80:83]
 v_exp_f32 v62, v62
 v_mfma_f32_16x16x32_bf16 v[108:111], v[188:191], v[236:239], v[108:111]
 ds_read_b128 v[184:187], v2 offset:16384
 v_mul_f32 v66, v154, v182
 v_mfma_f32_16x16x32_bf16 v[84:87], v[192:195], v[232:235], v[84:87]
 v_exp_f32 v63, v63
 v_mul_f32 v67, v155, v183
 v_mfma_f32_16x16x32_bf16 v[112:115], v[192:195], v[236:239], v[112:115]
 s_waitcnt lgkmcnt(3)
 ds_read_b128 v[188:191], v2 offset:17408
 v_fma_f32 v60, v60, v48, v48
 v_mfma_f32_16x16x32_bf16 v[88:91], v[196:199], v[232:235], v[88:91]
 buffer_load_dwordx4 v[228:231], v2, s[4:7], s85 offen offset:3072 sc1
 v_rcp_f32 v60, v60
 v_mfma_f32_16x16x32_bf16 v[116:119], v[196:199], v[236:239], v[116:119]
 ds_read_b128 v[192:195], v2 offset:18432
 v_fma_f32 v61, v61, v48, v48
 v_mfma_f32_16x16x32_bf16 v[92:95], v[200:203], v[232:235], v[92:95]
 v_rcp_f32 v61, v61
 v_mfma_f32_16x16x32_bf16 v[120:123], v[200:203], v[236:239], v[120:123]
 s_add_u32 s91, s78, 0xc000
 buffer_load_dwordx4 a[136:139], v2, s[4:7], s91 offen offset:2048 sc1
 v_mfma_f32_16x16x32_bf16 v[96:99], v[204:207], v[232:235], v[96:99]
 ds_read_b128 v[196:199], v2 offset:19456
 v_fma_f32 v62, v62, v48, v48
 v_mfma_f32_16x16x32_bf16 v[124:127], v[204:207], v[236:239], v[124:127]
 s_waitcnt vmcnt(10) lgkmcnt(3)
 ds_read_b128 v[200:203], v2 offset:20480
 v_rcp_f32 v62, v62
 v_mfma_f32_16x16x32_bf16 v[72:75], v[208:211], v[240:243], v[72:75]
 s_add_u32 s85, s73, 0x3000
 buffer_load_dwordx4 v[232:235], v2, s[4:7], s85 offen sc1
 v_fma_f32 v63, v63, v48, v48
 s_waitcnt vmcnt(10)
 v_mfma_f32_16x16x32_bf16 v[100:103], v[208:211], v[244:247], v[100:103]
 ds_read_b128 v[204:207], v2 offset:21504
 v_rcp_f32 v63, v63
 v_mfma_f32_16x16x32_bf16 v[76:79], v[212:215], v[240:243], v[76:79]
 v_mul_f32 v60, v60, v64
 v_mfma_f32_16x16x32_bf16 v[104:107], v[212:215], v[244:247], v[104:107]
 ds_read_b128 v[208:211], v2 offset:22528
 v_mul_f32 v61, v61, v65
 v_mul_f32 v62, v62, v66
 v_mfma_f32_16x16x32_bf16 v[80:83], v[184:187], v[240:243], v[80:83]
 v_mul_f32 v63, v63, v67
 v_cvt_pk_bf16_f32 v68, v60, v61
 v_mfma_f32_16x16x32_bf16 v[108:111], v[184:187], v[244:247], v[108:111]
 s_waitcnt lgkmcnt(2)
 ds_read_b128 v[212:215], v2 offset:23552
 v_cvt_pk_bf16_f32 v69, v62, v63
 v_mfma_f32_16x16x32_bf16 v[84:87], v[188:191], v[240:243], v[84:87]
 buffer_store_dwordx2 v[68:69], v28, s[4:7], s90 offen offset:1536 nt
 s_add_u32 s90, s75, 0xe000
 v_mul_f32 v60, v128, v128
 v_mfma_f32_16x16x32_bf16 v[112:115], v[188:191], v[244:247], v[112:115]
 ds_read_b128 v[184:187], v2 offset:24576
 v_mul_f32 v61, v129, v129
 v_mfma_f32_16x16x32_bf16 v[88:91], v[192:195], v[240:243], v[88:91]
 buffer_load_dwordx4 v[236:239], v2, s[4:7], s85 offen offset:1024 sc1
 v_mul_f32 v62, v130, v130
 v_mul_f32 v63, v131, v131
 v_mfma_f32_16x16x32_bf16 v[116:119], v[192:195], v[244:247], v[116:119]
 ds_read_b128 v[188:191], v2 offset:25600
 v_fma_f32 v60, v60, v42, v40
 v_mfma_f32_16x16x32_bf16 v[92:95], v[196:199], v[240:243], v[92:95]
 v_fma_f32 v61, v61, v42, v40
 v_fma_f32 v62, v62, v42, v40
 v_mfma_f32_16x16x32_bf16 v[120:123], v[196:199], v[244:247], v[120:123]
 ds_read_b128 v[192:195], v2 offset:26624
 v_fma_f32 v63, v63, v42, v40
 v_mfma_f32_16x16x32_bf16 v[96:99], v[200:203], v[240:243], v[96:99]
 v_mul_f32 v60, v60, v128
 v_mul_f32 v61, v61, v129
 v_mul_f32 v62, v62, v130
 v_mfma_f32_16x16x32_bf16 v[124:127], v[200:203], v[244:247], v[124:127]
 s_waitcnt vmcnt(10) lgkmcnt(3)
 ds_read_b128 v[196:199], v2 offset:27648
 v_mul_f32 v63, v63, v131
 v_mfma_f32_16x16x32_bf16 v[72:75], v[204:207], v[248:251], v[72:75]
 s_waitcnt vmcnt(9)
 buffer_load_dwordx4 v[240:243], v2, s[4:7], s85 offen offset:2048 sc1
 v_exp_f32 v60, v60
 v_mfma_f32_16x16x32_bf16 v[100:103], v[204:207], v[252:255], v[100:103]
 ds_read_b128 v[200:203], v2 offset:28672
 v_mul_f32 v64, v128, v132
 v_mfma_f32_16x16x32_bf16 v[76:79], v[208:211], v[248:251], v[76:79]
 v_exp_f32 v61, v61
 v_mfma_f32_16x16x32_bf16 v[104:107], v[208:211], v[252:255], v[104:107]
 ds_read_b128 v[204:207], v2 offset:29696
 v_mul_f32 v65, v129, v133
 v_mfma_f32_16x16x32_bf16 v[80:83], v[212:215], v[248:251], v[80:83]
 s_add_u32 s91, s78, 0xc000
 buffer_load_dwordx4 a[140:143], v2, s[4:7], s91 offen offset:3072 sc1
 v_mfma_f32_16x16x32_bf16 v[108:111], v[212:215], v[252:255], v[108:111]
 s_waitcnt lgkmcnt(2)
 ds_read_b128 v[208:211], v2 offset:30720
 v_exp_f32 v62, v62
 v_mfma_f32_16x16x32_bf16 v[84:87], v[184:187], v[248:251], v[84:87]
 v_mul_f32 v66, v130, v134
 v_exp_f32 v63, v63
 v_mfma_f32_16x16x32_bf16 v[112:115], v[184:187], v[252:255], v[112:115]
 ds_read_b128 v[212:215], v2 offset:31744
 buffer_load_dwordx4 v[244:247], v2, s[4:7], s85 offen offset:3072 sc1
 v_mfma_f32_16x16x32_bf16 v[88:91], v[188:191], v[248:251], v[88:91]
 v_mul_f32 v67, v131, v135
 v_fma_f32 v60, v60, v44, v44
 v_mfma_f32_16x16x32_bf16 v[116:119], v[188:191], v[252:255], v[116:119]
 ds_read_b128 v[184:187], v2 offset:32768
 v_mfma_f32_16x16x32_bf16 v[92:95], v[192:195], v[248:251], v[92:95]
 v_rcp_f32 v60, v60
 v_fma_f32 v61, v61, v44, v44
 v_mfma_f32_16x16x32_bf16 v[120:123], v[192:195], v[252:255], v[120:123]
 ds_read_b128 v[188:191], v2 offset:33792
 v_rcp_f32 v61, v61
 v_mfma_f32_16x16x32_bf16 v[96:99], v[196:199], v[248:251], v[96:99]
 v_fma_f32 v62, v62, v44, v44
 v_mfma_f32_16x16x32_bf16 v[124:127], v[196:199], v[252:255], v[124:127]
 s_waitcnt vmcnt(11) lgkmcnt(3)
 ds_read_b128 v[192:195], v2 offset:34816
 v_rcp_f32 v62, v62
 v_mfma_f32_16x16x32_bf16 v[72:75], v[200:203], v[216:219], v[72:75]
 s_add_u32 s85, s73, 0x4000
 buffer_load_dwordx4 v[248:251], v2, s[4:7], s85 offen sc1
 s_waitcnt vmcnt(10)
 v_mfma_f32_16x16x32_bf16 v[100:103], v[200:203], v[220:223], v[100:103]
 ds_read_b128 v[196:199], v2 offset:35840
 v_fma_f32 v63, v63, v44, v44
 v_mfma_f32_16x16x32_bf16 v[76:79], v[204:207], v[216:219], v[76:79]
 v_rcp_f32 v63, v63
 v_mul_f32 v60, v60, v64
 v_mfma_f32_16x16x32_bf16 v[104:107], v[204:207], v[220:223], v[104:107]
 ds_read_b128 v[200:203], v2 offset:36864
 v_mul_f32 v61, v61, v65
 v_mfma_f32_16x16x32_bf16 v[80:83], v[208:211], v[216:219], v[80:83]
 v_mul_f32 v62, v62, v66
 v_mul_f32 v63, v63, v67
 v_mfma_f32_16x16x32_bf16 v[108:111], v[208:211], v[220:223], v[108:111]
 s_waitcnt lgkmcnt(2)
 ds_read_b128 v[204:207], v2 offset:37888
 v_cvt_pk_bf16_f32 v34, v60, v61
 v_cvt_pk_bf16_f32 v35, v62, v63
 v_mfma_f32_16x16x32_bf16 v[84:87], v[212:215], v[216:219], v[84:87]
 v_mul_f32 v60, v136, v136
 v_mul_f32 v61, v137, v137
 v_mfma_f32_16x16x32_bf16 v[112:115], v[212:215], v[220:223], v[112:115]
 ds_read_b128 v[208:211], v2 offset:38912
 v_mul_f32 v62, v138, v138
 v_mfma_f32_16x16x32_bf16 v[88:91], v[184:187], v[216:219], v[88:91]
 buffer_load_dwordx4 v[252:255], v2, s[4:7], s85 offen offset:1024 sc1
 v_mul_f32 v63, v139, v139
 v_mfma_f32_16x16x32_bf16 v[116:119], v[184:187], v[220:223], v[116:119]
 ds_read_b128 v[212:215], v2 offset:39936
 v_fma_f32 v60, v60, v42, v40
 v_mfma_f32_16x16x32_bf16 v[92:95], v[188:191], v[216:219], v[92:95]
 v_fma_f32 v61, v61, v42, v40
 v_fma_f32 v62, v62, v42, v40
 v_fma_f32 v63, v63, v42, v40
 v_mfma_f32_16x16x32_bf16 v[120:123], v[188:191], v[220:223], v[120:123]
 s_add_u32 s91, s78, 0xd000
 buffer_load_dwordx4 a[144:147], v2, s[4:7], s91 offen sc1
 ds_read_b128 v[184:187], v2 offset:40960
 v_mfma_f32_16x16x32_bf16 v[96:99], v[192:195], v[216:219], v[96:99]
 v_mul_f32 v60, v60, v136
 v_mul_f32 v61, v61, v137
 v_mfma_f32_16x16x32_bf16 v[124:127], v[192:195], v[220:223], v[124:127]
 s_waitcnt vmcnt(11) lgkmcnt(3)
 ds_read_b128 v[188:191], v2 offset:41984
 v_mul_f32 v62, v62, v138
 v_mfma_f32_16x16x32_bf16 v[72:75], v[196:199], v[224:227], v[72:75]
 s_waitcnt vmcnt(10)
 buffer_load_dwordx4 v[216:219], v2, s[4:7], s85 offen offset:2048 sc1
 v_mul_f32 v63, v63, v139
 v_mfma_f32_16x16x32_bf16 v[100:103], v[196:199], v[228:231], v[100:103]
 ds_read_b128 v[192:195], v2 offset:43008
 v_exp_f32 v60, v60
 v_mfma_f32_16x16x32_bf16 v[76:79], v[200:203], v[224:227], v[76:79]
 v_mul_f32 v64, v136, v140
 v_mfma_f32_16x16x32_bf16 v[104:107], v[200:203], v[228:231], v[104:107]
 ds_read_b128 v[196:199], v2 offset:44032
 v_exp_f32 v61, v61
 v_mfma_f32_16x16x32_bf16 v[80:83], v[204:207], v[224:227], v[80:83]
 v_mul_f32 v65, v137, v141
 v_exp_f32 v62, v62
 v_mfma_f32_16x16x32_bf16 v[108:111], v[204:207], v[228:231], v[108:111]
 s_waitcnt lgkmcnt(2)
 ds_read_b128 v[200:203], v2 offset:45056
 v_mul_f32 v66, v138, v142
 v_mfma_f32_16x16x32_bf16 v[84:87], v[208:211], v[224:227], v[84:87]
 v_exp_f32 v63, v63
 v_mfma_f32_16x16x32_bf16 v[112:115], v[208:211], v[228:231], v[112:115]
 ds_read_b128 v[204:207], v2 offset:46080
 v_mul_f32 v67, v139, v143
 v_mfma_f32_16x16x32_bf16 v[88:91], v[212:215], v[224:227], v[88:91]
 buffer_load_dwordx4 v[220:223], v2, s[4:7], s85 offen offset:3072 sc1
 v_fma_f32 v60, v60, v44, v44
 v_mfma_f32_16x16x32_bf16 v[116:119], v[212:215], v[228:231], v[116:119]
 ds_read_b128 v[208:211], v2 offset:47104
 v_rcp_f32 v60, v60
 v_mfma_f32_16x16x32_bf16 v[92:95], v[184:187], v[224:227], v[92:95]
 v_fma_f32 v61, v61, v44, v44
 v_mfma_f32_16x16x32_bf16 v[120:123], v[184:187], v[228:231], v[120:123]
 ds_read_b128 v[212:215], v2 offset:48128
 v_rcp_f32 v61, v61
 v_mfma_f32_16x16x32_bf16 v[96:99], v[188:191], v[224:227], v[96:99]
 v_fma_f32 v62, v62, v44, v44
 v_mfma_f32_16x16x32_bf16 v[124:127], v[188:191], v[228:231], v[124:127]
 s_waitcnt vmcnt(10) lgkmcnt(3)
 ds_read_b128 v[184:187], v2 offset:49152
 v_rcp_f32 v62, v62
 v_mfma_f32_16x16x32_bf16 v[72:75], v[192:195], v[232:235], v[72:75]
 s_add_u32 s85, s73, 0x5000
 buffer_load_dwordx4 v[224:227], v2, s[4:7], s85 offen sc1
 v_fma_f32 v63, v63, v44, v44
 s_waitcnt vmcnt(9)
 v_mfma_f32_16x16x32_bf16 v[100:103], v[192:195], v[236:239], v[100:103]
 ds_read_b128 v[188:191], v2 offset:50176
 v_mfma_f32_16x16x32_bf16 v[76:79], v[196:199], v[232:235], v[76:79]
 v_rcp_f32 v63, v63
 v_mul_f32 v60, v60, v64
 v_mfma_f32_16x16x32_bf16 v[104:107], v[196:199], v[236:239], v[104:107]
 ds_read_b128 v[192:195], v2 offset:51200
 v_mul_f32 v61, v61, v65
 v_mfma_f32_16x16x32_bf16 v[80:83], v[200:203], v[232:235], v[80:83]
 s_add_u32 s91, s78, 0xd000
 buffer_load_dwordx4 a[148:151], v2, s[4:7], s91 offen offset:1024 sc1
 v_mul_f32 v62, v62, v66
 v_mfma_f32_16x16x32_bf16 v[108:111], v[200:203], v[236:239], v[108:111]
 s_waitcnt lgkmcnt(2)
 ds_read_b128 v[196:199], v2 offset:52224
 v_mul_f32 v63, v63, v67
 v_mfma_f32_16x16x32_bf16 v[84:87], v[204:207], v[232:235], v[84:87]
 v_cvt_pk_bf16_f32 v36, v60, v61
 v_cvt_pk_bf16_f32 v37, v62, v63
 v_mfma_f32_16x16x32_bf16 v[112:115], v[204:207], v[236:239], v[112:115]
 ds_read_b128 v[200:203], v2 offset:53248
 buffer_store_dwordx4 v[34:37], v2, s[4:7], s90 offen nt
 v_mfma_f32_16x16x32_bf16 v[88:91], v[208:211], v[232:235], v[88:91]
 buffer_load_dwordx4 v[228:231], v2, s[4:7], s85 offen offset:1024 sc1
 v_mul_f32 v60, v144, v144
 v_mul_f32 v61, v145, v145
 v_mfma_f32_16x16x32_bf16 v[116:119], v[208:211], v[236:239], v[116:119]
 ds_read_b128 v[204:207], v2 offset:54272
 v_mul_f32 v62, v146, v146
 v_mfma_f32_16x16x32_bf16 v[92:95], v[212:215], v[232:235], v[92:95]
 v_mul_f32 v63, v147, v147
 v_fma_f32 v60, v60, v42, v40
 v_mfma_f32_16x16x32_bf16 v[120:123], v[212:215], v[236:239], v[120:123]
 ds_read_b128 v[208:211], v2 offset:55296
 v_fma_f32 v61, v61, v42, v40
 v_mfma_f32_16x16x32_bf16 v[96:99], v[184:187], v[232:235], v[96:99]
 v_fma_f32 v62, v62, v42, v40
 v_fma_f32 v63, v63, v42, v40
 v_mfma_f32_16x16x32_bf16 v[124:127], v[184:187], v[236:239], v[124:127]
 s_waitcnt vmcnt(11) lgkmcnt(3)
 ds_read_b128 v[212:215], v2 offset:56320
 v_mul_f32 v60, v60, v144
 v_mul_f32 v61, v61, v145
 v_mfma_f32_16x16x32_bf16 v[72:75], v[188:191], v[240:243], v[72:75]
 s_waitcnt vmcnt(9)
 buffer_load_dwordx4 v[232:235], v2, s[4:7], s85 offen offset:2048 sc1
 v_mul_f32 v62, v62, v146
 v_mfma_f32_16x16x32_bf16 v[100:103], v[188:191], v[244:247], v[100:103]
 ds_read_b128 v[184:187], v26
 v_mul_f32 v63, v63, v147
 v_mfma_f32_16x16x32_bf16 v[76:79], v[192:195], v[240:243], v[76:79]
 v_exp_f32 v60, v60
 v_mfma_f32_16x16x32_bf16 v[104:107], v[192:195], v[244:247], v[104:107]
 ds_read_b128 v[188:191], v26 offset:1024
 v_mul_f32 v64, v144, v148
 v_mfma_f32_16x16x32_bf16 v[80:83], v[196:199], v[240:243], v[80:83]
 v_exp_f32 v61, v61
 v_mul_f32 v65, v145, v149
 v_mfma_f32_16x16x32_bf16 v[108:111], v[196:199], v[244:247], v[108:111]
 s_waitcnt lgkmcnt(2)
 ds_read_b128 v[192:195], v26 offset:2048
 v_mfma_f32_16x16x32_bf16 v[84:87], v[200:203], v[240:243], v[84:87]
 v_exp_f32 v62, v62
 v_mul_f32 v66, v146, v150
 v_mfma_f32_16x16x32_bf16 v[112:115], v[200:203], v[244:247], v[112:115]
 ds_read_b128 v[196:199], v26 offset:3072
 buffer_load_dwordx4 v[236:239], v2, s[4:7], s85 offen offset:3072 sc1
 v_mfma_f32_16x16x32_bf16 v[88:91], v[204:207], v[240:243], v[88:91]
 v_exp_f32 v63, v63
 v_mfma_f32_16x16x32_bf16 v[116:119], v[204:207], v[244:247], v[116:119]
 ds_read_b128 v[200:203], v26 offset:4096
 v_mul_f32 v67, v147, v151
 v_mfma_f32_16x16x32_bf16 v[92:95], v[208:211], v[240:243], v[92:95]
 v_fma_f32 v60, v60, v44, v44
 v_rcp_f32 v60, v60
 v_mfma_f32_16x16x32_bf16 v[120:123], v[208:211], v[244:247], v[120:123]
 s_add_u32 s91, s78, 0xd000
 buffer_load_dwordx4 a[152:155], v2, s[4:7], s91 offen offset:2048 sc1
 v_mfma_f32_16x16x32_bf16 v[96:99], v[212:215], v[240:243], v[96:99]
 ds_read_b128 v[204:207], v26 offset:5120
 v_fma_f32 v61, v61, v44, v44
 v_mfma_f32_16x16x32_bf16 v[124:127], v[212:215], v[244:247], v[124:127]
 s_waitcnt vmcnt(11) lgkmcnt(3)
 ds_read_b128 v[208:211], v26 offset:6144
 v_rcp_f32 v61, v61
 v_mfma_f32_16x16x32_bf16 v[72:75], v[184:187], v[248:251], v[72:75]
 s_add_u32 s85, s73, 0x6000
 buffer_load_dwordx4 v[240:243], v2, s[4:7], s85 offen sc1
 s_waitcnt vmcnt(11)
 v_mfma_f32_16x16x32_bf16 v[100:103], v[184:187], v[252:255], v[100:103]
 ds_read_b128 v[212:215], v26 offset:7168
 v_fma_f32 v62, v62, v44, v44
 v_mfma_f32_16x16x32_bf16 v[76:79], v[188:191], v[248:251], v[76:79]
 v_rcp_f32 v62, v62
 v_fma_f32 v63, v63, v44, v44
 v_mfma_f32_16x16x32_bf16 v[104:107], v[188:191], v[252:255], v[104:107]
 ds_read_b128 v[184:187], v26 offset:8192
 v_mfma_f32_16x16x32_bf16 v[80:83], v[192:195], v[248:251], v[80:83]
 v_rcp_f32 v63, v63
 v_mul_f32 v60, v60, v64
 v_mfma_f32_16x16x32_bf16 v[108:111], v[192:195], v[252:255], v[108:111]
 s_waitcnt lgkmcnt(2)
 ds_read_b128 v[188:191], v26 offset:9216
 v_mul_f32 v61, v61, v65
 v_mfma_f32_16x16x32_bf16 v[84:87], v[196:199], v[248:251], v[84:87]
 v_mul_f32 v62, v62, v66
 v_mul_f32 v63, v63, v67
 v_mfma_f32_16x16x32_bf16 v[112:115], v[196:199], v[252:255], v[112:115]
 ds_read_b128 v[192:195], v26 offset:10240
 v_cvt_pk_bf16_f32 v70, v60, v61
 v_mfma_f32_16x16x32_bf16 v[88:91], v[200:203], v[248:251], v[88:91]
 buffer_load_dwordx4 v[244:247], v2, s[4:7], s85 offen offset:1024 sc1
 v_cvt_pk_bf16_f32 v71, v62, v63
 v_mfma_f32_16x16x32_bf16 v[116:119], v[200:203], v[252:255], v[116:119]
 ds_read_b128 v[196:199], v26 offset:11264
 buffer_store_dwordx2 v[70:71], v27, s[4:7], s90 offen offset:1024 nt
 v_mfma_f32_16x16x32_bf16 v[92:95], v[204:207], v[248:251], v[92:95]
 s_add_u32 s90, s75, 0x0
 v_mul_f32 v60, v156, v156
 v_mul_f32 v61, v157, v157
 v_mfma_f32_16x16x32_bf16 v[120:123], v[204:207], v[252:255], v[120:123]
 ds_read_b128 v[200:203], v26 offset:12288
 v_mul_f32 v62, v158, v158
 v_mul_f32 v63, v159, v159
 v_mfma_f32_16x16x32_bf16 v[96:99], v[208:211], v[248:251], v[96:99]
 v_fma_f32 v60, v60, v43, v41
 v_fma_f32 v61, v61, v43, v41
 v_mfma_f32_16x16x32_bf16 v[124:127], v[208:211], v[252:255], v[124:127]
 s_waitcnt vmcnt(11) lgkmcnt(3)
 ds_read_b128 v[204:207], v26 offset:13312
 v_fma_f32 v62, v62, v43, v41
 v_mfma_f32_16x16x32_bf16 v[72:75], v[212:215], v[216:219], v[72:75]
 s_waitcnt vmcnt(10)
 buffer_load_dwordx4 v[248:251], v2, s[4:7], s85 offen offset:2048 sc1
 v_fma_f32 v63, v63, v43, v41
 v_mfma_f32_16x16x32_bf16 v[100:103], v[212:215], v[220:223], v[100:103]
 ds_read_b128 v[208:211], v26 offset:14336
 v_mul_f32 v60, v60, v156
 v_mfma_f32_16x16x32_bf16 v[76:79], v[184:187], v[216:219], v[76:79]
 v_mul_f32 v61, v61, v157
 v_mul_f32 v62, v62, v158
 v_mfma_f32_16x16x32_bf16 v[104:107], v[184:187], v[220:223], v[104:107]
 ds_read_b128 v[212:215], v26 offset:15360
 v_mul_f32 v63, v63, v159
 v_mfma_f32_16x16x32_bf16 v[80:83], v[188:191], v[216:219], v[80:83]
 s_add_u32 s91, s78, 0xd000
 buffer_load_dwordx4 a[156:159], v2, s[4:7], s91 offen offset:3072 sc1
 v_exp_f32 v60, v60
 v_mfma_f32_16x16x32_bf16 v[108:111], v[188:191], v[220:223], v[108:111]
 s_waitcnt lgkmcnt(3)
 ds_read_b128 v[184:187], v26 offset:16384
 v_mul_f32 v64, v156, v160
 v_mfma_f32_16x16x32_bf16 v[84:87], v[192:195], v[216:219], v[84:87]
 v_exp_f32 v61, v61
 v_mfma_f32_16x16x32_bf16 v[112:115], v[192:195], v[220:223], v[112:115]
 ds_read_b128 v[188:191], v26 offset:17408
 v_mul_f32 v65, v157, v161
 v_mfma_f32_16x16x32_bf16 v[88:91], v[196:199], v[216:219], v[88:91]
 buffer_load_dwordx4 v[252:255], v2, s[4:7], s85 offen offset:3072 sc1
 ds_read_b128 v[192:195], v26 offset:18432
 v_mfma_f32_16x16x32_bf16 v[116:119], v[196:199], v[220:223], v[116:119]
 v_exp_f32 v62, v62
 v_mfma_f32_16x16x32_bf16 v[92:95], v[200:203], v[216:219], v[92:95]
 v_mul_f32 v66, v158, v162
 v_mfma_f32_16x16x32_bf16 v[120:123], v[200:203], v[220:223], v[120:123]
 s_waitcnt lgkmcnt(3)
 ds_read_b128 v[196:199], v26 offset:19456
 v_exp_f32 v63, v63
 v_mfma_f32_16x16x32_bf16 v[96:99], v[204:207], v[216:219], v[96:99]
 v_mul_f32 v67, v159, v163
 v_fma_f32 v60, v60, v45, v45
 v_mfma_f32_16x16x32_bf16 v[124:127], v[204:207], v[220:223], v[124:127]
 s_waitcnt vmcnt(12)
 v_mfma_f32_16x16x32_bf16 v[72:75], v[208:211], v[224:227], v[72:75]
 s_add_u32 s85, s73, 0x7000
 ds_read_b128 v[200:203], v26 offset:20480
 buffer_load_dwordx4 v[216:219], v2, s[4:7], s85 offen sc1
 v_rcp_f32 v60, v60
 s_waitcnt vmcnt(10)
 v_mfma_f32_16x16x32_bf16 v[100:103], v[208:211], v[228:231], v[100:103]
 ds_read_b128 v[204:207], v26 offset:21504
 v_fma_f32 v61, v61, v45, v45
 v_mfma_f32_16x16x32_bf16 v[76:79], v[212:215], v[224:227], v[76:79]
 v_rcp_f32 v61, v61
 v_mfma_f32_16x16x32_bf16 v[104:107], v[212:215], v[228:231], v[104:107]
 s_waitcnt lgkmcnt(2)
 ds_read_b128 v[208:211], v26 offset:22528
 v_fma_f32 v62, v62, v45, v45
 v_mfma_f32_16x16x32_bf16 v[80:83], v[184:187], v[224:227], v[80:83]
 s_waitcnt vmcnt(4)
 v_mov_b32 v5, 5
 v_mfma_f32_16x16x32_bf16 v[108:111], v[184:187], v[228:231], v[108:111]
 buffer_store_dword v5, off, s[4:7], s68
 v_mfma_f32_16x16x32_bf16 v[84:87], v[188:191], v[224:227], v[84:87]
 ds_read_b128 v[212:215], v26 offset:23552
 v_rcp_f32 v62, v62
 v_mfma_f32_16x16x32_bf16 v[112:115], v[188:191], v[228:231], v[112:115]
 ds_read_b128 v[184:187], v26 offset:24576
 v_fma_f32 v63, v63, v45, v45
 v_mfma_f32_16x16x32_bf16 v[88:91], v[192:195], v[224:227], v[88:91]
 buffer_load_dwordx4 v[220:223], v2, s[4:7], s85 offen offset:1024 sc1
 v_rcp_f32 v63, v63
 v_mfma_f32_16x16x32_bf16 v[116:119], v[192:195], v[228:231], v[116:119]
 ds_read_b128 v[188:191], v26 offset:25600
 v_mul_f32 v60, v60, v64
 v_mfma_f32_16x16x32_bf16 v[92:95], v[196:199], v[224:227], v[92:95]
 v_mul_f32 v61, v61, v65
 v_mul_f32 v62, v62, v66
 v_mfma_f32_16x16x32_bf16 v[120:123], v[196:199], v[228:231], v[120:123]
 s_waitcnt lgkmcnt(3)
 ds_read_b128 v[192:195], v26 offset:26624
 v_mul_f32 v63, v63, v67
 v_mfma_f32_16x16x32_bf16 v[96:99], v[200:203], v[224:227], v[96:99]
 v_cvt_pk_bf16_f32 v34, v60, v61
 v_cvt_pk_bf16_f32 v35, v62, v63
 v_mfma_f32_16x16x32_bf16 v[124:127], v[200:203], v[228:231], v[124:127]
 ds_read_b128 v[196:199], v26 offset:27648
 v_mul_f32 v60, v164, v164
 v_mfma_f32_16x16x32_bf16 v[72:75], v[204:207], v[232:235], v[72:75]
 buffer_load_dwordx4 v[224:227], v2, s[4:7], s85 offen offset:2048 sc1
 v_mul_f32 v61, v165, v165
 v_mfma_f32_16x16x32_bf16 v[100:103], v[204:207], v[236:239], v[100:103]
 ds_read_b128 v[200:203], v26 offset:28672
 v_mul_f32 v62, v166, v166
 v_mfma_f32_16x16x32_bf16 v[76:79], v[208:211], v[232:235], v[76:79]
 v_mul_f32 v63, v167, v167
 v_fma_f32 v60, v60, v43, v41
 v_mfma_f32_16x16x32_bf16 v[104:107], v[208:211], v[236:239], v[104:107]
 s_waitcnt lgkmcnt(3)
 ds_read_b128 v[204:207], v26 offset:29696
 v_fma_f32 v61, v61, v43, v41
 v_mfma_f32_16x16x32_bf16 v[80:83], v[212:215], v[232:235], v[80:83]
 v_fma_f32 v62, v62, v43, v41
 v_fma_f32 v63, v63, v43, v41
 v_mfma_f32_16x16x32_bf16 v[108:111], v[212:215], v[236:239], v[108:111]
 ds_read_b128 v[208:211], v26 offset:30720
 v_mul_f32 v60, v60, v164
 v_mfma_f32_16x16x32_bf16 v[84:87], v[184:187], v[232:235], v[84:87]
 v_mul_f32 v61, v61, v165
 v_mul_f32 v62, v62, v166
 v_mfma_f32_16x16x32_bf16 v[112:115], v[184:187], v[236:239], v[112:115]
 ds_read_b128 v[212:215], v26 offset:31744
 v_mul_f32 v63, v63, v167
 v_mfma_f32_16x16x32_bf16 v[88:91], v[188:191], v[232:235], v[88:91]
 buffer_load_dwordx4 v[228:231], v2, s[4:7], s85 offen offset:3072 sc1
 v_exp_f32 v60, v60
 v_mfma_f32_16x16x32_bf16 v[116:119], v[188:191], v[236:239], v[116:119]
 s_waitcnt lgkmcnt(3)
 ds_read_b128 v[184:187], v26 offset:32768
 v_mul_f32 v64, v164, v168
 v_mfma_f32_16x16x32_bf16 v[92:95], v[192:195], v[232:235], v[92:95]
 v_exp_f32 v61, v61
 v_mfma_f32_16x16x32_bf16 v[120:123], v[192:195], v[236:239], v[120:123]
 ds_read_b128 v[188:191], v26 offset:33792
 v_mul_f32 v65, v165, v169
 v_mfma_f32_16x16x32_bf16 v[96:99], v[196:199], v[232:235], v[96:99]
 v_exp_f32 v62, v62
 v_mfma_f32_16x16x32_bf16 v[124:127], v[196:199], v[236:239], v[124:127]
 ds_read_b128 v[192:195], v26 offset:34816
 v_mul_f32 v66, v166, v170
 v_mfma_f32_16x16x32_bf16 v[72:75], v[200:203], v[240:243], v[72:75]
 v_exp_f32 v63, v63
 v_mfma_f32_16x16x32_bf16 v[100:103], v[200:203], v[244:247], v[100:103]
 s_waitcnt lgkmcnt(3)
 ds_read_b128 v[196:199], v26 offset:35840
 v_mul_f32 v67, v167, v171
 v_mfma_f32_16x16x32_bf16 v[76:79], v[204:207], v[240:243], v[76:79]
 v_fma_f32 v60, v60, v45, v45
 v_rcp_f32 v60, v60
 v_mfma_f32_16x16x32_bf16 v[104:107], v[204:207], v[244:247], v[104:107]
 ds_read_b128 v[200:203], v26 offset:36864
 v_fma_f32 v61, v61, v45, v45
 v_mfma_f32_16x16x32_bf16 v[80:83], v[208:211], v[240:243], v[80:83]
 v_rcp_f32 v61, v61
 v_mfma_f32_16x16x32_bf16 v[108:111], v[208:211], v[244:247], v[108:111]
 ds_read_b128 v[204:207], v26 offset:37888
 v_fma_f32 v62, v62, v45, v45
 v_mfma_f32_16x16x32_bf16 v[84:87], v[212:215], v[240:243], v[84:87]
 v_rcp_f32 v62, v62
 v_mfma_f32_16x16x32_bf16 v[112:115], v[212:215], v[244:247], v[112:115]
 s_waitcnt lgkmcnt(3)
 ds_read_b128 v[208:211], v26 offset:38912
 v_mfma_f32_16x16x32_bf16 v[88:91], v[184:187], v[240:243], v[88:91]
 buffer_load_dword v3, v7, s[4:7], s66 offen sc1
 v_fma_f32 v63, v63, v45, v45
 v_mfma_f32_16x16x32_bf16 v[116:119], v[184:187], v[244:247], v[116:119]
 ds_read_b128 v[212:215], v26 offset:39936
 v_rcp_f32 v63, v63
 v_mfma_f32_16x16x32_bf16 v[92:95], v[188:191], v[240:243], v[92:95]
 v_mul_f32 v60, v60, v64
 v_mfma_f32_16x16x32_bf16 v[120:123], v[188:191], v[244:247], v[120:123]
 ds_read_b128 v[184:187], v26 offset:40960
 v_mul_f32 v61, v61, v65
 v_mfma_f32_16x16x32_bf16 v[96:99], v[192:195], v[240:243], v[96:99]
 v_mul_f32 v62, v62, v66
 v_mul_f32 v63, v63, v67
 v_mfma_f32_16x16x32_bf16 v[124:127], v[192:195], v[244:247], v[124:127]
 s_waitcnt vmcnt(8) lgkmcnt(3)
 ds_read_b128 v[188:191], v26 offset:41984
 v_cvt_pk_bf16_f32 v36, v60, v61
 v_mfma_f32_16x16x32_bf16 v[72:75], v[196:199], v[248:251], v[72:75]
 s_waitcnt vmcnt(6)
 v_cvt_pk_bf16_f32 v37, v62, v63
 v_mfma_f32_16x16x32_bf16 v[100:103], v[196:199], v[252:255], v[100:103]
 buffer_store_dwordx4 v[34:37], v2, s[4:7], s90 offen nt
 ds_read_b128 v[192:195], v26 offset:43008
 v_mfma_f32_16x16x32_bf16 v[76:79], v[200:203], v[248:251], v[76:79]
 v_mul_f32 v60, v172, v172
 v_mul_f32 v61, v173, v173
 v_mul_f32 v62, v174, v174
 v_mfma_f32_16x16x32_bf16 v[104:107], v[200:203], v[252:255], v[104:107]
 ds_read_b128 v[196:199], v26 offset:44032
 v_mul_f32 v63, v175, v175
 v_mfma_f32_16x16x32_bf16 v[80:83], v[204:207], v[248:251], v[80:83]
 v_fma_f32 v60, v60, v43, v41
 v_fma_f32 v61, v61, v43, v41
 v_mfma_f32_16x16x32_bf16 v[108:111], v[204:207], v[252:255], v[108:111]
 s_waitcnt lgkmcnt(3)
 ds_read_b128 v[200:203], v26 offset:45056
 v_fma_f32 v62, v62, v43, v41
 v_mfma_f32_16x16x32_bf16 v[84:87], v[208:211], v[248:251], v[84:87]
 v_fma_f32 v63, v63, v43, v41
 v_mul_f32 v60, v60, v172
 v_mfma_f32_16x16x32_bf16 v[112:115], v[208:211], v[252:255], v[112:115]
 ds_read_b128 v[204:207], v26 offset:46080
 v_mul_f32 v61, v61, v173
 v_mfma_f32_16x16x32_bf16 v[88:91], v[212:215], v[248:251], v[88:91]
 v_mul_f32 v62, v62, v174
 v_mul_f32 v63, v63, v175
 v_mfma_f32_16x16x32_bf16 v[116:119], v[212:215], v[252:255], v[116:119]
 ds_read_b128 v[208:211], v26 offset:47104
 v_exp_f32 v60, v60
 v_mfma_f32_16x16x32_bf16 v[92:95], v[184:187], v[248:251], v[92:95]
 v_mul_f32 v64, v172, v176
 v_mfma_f32_16x16x32_bf16 v[120:123], v[184:187], v[252:255], v[120:123]
 s_waitcnt lgkmcnt(3)
 ds_read_b128 v[212:215], v26 offset:48128
 v_mfma_f32_16x16x32_bf16 v[96:99], v[188:191], v[248:251], v[96:99]
 v_exp_f32 v61, v61
 v_mul_f32 v65, v173, v177
 v_mfma_f32_16x16x32_bf16 v[124:127], v[188:191], v[252:255], v[124:127]
 s_waitcnt vmcnt(6)
 ds_read_b128 v[184:187], v26 offset:49152
 v_mfma_f32_16x16x32_bf16 v[72:75], v[192:195], v[216:219], v[72:75]
 s_waitcnt vmcnt(4)
 v_exp_f32 v62, v62
 v_mfma_f32_16x16x32_bf16 v[100:103], v[192:195], v[220:223], v[100:103]
 ds_read_b128 v[188:191], v26 offset:50176
 v_mul_f32 v66, v174, v178
 v_mfma_f32_16x16x32_bf16 v[76:79], v[196:199], v[216:219], v[76:79]
 v_exp_f32 v63, v63
 v_mfma_f32_16x16x32_bf16 v[104:107], v[196:199], v[220:223], v[104:107]
 s_waitcnt lgkmcnt(3)
 ds_read_b128 v[192:195], v26 offset:51200
 v_mul_f32 v67, v175, v179
 v_mfma_f32_16x16x32_bf16 v[80:83], v[200:203], v[216:219], v[80:83]
 s_waitcnt vmcnt(1)
 v_cmp_gt_u32 vcc, 5, v3
 s_nop 0
 s_cbranch_vccnz .Lps_54
.Lpb_55:
 v_fma_f32 v60, v60, v45, v45
 v_mfma_f32_16x16x32_bf16 v[108:111], v[200:203], v[220:223], v[108:111]
 s_add_u32 s85, s76, 0xe000
 buffer_load_dwordx4 a[160:163], v2, s[4:7], s85 offen sc1
 ds_read_b128 v[196:199], v26 offset:52224
 v_mfma_f32_16x16x32_bf16 v[84:87], v[204:207], v[216:219], v[84:87]
 v_rcp_f32 v60, v60
 v_mfma_f32_16x16x32_bf16 v[112:115], v[204:207], v[220:223], v[112:115]
 ds_read_b128 v[200:203], v26 offset:53248
 v_mfma_f32_16x16x32_bf16 v[88:91], v[208:211], v[216:219], v[88:91]
 buffer_load_dwordx4 a[164:167], v2, s[4:7], s85 offen offset:1024 sc1
 v_fma_f32 v61, v61, v45, v45
 v_mfma_f32_16x16x32_bf16 v[116:119], v[208:211], v[220:223], v[116:119]
 s_waitcnt lgkmcnt(3)
 ds_read_b128 v[204:207], v26 offset:54272
 v_mfma_f32_16x16x32_bf16 v[92:95], v[212:215], v[216:219], v[92:95]
 v_rcp_f32 v61, v61
 v_fma_f32 v62, v62, v45, v45
 v_mfma_f32_16x16x32_bf16 v[120:123], v[212:215], v[220:223], v[120:123]
 buffer_load_dwordx4 a[168:171], v2, s[4:7], s85 offen offset:2048 sc1
 ds_read_b128 v[208:211], v26 offset:55296
 v_mfma_f32_16x16x32_bf16 v[96:99], v[184:187], v[216:219], v[96:99]
 v_rcp_f32 v62, v62
 v_mfma_f32_16x16x32_bf16 v[124:127], v[184:187], v[220:223], v[124:127]
 ds_read_b128 v[212:215], v26 offset:56320
 v_mfma_f32_16x16x32_bf16 v[72:75], v[188:191], v[224:227], v[72:75]
 buffer_load_dwordx4 a[172:175], v2, s[4:7], s85 offen offset:3072 sc1
 v_fma_f32 v63, v63, v45, v45
 v_mfma_f32_16x16x32_bf16 v[100:103], v[188:191], v[228:231], v[100:103]
 s_waitcnt lgkmcnt(3)
 v_rcp_f32 v63, v63
 v_mfma_f32_16x16x32_bf16 v[76:79], v[192:195], v[224:227], v[76:79]
 v_mul_f32 v60, v60, v64
 v_mfma_f32_16x16x32_bf16 v[104:107], v[192:195], v[228:231], v[104:107]
 s_add_u32 s85, s76, 0xf000
 buffer_load_dwordx4 a[176:179], v2, s[4:7], s85 offen sc1
 v_mfma_f32_16x16x32_bf16 v[80:83], v[196:199], v[224:227], v[80:83]
 v_mul_f32 v61, v61, v65
 v_mul_f32 v62, v62, v66
 v_mfma_f32_16x16x32_bf16 v[108:111], v[196:199], v[228:231], v[108:111]
 v_mul_f32 v63, v63, v67
 v_cvt_pk_bf16_f32 v70, v60, v61
 v_mfma_f32_16x16x32_bf16 v[84:87], v[200:203], v[224:227], v[84:87]
 buffer_load_dwordx4 a[180:183], v2, s[4:7], s85 offen offset:1024 sc1
 v_cvt_pk_bf16_f32 v71, v62, v63
 v_mfma_f32_16x16x32_bf16 v[112:115], v[200:203], v[228:231], v[112:115]
 s_waitcnt lgkmcnt(0)
 v_mfma_f32_16x16x32_bf16 v[88:91], v[204:207], v[224:227], v[88:91]
 buffer_store_dwordx2 v[70:71], v27, s[4:7], s90 offen offset:1024 nt
 v_mfma_f32_16x16x32_bf16 v[116:119], v[204:207], v[228:231], v[116:119]
 buffer_load_dwordx4 a[184:187], v2, s[4:7], s85 offen offset:2048 sc1
 v_mfma_f32_16x16x32_bf16 v[92:95], v[208:211], v[224:227], v[92:95]
 v_mfma_f32_16x16x32_bf16 v[120:123], v[208:211], v[228:231], v[120:123]
 v_mfma_f32_16x16x32_bf16 v[96:99], v[212:215], v[224:227], v[96:99]
 buffer_load_dwordx4 a[188:191], v2, s[4:7], s85 offen offset:3072 sc1
 v_mfma_f32_16x16x32_bf16 v[124:127], v[212:215], v[228:231], v[124:127]
 s_add_u32 s90, s75, 0x400000
 s_nop 6
 v_permlane32_swap_b32 v96, v124
 v_permlane32_swap_b32 v97, v125
 v_permlane32_swap_b32 v98, v126
 v_permlane32_swap_b32 v99, v127
 v_pk_mul_f32 v[60:61], v[96:97], v[96:97]
 v_pk_mul_f32 v[62:63], v[98:99], v[98:99]
 s_add_u32 s85, s76, 0x10000
 buffer_load_dwordx4 v[128:131], v2, s[4:7], s85 offen sc1
 v_pk_fma_f32 v[60:61], v[60:61], v[56:57], v[56:57] op_sel:[0,1,0] op_sel_hi:[1,1,0]
 v_pk_fma_f32 v[62:63], v[62:63], v[56:57], v[56:57] op_sel:[0,1,0] op_sel_hi:[1,1,0]
 v_pk_mul_f32 v[60:61], v[60:61], v[96:97]
 v_pk_mul_f32 v[62:63], v[62:63], v[98:99]
 v_exp_f32 v60, v60
 v_exp_f32 v61, v61
 v_exp_f32 v62, v62
 v_exp_f32 v63, v63
 v_pk_mul_f32 v[64:65], v[96:97], v[124:125]
 v_pk_mul_f32 v[66:67], v[98:99], v[126:127]
 v_pk_fma_f32 v[60:61], v[60:61], v[58:59], v[58:59] op_sel:[0,0,0] op_sel_hi:[1,0,0]
 v_pk_fma_f32 v[62:63], v[62:63], v[58:59], v[58:59] op_sel:[0,0,0] op_sel_hi:[1,0,0]
 buffer_load_dwordx4 v[132:135], v2, s[4:7], s85 offen offset:1024 sc1
 v_rcp_f32 v60, v60
 v_rcp_f32 v61, v61
 v_rcp_f32 v62, v62
 v_rcp_f32 v63, v63
 v_pk_mul_f32 v[60:61], v[60:61], v[64:65]
 v_pk_mul_f32 v[62:63], v[62:63], v[66:67]
 v_cvt_pk_bf16_f32 v68, v60, v61
 v_cvt_pk_bf16_f32 v69, v62, v63
 buffer_store_dwordx2 v[68:69], v28, s[4:7], s90 offen offset:1536 nt
 s_add_u32 s90, s75, 0x40e000
 v_pk_mul_f32 v[60:61], v[72:73], v[72:73]
 v_pk_mul_f32 v[62:63], v[74:75], v[74:75]
 v_pk_fma_f32 v[60:61], v[60:61], v[52:53], v[50:51] op_sel:[0,0,0] op_sel_hi:[1,0,0]
 buffer_load_dwordx4 v[136:139], v2, s[4:7], s85 offen offset:2048 sc1
 v_pk_fma_f32 v[62:63], v[62:63], v[52:53], v[50:51] op_sel:[0,0,0] op_sel_hi:[1,0,0]
 v_pk_mul_f32 v[60:61], v[60:61], v[72:73]
 v_pk_mul_f32 v[62:63], v[62:63], v[74:75]
 v_exp_f32 v60, v60
 v_exp_f32 v61, v61
 v_exp_f32 v62, v62
 v_exp_f32 v63, v63
 v_pk_mul_f32 v[64:65], v[72:73], v[76:77]
 v_pk_mul_f32 v[66:67], v[74:75], v[78:79]
 v_pk_fma_f32 v[60:61], v[60:61], v[54:55], v[54:55] op_sel:[0,0,0] op_sel_hi:[1,0,0]
 v_pk_fma_f32 v[62:63], v[62:63], v[54:55], v[54:55] op_sel:[0,0,0] op_sel_hi:[1,0,0]
 v_rcp_f32 v60, v60
 v_mov_b32 v5, 6
 s_waitcnt vmcnt(6)
 buffer_store_dword v5, off, s[4:7], s68
 v_rcp_f32 v61, v61
 v_rcp_f32 v62, v62
 v_rcp_f32 v63, v63
 v_pk_mul_f32 v[60:61], v[60:61], v[64:65]
 v_pk_mul_f32 v[62:63], v[62:63], v[66:67]
 v_cvt_pk_bf16_f32 v34, v60, v61
 v_cvt_pk_bf16_f32 v35, v62, v63
 v_pk_mul_f32 v[60:61], v[80:81], v[80:81]
 v_pk_mul_f32 v[62:63], v[82:83], v[82:83]
 v_pk_fma_f32 v[60:61], v[60:61], v[52:53], v[50:51] op_sel:[0,0,0] op_sel_hi:[1,0,0]
 v_pk_fma_f32 v[62:63], v[62:63], v[52:53], v[50:51] op_sel:[0,0,0] op_sel_hi:[1,0,0]
 v_pk_mul_f32 v[60:61], v[60:61], v[80:81]
 v_pk_mul_f32 v[62:63], v[62:63], v[82:83]
 buffer_load_dwordx4 v[140:143], v2, s[4:7], s85 offen offset:3072 sc1
 v_exp_f32 v60, v60
 v_exp_f32 v61, v61
 v_exp_f32 v62, v62
 v_exp_f32 v63, v63
 v_pk_mul_f32 v[64:65], v[80:81], v[84:85]
 v_pk_mul_f32 v[66:67], v[82:83], v[86:87]
 v_pk_fma_f32 v[60:61], v[60:61], v[54:55], v[54:55] op_sel:[0,0,0] op_sel_hi:[1,0,0]
 v_pk_fma_f32 v[62:63], v[62:63], v[54:55], v[54:55] op_sel:[0,0,0] op_sel_hi:[1,0,0]
 v_rcp_f32 v60, v60
 v_rcp_f32 v61, v61
 s_add_u32 s85, s76, 0x11000
 buffer_load_dwordx4 v[144:147], v2, s[4:7], s85 offen sc1
 v_rcp_f32 v62, v62
 v_rcp_f32 v63, v63
 v_pk_mul_f32 v[60:61], v[60:61], v[64:65]
 v_pk_mul_f32 v[62:63], v[62:63], v[66:67]
 v_cvt_pk_bf16_f32 v36, v60, v61
 v_cvt_pk_bf16_f32 v37, v62, v63
 buffer_store_dwordx4 v[34:37], v2, s[4:7], s90 offen nt
 v_pk_mul_f32 v[60:61], v[88:89], v[88:89]
 v_pk_mul_f32 v[62:63], v[90:91], v[90:91]
 v_pk_fma_f32 v[60:61], v[60:61], v[52:53], v[50:51] op_sel:[0,0,0] op_sel_hi:[1,0,0]
 v_pk_fma_f32 v[62:63], v[62:63], v[52:53], v[50:51] op_sel:[0,0,0] op_sel_hi:[1,0,0]
 v_pk_mul_f32 v[60:61], v[60:61], v[88:89]
 v_pk_mul_f32 v[62:63], v[62:63], v[90:91]
 v_exp_f32 v60, v60
 v_exp_f32 v61, v61
 v_exp_f32 v62, v62
 v_exp_f32 v63, v63
 v_pk_mul_f32 v[64:65], v[88:89], v[92:93]
 v_pk_mul_f32 v[66:67], v[90:91], v[94:95]
 v_pk_fma_f32 v[60:61], v[60:61], v[54:55], v[54:55] op_sel:[0,0,0] op_sel_hi:[1,0,0]
 v_pk_fma_f32 v[62:63], v[62:63], v[54:55], v[54:55] op_sel:[0,0,0] op_sel_hi:[1,0,0]
 v_rcp_f32 v60, v60
 v_rcp_f32 v61, v61
 v_rcp_f32 v62, v62
 v_rcp_f32 v63, v63
 v_pk_mul_f32 v[60:61], v[60:61], v[64:65]
 v_pk_mul_f32 v[62:63], v[62:63], v[66:67]
 v_cvt_pk_bf16_f32 v70, v60, v61
 v_cvt_pk_bf16_f32 v71, v62, v63
 buffer_store_dwordx2 v[70:71], v27, s[4:7], s90 offen offset:1024 nt
 v_mfma_f32_16x16x32_bf16 v[184:187], a[192:195], a[160:163], 0
 s_add_u32 s90, s75, 0x400000
 buffer_load_dwordx4 v[148:151], v2, s[4:7], s85 offen offset:1024 sc1
 v_mul_f32 v60, v100, v100
 v_mfma_f32_16x16x32_bf16 v[188:191], a[196:199], a[160:163], 0
 v_mul_f32 v61, v101, v101
 v_mul_f32 v62, v102, v102
 v_mul_f32 v63, v103, v103
 v_mfma_f32_16x16x32_bf16 v[192:195], a[200:203], a[160:163], 0
 v_fma_f32 v60, v60, v53, v51
 v_fma_f32 v61, v61, v53, v51
 v_fma_f32 v62, v62, v53, v51
 v_mfma_f32_16x16x32_bf16 v[196:199], a[0:3], a[160:163], 0
 v_fma_f32 v63, v63, v53, v51
 v_mul_f32 v60, v60, v100
 v_mul_f32 v61, v61, v101
 v_mfma_f32_16x16x32_bf16 v[184:187], a[204:207], a[164:167], v[184:187]
 v_mul_f32 v62, v62, v102
 v_mul_f32 v63, v63, v103
 v_mfma_f32_16x16x32_bf16 v[188:191], a[208:211], a[164:167], v[188:191]
 v_exp_f32 v60, v60
 v_mul_f32 v64, v100, v104
 v_mfma_f32_16x16x32_bf16 v[192:195], a[212:215], a[164:167], v[192:195]
 v_exp_f32 v61, v61
 v_mul_f32 v65, v101, v105
 v_mfma_f32_16x16x32_bf16 v[196:199], a[4:7], a[164:167], v[196:199]
 v_exp_f32 v62, v62
 v_mul_f32 v66, v102, v106
 v_mfma_f32_16x16x32_bf16 v[184:187], a[216:219], a[168:171], v[184:187]
 v_exp_f32 v63, v63
 v_mul_f32 v67, v103, v107
 v_mfma_f32_16x16x32_bf16 v[188:191], a[220:223], a[168:171], v[188:191]
 buffer_load_dword v3, v7, s[4:7], s66 offen sc1
 v_fma_f32 v60, v60, v55, v55
 v_mfma_f32_16x16x32_bf16 v[192:195], a[224:227], a[168:171], v[192:195]
 v_rcp_f32 v60, v60
 v_fma_f32 v61, v61, v55, v55
 v_mfma_f32_16x16x32_bf16 v[196:199], a[8:11], a[168:171], v[196:199]
 v_rcp_f32 v61, v61
 v_fma_f32 v62, v62, v55, v55
 v_mfma_f32_16x16x32_bf16 v[184:187], a[228:231], a[172:175], v[184:187]
 v_rcp_f32 v62, v62
 v_fma_f32 v63, v63, v55, v55
 v_mfma_f32_16x16x32_bf16 v[188:191], a[232:235], a[172:175], v[188:191]
 v_rcp_f32 v63, v63
 v_mul_f32 v60, v60, v64
 v_mfma_f32_16x16x32_bf16 v[192:195], a[236:239], a[172:175], v[192:195]
 v_mul_f32 v61, v61, v65
 v_mul_f32 v62, v62, v66
 v_mul_f32 v63, v63, v67
 v_mfma_f32_16x16x32_bf16 v[196:199], a[12:15], a[172:175], v[196:199]
 v_cvt_pk_bf16_f32 v34, v60, v61
 v_cvt_pk_bf16_f32 v35, v62, v63
 v_mul_f32 v60, v108, v108
 v_mfma_f32_16x16x32_bf16 v[184:187], a[240:243], a[176:179], v[184:187]
 v_mul_f32 v61, v109, v109
 v_mul_f32 v62, v110, v110
 v_mfma_f32_16x16x32_bf16 v[188:191], a[244:247], a[176:179], v[188:191]
 v_mul_f32 v63, v111, v111
 v_fma_f32 v60, v60, v53, v51
 v_fma_f32 v61, v61, v53, v51
 v_mfma_f32_16x16x32_bf16 v[192:195], a[248:251], a[176:179], v[192:195]
 v_fma_f32 v62, v62, v53, v51
 v_fma_f32 v63, v63, v53, v51
 v_mul_f32 v60, v60, v108
 v_mfma_f32_16x16x32_bf16 v[196:199], a[16:19], a[176:179], v[196:199]
 v_mul_f32 v61, v61, v109
 v_mul_f32 v62, v62, v110
 v_mfma_f32_16x16x32_bf16 v[184:187], a[252:255], a[180:183], v[184:187]
 s_waitcnt vmcnt(2)
 v_mul_f32 v63, v63, v111
 v_mov_b32 v5, 7
 v_mfma_f32_16x16x32_bf16 v[188:191], a[20:23], a[180:183], v[188:191]
 buffer_store_dword v5, off, s[4:7], s68
 v_exp_f32 v60, v60
 v_mfma_f32_16x16x32_bf16 v[192:195], a[24:27], a[180:183], v[192:195]
 v_mul_f32 v64, v108, v112
 v_exp_f32 v61, v61
 v_mfma_f32_16x16x32_bf16 v[196:199], a[28:31], a[180:183], v[196:199]
 v_mul_f32 v65, v109, v113
 v_exp_f32 v62, v62
 v_mfma_f32_16x16x32_bf16 v[184:187], a[32:35], a[184:187], v[184:187]
 v_mul_f32 v66, v110, v114
 v_exp_f32 v63, v63
 v_mfma_f32_16x16x32_bf16 v[188:191], a[36:39], a[184:187], v[188:191]
 v_mul_f32 v67, v111, v115
 v_fma_f32 v60, v60, v55, v55
 v_mfma_f32_16x16x32_bf16 v[192:195], a[40:43], a[184:187], v[192:195]
 v_rcp_f32 v60, v60
 v_fma_f32 v61, v61, v55, v55
 v_mfma_f32_16x16x32_bf16 v[196:199], a[44:47], a[184:187], v[196:199]
 v_rcp_f32 v61, v61
 v_fma_f32 v62, v62, v55, v55
 v_mfma_f32_16x16x32_bf16 v[184:187], a[48:51], a[188:191], v[184:187]
 s_waitcnt vmcnt(1)
 v_cmp_gt_u32 vcc, 6, v3
 s_nop 0
 s_cbranch_vccnz .Lps_56
.Lpb_57:
 s_add_u32 s85, s76, 0x0
 v_mfma_f32_16x16x32_bf16 v[188:191], a[52:55], a[188:191], v[188:191]
 buffer_load_dwordx4 a[160:163], v2, s[4:7], s85 offen sc1
 v_rcp_f32 v62, v62
 v_mfma_f32_16x16x32_bf16 v[192:195], a[56:59], a[188:191], v[192:195]
 v_fma_f32 v63, v63, v55, v55
 v_rcp_f32 v63, v63
 v_mfma_f32_16x16x32_bf16 v[196:199], a[60:63], a[188:191], v[196:199]
 v_mul_f32 v60, v60, v64
 v_mul_f32 v61, v61, v65
 v_mul_f32 v62, v62, v66
 v_mfma_f32_16x16x32_bf16 v[184:187], a[64:67], v[128:131], v[184:187]
 buffer_load_dwordx4 a[164:167], v2, s[4:7], s85 offen offset:1024 sc1
 v_mul_f32 v63, v63, v67
 v_cvt_pk_bf16_f32 v36, v60, v61
 v_cvt_pk_bf16_f32 v37, v62, v63
 v_mfma_f32_16x16x32_bf16 v[188:191], a[68:71], v[128:131], v[188:191]
 buffer_store_dwordx4 v[34:37], v2, s[4:7], s90 offen nt
 v_mfma_f32_16x16x32_bf16 v[192:195], a[72:75], v[128:131], v[192:195]
 v_mul_f32 v60, v116, v116
 v_mul_f32 v61, v117, v117
 v_mul_f32 v62, v118, v118
 v_mfma_f32_16x16x32_bf16 v[196:199], a[76:79], v[128:131], v[196:199]
 v_mul_f32 v63, v119, v119
 v_fma_f32 v60, v60, v53, v51
 v_fma_f32 v61, v61, v53, v51
 v_mfma_f32_16x16x32_bf16 v[184:187], a[80:83], v[132:135], v[184:187]
 buffer_load_dwordx4 a[168:171], v2, s[4:7], s85 offen offset:2048 sc1
 v_fma_f32 v62, v62, v53, v51
 v_mfma_f32_16x16x32_bf16 v[188:191], a[84:87], v[132:135], v[188:191]
 v_fma_f32 v63, v63, v53, v51
 v_mul_f32 v60, v60, v116
 v_mul_f32 v61, v61, v117
 v_mfma_f32_16x16x32_bf16 v[192:195], a[88:91], v[132:135], v[192:195]
 v_mul_f32 v62, v62, v118
 v_mul_f32 v63, v63, v119
 v_mfma_f32_16x16x32_bf16 v[196:199], a[92:95], v[132:135], v[196:199]
 v_exp_f32 v60, v60
 v_mul_f32 v64, v116, v120
 v_mfma_f32_16x16x32_bf16 v[184:187], a[96:99], v[136:139], v[184:187]
 buffer_load_dwordx4 a[172:175], v2, s[4:7], s85 offen offset:3072 sc1
 v_exp_f32 v61, v61
 v_mfma_f32_16x16x32_bf16 v[188:191], a[100:103], v[136:139], v[188:191]
 v_mul_f32 v65, v117, v121
 v_exp_f32 v62, v62
 v_mfma_f32_16x16x32_bf16 v[192:195], a[104:107], v[136:139], v[192:195]
 v_mul_f32 v66, v118, v122
 v_mfma_f32_16x16x32_bf16 v[196:199], a[108:111], v[136:139], v[196:199]
 v_exp_f32 v63, v63
 v_mul_f32 v67, v119, v123
 v_mfma_f32_16x16x32_bf16 v[184:187], a[112:115], v[140:143], v[184:187]
 s_add_u32 s85, s76, 0x1000
 buffer_load_dwordx4 a[176:179], v2, s[4:7], s85 offen sc1
 v_fma_f32 v60, v60, v55, v55
 v_mfma_f32_16x16x32_bf16 v[188:191], a[116:119], v[140:143], v[188:191]
 v_rcp_f32 v60, v60
 v_fma_f32 v61, v61, v55, v55
 v_mfma_f32_16x16x32_bf16 v[192:195], a[120:123], v[140:143], v[192:195]
 v_rcp_f32 v61, v61
 v_mfma_f32_16x16x32_bf16 v[196:199], a[124:127], v[140:143], v[196:199]
 v_fma_f32 v62, v62, v55, v55
 v_rcp_f32 v62, v62
 v_mfma_f32_16x16x32_bf16 v[184:187], a[128:131], v[144:147], v[184:187]
 buffer_load_dwordx4 a[180:183], v2, s[4:7], s85 offen offset:1024 sc1
 v_fma_f32 v63, v63, v55, v55
 v_mfma_f32_16x16x32_bf16 v[188:191], a[132:135], v[144:147], v[188:191]
 v_rcp_f32 v63, v63
 v_mul_f32 v60, v60, v64
 v_mfma_f32_16x16x32_bf16 v[192:195], a[136:139], v[144:147], v[192:195]
 s_barrier
 v_mul_f32 v61, v61, v65
 v_mul_f32 v62, v62, v66
 v_mfma_f32_16x16x32_bf16 v[196:199], a[140:143], v[144:147], v[196:199]
 v_mul_f32 v63, v63, v67
 v_cvt_pk_bf16_f32 v70, v60, v61
 v_mfma_f32_16x16x32_bf16 v[184:187], a[144:147], v[148:151], v[184:187]
 buffer_load_dwordx4 a[184:187], v2, s[4:7], s85 offen offset:2048 sc1
 v_cvt_pk_bf16_f32 v71, v62, v63
 v_mfma_f32_16x16x32_bf16 v[188:191], a[148:151], v[148:151], v[188:191]
 buffer_load_dword v3, v7, s[4:7], s66 offen sc1
 v_mfma_f32_16x16x32_bf16 v[192:195], a[152:155], v[148:151], v[192:195]
 buffer_store_dwordx2 v[70:71], v27, s[4:7], s90 offen offset:1024 nt
 v_mfma_f32_16x16x32_bf16 v[196:199], a[156:159], v[148:151], v[196:199]
 s_waitcnt vmcnt(9)
 v_mfma_f32_16x16x32_bf16 v[200:203], a[192:195], a[160:163], 0
 buffer_load_dwordx4 a[188:191], v2, s[4:7], s85 offen offset:3072 sc1
 v_mfma_f32_16x16x32_bf16 v[204:207], a[196:199], a[160:163], 0
 v_mfma_f32_16x16x32_bf16 v[208:211], a[200:203], a[160:163], 0
 v_mfma_f32_16x16x32_bf16 v[212:215], a[0:3], a[160:163], 0
 s_waitcnt vmcnt(9)
 v_mfma_f32_16x16x32_bf16 v[200:203], a[204:207], a[164:167], v[200:203]
 s_add_u32 s85, s76, 0x2000
 buffer_load_dwordx4 v[128:131], v2, s[4:7], s85 offen sc1
 v_mfma_f32_16x16x32_bf16 v[204:207], a[208:211], a[164:167], v[204:207]
 v_mfma_f32_16x16x32_bf16 v[208:211], a[212:215], a[164:167], v[208:211]
 ds_write_b128 v9, v[184:187]
 v_mfma_f32_16x16x32_bf16 v[212:215], a[4:7], a[164:167], v[212:215]
 s_waitcnt vmcnt(8)
 ds_write_b128 v10, v[188:191]
 v_mfma_f32_16x16x32_bf16 v[200:203], a[216:219], a[168:171], v[200:203]
 buffer_load_dwordx4 v[132:135], v2, s[4:7], s85 offen offset:1024 sc1
 v_mfma_f32_16x16x32_bf16 v[204:207], a[220:223], a[168:171], v[204:207]
 v_mfma_f32_16x16x32_bf16 v[208:211], a[224:227], a[168:171], v[208:211]
 ds_write_b128 v9, v[192:195] offset:128
 v_mfma_f32_16x16x32_bf16 v[212:215], a[8:11], a[168:171], v[212:215]
 s_waitcnt vmcnt(8)
 ds_write_b128 v10, v[196:199] offset:128
 v_mfma_f32_16x16x32_bf16 v[200:203], a[228:231], a[172:175], v[200:203]
 buffer_load_dwordx4 v[136:139], v2, s[4:7], s85 offen offset:2048 sc1
 v_mfma_f32_16x16x32_bf16 v[204:207], a[232:235], a[172:175], v[204:207]
 v_mfma_f32_16x16x32_bf16 v[208:211], a[236:239], a[172:175], v[208:211]
 v_mfma_f32_16x16x32_bf16 v[212:215], a[12:15], a[172:175], v[212:215]
 s_waitcnt vmcnt(8)
 v_mfma_f32_16x16x32_bf16 v[200:203], a[240:243], a[176:179], v[200:203]
 buffer_load_dwordx4 v[140:143], v2, s[4:7], s85 offen offset:3072 sc1
 v_mfma_f32_16x16x32_bf16 v[204:207], a[244:247], a[176:179], v[204:207]
 v_mfma_f32_16x16x32_bf16 v[208:211], a[248:251], a[176:179], v[208:211]
 v_mfma_f32_16x16x32_bf16 v[212:215], a[16:19], a[176:179], v[212:215]
 s_waitcnt vmcnt(8)
 v_mfma_f32_16x16x32_bf16 v[200:203], a[252:255], a[180:183], v[200:203]
 s_add_u32 s85, s76, 0x3000
 buffer_load_dwordx4 v[144:147], v2, s[4:7], s85 offen sc1
 v_mfma_f32_16x16x32_bf16 v[204:207], a[20:23], a[180:183], v[204:207]
 v_mfma_f32_16x16x32_bf16 v[208:211], a[24:27], a[180:183], v[208:211]
 s_waitcnt lgkmcnt(0)
 s_barrier
 v_mov_b32 v5, 8
 s_waitcnt vmcnt(6)
 v_mfma_f32_16x16x32_bf16 v[212:215], a[28:31], a[180:183], v[212:215]
 buffer_store_dword v5, off, s[4:7], s68
 v_mfma_f32_16x16x32_bf16 v[200:203], a[32:35], a[184:187], v[200:203]
 ds_read_b128 v[216:219], v11
 ds_read_b128 v[220:223], v11 offset:4096
 v_mfma_f32_16x16x32_bf16 v[204:207], a[36:39], a[184:187], v[204:207]
 buffer_load_dwordx4 v[148:151], v2, s[4:7], s85 offen offset:1024 sc1
 ds_read_b128 v[224:227], v11 offset:8192
 v_mfma_f32_16x16x32_bf16 v[208:211], a[40:43], a[184:187], v[208:211]
 ds_read_b128 v[228:231], v11 offset:12288
 v_mfma_f32_16x16x32_bf16 v[212:215], a[44:47], a[184:187], v[212:215]
 s_waitcnt vmcnt(7)
 v_cmp_gt_u32 vcc, 7, v3
 v_mfma_f32_16x16x32_bf16 v[200:203], a[48:51], a[188:191], v[200:203]
 s_cbranch_vccnz .Lps_58
.Lpb_59:
 s_add_u32 s85, s76, 0x40e000
 buffer_load_dwordx4 a[160:163], v2, s[4:7], s85 offen sc1
 v_mfma_f32_16x16x32_bf16 v[204:207], a[52:55], a[188:191], v[204:207]
 v_mfma_f32_16x16x32_bf16 v[208:211], a[56:59], a[188:191], v[208:211]
 v_mfma_f32_16x16x32_bf16 v[212:215], a[60:63], a[188:191], v[212:215]
 s_waitcnt vmcnt(7)
 v_mfma_f32_16x16x32_bf16 v[200:203], a[64:67], v[128:131], v[200:203]
 s_add_u32 s91, s56, 0x18000
 buffer_load_dwordx4 a[164:167], v2, s[4:7], s85 offen offset:1024 sc1
 v_mfma_f32_16x16x32_bf16 v[204:207], a[68:71], v[128:131], v[204:207]
 v_lshlrev_b32 v232, 16, v22
 v_and_b32 v233, 0xffff0000, v22
 v_mfma_f32_16x16x32_bf16 v[208:211], a[72:75], v[128:131], v[208:211]
 v_lshlrev_b32 v234, 16, v23
 v_mfma_f32_16x16x32_bf16 v[212:215], a[76:79], v[128:131], v[212:215]
 s_waitcnt vmcnt(7)
 v_and_b32 v235, 0xffff0000, v23
 v_mfma_f32_16x16x32_bf16 v[200:203], a[80:83], v[132:135], v[200:203]
 s_waitcnt lgkmcnt(0)
 buffer_load_dwordx4 a[168:171], v2, s[4:7], s85 offen offset:2048 sc1
 v_mfma_f32_16x16x32_bf16 v[204:207], a[84:87], v[132:135], v[204:207]
 v_add_f32 v216, v216, v220
 v_add_f32 v224, v224, v228
 v_mfma_f32_16x16x32_bf16 v[208:211], a[88:91], v[132:135], v[208:211]
 v_add_f32 v217, v217, v221
 v_add_f32 v225, v225, v229
 v_mfma_f32_16x16x32_bf16 v[212:215], a[92:95], v[132:135], v[212:215]
 s_waitcnt vmcnt(7)
 v_add_f32 v218, v218, v222
 v_mfma_f32_16x16x32_bf16 v[200:203], a[96:99], v[136:139], v[200:203]
 buffer_load_dwordx4 a[172:175], v2, s[4:7], s85 offen offset:3072 sc1
 v_mfma_f32_16x16x32_bf16 v[204:207], a[100:103], v[136:139], v[204:207]
 v_add_f32 v226, v226, v230
 v_add_f32 v219, v219, v223
 v_mfma_f32_16x16x32_bf16 v[208:211], a[104:107], v[136:139], v[208:211]
 v_add_f32 v227, v227, v231
 v_mfma_f32_16x16x32_bf16 v[212:215], a[108:111], v[136:139], v[212:215]
 s_waitcnt vmcnt(7)
 v_add_f32 v216, v216, v224
 v_add_f32 v217, v217, v225
 v_mfma_f32_16x16x32_bf16 v[200:203], a[112:115], v[140:143], v[200:203]
 s_add_u32 s85, s76, 0x40f000
 buffer_load_dwordx4 a[176:179], v2, s[4:7], s85 offen sc1
 v_mfma_f32_16x16x32_bf16 v[204:207], a[116:119], v[140:143], v[204:207]
 v_add_f32 v218, v218, v226
 v_mfma_f32_16x16x32_bf16 v[208:211], a[120:123], v[140:143], v[208:211]
 v_add_f32 v219, v219, v227
 v_mfma_f32_16x16x32_bf16 v[212:215], a[124:127], v[140:143], v[212:215]
 s_waitcnt vmcnt(7)
 v_add_f32 v232, v232, v216
 v_add_f32 v233, v233, v217
 v_mfma_f32_16x16x32_bf16 v[200:203], a[128:131], v[144:147], v[200:203]
 buffer_load_dwordx4 a[180:183], v2, s[4:7], s85 offen offset:1024 sc1
 v_mfma_f32_16x16x32_bf16 v[204:207], a[132:135], v[144:147], v[204:207]
 v_add_f32 v234, v234, v218
 v_mfma_f32_16x16x32_bf16 v[208:211], a[136:139], v[144:147], v[208:211]
 v_add_f32 v235, v235, v219
 v_mfma_f32_16x16x32_bf16 v[212:215], a[140:143], v[144:147], v[212:215]
 s_waitcnt vmcnt(6)
 v_cvt_pk_bf16_f32 v22, v232, v233
 v_cvt_pk_bf16_f32 v23, v234, v235
 v_mfma_f32_16x16x32_bf16 v[200:203], a[144:147], v[148:151], v[200:203]
 buffer_load_dwordx4 a[184:187], v2, s[4:7], s85 offen offset:2048 sc1
 v_mfma_f32_16x16x32_bf16 v[204:207], a[148:151], v[148:151], v[204:207]
 buffer_load_dword v3, v7, s[4:7], s66 offen sc1
 v_mfma_f32_16x16x32_bf16 v[208:211], a[152:155], v[148:151], v[208:211]
 buffer_store_dwordx2 v[22:23], v13, s[12:15], s91 offen nt
 v_mfma_f32_16x16x32_bf16 v[212:215], a[156:159], v[148:151], v[212:215]
 s_waitcnt vmcnt(8)
 v_mfma_f32_16x16x32_bf16 v[184:187], a[192:195], a[160:163], 0
 buffer_load_dwordx4 a[188:191], v2, s[4:7], s85 offen offset:3072 sc1
 v_mfma_f32_16x16x32_bf16 v[188:191], a[196:199], a[160:163], 0
 v_mfma_f32_16x16x32_bf16 v[192:195], a[200:203], a[160:163], 0
 v_mfma_f32_16x16x32_bf16 v[196:199], a[0:3], a[160:163], 0
 s_waitcnt vmcnt(8)
 v_mfma_f32_16x16x32_bf16 v[184:187], a[204:207], a[164:167], v[184:187]
 s_add_u32 s85, s76, 0x410000
 buffer_load_dwordx4 v[128:131], v2, s[4:7], s85 offen sc1
 v_mfma_f32_16x16x32_bf16 v[188:191], a[208:211], a[164:167], v[188:191]
 v_mfma_f32_16x16x32_bf16 v[192:195], a[212:215], a[164:167], v[192:195]
 ds_write_b128 v9, v[200:203] offset:16384
 v_mfma_f32_16x16x32_bf16 v[196:199], a[4:7], a[164:167], v[196:199]
 s_waitcnt vmcnt(8)
 ds_write_b128 v10, v[204:207] offset:16384
 v_mfma_f32_16x16x32_bf16 v[184:187], a[216:219], a[168:171], v[184:187]
 buffer_load_dwordx4 v[132:135], v2, s[4:7], s85 offen offset:1024 sc1
 v_mfma_f32_16x16x32_bf16 v[188:191], a[220:223], a[168:171], v[188:191]
 v_mfma_f32_16x16x32_bf16 v[192:195], a[224:227], a[168:171], v[192:195]
 ds_write_b128 v9, v[208:211] offset:16512
 v_mfma_f32_16x16x32_bf16 v[196:199], a[8:11], a[168:171], v[196:199]
 s_waitcnt vmcnt(8)
 ds_write_b128 v10, v[212:215] offset:16512
 v_mfma_f32_16x16x32_bf16 v[184:187], a[228:231], a[172:175], v[184:187]
 buffer_load_dwordx4 v[136:139], v2, s[4:7], s85 offen offset:2048 sc1
 v_mfma_f32_16x16x32_bf16 v[188:191], a[232:235], a[172:175], v[188:191]
 v_mfma_f32_16x16x32_bf16 v[192:195], a[236:239], a[172:175], v[192:195]
 v_mfma_f32_16x16x32_bf16 v[196:199], a[12:15], a[172:175], v[196:199]
 s_waitcnt vmcnt(8)
 v_mfma_f32_16x16x32_bf16 v[184:187], a[240:243], a[176:179], v[184:187]
 buffer_load_dwordx4 v[140:143], v2, s[4:7], s85 offen offset:3072 sc1
 v_mfma_f32_16x16x32_bf16 v[188:191], a[244:247], a[176:179], v[188:191]
 v_mfma_f32_16x16x32_bf16 v[192:195], a[248:251], a[176:179], v[192:195]
 v_mfma_f32_16x16x32_bf16 v[196:199], a[16:19], a[176:179], v[196:199]
 s_waitcnt vmcnt(8)
 v_mfma_f32_16x16x32_bf16 v[184:187], a[252:255], a[180:183], v[184:187]
 s_add_u32 s85, s76, 0x411000
 buffer_load_dwordx4 v[144:147], v2, s[4:7], s85 offen sc1
 v_mfma_f32_16x16x32_bf16 v[188:191], a[20:23], a[180:183], v[188:191]
 v_mfma_f32_16x16x32_bf16 v[192:195], a[24:27], a[180:183], v[192:195]
 s_waitcnt lgkmcnt(0)
 s_barrier
 v_mfma_f32_16x16x32_bf16 v[196:199], a[28:31], a[180:183], v[196:199]
 s_waitcnt vmcnt(8)
 ds_read_b128 v[216:219], v11 offset:16384
 v_mfma_f32_16x16x32_bf16 v[184:187], a[32:35], a[184:187], v[184:187]
 ds_read_b128 v[220:223], v11 offset:20480
 buffer_load_dwordx4 v[148:151], v2, s[4:7], s85 offen offset:1024 sc1
 v_mfma_f32_16x16x32_bf16 v[188:191], a[36:39], a[184:187], v[188:191]
 ds_read_b128 v[224:227], v11 offset:24576
 v_mfma_f32_16x16x32_bf16 v[192:195], a[40:43], a[184:187], v[192:195]
 ds_read_b128 v[228:231], v11 offset:28672
 v_mfma_f32_16x16x32_bf16 v[196:199], a[44:47], a[184:187], v[196:199]
 s_waitcnt vmcnt(6)
 v_cmp_gt_u32 vcc, 8, v3
 v_mfma_f32_16x16x32_bf16 v[184:187], a[48:51], a[188:191], v[184:187]
 s_cbranch_vccnz .Lps_60
.Lpb_61:
 s_add_u32 s85, s76, 0x400000
 buffer_load_dwordx4 a[160:163], v2, s[4:7], s85 offen sc1
 v_mfma_f32_16x16x32_bf16 v[188:191], a[52:55], a[188:191], v[188:191]
 v_mfma_f32_16x16x32_bf16 v[192:195], a[56:59], a[188:191], v[192:195]
 v_mfma_f32_16x16x32_bf16 v[196:199], a[60:63], a[188:191], v[196:199]
 s_waitcnt vmcnt(6)
 v_mfma_f32_16x16x32_bf16 v[184:187], a[64:67], v[128:131], v[184:187]
 s_add_u32 s91, s56, 0x10000
 buffer_load_dwordx4 a[164:167], v2, s[4:7], s85 offen offset:1024 sc1
 v_mfma_f32_16x16x32_bf16 v[188:191], a[68:71], v[128:131], v[188:191]
 v_lshlrev_b32 v232, 16, v20
 v_mfma_f32_16x16x32_bf16 v[192:195], a[72:75], v[128:131], v[192:195]
 v_and_b32 v233, 0xffff0000, v20
 v_lshlrev_b32 v234, 16, v21
 v_mfma_f32_16x16x32_bf16 v[196:199], a[76:79], v[128:131], v[196:199]
 s_waitcnt vmcnt(6)
 v_and_b32 v235, 0xffff0000, v21
 v_mfma_f32_16x16x32_bf16 v[184:187], a[80:83], v[132:135], v[184:187]
 s_waitcnt lgkmcnt(0)
 buffer_load_dwordx4 a[168:171], v2, s[4:7], s85 offen offset:2048 sc1
 v_mfma_f32_16x16x32_bf16 v[188:191], a[84:87], v[132:135], v[188:191]
 v_add_f32 v216, v216, v220
 v_add_f32 v224, v224, v228
 v_mfma_f32_16x16x32_bf16 v[192:195], a[88:91], v[132:135], v[192:195]
 v_add_f32 v217, v217, v221
 v_mfma_f32_16x16x32_bf16 v[196:199], a[92:95], v[132:135], v[196:199]
 s_waitcnt vmcnt(6)
 v_add_f32 v225, v225, v229
 v_add_f32 v218, v218, v222
 v_mfma_f32_16x16x32_bf16 v[184:187], a[96:99], v[136:139], v[184:187]
 buffer_load_dwordx4 a[172:175], v2, s[4:7], s85 offen offset:3072 sc1
 v_mfma_f32_16x16x32_bf16 v[188:191], a[100:103], v[136:139], v[188:191]
 v_add_f32 v226, v226, v230
 v_mfma_f32_16x16x32_bf16 v[192:195], a[104:107], v[136:139], v[192:195]
 v_add_f32 v219, v219, v223
 v_add_f32 v227, v227, v231
 v_mfma_f32_16x16x32_bf16 v[196:199], a[108:111], v[136:139], v[196:199]
 s_waitcnt vmcnt(6)
 v_add_f32 v216, v216, v224
 v_mfma_f32_16x16x32_bf16 v[184:187], a[112:115], v[140:143], v[184:187]
 s_add_u32 s85, s76, 0x401000
 buffer_load_dwordx4 a[176:179], v2, s[4:7], s85 offen sc1
 v_mfma_f32_16x16x32_bf16 v[188:191], a[116:119], v[140:143], v[188:191]
 v_add_f32 v217, v217, v225
 v_mfma_f32_16x16x32_bf16 v[192:195], a[120:123], v[140:143], v[192:195]
 v_add_f32 v218, v218, v226
 v_add_f32 v219, v219, v227
 v_mfma_f32_16x16x32_bf16 v[196:199], a[124:127], v[140:143], v[196:199]
 s_waitcnt vmcnt(6)
 v_add_f32 v232, v232, v216
 v_mfma_f32_16x16x32_bf16 v[184:187], a[128:131], v[144:147], v[184:187]
 buffer_load_dwordx4 a[180:183], v2, s[4:7], s85 offen offset:1024 sc1
 v_mfma_f32_16x16x32_bf16 v[188:191], a[132:135], v[144:147], v[188:191]
 v_add_f32 v233, v233, v217
 v_mfma_f32_16x16x32_bf16 v[192:195], a[136:139], v[144:147], v[192:195]
 v_add_f32 v234, v234, v218
 v_add_f32 v235, v235, v219
 v_mfma_f32_16x16x32_bf16 v[196:199], a[140:143], v[144:147], v[196:199]
 s_waitcnt vmcnt(6)
 v_cvt_pk_bf16_f32 v20, v232, v233
 v_mfma_f32_16x16x32_bf16 v[184:187], a[144:147], v[148:151], v[184:187]
 buffer_load_dwordx4 a[184:187], v2, s[4:7], s85 offen offset:2048 sc1
 v_mfma_f32_16x16x32_bf16 v[188:191], a[148:151], v[148:151], v[188:191]
 v_cvt_pk_bf16_f32 v21, v234, v235
 v_mfma_f32_16x16x32_bf16 v[192:195], a[152:155], v[148:151], v[192:195]
 buffer_store_dwordx2 v[20:21], v13, s[12:15], s91 offen nt
 v_mfma_f32_16x16x32_bf16 v[196:199], a[156:159], v[148:151], v[196:199]
 s_waitcnt vmcnt(7)
 v_mfma_f32_16x16x32_bf16 v[200:203], a[192:195], a[160:163], 0
 buffer_load_dwordx4 a[188:191], v2, s[4:7], s85 offen offset:3072 sc1
 v_mfma_f32_16x16x32_bf16 v[204:207], a[196:199], a[160:163], 0
 v_mfma_f32_16x16x32_bf16 v[208:211], a[200:203], a[160:163], 0
 v_mfma_f32_16x16x32_bf16 v[212:215], a[0:3], a[160:163], 0
 s_waitcnt vmcnt(7)
 v_mfma_f32_16x16x32_bf16 v[200:203], a[204:207], a[164:167], v[200:203]
 s_add_u32 s85, s76, 0x402000
 buffer_load_dwordx4 v[128:131], v2, s[4:7], s85 offen sc1
 v_mfma_f32_16x16x32_bf16 v[204:207], a[208:211], a[164:167], v[204:207]
 v_mfma_f32_16x16x32_bf16 v[208:211], a[212:215], a[164:167], v[208:211]
 ds_write_b128 v9, v[184:187]
 v_mfma_f32_16x16x32_bf16 v[212:215], a[4:7], a[164:167], v[212:215]
 s_waitcnt vmcnt(7)
 ds_write_b128 v10, v[188:191]
 v_mfma_f32_16x16x32_bf16 v[200:203], a[216:219], a[168:171], v[200:203]
 buffer_load_dwordx4 v[132:135], v2, s[4:7], s85 offen offset:1024 sc1
 v_mfma_f32_16x16x32_bf16 v[204:207], a[220:223], a[168:171], v[204:207]
 v_mfma_f32_16x16x32_bf16 v[208:211], a[224:227], a[168:171], v[208:211]
 ds_write_b128 v9, v[192:195] offset:128
 v_mfma_f32_16x16x32_bf16 v[212:215], a[8:11], a[168:171], v[212:215]
 s_waitcnt vmcnt(7)
 ds_write_b128 v10, v[196:199] offset:128
 v_mfma_f32_16x16x32_bf16 v[200:203], a[228:231], a[172:175], v[200:203]
 buffer_load_dwordx4 v[136:139], v2, s[4:7], s85 offen offset:2048 sc1
 v_mfma_f32_16x16x32_bf16 v[204:207], a[232:235], a[172:175], v[204:207]
 v_mfma_f32_16x16x32_bf16 v[208:211], a[236:239], a[172:175], v[208:211]
 v_mfma_f32_16x16x32_bf16 v[212:215], a[12:15], a[172:175], v[212:215]
 s_waitcnt vmcnt(7)
 v_mfma_f32_16x16x32_bf16 v[200:203], a[240:243], a[176:179], v[200:203]
 buffer_load_dwordx4 v[140:143], v2, s[4:7], s85 offen offset:3072 sc1
 v_mfma_f32_16x16x32_bf16 v[204:207], a[244:247], a[176:179], v[204:207]
 v_mfma_f32_16x16x32_bf16 v[208:211], a[248:251], a[176:179], v[208:211]
 v_mfma_f32_16x16x32_bf16 v[212:215], a[16:19], a[176:179], v[212:215]
 s_waitcnt vmcnt(7)
 v_mfma_f32_16x16x32_bf16 v[200:203], a[252:255], a[180:183], v[200:203]
 s_add_u32 s85, s76, 0x403000
 buffer_load_dwordx4 v[144:147], v2, s[4:7], s85 offen sc1
 v_mfma_f32_16x16x32_bf16 v[204:207], a[20:23], a[180:183], v[204:207]
 v_mfma_f32_16x16x32_bf16 v[208:211], a[24:27], a[180:183], v[208:211]
 s_waitcnt lgkmcnt(0)
 s_barrier
 v_mfma_f32_16x16x32_bf16 v[212:215], a[28:31], a[180:183], v[212:215]
 s_waitcnt vmcnt(7)
 ds_read_b128 v[216:219], v11
 v_mfma_f32_16x16x32_bf16 v[200:203], a[32:35], a[184:187], v[200:203]
 ds_read_b128 v[220:223], v11 offset:4096
 buffer_load_dwordx4 v[148:151], v2, s[4:7], s85 offen offset:1024 sc1
 v_mfma_f32_16x16x32_bf16 v[204:207], a[36:39], a[184:187], v[204:207]
 ds_read_b128 v[224:227], v11 offset:8192
 v_mfma_f32_16x16x32_bf16 v[208:211], a[40:43], a[184:187], v[208:211]
 ds_read_b128 v[228:231], v11 offset:12288
 v_mfma_f32_16x16x32_bf16 v[212:215], a[44:47], a[184:187], v[212:215]
 s_waitcnt vmcnt(6)
 v_mfma_f32_16x16x32_bf16 v[200:203], a[48:51], a[188:191], v[200:203]
 v_mfma_f32_16x16x32_bf16 v[204:207], a[52:55], a[188:191], v[204:207]
 v_mfma_f32_16x16x32_bf16 v[208:211], a[56:59], a[188:191], v[208:211]
 v_mfma_f32_16x16x32_bf16 v[212:215], a[60:63], a[188:191], v[212:215]
 s_waitcnt vmcnt(5)
 v_mfma_f32_16x16x32_bf16 v[200:203], a[64:67], v[128:131], v[200:203]
 s_add_u32 s91, s56, 0x8000
 v_lshlrev_b32 v232, 16, v18
 v_mfma_f32_16x16x32_bf16 v[204:207], a[68:71], v[128:131], v[204:207]
 v_and_b32 v233, 0xffff0000, v18
 v_mfma_f32_16x16x32_bf16 v[208:211], a[72:75], v[128:131], v[208:211]
 v_lshlrev_b32 v234, 16, v19
 v_mfma_f32_16x16x32_bf16 v[212:215], a[76:79], v[128:131], v[212:215]
 s_waitcnt vmcnt(4)
 v_and_b32 v235, 0xffff0000, v19
 v_mfma_f32_16x16x32_bf16 v[200:203], a[80:83], v[132:135], v[200:203]
 s_waitcnt lgkmcnt(1)
 v_add_f32 v216, v216, v220
 v_mfma_f32_16x16x32_bf16 v[204:207], a[84:87], v[132:135], v[204:207]
 s_waitcnt lgkmcnt(0)
 v_add_f32 v224, v224, v228
 v_mfma_f32_16x16x32_bf16 v[208:211], a[88:91], v[132:135], v[208:211]
 v_add_f32 v217, v217, v221
 v_mfma_f32_16x16x32_bf16 v[212:215], a[92:95], v[132:135], v[212:215]
 s_waitcnt vmcnt(3)
 v_add_f32 v225, v225, v229
 v_mfma_f32_16x16x32_bf16 v[200:203], a[96:99], v[136:139], v[200:203]
 v_add_f32 v218, v218, v222
 v_mfma_f32_16x16x32_bf16 v[204:207], a[100:103], v[136:139], v[204:207]
 v_add_f32 v226, v226, v230
 v_add_f32 v219, v219, v223
 v_mfma_f32_16x16x32_bf16 v[208:211], a[104:107], v[136:139], v[208:211]
 v_add_f32 v227, v227, v231
 v_mfma_f32_16x16x32_bf16 v[212:215], a[108:111], v[136:139], v[212:215]
 s_waitcnt vmcnt(2)
 v_add_f32 v216, v216, v224
 v_mfma_f32_16x16x32_bf16 v[200:203], a[112:115], v[140:143], v[200:203]
 v_mfma_f32_16x16x32_bf16 v[204:207], a[116:119], v[140:143], v[204:207]
 v_add_f32 v217, v217, v225
 v_add_f32 v218, v218, v226
 v_mfma_f32_16x16x32_bf16 v[208:211], a[120:123], v[140:143], v[208:211]
 v_add_f32 v219, v219, v227
 v_mfma_f32_16x16x32_bf16 v[212:215], a[124:127], v[140:143], v[212:215]
 s_waitcnt vmcnt(1)
 v_mfma_f32_16x16x32_bf16 v[200:203], a[128:131], v[144:147], v[200:203]
 v_add_f32 v232, v232, v216
 v_add_f32 v233, v233, v217
 v_mfma_f32_16x16x32_bf16 v[204:207], a[132:135], v[144:147], v[204:207]
 v_mfma_f32_16x16x32_bf16 v[208:211], a[136:139], v[144:147], v[208:211]
 v_add_f32 v234, v234, v218
 v_add_f32 v235, v235, v219
 v_mfma_f32_16x16x32_bf16 v[212:215], a[140:143], v[144:147], v[212:215]
 s_waitcnt vmcnt(0)
 v_mfma_f32_16x16x32_bf16 v[200:203], a[144:147], v[148:151], v[200:203]
 v_cvt_pk_bf16_f32 v18, v232, v233
 v_mfma_f32_16x16x32_bf16 v[204:207], a[148:151], v[148:151], v[204:207]
 v_cvt_pk_bf16_f32 v19, v234, v235
 v_mfma_f32_16x16x32_bf16 v[208:211], a[152:155], v[148:151], v[208:211]
 buffer_store_dwordx2 v[18:19], v13, s[12:15], s91 offen nt
 v_mfma_f32_16x16x32_bf16 v[212:215], a[156:159], v[148:151], v[212:215]
 s_nop 1
 ds_write_b128 v9, v[200:203] offset:16384
 s_nop 0
 ds_write_b128 v10, v[204:207] offset:16384
 s_nop 0
 ds_write_b128 v9, v[208:211] offset:16512
 s_nop 0
 ds_write_b128 v10, v[212:215] offset:16512
 s_waitcnt lgkmcnt(0)
 s_barrier
 ds_read_b128 v[216:219], v11 offset:16384
 ds_read_b128 v[220:223], v11 offset:20480
 ds_read_b128 v[224:227], v11 offset:24576
 ds_read_b128 v[228:231], v11 offset:28672
 s_add_u32 s91, s56, 0x0
 v_lshlrev_b32 v232, 16, v16
 v_and_b32 v233, 0xffff0000, v16
 v_lshlrev_b32 v234, 16, v17
 v_and_b32 v235, 0xffff0000, v17
 s_waitcnt lgkmcnt(2)
 v_pk_add_f32 v[216:217], v[216:217], v[220:221]
 s_waitcnt lgkmcnt(0)
 v_pk_add_f32 v[224:225], v[224:225], v[228:229]
 v_pk_add_f32 v[218:219], v[218:219], v[222:223]
 v_pk_add_f32 v[226:227], v[226:227], v[230:231]
 v_pk_add_f32 v[216:217], v[216:217], v[224:225]
 v_pk_add_f32 v[218:219], v[218:219], v[226:227]
 v_pk_add_f32 v[232:233], v[232:233], v[216:217]
 v_pk_add_f32 v[234:235], v[234:235], v[218:219]
 v_cvt_pk_bf16_f32 v16, v232, v233
 v_cvt_pk_bf16_f32 v17, v234, v235
 buffer_store_dwordx2 v[16:17], v13, s[12:15], s91 offen nt
.Ldone:
.Lend:
 s_endpgm
.Lnr_7:
 s_sleep 8
 buffer_load_dwordx2 v[146:147], off, s[24:27], 0 sc1
 s_add_u32 s54, s54, 1
 s_cmp_gt_u32 s54, 1000000
 s_cbranch_scc1 .Lend
 s_waitcnt vmcnt(0)
 s_branch .Lnc_6
.Lrr_9:
 s_sleep 2
 v_lshlrev_b32 v132, 7, v1
 s_lshl_b32 s85, s48, 13
 s_add_u32 s85, s85, 0x8c0000
 buffer_load_dwordx2 v[128:129], v132, s[4:7], s85 offen sc1
 v_lshlrev_b32 v133, 5, v6
 s_lshl_b32 s86, s49, 12
 s_add_u32 s86, s86, 0x8c0000
 buffer_load_dwordx2 v[130:131], v133, s[4:7], s86 offen sc1
 s_add_u32 s54, s54, 1
 s_cmp_gt_u32 s54, 1000000
 s_cbranch_scc1 .Lend
 s_waitcnt vmcnt(0)
 s_branch .Lrc_8
.Lps_10:
 buffer_load_dword v3, v7, s[4:7], s64 offen sc1
 s_add_u32 s54, s54, 1
 s_cmp_gt_u32 s54, 1000000
 s_cbranch_scc1 .Lend
 s_waitcnt vmcnt(0)
 v_cmp_gt_u32 vcc, 1, v3
 s_nop 1
 s_cbranch_vccnz .Lps_10
 s_branch .Lpb_11
.Lps_12:
 buffer_load_dword v3, v7, s[4:7], s64 offen sc1
 s_add_u32 s54, s54, 1
 s_cmp_gt_u32 s54, 1000000
 s_cbranch_scc1 .Lend
 s_waitcnt vmcnt(0)
 v_cmp_gt_u32 vcc, 2, v3
 s_nop 1
 s_cbranch_vccnz .Lps_12
 s_branch .Lpb_13
.Lps_14:
 buffer_load_dword v3, v7, s[4:7], s64 offen sc1
 s_add_u32 s54, s54, 1
 s_cmp_gt_u32 s54, 1000000
 s_cbranch_scc1 .Lend
 s_waitcnt vmcnt(0)
 v_cmp_gt_u32 vcc, 3, v3
 s_nop 1
 s_cbranch_vccnz .Lps_14
 s_branch .Lpb_15
.Lps_16:
 buffer_load_dword v3, v7, s[4:7], s64 offen sc1
 s_add_u32 s54, s54, 1
 s_cmp_gt_u32 s54, 1000000
 s_cbranch_scc1 .Lend
 s_waitcnt vmcnt(0)
 v_cmp_gt_u32 vcc, 4, v3
 s_nop 1
 s_cbranch_vccnz .Lps_16
 s_branch .Lpb_17
.Lps_18:
 buffer_load_dword v3, v6, s[4:7], s65 offen sc1
 s_add_u32 s54, s54, 1
 s_cmp_gt_u32 s54, 1000000
 s_cbranch_scc1 .Lend
 s_waitcnt vmcnt(0)
 v_cmp_gt_u32 vcc, 2, v3
 s_nop 1
 s_cbranch_vccnz .Lps_18
 s_branch .Lpb_19
.Lps_20:
 buffer_load_dword v3, v6, s[4:7], s65 offen sc1
 s_add_u32 s54, s54, 1
 s_cmp_gt_u32 s54, 1000000
 s_cbranch_scc1 .Lend
 s_waitcnt vmcnt(0)
 v_cmp_gt_u32 vcc, 4, v3
 s_nop 1
 s_cbranch_vccnz .Lps_20
 s_branch .Lpb_21
.Lps_22:
 s_sleep 16
 buffer_load_dword v3, v30, s[4:7], s86 offen offset:2560 sc1
 s_add_u32 s54, s54, 1
 s_cmp_gt_u32 s54, 1000000
 s_cbranch_scc1 .Lend
 s_waitcnt vmcnt(0)
 v_cmp_gt_u32 vcc, 1, v3
 s_nop 1
 s_cbranch_vccnz .Lps_22
 s_branch .Lpb_23
.Lps_24:
 buffer_load_dword v3, v7, s[4:7], s66 offen sc1
 s_add_u32 s54, s54, 1
 s_cmp_gt_u32 s54, 1000000
 s_cbranch_scc1 .Lend
 s_waitcnt vmcnt(0)
 v_cmp_gt_u32 vcc, 1, v3
 s_nop 1
 s_cbranch_vccnz .Lps_24
 s_branch .Lpb_25
.Lps_26:
 buffer_load_dword v3, v7, s[4:7], s66 offen sc1
 s_add_u32 s54, s54, 1
 s_cmp_gt_u32 s54, 1000000
 s_cbranch_scc1 .Lend
 s_waitcnt vmcnt(0)
 v_cmp_gt_u32 vcc, 2, v3
 s_nop 1
 s_cbranch_vccnz .Lps_26
 s_branch .Lpb_27
.Lps_28:
 buffer_load_dword v3, v7, s[4:7], s66 offen sc1
 s_add_u32 s54, s54, 1
 s_cmp_gt_u32 s54, 1000000
 s_cbranch_scc1 .Lend
 s_waitcnt vmcnt(0)
 v_cmp_gt_u32 vcc, 3, v3
 s_nop 1
 s_cbranch_vccnz .Lps_28
 s_branch .Lpb_29
.Lps_30:
 buffer_load_dword v3, v7, s[4:7], s66 offen sc1
 s_add_u32 s54, s54, 1
 s_cmp_gt_u32 s54, 1000000
 s_cbranch_scc1 .Lend
 s_waitcnt vmcnt(0)
 v_cmp_gt_u32 vcc, 4, v3
 s_nop 1
 s_cbranch_vccnz .Lps_30
 s_branch .Lpb_31
.Lps_32:
 buffer_load_dword v3, v6, s[4:7], s63 offen sc1
 s_add_u32 s54, s54, 1
 s_cmp_gt_u32 s54, 1000000
 s_cbranch_scc1 .Lend
 s_waitcnt vmcnt(0)
 v_cmp_gt_u32 vcc, 1, v3
 s_nop 1
 s_cbranch_vccnz .Lps_32
 s_branch .Lpb_33
.Lps_34:
 buffer_load_dword v3, v6, s[4:7], s62 offen sc1
 s_add_u32 s54, s54, 1
 s_cmp_gt_u32 s54, 1000000
 s_cbranch_scc1 .Lend
 s_waitcnt vmcnt(0)
 v_cmp_gt_u32 vcc, 1, v3
 s_nop 1
 s_cbranch_vccnz .Lps_34
 s_branch .Lpb_35
.Lps_36:
 buffer_load_dword v3, v6, s[4:7], s63 offen sc1
 s_add_u32 s54, s54, 1
 s_cmp_gt_u32 s54, 1000000
 s_cbranch_scc1 .Lend
 s_waitcnt vmcnt(0)
 v_cmp_gt_u32 vcc, 2, v3
 s_nop 1
 s_cbranch_vccnz .Lps_36
 s_branch .Lpb_37
.Lps_38:
 buffer_load_dword v3, v6, s[4:7], s63 offen sc1
 s_add_u32 s54, s54, 1
 s_cmp_gt_u32 s54, 1000000
 s_cbranch_scc1 .Lend
 s_waitcnt vmcnt(0)
 v_cmp_gt_u32 vcc, 3, v3
 s_nop 1
 s_cbranch_vccnz .Lps_38
 s_branch .Lpb_39
.Lps_40:
 buffer_load_dword v3, v6, s[4:7], s63 offen sc1
 s_add_u32 s54, s54, 1
 s_cmp_gt_u32 s54, 1000000
 s_cbranch_scc1 .Lend
 s_waitcnt vmcnt(0)
 v_cmp_gt_u32 vcc, 4, v3
 s_nop 1
 s_cbranch_vccnz .Lps_40
 s_branch .Lpb_41
.Lps_42:
 buffer_load_dword v3, v7, s[4:7], s64 offen sc1
 s_add_u32 s54, s54, 1
 s_cmp_gt_u32 s54, 1000000
 s_cbranch_scc1 .Lend
 s_waitcnt vmcnt(0)
 v_cmp_gt_u32 vcc, 5, v3
 s_nop 1
 s_cbranch_vccnz .Lps_42
 s_branch .Lpb_43
.Lps_44:
 buffer_load_dword v3, v7, s[4:7], s64 offen sc1
 s_add_u32 s54, s54, 1
 s_cmp_gt_u32 s54, 1000000
 s_cbranch_scc1 .Lend
 s_waitcnt vmcnt(0)
 v_cmp_gt_u32 vcc, 6, v3
 s_nop 1
 s_cbranch_vccnz .Lps_44
 s_branch .Lpb_45
.Lps_46:
 buffer_load_dword v3, v7, s[4:7], s64 offen sc1
 s_add_u32 s54, s54, 1
 s_cmp_gt_u32 s54, 1000000
 s_cbranch_scc1 .Lend
 s_waitcnt vmcnt(0)
 v_cmp_gt_u32 vcc, 7, v3
 s_nop 1
 s_cbranch_vccnz .Lps_46
 s_branch .Lpb_47
.Lps_48:
 buffer_load_dword v3, v7, s[4:7], s64 offen sc1
 s_add_u32 s54, s54, 1
 s_cmp_gt_u32 s54, 1000000
 s_cbranch_scc1 .Lend
 s_waitcnt vmcnt(0)
 v_cmp_gt_u32 vcc, 8, v3
 s_nop 1
 s_cbranch_vccnz .Lps_48
 s_branch .Lpb_49
.Lps_50:
 buffer_load_dword v3, v6, s[4:7], s65 offen sc1
 s_add_u32 s54, s54, 1
 s_cmp_gt_u32 s54, 1000000
 s_cbranch_scc1 .Lend
 s_waitcnt vmcnt(0)
 v_cmp_gt_u32 vcc, 6, v3
 s_nop 1
 s_cbranch_vccnz .Lps_50
 s_branch .Lpb_51
.Lps_52:
 buffer_load_dword v3, v6, s[4:7], s65 offen sc1
 s_add_u32 s54, s54, 1
 s_cmp_gt_u32 s54, 1000000
 s_cbranch_scc1 .Lend
 s_waitcnt vmcnt(0)
 v_cmp_gt_u32 vcc, 8, v3
 s_nop 1
 s_cbranch_vccnz .Lps_52
 s_branch .Lpb_53
.Lps_54:
 buffer_load_dword v3, v7, s[4:7], s66 offen sc1
 s_add_u32 s54, s54, 1
 s_cmp_gt_u32 s54, 1000000
 s_cbranch_scc1 .Lend
 s_waitcnt vmcnt(0)
 v_cmp_gt_u32 vcc, 5, v3
 s_nop 1
 s_cbranch_vccnz .Lps_54
 s_branch .Lpb_55
.Lps_56:
 buffer_load_dword v3, v7, s[4:7], s66 offen sc1
 s_add_u32 s54, s54, 1
 s_cmp_gt_u32 s54, 1000000
 s_cbranch_scc1 .Lend
 s_waitcnt vmcnt(0)
 v_cmp_gt_u32 vcc, 6, v3
 s_nop 1
 s_cbranch_vccnz .Lps_56
 s_branch .Lpb_57
.Lps_58:
 buffer_load_dword v3, v7, s[4:7], s66 offen sc1
 s_add_u32 s54, s54, 1
 s_cmp_gt_u32 s54, 1000000
 s_cbranch_scc1 .Lend
 s_waitcnt vmcnt(0)
 v_cmp_gt_u32 vcc, 7, v3
 s_nop 1
 s_cbranch_vccnz .Lps_58
 s_branch .Lpb_59
.Lps_60:
 buffer_load_dword v3, v7, s[4:7], s66 offen sc1
 s_add_u32 s54, s54, 1
 s_cmp_gt_u32 s54, 1000000
 s_cbranch_scc1 .Lend
 s_waitcnt vmcnt(0)
 v_cmp_gt_u32 vcc, 8, v3
 s_nop 1
 s_cbranch_vccnz .Lps_60
 s_branch .Lpb_61
.Lfast_end:
.Lslow:
 s_waitcnt vmcnt(0) lgkmcnt(0)
 s_nop 7
 s_nop 7
 v_mfma_f32_16x16x32_bf16 v[116:119], a[112:115], v[216:219], v[116:119]
 v_and_b32 v29, 32, v6
 v_lshlrev_b32 v28, 1, v7
 v_lshl_add_u32 v28, v29, 2, v28
 s_lshl_b32 s85, s49, 2
 s_add_u32 s85, s85, s51
 s_lshl_b32 s85, s85, 10
 s_add_u32 s85, s85, 0x840000
 buffer_load_dwordx2 v[204:205], v28, s[4:7], s85 offen offset:768 sc1
 buffer_load_dwordx2 v[206:207], v28, s[4:7], s85 offen offset:512 sc1
 buffer_load_dwordx2 v[208:209], v28, s[4:7], s85 offen offset:256 sc1
 buffer_load_dwordx2 v[210:211], v28, s[4:7], s85 offen sc1
 s_sub_u32 s86, s85, 256
 s_cmp_eq_u32 s55, 1
 s_cselect_b32 s86, s85, s86
 buffer_load_dwordx2 v[212:213], v28, s[4:7], s86 offen sc1
 v_mfma_f32_16x16x32_bf16 v[120:123], a[176:179], v[216:219], v[120:123]
 s_barrier
 ds_read_b128 v[232:235], v30 offset:16384
 ds_read_b128 v[236:239], v31 offset:16384
 v_mfma_f32_16x16x32_bf16 v[112:115], a[52:55], v[220:223], v[112:115]
 s_add_u32 m0, s16, 0
 s_add_u32 s89, s88, 0x0
 buffer_load_dwordx4 v2, s[4:7], s89 offen sc1 lds
 v_mfma_f32_16x16x32_bf16 v[116:119], a[116:119], v[220:223], v[116:119]
 v_mfma_f32_16x16x32_bf16 v[120:123], a[180:183], v[220:223], v[120:123]
 ds_read_b128 v[216:219], v32 offset:16384
 v_mfma_f32_16x16x32_bf16 v[112:115], a[56:59], v[224:227], v[112:115]
 v_mfma_f32_16x16x32_bf16 v[116:119], a[120:123], v[224:227], v[116:119]
 v_mfma_f32_16x16x32_bf16 v[120:123], a[184:187], v[224:227], v[120:123]
 ds_read_b128 v[220:223], v33 offset:16384
 v_mfma_f32_16x16x32_bf16 v[112:115], a[60:63], v[228:231], v[112:115]
 v_mfma_f32_16x16x32_bf16 v[116:119], a[124:127], v[228:231], v[116:119]
 v_mfma_f32_16x16x32_bf16 v[120:123], a[188:191], v[228:231], v[120:123]
 buffer_load_dwordx4 v2, s[4:7], s89 offen offset:1024 sc1 lds
 ds_read_b128 v[224:227], v30 offset:16640
 s_waitcnt lgkmcnt(4)
 v_mfma_f32_16x16x32_bf16 v[240:243], a[0:3], v[232:235], 0
 v_mfma_f32_16x16x32_bf16 v[192:195], a[44:47], v[64:67], v[192:195]
 v_mfma_f32_16x16x32_bf16 v[244:247], a[64:67], v[232:235], 0
 v_mfma_f32_16x16x32_bf16 v[196:199], a[108:111], v[64:67], v[196:199]
 v_mfma_f32_16x16x32_bf16 v[248:251], a[128:131], v[232:235], 0
 v_mfma_f32_16x16x32_bf16 v[200:203], a[172:175], v[64:67], v[200:203]
 ds_read_b128 v[228:231], v31 offset:16640
 s_waitcnt lgkmcnt(3)
 v_mfma_f32_16x16x32_bf16 v[240:243], a[4:7], v[236:239], v[240:243]
 v_mfma_f32_16x16x32_bf16 v[192:195], a[48:51], v[64:67], v[192:195]
 v_mfma_f32_16x16x32_bf16 v[244:247], a[68:71], v[236:239], v[244:247]
 s_and_b32 s85, s77, -65536
 s_lshl_b32 s86, s51, 2
 s_add_u32 s86, s86, s48
 s_lshl_b32 s86, s86, 12
 s_add_u32 s85, s85, s86
 v_lshlrev_b32 v5, 5, v6
 buffer_load_dword a255, v5, s[4:7], s85 offen sc1
 v_mfma_f32_16x16x32_bf16 v[196:199], a[112:115], v[64:67], v[196:199]
 v_mfma_f32_16x16x32_bf16 v[248:251], a[132:135], v[236:239], v[248:251]
 v_mfma_f32_16x16x32_bf16 v[200:203], a[176:179], v[64:67], v[200:203]
 ds_read_b128 v[232:235], v32 offset:16640
 v_mfma_f32_16x16x32_bf16 v[240:243], a[8:11], v[216:219], v[240:243]
 v_and_b32 v5, 60, v6
 v_lshlrev_b32 v5, 5, v5
 buffer_load_dword a255, v5, s[4:7], s61 offen sc1
 v_mfma_f32_16x16x32_bf16 v[192:195], a[52:55], v[64:67], v[192:195]
 v_mfma_f32_16x16x32_bf16 v[244:247], a[72:75], v[216:219], v[244:247]
 v_mfma_f32_16x16x32_bf16 v[196:199], a[116:119], v[64:67], v[196:199]
 v_mfma_f32_16x16x32_bf16 v[248:251], a[136:139], v[216:219], v[248:251]
 v_lshrrev_b32 v184, 3, v1
 v_lshlrev_b32 v185, 2, v7
 v_lshl_add_u32 v184, v184, 9, v185
 s_lshl_b32 s86, s48, 7
 s_lshl_b32 s87, s50, 13
 s_add_u32 s87, s87, s86
 s_add_u32 s87, s87, 0x180000
 buffer_load_dwordx4 v[176:179], v184, s[4:7], s87 offen sc1
 s_add_u32 s87, s87, 0x1000
 buffer_load_dwordx4 v[180:183], v184, s[4:7], s87 offen sc1
 v_mfma_f32_16x16x32_bf16 v[200:203], a[180:183], v[64:67], v[200:203]
 ds_read_b128 v[236:239], v33 offset:16640
 s_waitcnt lgkmcnt(2)
 v_mfma_f32_16x16x32_bf16 v[240:243], a[12:15], v[220:223], v[240:243]
 v_mfma_f32_16x16x32_bf16 v[192:195], a[56:59], v[64:67], v[192:195]
 v_mfma_f32_16x16x32_bf16 v[244:247], a[76:79], v[220:223], v[244:247]
 v_mfma_f32_16x16x32_bf16 v[196:199], a[120:123], v[64:67], v[196:199]
 v_mfma_f32_16x16x32_bf16 v[248:251], a[140:143], v[220:223], v[248:251]
 v_mfma_f32_16x16x32_bf16 v[200:203], a[184:187], v[64:67], v[200:203]
 ds_read_b128 v[216:219], v30 offset:16896
 v_mfma_f32_16x16x32_bf16 v[240:243], a[16:19], v[224:227], v[240:243]
 v_mfma_f32_16x16x32_bf16 v[192:195], a[60:63], v[64:67], v[192:195]
 v_mfma_f32_16x16x32_bf16 v[244:247], a[80:83], v[224:227], v[244:247]
 v_mfma_f32_16x16x32_bf16 v[196:199], a[124:127], v[64:67], v[196:199]
 v_mfma_f32_16x16x32_bf16 v[248:251], a[144:147], v[224:227], v[248:251]
 buffer_load_dwordx4 v2, s[4:7], s89 offen offset:2048 sc1 lds
 v_mfma_f32_16x16x32_bf16 v[200:203], a[188:191], v[64:67], v[200:203]
 ds_read_b128 v[220:223], v31 offset:16896
 v_mfma_f32_16x16x32_bf16 v[240:243], a[20:23], v[228:231], v[240:243]
 v_mfma_f32_16x16x32_bf16 v[244:247], a[84:87], v[228:231], v[244:247]
 v_mfma_f32_16x16x32_bf16 v[248:251], a[148:151], v[228:231], v[248:251]
 ds_read_b128 v[224:227], v32 offset:16896
 s_waitcnt lgkmcnt(3)
 v_mfma_f32_16x16x32_bf16 v[240:243], a[24:27], v[232:235], v[240:243]
 v_mfma_f32_16x16x32_bf16 v[244:247], a[88:91], v[232:235], v[244:247]
 v_mfma_f32_16x16x32_bf16 v[248:251], a[152:155], v[232:235], v[248:251]
 ds_read_b128 v[228:231], v33 offset:16896
 v_mfma_f32_16x16x32_bf16 v[240:243], a[28:31], v[236:239], v[240:243]
 v_mfma_f32_16x16x32_bf16 v[244:247], a[92:95], v[236:239], v[244:247]
 v_mfma_f32_16x16x32_bf16 v[248:251], a[156:159], v[236:239], v[248:251]
 ds_read_b128 v[232:235], v30 offset:17152
 s_waitcnt lgkmcnt(4)
 v_mfma_f32_16x16x32_bf16 v[240:243], a[32:35], v[216:219], v[240:243]
 buffer_load_dwordx4 v2, s[4:7], s89 offen offset:3072 sc1 lds
 v_mfma_f32_16x16x32_bf16 v[244:247], a[96:99], v[216:219], v[244:247]
 v_mfma_f32_16x16x32_bf16 v[248:251], a[160:163], v[216:219], v[248:251]
 v_and_b32 v145, 48, v1
 s_lshl_b32 s85, s48, 8
 s_add_u32 s85, s85, s79
 buffer_store_dwordx4 v[192:195], v145, s[4:7], s85 offen offset:512
 buffer_store_dwordx4 v[196:199], v145, s[4:7], s85 offen offset:576
 buffer_store_dwordx4 v[200:203], v145, s[4:7], s85 offen offset:640
 ds_read_b128 v[236:239], v31 offset:17152
 s_waitcnt lgkmcnt(3)
 v_mfma_f32_16x16x32_bf16 v[240:243], a[36:39], v[220:223], v[240:243]
 v_mfma_f32_16x16x32_bf16 v[244:247], a[100:103], v[220:223], v[244:247]
 s_waitcnt vmcnt(15)
 v_fmac_f32 v120, v200, v204
 v_fmac_f32 v121, v201, v204
 v_fmac_f32 v122, v202, v204
 v_mfma_f32_16x16x32_bf16 v[248:251], a[164:167], v[220:223], v[248:251]
 ds_read_b128 v[216:219], v32 offset:17152
 v_fmac_f32 v123, v203, v204
 v_mfma_f32_16x16x32_bf16 v[240:243], a[40:43], v[224:227], v[240:243]
 v_mul_f32 v120, v120, v205
 v_mul_f32 v121, v121, v205
 v_mul_f32 v122, v122, v205
 v_mfma_f32_16x16x32_bf16 v[244:247], a[104:107], v[224:227], v[244:247]
 v_mul_f32 v123, v123, v205
 v_cvt_pk_bf16_f32 v40, v120, v121
 v_mfma_f32_16x16x32_bf16 v[248:251], a[168:171], v[224:227], v[248:251]
 ds_read_b128 v[220:223], v33 offset:17152
 v_cvt_pk_bf16_f32 v41, v122, v123
 s_waitcnt lgkmcnt(3)
 v_mfma_f32_16x16x32_bf16 v[240:243], a[44:47], v[228:231], v[240:243]
 v_fmac_f32 v116, v196, v204
 v_fmac_f32 v117, v197, v204
 v_mfma_f32_16x16x32_bf16 v[244:247], a[108:111], v[228:231], v[244:247]
 v_mfma_f32_16x16x16_bf16 v[120:123], v[40:41], v[92:93], 0
 v_fmac_f32 v118, v198, v204
 v_mfma_f32_16x16x32_bf16 v[248:251], a[172:175], v[228:231], v[248:251]
 s_add_u32 m0, s16, 4096
 s_add_u32 s89, s88, 0x1000
 buffer_load_dwordx4 v2, s[4:7], s89 offen sc1 lds
 v_fmac_f32 v119, v199, v204
 v_mfma_f32_16x16x32_bf16 v[240:243], a[48:51], v[232:235], v[240:243]
 v_mul_f32 v116, v116, v205
 v_mul_f32 v117, v117, v205
 v_mfma_f32_16x16x32_bf16 v[244:247], a[112:115], v[232:235], v[244:247]
 v_mul_f32 v118, v118, v205
 v_mul_f32 v119, v119, v205
 v_mfma_f32_16x16x32_bf16 v[248:251], a[176:179], v[232:235], v[248:251]
 s_waitcnt lgkmcnt(0)
 s_barrier
 v_add_u32 v30, 32768, v30
 v_add_u32 v31, 32768, v31
 v_add_u32 v32, 32768, v32
 v_add_u32 v33, 32768, v33
 ds_read_b128 v[224:227], v30
 ds_read_b128 v[228:231], v31
 v_mfma_f32_16x16x32_bf16 v[240:243], a[52:55], v[236:239], v[240:243]
 v_mfma_f32_16x16x32_bf16 v[244:247], a[116:119], v[236:239], v[244:247]
 v_cvt_pk_bf16_f32 v80, v116, v117
 v_cvt_pk_bf16_f32 v81, v118, v119
 v_mfma_f32_16x16x32_bf16 v[248:251], a[180:183], v[236:239], v[248:251]
 ds_read_b128 v[232:235], v32
 v_mfma_f32_16x16x32_bf16 v[240:243], a[56:59], v[216:219], v[240:243]
 v_fmac_f32 v112, v192, v204
 v_fmac_f32 v113, v193, v204
 v_mfma_f32_16x16x32_bf16 v[244:247], a[120:123], v[216:219], v[244:247]
 v_fmac_f32 v114, v194, v204
 v_fmac_f32 v115, v195, v204
 v_mfma_f32_16x16x32_bf16 v[248:251], a[184:187], v[216:219], v[248:251]
 ds_read_b128 v[236:239], v33
 v_cvt_pk_bf16_f32 v68, v112, v113
 v_mfma_f32_16x16x32_bf16 v[240:243], a[60:63], v[220:223], v[240:243]
 v_cvt_pk_bf16_f32 v69, v114, v115
 v_mul_f32 v38, 0x3eb8aa3b, v205
 v_mfma_f32_16x16x32_bf16 v[244:247], a[124:127], v[220:223], v[244:247]
 buffer_load_dwordx4 v2, s[4:7], s89 offen offset:1024 sc1 lds
 v_cvt_pk_bf16_f32 v90, v120, v121
 v_mfma_f32_16x16x32_bf16 v[248:251], a[188:191], v[220:223], v[248:251]
 v_cvt_pk_bf16_f32 v91, v122, v123
 ds_read_b128 v[216:219], v30 offset:256
 s_waitcnt lgkmcnt(3)
 v_mfma_f32_16x16x32_bf16 v[112:115], a[0:3], v[224:227], 0
 buffer_load_dwordx4 v2, s[4:7], s89 offen offset:2048 sc1 lds
 v_mfma_f32_16x16x32_bf16 v[116:119], a[64:67], v[224:227], 0
 v_mfma_f32_16x16x32_bf16 v[120:123], a[128:131], v[224:227], 0
 ds_read_b128 v[220:223], v31 offset:256
 v_mfma_f32_16x16x32_bf16 v[112:115], a[4:7], v[228:231], v[112:115]
 v_mfma_f32_16x16x32_bf16 v[116:119], a[68:71], v[228:231], v[116:119]
 s_add_u32 m0, s16, 28672
 s_add_u32 s89, s88, 0x7000
 buffer_load_dwordx4 v2, s[4:7], s89 offen sc1 lds
 s_waitcnt vmcnt(15)
 v_fmac_f32 v248, v200, v206
 v_fmac_f32 v249, v201, v206
 v_mfma_f32_16x16x32_bf16 v[120:123], a[132:135], v[228:231], v[120:123]
 ds_read_b128 v[224:227], v32 offset:256
 v_fmac_f32 v250, v202, v206
 v_fmac_f32 v251, v203, v206
 s_waitcnt lgkmcnt(3)
 v_mfma_f32_16x16x32_bf16 v[112:115], a[8:11], v[232:235], v[112:115]
 v_mul_f32 v248, v248, v207
 v_mul_f32 v249, v249, v207
 v_mfma_f32_16x16x32_bf16 v[116:119], a[72:75], v[232:235], v[116:119]
 v_mul_f32 v250, v250, v207
 v_mul_f32 v251, v251, v207
 v_cvt_pk_bf16_f32 v40, v248, v249
 v_mfma_f32_16x16x32_bf16 v[120:123], a[136:139], v[232:235], v[120:123]
 ds_read_b128 v[228:231], v33 offset:256
 v_cvt_pk_bf16_f32 v41, v250, v251
 v_fmac_f32 v244, v196, v206
 v_mfma_f32_16x16x32_bf16 v[112:115], a[12:15], v[236:239], v[112:115]
 buffer_load_dwordx4 v2, s[4:7], s89 offen offset:1024 sc1 lds
 v_fmac_f32 v245, v197, v206
 v_mfma_f32_16x16x32_bf16 v[116:119], a[76:79], v[236:239], v[116:119]
 v_mfma_f32_16x16x16_bf16 v[248:251], v[40:41], v[92:93], 0
 v_fmac_f32 v246, v198, v206
 v_mfma_f32_16x16x32_bf16 v[120:123], a[140:143], v[236:239], v[120:123]
 ds_read_b128 v[232:235], v30 offset:512
 v_fmac_f32 v247, v199, v206
 v_mul_f32 v244, v244, v207
 s_waitcnt lgkmcnt(2)
 v_mfma_f32_16x16x32_bf16 v[112:115], a[16:19], v[216:219], v[112:115]
 v_mul_f32 v245, v245, v207
 v_mul_f32 v246, v246, v207
 v_mul_f32 v247, v247, v207
 v_mfma_f32_16x16x32_bf16 v[116:119], a[80:83], v[216:219], v[116:119]
 v_cvt_pk_bf16_f32 v78, v244, v245
 v_cvt_pk_bf16_f32 v79, v246, v247
 v_mfma_f32_16x16x32_bf16 v[120:123], a[144:147], v[216:219], v[120:123]
 buffer_load_dwordx4 v2, s[4:7], s89 offen offset:2048 sc1 lds
 ds_read_b128 v[236:239], v31 offset:512
 v_mfma_f32_16x16x32_bf16 v[112:115], a[20:23], v[220:223], v[112:115]
 v_mfma_f32_16x16x16_bf16 v[104:107], v[80:81], v[68:69], v[56:59]
 v_mfma_f32_16x16x32_bf16 v[116:119], a[84:87], v[220:223], v[116:119]
 v_mfma_f32_16x16x16_bf16 v[100:103], v[78:79], v[68:69], v[96:99]
 v_fmac_f32 v240, v192, v206
 v_mfma_f32_16x16x32_bf16 v[120:123], a[148:151], v[220:223], v[120:123]
 ds_read_b128 v[216:219], v32 offset:512
 v_fmac_f32 v241, v193, v206
 v_fmac_f32 v242, v194, v206
 v_mfma_f32_16x16x32_bf16 v[112:115], a[24:27], v[224:227], v[112:115]
 v_fmac_f32 v243, v195, v206
 v_cvt_pk_bf16_f32 v70, v240, v241
 v_cvt_pk_bf16_f32 v71, v242, v243
 v_mfma_f32_16x16x32_bf16 v[116:119], a[88:91], v[224:227], v[116:119]
 v_mul_f32 v39, 0x3eb8aa3b, v207
 v_cvt_pk_bf16_f32 v88, v248, v249
 v_mfma_f32_16x16x32_bf16 v[120:123], a[152:155], v[224:227], v[120:123]
 s_add_u32 s91, s77, 0x0
 buffer_load_dwordx4 v[128:131], v2, s[4:7], s91 offen sc1
 ds_read_b128 v[220:223], v33 offset:512
 v_cvt_pk_bf16_f32 v89, v250, v251
 s_waitcnt lgkmcnt(2)
 v_mfma_f32_16x16x32_bf16 v[112:115], a[28:31], v[228:231], v[112:115]
 v_max3_f32 v24, v104, v105, v106
 v_max3_f32 v24, v24, v107, v100
 v_max3_f32 v24, v24, v101, v102
 v_mfma_f32_16x16x32_bf16 v[116:119], a[92:95], v[228:231], v[116:119]
 v_max_f32 v24, v24, v103
 v_mov_b32 v25, v24
 v_mfma_f32_16x16x32_bf16 v[120:123], a[156:159], v[228:231], v[120:123]
 ds_read_b128 v[224:227], v30 offset:768
 v_permlane32_swap_b32 v24, v25
 v_max_f32 v24, v24, v25
 v_mfma_f32_16x16x32_bf16 v[112:115], a[32:35], v[232:235], v[112:115]
 buffer_load_dwordx4 v[132:135], v2, s[4:7], s91 offen offset:1024 sc1
 v_mov_b32 v25, v24
 v_mfma_f32_16x16x32_bf16 v[116:119], a[96:99], v[232:235], v[116:119]
 v_mfma_f32_16x16x32_bf16 v[120:123], a[160:163], v[232:235], v[120:123]
 ds_read_b128 v[228:231], v31 offset:768
 v_permlane16_swap_b32 v24, v25
 v_max_f32 v24, v24, v25
 v_mfma_f32_16x16x32_bf16 v[112:115], a[36:39], v[236:239], v[112:115]
 v_mul_f32 v24, v24, v38
 v_fma_f32 v100, v100, v38, -v24
 v_exp_f32 v100, v100
 v_mfma_f32_16x16x32_bf16 v[116:119], a[100:103], v[236:239], v[116:119]
 v_fma_f32 v101, v101, v38, -v24
 v_mfma_f32_16x16x32_bf16 v[120:123], a[164:167], v[236:239], v[120:123]
 buffer_load_dwordx4 v[136:139], v2, s[4:7], s91 offen offset:2048 sc1
 ds_read_b128 v[232:235], v32 offset:768
 v_exp_f32 v101, v101
 s_waitcnt lgkmcnt(2)
 v_mfma_f32_16x16x32_bf16 v[112:115], a[40:43], v[216:219], v[112:115]
 v_fma_f32 v102, v102, v38, -v24
 v_exp_f32 v102, v102
 v_mfma_f32_16x16x32_bf16 v[116:119], a[104:107], v[216:219], v[116:119]
 v_fma_f32 v103, v103, v38, -v24
 v_mfma_f32_16x16x32_bf16 v[120:123], a[168:171], v[216:219], v[120:123]
 ds_read_b128 v[236:239], v33 offset:768
 v_exp_f32 v103, v103
 v_mfma_f32_16x16x32_bf16 v[112:115], a[44:47], v[220:223], v[112:115]
 v_fma_f32 v104, v104, v38, -v24
 v_cvt_pk_bf16_f32 v108, v100, v101
 v_exp_f32 v104, v104
 v_mfma_f32_16x16x32_bf16 v[116:119], a[108:111], v[220:223], v[116:119]
 buffer_load_dwordx4 v[140:143], v2, s[4:7], s91 offen offset:3072 sc1
 v_fma_f32 v105, v105, v38, -v24
 v_mfma_f32_16x16x32_bf16 v[120:123], a[172:175], v[220:223], v[120:123]
 v_exp_f32 v105, v105
 v_mfma_f32_16x16x32_bf16 v[112:115], a[48:51], v[224:227], v[112:115]
 v_fma_f32 v106, v106, v38, -v24
 v_cvt_pk_bf16_f32 v109, v102, v103
 v_exp_f32 v106, v106
 v_mfma_f32_16x16x32_bf16 v[116:119], a[112:115], v[224:227], v[116:119]
 v_fma_f32 v107, v107, v38, -v24
 v_mfma_f32_16x16x32_bf16 v[120:123], a[176:179], v[224:227], v[120:123]
 s_waitcnt lgkmcnt(0)
 s_barrier
 ds_read_b128 v[216:219], v30 offset:16384
 ds_read_b128 v[220:223], v31 offset:16384
 v_mfma_f32_16x16x32_bf16 v[112:115], a[52:55], v[228:231], v[112:115]
 s_add_u32 s91, s77, 0x1000
 buffer_load_dwordx4 v[144:147], v2, s[4:7], s91 offen sc1
 v_exp_f32 v107, v107
 v_mfma_f32_16x16x32_bf16 v[116:119], a[116:119], v[228:231], v[116:119]
 v_cvt_pk_bf16_f32 v110, v104, v105
 s_add_u32 s90, s69, 0xc000
 v_mfma_f32_16x16x32_bf16 v[120:123], a[180:183], v[228:231], v[120:123]
 ds_read_b128 v[224:227], v32 offset:16384
 v_cvt_pk_bf16_f32 v111, v106, v107
 v_mfma_f32_16x16x32_bf16 v[112:115], a[56:59], v[232:235], v[112:115]
 v_mfma_f32_16x16x32_bf16 v[116:119], a[120:123], v[232:235], v[116:119]
 v_mfma_f32_16x16x32_bf16 v[48:51], v[64:67], v[108:111], 0
 v_mfma_f32_16x16x32_bf16 v[44:47], v[88:91], v[108:111], 0
 v_mfma_f32_16x16x32_bf16 v[120:123], a[184:187], v[232:235], v[120:123]
 buffer_load_dwordx4 v[148:151], v2, s[4:7], s91 offen offset:1024 sc1
 ds_read_b128 v[228:231], v33 offset:16384
 v_mfma_f32_16x16x32_bf16 v[112:115], a[60:63], v[236:239], v[112:115]
 v_mfma_f32_16x16x32_bf16 v[116:119], a[124:127], v[236:239], v[116:119]
 v_mfma_f32_16x16x32_bf16 v[120:123], a[188:191], v[236:239], v[120:123]
 s_nop 0
 v_rcp_f32 v24, v48
 s_nop 0
 v_mul_f32 v52, v44, v24
 v_mul_f32 v53, v45, v24
 v_mul_f32 v54, v46, v24
 v_mul_f32 v55, v47, v24
 v_cvt_pk_bf16_f32 v42, v52, v53
 v_cvt_pk_bf16_f32 v43, v54, v55
 buffer_store_dwordx2 v[42:43], v34, s[4:7], s90 offen sc1
 ds_read_b128 v[232:235], v30 offset:16640
 s_waitcnt lgkmcnt(2)
 v_mfma_f32_16x16x32_bf16 v[240:243], a[0:3], v[216:219], 0
 buffer_load_dwordx4 v2, s[4:7], s89 offen offset:3072 sc1 lds
 s_waitcnt vmcnt(19)
 v_add_f32 v176, v176, v180
 v_add_f32 v177, v177, v181
 v_add_f32 v178, v178, v182
 v_mfma_f32_16x16x32_bf16 v[244:247], a[64:67], v[216:219], 0
 v_add_f32 v179, v179, v183
 v_add_f32_dpp v176, v176, v176 row_ror:8 row_mask:0xf bank_mask:0xf
 v_fmac_f32 v120, v200, v208
 v_fmac_f32 v121, v201, v208
 v_mfma_f32_16x16x32_bf16 v[248:251], a[128:131], v[216:219], 0
 ds_read_b128 v[236:239], v31 offset:16640
 v_fmac_f32 v122, v202, v208
 v_fmac_f32 v123, v203, v208
 v_mul_f32 v120, v120, v209
 v_mfma_f32_16x16x32_bf16 v[240:243], a[4:7], v[220:223], v[240:243]
 v_mul_f32 v121, v121, v209
 v_mul_f32 v122, v122, v209
 v_mul_f32 v123, v123, v209
 v_cvt_pk_bf16_f32 v40, v120, v121
 v_mfma_f32_16x16x32_bf16 v[244:247], a[68:71], v[220:223], v[244:247]
 s_add_u32 m0, s16, 32768
 s_add_u32 s89, s88, 0x8000
 buffer_load_dwordx4 v2, s[4:7], s89 offen sc1 lds
 v_cvt_pk_bf16_f32 v41, v122, v123
 v_fmac_f32 v116, v196, v208
 v_mfma_f32_16x16x32_bf16 v[248:251], a[132:135], v[220:223], v[248:251]
 ds_read_b128 v[216:219], v32 offset:16640
 v_fmac_f32 v117, v197, v208
 v_mfma_f32_16x16x16_bf16 v[120:123], v[40:41], v[92:93], 0
 v_mfma_f32_16x16x32_bf16 v[240:243], a[8:11], v[224:227], v[240:243]
 v_fmac_f32 v118, v198, v208
 v_fmac_f32 v119, v199, v208
 v_mul_f32 v116, v116, v209
 v_mul_f32 v117, v117, v209
 v_mfma_f32_16x16x32_bf16 v[244:247], a[72:75], v[224:227], v[244:247]
 v_mul_f32 v118, v118, v209
 v_mul_f32 v119, v119, v209
 v_cvt_pk_bf16_f32 v76, v116, v117
 v_cvt_pk_bf16_f32 v77, v118, v119
 v_mfma_f32_16x16x32_bf16 v[248:251], a[136:139], v[224:227], v[248:251]
 ds_read_b128 v[220:223], v33 offset:16640
 v_mfma_f32_16x16x16_bf16 v[104:107], v[78:79], v[70:71], v[56:59]
 v_add_f32_dpp v177, v177, v177 row_ror:8 row_mask:0xf bank_mask:0xf
 s_waitcnt lgkmcnt(2)
 v_mfma_f32_16x16x32_bf16 v[240:243], a[12:15], v[228:231], v[240:243]
 buffer_load_dwordx4 v2, s[4:7], s89 offen offset:1024 sc1 lds
 v_mfma_f32_16x16x16_bf16 v[100:103], v[76:77], v[70:71], v[96:99]
 v_fmac_f32 v112, v192, v208
 v_mfma_f32_16x16x32_bf16 v[244:247], a[76:79], v[228:231], v[244:247]
 v_fmac_f32 v113, v193, v208
 v_fmac_f32 v114, v194, v208
 v_fmac_f32 v115, v195, v208
 v_cvt_pk_bf16_f32 v68, v112, v113
 v_mfma_f32_16x16x32_bf16 v[248:251], a[140:143], v[228:231], v[248:251]
 ds_read_b128 v[224:227], v30 offset:16896
 v_cvt_pk_bf16_f32 v69, v114, v115
 v_mul_f32 v38, 0x3eb8aa3b, v209
 v_cvt_pk_bf16_f32 v86, v120, v121
 v_mfma_f32_16x16x32_bf16 v[240:243], a[16:19], v[232:235], v[240:243]
 v_cvt_pk_bf16_f32 v87, v122, v123
 v_max3_f32 v24, v104, v105, v106
 v_max3_f32 v24, v24, v107, v100
 v_max3_f32 v24, v24, v101, v102
 v_mfma_f32_16x16x32_bf16 v[244:247], a[80:83], v[232:235], v[244:247]
 v_max_f32 v24, v24, v103
 v_mov_b32 v25, v24
 v_add_f32_dpp v178, v178, v178 row_ror:8 row_mask:0xf bank_mask:0xf
 v_add_f32_dpp v179, v179, v179 row_ror:8 row_mask:0xf bank_mask:0xf
 v_mfma_f32_16x16x32_bf16 v[248:251], a[144:147], v[232:235], v[248:251]
 buffer_load_dwordx4 v2, s[4:7], s89 offen offset:2048 sc1 lds
 ds_read_b128 v[228:231], v31 offset:16896
 v_permlane32_swap_b32 v24, v25
 v_mfma_f32_16x16x32_bf16 v[240:243], a[20:23], v[236:239], v[240:243]
 v_max_f32 v24, v24, v25
 v_mov_b32 v25, v24
 v_mov_b32 v180, v176
 v_mov_b32 v181, v177
 v_mfma_f32_16x16x32_bf16 v[244:247], a[84:87], v[236:239], v[244:247]
 v_permlane16_swap_b32 v24, v25
 v_max_f32 v24, v24, v25
 v_mul_f32 v24, v24, v39
 v_fma_f32 v100, v100, v39, -v24
 v_mfma_f32_16x16x32_bf16 v[248:251], a[148:151], v[236:239], v[248:251]
 ds_read_b128 v[232:235], v32 offset:16896
 v_exp_f32 v100, v100
 v_fma_f32 v101, v101, v39, -v24
 s_waitcnt lgkmcnt(2)
 v_mfma_f32_16x16x32_bf16 v[240:243], a[24:27], v[216:219], v[240:243]
 v_exp_f32 v101, v101
 v_fma_f32 v102, v102, v39, -v24
 v_mfma_f32_16x16x32_bf16 v[244:247], a[88:91], v[216:219], v[244:247]
 v_exp_f32 v102, v102
 v_fma_f32 v103, v103, v39, -v24
 v_exp_f32 v103, v103
 v_mfma_f32_16x16x32_bf16 v[248:251], a[152:155], v[216:219], v[248:251]
 buffer_load_dwordx4 v[152:155], v2, s[4:7], s91 offen offset:2048 sc1
 ds_read_b128 v[236:239], v33 offset:16896
 v_fma_f32 v104, v104, v39, -v24
 v_mfma_f32_16x16x32_bf16 v[240:243], a[28:31], v[220:223], v[240:243]
 v_mov_b32 v5, 1
 s_waitcnt vmcnt(5)
 buffer_store_dword v5, off, s[4:7], s67 offset:512 sc1
 v_cvt_pk_bf16_f32 v108, v100, v101
 v_mfma_f32_16x16x32_bf16 v[244:247], a[92:95], v[220:223], v[244:247]
 v_exp_f32 v104, v104
 v_fma_f32 v105, v105, v39, -v24
 v_mfma_f32_16x16x32_bf16 v[248:251], a[156:159], v[220:223], v[248:251]
 ds_read_b128 v[216:219], v30 offset:17152
 v_exp_f32 v105, v105
 v_fma_f32 v106, v106, v39, -v24
 v_mfma_f32_16x16x32_bf16 v[240:243], a[32:35], v[224:227], v[240:243]
 buffer_load_dwordx4 v[156:159], v2, s[4:7], s91 offen offset:3072 sc1
 v_cvt_pk_bf16_f32 v109, v102, v103
 v_exp_f32 v106, v106
 v_mfma_f32_16x16x32_bf16 v[244:247], a[96:99], v[224:227], v[244:247]
 v_fma_f32 v107, v107, v39, -v24
 v_exp_f32 v107, v107
 v_cvt_pk_bf16_f32 v110, v104, v105
 v_mfma_f32_16x16x32_bf16 v[248:251], a[160:163], v[224:227], v[248:251]
 ds_read_b128 v[220:223], v31 offset:17152
 s_add_u32 s90, s69, 0x8000
 v_cvt_pk_bf16_f32 v111, v106, v107
 v_mov_b32 v182, v178
 s_waitcnt lgkmcnt(2)
 v_mfma_f32_16x16x32_bf16 v[240:243], a[36:39], v[228:231], v[240:243]
 v_mov_b32 v183, v179
 v_permlane16_swap_b32 v176, v180
 v_mfma_f32_16x16x32_bf16 v[48:51], v[64:67], v[108:111], 0
 v_mfma_f32_16x16x32_bf16 v[244:247], a[100:103], v[228:231], v[244:247]
 v_permlane16_swap_b32 v177, v181
 v_permlane16_swap_b32 v178, v182
 v_mfma_f32_16x16x32_bf16 v[44:47], v[86:89], v[108:111], 0
 v_mfma_f32_16x16x32_bf16 v[248:251], a[164:167], v[228:231], v[248:251]
 s_add_u32 s91, s77, 0x2000
 buffer_load_dwordx4 v[160:163], v2, s[4:7], s91 offen sc1
 ds_read_b128 v[224:227], v32 offset:17152
 v_permlane16_swap_b32 v179, v183
 v_mfma_f32_16x16x32_bf16 v[240:243], a[40:43], v[232:235], v[240:243]
 v_add_f32 v176, v176, v180
 v_add_f32 v177, v177, v181
 v_add_f32 v178, v178, v182
 v_mfma_f32_16x16x32_bf16 v[244:247], a[104:107], v[232:235], v[244:247]
 v_add_f32 v179, v179, v183
 v_mov_b32 v180, v176
 v_mov_b32 v181, v177
 v_mov_b32 v182, v178
 v_mfma_f32_16x16x32_bf16 v[248:251], a[168:171], v[232:235], v[248:251]
 ds_read_b128 v[228:231], v33 offset:17152
 v_mov_b32 v183, v179
 v_rcp_f32 v24, v48
 v_mfma_f32_16x16x32_bf16 v[240:243], a[44:47], v[236:239], v[240:243]
 v_permlane32_swap_b32 v176, v180
 v_permlane32_swap_b32 v177, v181
 v_permlane32_swap_b32 v178, v182
 v_mfma_f32_16x16x32_bf16 v[244:247], a[108:111], v[236:239], v[244:247]
 buffer_load_dwordx4 v[164:167], v2, s[4:7], s91 offen offset:1024 sc1
 v_mul_f32 v52, v44, v24
 v_permlane32_swap_b32 v179, v183
 v_mfma_f32_16x16x32_bf16 v[248:251], a[172:175], v[236:239], v[248:251]
 v_mul_f32 v53, v45, v24
 v_add_f32 v176, v176, v180
 v_mul_f32 v54, v46, v24
 v_add_f32 v177, v177, v181
 s_waitcnt lgkmcnt(1)
 v_mfma_f32_16x16x32_bf16 v[240:243], a[48:51], v[216:219], v[240:243]
 v_mul_f32 v55, v47, v24
 v_add_f32 v178, v178, v182
 v_cvt_pk_bf16_f32 v42, v52, v53
 v_mfma_f32_16x16x32_bf16 v[244:247], a[112:115], v[216:219], v[244:247]
 v_add_f32 v179, v179, v183
 v_cvt_pk_bf16_f32 v43, v54, v55
 s_lshl_b32 s87, s48, 7
 s_add_u32 s87, s87, s79
 buffer_store_dwordx4 v[176:179], v185, s[4:7], s87 offen
 v_mfma_f32_16x16x32_bf16 v[248:251], a[176:179], v[216:219], v[248:251]
 s_waitcnt lgkmcnt(0)
 s_barrier
 ds_read_b128 v[232:235], v30 offset:32768
 ds_read_b128 v[236:239], v31 offset:32768
 v_mfma_f32_16x16x32_bf16 v[240:243], a[52:55], v[220:223], v[240:243]
 buffer_load_dwordx4 v[168:171], v2, s[4:7], s91 offen offset:2048 sc1
 buffer_store_dwordx2 v[42:43], v34, s[4:7], s90 offen sc1
 v_mfma_f32_16x16x32_bf16 v[244:247], a[116:119], v[220:223], v[244:247]
 v_mfma_f32_16x16x32_bf16 v[248:251], a[180:183], v[220:223], v[248:251]
 ds_read_b128 v[216:219], v32 offset:32768
 v_mfma_f32_16x16x32_bf16 v[240:243], a[56:59], v[224:227], v[240:243]
 buffer_load_dword v3, v7, s[4:7], s64 offen sc1
 v_mfma_f32_16x16x32_bf16 v[244:247], a[120:123], v[224:227], v[244:247]
 v_mfma_f32_16x16x32_bf16 v[248:251], a[184:187], v[224:227], v[248:251]
 buffer_load_dwordx4 v[172:175], v2, s[4:7], s91 offen offset:3072 sc1
 ds_read_b128 v[220:223], v33 offset:32768
 v_mfma_f32_16x16x32_bf16 v[240:243], a[60:63], v[228:231], v[240:243]
 v_mfma_f32_16x16x32_bf16 v[244:247], a[124:127], v[228:231], v[244:247]
 v_mfma_f32_16x16x32_bf16 v[248:251], a[188:191], v[228:231], v[248:251]
 ds_read_b128 v[224:227], v30 offset:33024
 s_waitcnt lgkmcnt(4)
 v_mfma_f32_16x16x32_bf16 v[116:119], a[64:67], v[232:235], 0
 s_add_u32 s91, s77, 0x3000
 buffer_load_dwordx4 v[176:179], v2, s[4:7], s91 offen sc1
 v_mfma_f32_16x16x32_bf16 v[120:123], a[128:131], v[232:235], 0
 s_add_u32 m0, s16, 57344
 s_add_u32 s89, s88, 0xe000
 buffer_load_dwordx4 v2, s[4:7], s89 offen sc1 lds
 ds_read_b128 v[228:231], v31 offset:33024
 s_waitcnt lgkmcnt(4)
 v_mfma_f32_16x16x32_bf16 v[116:119], a[68:71], v[236:239], v[116:119]
 v_fmac_f32 v248, v200, v210
 v_fmac_f32 v249, v201, v210
 v_fmac_f32 v250, v202, v210
 v_fmac_f32 v251, v203, v210
 v_mul_f32 v248, v248, v211
 v_mfma_f32_16x16x32_bf16 v[120:123], a[132:135], v[236:239], v[120:123]
 ds_read_b128 v[232:235], v32 offset:33024
 v_mul_f32 v249, v249, v211
 v_mul_f32 v250, v250, v211
 v_mul_f32 v251, v251, v211
 s_waitcnt lgkmcnt(3)
 v_mfma_f32_16x16x32_bf16 v[116:119], a[72:75], v[216:219], v[116:119]
 buffer_load_dwordx4 v[180:183], v2, s[4:7], s91 offen offset:1024 sc1
 v_cvt_pk_bf16_f32 v40, v248, v249
 v_cvt_pk_bf16_f32 v41, v250, v251
 v_fmac_f32 v244, v196, v210
 v_mfma_f32_16x16x32_bf16 v[120:123], a[136:139], v[216:219], v[120:123]
 ds_read_b128 v[236:239], v33 offset:33024
 v_fmac_f32 v245, v197, v210
 v_mfma_f32_16x16x16_bf16 v[248:251], v[40:41], v[92:93], 0
 v_mfma_f32_16x16x32_bf16 v[116:119], a[76:79], v[220:223], v[116:119]
 v_fmac_f32 v246, v198, v210
 v_fmac_f32 v247, v199, v210
 v_mul_f32 v244, v244, v211
 v_mfma_f32_16x16x32_bf16 v[120:123], a[140:143], v[220:223], v[120:123]
 buffer_load_dwordx4 v2, s[4:7], s89 offen offset:1024 sc1 lds
 ds_read_b128 v[216:219], v30 offset:33280
 v_mul_f32 v245, v245, v211
 v_mul_f32 v246, v246, v211
 s_waitcnt lgkmcnt(3)
 v_mfma_f32_16x16x32_bf16 v[116:119], a[80:83], v[224:227], v[116:119]
 buffer_load_dwordx4 v[184:187], v2, s[4:7], s91 offen offset:2048 sc1
 v_mul_f32 v247, v247, v211
 v_cvt_pk_bf16_f32 v74, v244, v245
 v_cvt_pk_bf16_f32 v75, v246, v247
 v_mfma_f32_16x16x32_bf16 v[120:123], a[144:147], v[224:227], v[120:123]
 v_mov_b32 v5, 2
 s_waitcnt vmcnt(7)
 buffer_store_dword v5, off, s[4:7], s67 offset:512 sc1
 ds_read_b128 v[220:223], v31 offset:33280
 v_mfma_f32_16x16x32_bf16 v[116:119], a[84:87], v[228:231], v[116:119]
 v_mfma_f32_16x16x16_bf16 v[104:107], v[76:77], v[68:69], v[56:59]
 v_mfma_f32_16x16x32_bf16 v[120:123], a[148:151], v[228:231], v[120:123]
 ds_read_b128 v[224:227], v32 offset:33280
 v_mfma_f32_16x16x16_bf16 v[100:103], v[74:75], v[68:69], v[96:99]
 v_fmac_f32 v240, v192, v210
 v_fmac_f32 v241, v193, v210
 s_waitcnt lgkmcnt(3)
 v_mfma_f32_16x16x32_bf16 v[116:119], a[88:91], v[232:235], v[116:119]
 buffer_load_dwordx4 v[188:191], v2, s[4:7], s91 offen offset:3072 sc1
 v_fmac_f32 v242, v194, v210
 v_fmac_f32 v243, v195, v210
 v_cvt_pk_bf16_f32 v70, v240, v241
 v_mfma_f32_16x16x32_bf16 v[120:123], a[152:155], v[232:235], v[120:123]
 ds_read_b128 v[228:231], v33 offset:33280
 v_cvt_pk_bf16_f32 v71, v242, v243
 v_mul_f32 v39, 0x3eb8aa3b, v211
 v_mfma_f32_16x16x32_bf16 v[116:119], a[92:95], v[236:239], v[116:119]
 buffer_load_dwordx4 v2, s[4:7], s89 offen offset:2048 sc1 lds
 v_cvt_pk_bf16_f32 v84, v248, v249
 v_cvt_pk_bf16_f32 v85, v250, v251
 v_max3_f32 v24, v104, v105, v106
 v_mfma_f32_16x16x32_bf16 v[120:123], a[156:159], v[236:239], v[120:123]
 s_add_u32 s85, s70, 0xc000
 s_waitcnt vmcnt(9)
 v_cmp_gt_u32 vcc, 1, v3
 s_nop 0
 s_cbranch_vccnz .Lps_64
.Lpb_65:
 ds_read_b128 v[232:235], v30 offset:33536
 v_max3_f32 v24, v24, v107, v100
 v_max3_f32 v24, v24, v101, v102
 s_waitcnt lgkmcnt(2)
 v_mfma_f32_16x16x32_bf16 v[116:119], a[96:99], v[216:219], v[116:119]
 v_max_f32 v24, v24, v103
 v_mov_b32 v25, v24
 v_mfma_f32_16x16x32_bf16 v[120:123], a[160:163], v[216:219], v[120:123]
 buffer_load_dwordx4 v[204:207], v2, s[4:7], s85 offen sc1
 ds_read_b128 v[236:239], v31 offset:33536
 v_permlane32_swap_b32 v24, v25
 v_max_f32 v24, v24, v25
 v_mov_b32 v25, v24
 v_mfma_f32_16x16x32_bf16 v[116:119], a[100:103], v[220:223], v[116:119]
 v_mfma_f32_16x16x32_bf16 v[120:123], a[164:167], v[220:223], v[120:123]
 ds_read_b128 v[216:219], v32 offset:33536
 v_permlane16_swap_b32 v24, v25
 v_max_f32 v24, v24, v25
 v_mul_f32 v24, v24, v38
 v_fma_f32 v100, v100, v38, -v24
 v_mfma_f32_16x16x32_bf16 v[116:119], a[104:107], v[224:227], v[116:119]
 buffer_load_dwordx4 v[124:127], v2, s[4:7], s85 offen offset:1024 sc1
 v_exp_f32 v100, v100
 v_fma_f32 v101, v101, v38, -v24
 v_mfma_f32_16x16x32_bf16 v[120:123], a[168:171], v[224:227], v[120:123]
 ds_read_b128 v[220:223], v33 offset:33536
 v_exp_f32 v101, v101
 v_fma_f32 v102, v102, v38, -v24
 s_waitcnt lgkmcnt(3)
 v_mfma_f32_16x16x32_bf16 v[116:119], a[108:111], v[228:231], v[116:119]
 v_exp_f32 v102, v102
 v_fma_f32 v103, v103, v38, -v24
 v_mfma_f32_16x16x32_bf16 v[120:123], a[172:175], v[228:231], v[120:123]
 buffer_load_dwordx4 v[252:255], v2, s[4:7], s85 offen offset:2048 sc1
 buffer_load_dword v3, v7, s[4:7], s64 offen sc1
 v_exp_f32 v103, v103
 v_fma_f32 v104, v104, v38, -v24
 v_mfma_f32_16x16x32_bf16 v[116:119], a[112:115], v[232:235], v[116:119]
 v_cvt_pk_bf16_f32 v108, v100, v101
 v_exp_f32 v104, v104
 v_fma_f32 v105, v105, v38, -v24
 v_mfma_f32_16x16x32_bf16 v[120:123], a[176:179], v[232:235], v[120:123]
 v_exp_f32 v105, v105
 v_fma_f32 v106, v106, v38, -v24
 v_cvt_pk_bf16_f32 v109, v102, v103
 s_waitcnt lgkmcnt(0)
 v_mfma_f32_16x16x32_bf16 v[116:119], a[116:119], v[236:239], v[116:119]
 buffer_load_dwordx4 v[240:243], v2, s[4:7], s85 offen offset:3072 sc1
 v_exp_f32 v106, v106
 v_mfma_f32_16x16x32_bf16 v[120:123], a[180:183], v[236:239], v[120:123]
 v_fma_f32 v107, v107, v38, -v24
 v_exp_f32 v107, v107
 v_cvt_pk_bf16_f32 v110, v104, v105
 s_add_u32 s90, s69, 0x4000
 v_mfma_f32_16x16x32_bf16 v[116:119], a[120:123], v[216:219], v[116:119]
 v_cvt_pk_bf16_f32 v111, v106, v107
 v_mfma_f32_16x16x32_bf16 v[120:123], a[184:187], v[216:219], v[120:123]
 v_mfma_f32_16x16x32_bf16 v[116:119], a[124:127], v[220:223], v[116:119]
 v_mfma_f32_16x16x32_bf16 v[48:51], v[64:67], v[108:111], 0
 v_mfma_f32_16x16x32_bf16 v[44:47], v[84:87], v[108:111], 0
 v_mfma_f32_16x16x32_bf16 v[120:123], a[188:191], v[220:223], v[120:123]
 s_nop 5
 v_rcp_f32 v24, v48
 s_nop 0
 v_mul_f32 v52, v44, v24
 v_mul_f32 v53, v45, v24
 v_mul_f32 v54, v46, v24
 v_mul_f32 v55, v47, v24
 v_cvt_pk_bf16_f32 v42, v52, v53
 v_cvt_pk_bf16_f32 v43, v54, v55
 buffer_store_dwordx2 v[42:43], v34, s[4:7], s90 offen sc1
 s_add_u32 s85, s70, 0x8000
 s_waitcnt vmcnt(2)
 v_cmp_gt_u32 vcc, 2, v3
 s_nop 0
 s_cbranch_vccnz .Lps_66
.Lpb_67:
 buffer_load_dwordx4 v[216:219], v2, s[4:7], s85 offen sc1
 v_mfma_f32_16x16x32_bf16 v[244:247], v[128:131], v[204:207], 0
 v_mfma_f32_16x16x32_bf16 v[248:251], v[132:135], v[204:207], 0
 buffer_load_dwordx4 v[220:223], v2, s[4:7], s85 offen offset:1024 sc1
 v_mfma_f32_16x16x32_bf16 v[232:235], v[136:139], v[204:207], 0
 v_mfma_f32_16x16x32_bf16 v[236:239], v[140:143], v[204:207], 0
 buffer_load_dwordx4 v[224:227], v2, s[4:7], s85 offen offset:2048 sc1
 v_fmac_f32 v120, v200, v212
 v_fmac_f32 v121, v201, v212
 v_fmac_f32 v122, v202, v212
 v_mfma_f32_16x16x32_bf16 v[244:247], v[144:147], v[124:127], v[244:247]
 v_fmac_f32 v123, v203, v212
 v_mul_f32 v120, v120, v213
 v_mul_f32 v121, v121, v213
 v_mul_f32 v122, v122, v213
 v_mfma_f32_16x16x32_bf16 v[248:251], v[148:151], v[124:127], v[248:251]
 buffer_load_dwordx4 v[228:231], v2, s[4:7], s85 offen offset:3072 sc1
 v_mul_f32 v123, v123, v213
 v_cvt_pk_bf16_f32 v40, v120, v121
 v_cvt_pk_bf16_f32 v41, v122, v123
 v_mfma_f32_16x16x32_bf16 v[232:235], v[152:155], v[124:127], v[232:235]
 v_fmac_f32 v116, v196, v212
 v_fmac_f32 v117, v197, v212
 v_mfma_f32_16x16x16_bf16 v[120:123], v[40:41], v[92:93], 0
 v_mfma_f32_16x16x32_bf16 v[236:239], v[156:159], v[124:127], v[236:239]
 v_fmac_f32 v118, v198, v212
 v_fmac_f32 v119, v199, v212
 v_mul_f32 v116, v116, v213
 v_mfma_f32_16x16x32_bf16 v[244:247], v[160:163], v[252:255], v[244:247]
 buffer_load_dwordx4 v2, s[4:7], s89 offen offset:3072 sc1 lds
 v_mul_f32 v117, v117, v213
 v_mul_f32 v118, v118, v213
 v_mul_f32 v119, v119, v213
 v_mfma_f32_16x16x32_bf16 v[248:251], v[164:167], v[252:255], v[248:251]
 v_mov_b32 v5, 3
 s_waitcnt vmcnt(5)
 buffer_store_dword v5, off, s[4:7], s67 offset:512 sc1
 v_mfma_f32_16x16x32_bf16 v[232:235], v[168:171], v[252:255], v[232:235]
 v_cvt_pk_bf16_f32 v72, v116, v117
 v_cvt_pk_bf16_f32 v73, v118, v119
 v_mfma_f32_16x16x16_bf16 v[104:107], v[74:75], v[70:71], v[56:59]
 v_mfma_f32_16x16x32_bf16 v[236:239], v[172:175], v[252:255], v[236:239]
 s_add_u32 m0, s16, 61440
 s_add_u32 s89, s88, 0xf000
 buffer_load_dwordx4 v2, s[4:7], s89 offen sc1 lds
 v_mfma_f32_16x16x32_bf16 v[244:247], v[176:179], v[240:243], v[244:247]
 v_mfma_f32_16x16x16_bf16 v[100:103], v[72:73], v[70:71], v[60:63]
 v_cvt_pk_bf16_f32 v82, v120, v121
 v_cvt_pk_bf16_f32 v83, v122, v123
 v_mfma_f32_16x16x32_bf16 v[248:251], v[180:183], v[240:243], v[248:251]
 v_mfma_f32_16x16x32_bf16 v[232:235], v[184:187], v[240:243], v[232:235]
 buffer_load_dwordx4 v2, s[4:7], s89 offen offset:1024 sc1 lds
 v_mfma_f32_16x16x32_bf16 v[236:239], v[188:191], v[240:243], v[236:239]
 v_max3_f32 v24, v104, v105, v106
 s_nop 0
 v_max3_f32 v24, v24, v107, v100
 v_max3_f32 v24, v24, v101, v102
 v_max_f32 v24, v24, v103
 s_waitcnt vmcnt(7)
 v_mfma_f32_16x16x32_bf16 v[96:99], v[128:131], v[216:219], 0
 v_mov_b32 v25, v24
 v_mfma_f32_16x16x32_bf16 v[192:195], v[132:135], v[216:219], 0
 buffer_load_dwordx4 v2, s[4:7], s89 offen offset:2048 sc1 lds
 v_permlane32_swap_b32 v24, v25
 v_max_f32 v24, v24, v25
 v_mov_b32 v25, v24
 v_mfma_f32_16x16x32_bf16 v[196:199], v[136:139], v[216:219], 0
 v_mfma_f32_16x16x32_bf16 v[200:203], v[140:143], v[216:219], 0
 v_permlane16_swap_b32 v24, v25
 v_max_f32 v24, v24, v25
 v_mul_f32 v24, v24, v39
 v_fma_f32 v100, v100, v39, -v24
 s_waitcnt vmcnt(7)
 v_mfma_f32_16x16x32_bf16 v[96:99], v[144:147], v[220:223], v[96:99]
 s_add_u32 s87, s78, 0x0
 buffer_load_dwordx4 a[192:195], v2, s[4:7], s87 offen sc1
 v_exp_f32 v100, v100
 v_fma_f32 v101, v101, v39, -v24
 v_mfma_f32_16x16x32_bf16 v[192:195], v[148:151], v[220:223], v[192:195]
 ds_write_b128 v9, v[244:247]
 v_exp_f32 v101, v101
 v_fma_f32 v102, v102, v39, -v24
 v_mfma_f32_16x16x32_bf16 v[196:199], v[152:155], v[220:223], v[196:199]
 v_exp_f32 v102, v102
 v_fma_f32 v103, v103, v39, -v24
 v_exp_f32 v103, v103
 v_mfma_f32_16x16x32_bf16 v[200:203], v[156:159], v[220:223], v[200:203]
 v_fma_f32 v104, v104, v39, -v24
 v_cvt_pk_bf16_f32 v108, v100, v101
 v_exp_f32 v104, v104
 s_waitcnt vmcnt(7)
 v_mfma_f32_16x16x32_bf16 v[96:99], v[160:163], v[224:227], v[96:99]
 buffer_load_dword v3, v7, s[4:7], s64 offen sc1
 ds_write_b128 v10, v[248:251]
 v_fma_f32 v105, v105, v39, -v24
 v_mfma_f32_16x16x32_bf16 v[192:195], v[164:167], v[224:227], v[192:195]
 v_exp_f32 v105, v105
 v_fma_f32 v106, v106, v39, -v24
 v_cvt_pk_bf16_f32 v109, v102, v103
 v_mfma_f32_16x16x32_bf16 v[196:199], v[168:171], v[224:227], v[196:199]
 v_exp_f32 v106, v106
 v_fma_f32 v107, v107, v39, -v24
 v_exp_f32 v107, v107
 v_mfma_f32_16x16x32_bf16 v[200:203], v[172:175], v[224:227], v[200:203]
 ds_write_b128 v9, v[232:235] offset:128
 v_cvt_pk_bf16_f32 v110, v104, v105
 s_add_u32 s90, s69, 0x0
 v_cvt_pk_bf16_f32 v111, v106, v107
 s_waitcnt vmcnt(7)
 v_mfma_f32_16x16x32_bf16 v[96:99], v[176:179], v[228:231], v[96:99]
 v_mfma_f32_16x16x32_bf16 v[192:195], v[180:183], v[228:231], v[192:195]
 v_mfma_f32_16x16x32_bf16 v[48:51], v[64:67], v[108:111], 0
 v_mfma_f32_16x16x32_bf16 v[44:47], v[82:85], v[108:111], 0
 v_mfma_f32_16x16x32_bf16 v[196:199], v[184:187], v[228:231], v[196:199]
 ds_write_b128 v10, v[236:239] offset:128
 v_mfma_f32_16x16x32_bf16 v[200:203], v[188:191], v[228:231], v[200:203]
 s_nop 3
 v_rcp_f32 v24, v48
 s_nop 0
 v_mul_f32 v52, v44, v24
 v_mul_f32 v53, v45, v24
 v_mul_f32 v54, v46, v24
 v_mul_f32 v55, v47, v24
 v_cvt_pk_bf16_f32 v42, v52, v53
 v_cvt_pk_bf16_f32 v43, v54, v55
 buffer_store_dwordx2 v[42:43], v34, s[4:7], s90 offen sc1
 ds_write_b128 v9, v[96:99] offset:16384
 ds_write_b128 v10, v[192:195] offset:16384
 ds_write_b128 v9, v[196:199] offset:16512
 ds_write_b128 v10, v[200:203] offset:16512
 s_add_u32 s87, s78, 0x0
 buffer_load_dwordx4 a[196:199], v2, s[4:7], s87 offen offset:1024 sc1
 v_add_u32 v26, 57344, v2
 v_and_b32 v24, 15, v1
 v_lshrrev_b32 v25, 4, v1
 v_lshlrev_b32 v29, 4, v25
 s_add_u32 s87, s78, 0x0
 buffer_load_dwordx4 a[200:203], v2, s[4:7], s87 offen offset:2048 sc1
 v_and_b32 v28, 1, v25
 v_lshlrev_b32 v28, 3, v28
 v_lshl_add_u32 v28, v24, 4, v28
 v_lshrrev_b32 v25, 1, v25
 s_add_u32 s87, s78, 0x1000
 buffer_load_dwordx4 a[204:207], v2, s[4:7], s87 offen sc1
 v_lshl_add_u32 v27, v25, 8, v28
 v_xor_b32 v25, 1, v25
 v_mul_u32_u24 v25, 57344, v25
 v_add_u32 v28, v28, v25
 s_waitcnt lgkmcnt(0)
 s_barrier
 ds_read_b128 v[204:207], v11
 ds_read_b128 v[124:127], v11 offset:4096
 ds_read_b128 v[252:255], v11 offset:8192
 ds_read_b128 v[240:243], v11 offset:12288
 ds_read_b128 v[216:219], v11 offset:16384
 ds_read_b128 v[220:223], v11 offset:20480
 ds_read_b128 v[224:227], v11 offset:24576
 ds_read_b128 v[228:231], v11 offset:28672
 s_add_u32 s85, s70, 0x4000
 s_waitcnt vmcnt(4)
 v_cmp_gt_u32 vcc, 3, v3
 s_nop 0
 s_cbranch_vccnz .Lps_68
.Lpb_69:
 buffer_load_dwordx4 v[44:47], v2, s[4:7], s85 offen sc1
 buffer_load_dwordx4 v[48:51], v2, s[4:7], s85 offen offset:1024 sc1
 v_mov_b32 v5, 4
 s_waitcnt vmcnt(5)
 buffer_store_dword v5, off, s[4:7], s67 offset:512 sc1
 s_add_u32 s90, s71, 0x8000
 s_add_u32 s91, s71, 0x8000
 v_lshlrev_b32 v100, 16, v22
 v_lshlrev_b32 v104, 16, v20
 v_and_b32 v101, 0xffff0000, v22
 v_and_b32 v105, 0xffff0000, v20
 buffer_load_dwordx4 v[52:55], v2, s[4:7], s85 offen offset:2048 sc1
 v_lshlrev_b32 v102, 16, v23
 v_lshlrev_b32 v106, 16, v21
 v_and_b32 v103, 0xffff0000, v23
 v_and_b32 v107, 0xffff0000, v21
 s_waitcnt lgkmcnt(6)
 v_pk_add_f32 v[204:205], v[204:205], v[124:125]
 s_waitcnt lgkmcnt(2)
 v_pk_add_f32 v[216:217], v[216:217], v[220:221]
 v_pk_add_f32 v[252:253], v[252:253], v[240:241]
 s_waitcnt lgkmcnt(0)
 v_pk_add_f32 v[224:225], v[224:225], v[228:229]
 v_pk_add_f32 v[206:207], v[206:207], v[126:127]
 v_pk_add_f32 v[218:219], v[218:219], v[222:223]
 buffer_load_dwordx4 v[56:59], v2, s[4:7], s85 offen offset:3072 sc1
 v_pk_add_f32 v[254:255], v[254:255], v[242:243]
 v_pk_add_f32 v[226:227], v[226:227], v[230:231]
 v_pk_add_f32 v[204:205], v[204:205], v[252:253]
 v_pk_add_f32 v[216:217], v[216:217], v[224:225]
 v_pk_add_f32 v[206:207], v[206:207], v[254:255]
 v_pk_add_f32 v[218:219], v[218:219], v[226:227]
 v_pk_add_f32 v[100:101], v[100:101], v[204:205]
 v_pk_add_f32 v[104:105], v[104:105], v[216:217]
 v_pk_add_f32 v[102:103], v[102:103], v[206:207]
 v_pk_add_f32 v[106:107], v[106:107], v[218:219]
 v_cvt_pk_bf16_f32 v22, v100, v101
 v_cvt_pk_bf16_f32 v20, v104, v105
 v_cvt_pk_bf16_f32 v23, v102, v103
 v_cvt_pk_bf16_f32 v21, v106, v107
 buffer_store_dwordx2 v[22:23], v12, s[4:7], s90 offen sc1
 buffer_store_dwordx2 v[20:21], v12, s[4:7], s91 offen offset:1024 sc1
 v_add_f32 v108, v100, v101
 v_add_f32 v110, v104, v105
 v_mul_f32 v109, v100, v100
 v_mul_f32 v111, v104, v104
 v_add_f32 v108, v108, v102
 v_add_f32 v110, v110, v106
 v_fmac_f32 v109, v101, v101
 v_fmac_f32 v111, v105, v105
 v_add_f32 v108, v108, v103
 v_add_f32 v110, v110, v107
 v_fmac_f32 v109, v102, v102
 v_fmac_f32 v111, v106, v106
 v_fmac_f32 v109, v103, v103
 v_fmac_f32 v111, v107, v107
 v_add_f32_dpp v108, v108, v108 row_ror:8 row_mask:0xf bank_mask:0xf
 v_add_f32_dpp v110, v110, v110 row_ror:8 row_mask:0xf bank_mask:0xf
 v_add_f32_dpp v108, v109, v109 row_ror:8 row_mask:0xf bank_mask:0xc
 v_add_f32_dpp v110, v111, v111 row_ror:8 row_mask:0xf bank_mask:0xc
 s_nop 0
 v_add_f32_dpp v108, v108, v108 row_half_mirror row_mask:0xf bank_mask:0xf
 v_add_f32_dpp v110, v110, v110 row_half_mirror row_mask:0xf bank_mask:0xf
 s_nop 0
 v_add_f32_dpp v108, v108, v108 quad_perm:[1,0,3,2] row_mask:0xf bank_mask:0xf
 v_add_f32_dpp v110, v110, v110 quad_perm:[1,0,3,2] row_mask:0xf bank_mask:0xf
 s_nop 0
 v_add_f32_dpp v108, v108, v108 quad_perm:[2,3,0,1] row_mask:0xf bank_mask:0xf
 v_add_f32_dpp v110, v110, v110 quad_perm:[2,3,0,1] row_mask:0xf bank_mask:0xf
 buffer_store_dword v108, v14, s[4:7], s72 offen offset:3072 sc1
 buffer_store_dword v110, v14, s[4:7], s72 offen offset:2048 sc1
 buffer_load_dword v3, v7, s[4:7], s64 offen sc1
 s_waitcnt vmcnt(9)
 v_mfma_f32_16x16x32_bf16 v[116:119], v[128:131], v[44:47], 0
 v_mfma_f32_16x16x32_bf16 v[120:123], v[132:135], v[44:47], 0
 v_mfma_f32_16x16x32_bf16 v[212:215], v[136:139], v[44:47], 0
 s_add_u32 s87, s78, 0x1000
 buffer_load_dwordx4 a[208:211], v2, s[4:7], s87 offen offset:1024 sc1
 v_mfma_f32_16x16x32_bf16 v[208:211], v[140:143], v[44:47], 0
 s_waitcnt vmcnt(9)
 v_mfma_f32_16x16x32_bf16 v[116:119], v[144:147], v[48:51], v[116:119]
 v_mfma_f32_16x16x32_bf16 v[120:123], v[148:151], v[48:51], v[120:123]
 v_mfma_f32_16x16x32_bf16 v[212:215], v[152:155], v[48:51], v[212:215]
 s_add_u32 s87, s78, 0x1000
 buffer_load_dwordx4 a[212:215], v2, s[4:7], s87 offen offset:2048 sc1
 v_mfma_f32_16x16x32_bf16 v[208:211], v[156:159], v[48:51], v[208:211]
 s_waitcnt vmcnt(8)
 v_mfma_f32_16x16x32_bf16 v[116:119], v[160:163], v[52:55], v[116:119]
 v_mfma_f32_16x16x32_bf16 v[120:123], v[164:167], v[52:55], v[120:123]
 v_mfma_f32_16x16x32_bf16 v[212:215], v[168:171], v[52:55], v[212:215]
 s_add_u32 s87, s78, 0x2000
 buffer_load_dwordx4 a[216:219], v2, s[4:7], s87 offen sc1
 v_mfma_f32_16x16x32_bf16 v[208:211], v[172:175], v[52:55], v[208:211]
 s_waitcnt vmcnt(8)
 v_mfma_f32_16x16x32_bf16 v[116:119], v[176:179], v[56:59], v[116:119]
 v_mfma_f32_16x16x32_bf16 v[120:123], v[180:183], v[56:59], v[120:123]
 v_mfma_f32_16x16x32_bf16 v[212:215], v[184:187], v[56:59], v[212:215]
 s_add_u32 s87, s78, 0x2000
 buffer_load_dwordx4 a[220:223], v2, s[4:7], s87 offen offset:1024 sc1
 v_mfma_f32_16x16x32_bf16 v[208:211], v[188:191], v[56:59], v[208:211]
 v_mov_b32 v5, 2
 s_waitcnt vmcnt(5)
 buffer_store_dword v5, off, s[4:7], s67 offset:1024 sc1
 s_add_u32 s85, s70, 0x0
 s_waitcnt vmcnt(5)
 v_cmp_gt_u32 vcc, 4, v3
 s_nop 0
 s_cbranch_vccnz .Lps_70
.Lpb_71:
 buffer_load_dwordx4 v[60:63], v2, s[4:7], s85 offen sc1
 buffer_load_dwordx4 v[64:67], v2, s[4:7], s85 offen offset:1024 sc1
 buffer_load_dwordx4 v[68:71], v2, s[4:7], s85 offen offset:2048 sc1
 buffer_load_dwordx4 v[112:115], v2, s[4:7], s85 offen offset:3072 sc1
 ds_write_b128 v9, v[116:119] offset:32768
 ds_write_b128 v10, v[120:123] offset:32768
 ds_write_b128 v9, v[212:215] offset:32896
 ds_write_b128 v10, v[208:211] offset:32896
 s_add_u32 s87, s78, 0x2000
 buffer_load_dwordx4 a[224:227], v2, s[4:7], s87 offen offset:2048 sc1
 s_add_u32 s87, s78, 0x3000
 buffer_load_dwordx4 a[228:231], v2, s[4:7], s87 offen sc1
 s_add_u32 s87, s78, 0x3000
 buffer_load_dwordx4 a[232:235], v2, s[4:7], s87 offen offset:1024 sc1
 s_waitcnt lgkmcnt(0)
 s_barrier
 ds_read_b128 v[44:47], v11 offset:32768
 ds_read_b128 v[48:51], v11 offset:36864
 ds_read_b128 v[52:55], v11 offset:40960
 ds_read_b128 v[56:59], v11 offset:45056
 s_waitcnt vmcnt(6)
 v_mfma_f32_16x16x32_bf16 v[192:195], v[128:131], v[60:63], 0
 v_lshlrev_b32 v100, 16, v18
 v_and_b32 v101, 0xffff0000, v18
 v_mfma_f32_16x16x32_bf16 v[196:199], v[132:135], v[60:63], 0
 v_lshlrev_b32 v102, 16, v19
 v_and_b32 v103, 0xffff0000, v19
 v_mfma_f32_16x16x32_bf16 v[200:203], v[136:139], v[60:63], 0
 buffer_load_dword v3, v6, s[4:7], s65 offen sc1
 v_mfma_f32_16x16x32_bf16 v[124:127], v[140:143], v[60:63], 0
 s_waitcnt lgkmcnt(2)
 v_add_f32 v44, v44, v48
 s_waitcnt lgkmcnt(0)
 v_add_f32 v52, v52, v56
 s_waitcnt vmcnt(6)
 v_mfma_f32_16x16x32_bf16 v[192:195], v[144:147], v[64:67], v[192:195]
 s_add_u32 s87, s78, 0x3000
 buffer_load_dwordx4 a[236:239], v2, s[4:7], s87 offen offset:2048 sc1
 v_mfma_f32_16x16x32_bf16 v[196:199], v[148:151], v[64:67], v[196:199]
 v_add_f32 v45, v45, v49
 v_add_f32 v53, v53, v57
 v_mfma_f32_16x16x32_bf16 v[200:203], v[152:155], v[64:67], v[200:203]
 v_add_f32 v46, v46, v50
 v_add_f32 v54, v54, v58
 v_mfma_f32_16x16x32_bf16 v[124:127], v[156:159], v[64:67], v[124:127]
 v_add_f32 v47, v47, v51
 v_add_f32 v55, v55, v59
 s_waitcnt vmcnt(6)
 v_mfma_f32_16x16x32_bf16 v[192:195], v[160:163], v[68:71], v[192:195]
 v_add_f32 v44, v44, v52
 v_mfma_f32_16x16x32_bf16 v[196:199], v[164:167], v[68:71], v[196:199]
 v_add_f32 v45, v45, v53
 v_add_f32 v46, v46, v54
 v_mfma_f32_16x16x32_bf16 v[200:203], v[168:171], v[68:71], v[200:203]
 v_add_f32 v47, v47, v55
 v_add_f32 v100, v100, v44
 v_mfma_f32_16x16x32_bf16 v[124:127], v[172:175], v[68:71], v[124:127]
 v_add_f32 v101, v101, v45
 s_waitcnt vmcnt(5)
 v_mfma_f32_16x16x32_bf16 v[192:195], v[176:179], v[112:115], v[192:195]
 v_add_f32 v102, v102, v46
 v_add_f32 v103, v103, v47
 v_mfma_f32_16x16x32_bf16 v[196:199], v[180:183], v[112:115], v[196:199]
 v_cvt_pk_bf16_f32 v18, v100, v101
 v_mfma_f32_16x16x32_bf16 v[200:203], v[184:187], v[112:115], v[200:203]
 v_cvt_pk_bf16_f32 v19, v102, v103
 buffer_store_dwordx2 v[18:19], v12, s[4:7], s71 offen sc1
 v_mfma_f32_16x16x32_bf16 v[124:127], v[188:191], v[112:115], v[124:127]
 v_add_f32 v108, v100, v101
 v_mul_f32 v109, v100, v100
 v_add_f32 v108, v108, v102
 v_fmac_f32 v109, v101, v101
 v_add_f32 v108, v108, v103
 v_fmac_f32 v109, v102, v102
 v_fmac_f32 v109, v103, v103
 v_add_f32_dpp v108, v108, v108 row_ror:8 row_mask:0xf bank_mask:0xf
 ds_write_b128 v9, v[192:195]
 ds_write_b128 v10, v[196:199]
 ds_write_b128 v9, v[200:203] offset:128
 ds_write_b128 v10, v[124:127] offset:128
 v_add_f32_dpp v108, v109, v109 row_ror:8 row_mask:0xf bank_mask:0xc
 s_nop 1
 v_add_f32_dpp v108, v108, v108 row_half_mirror row_mask:0xf bank_mask:0xf
 s_nop 1
 v_add_f32_dpp v108, v108, v108 quad_perm:[1,0,3,2] row_mask:0xf bank_mask:0xf
 s_nop 1
 v_add_f32_dpp v108, v108, v108 quad_perm:[2,3,0,1] row_mask:0xf bank_mask:0xf
 buffer_store_dword v108, v14, s[4:7], s72 offen offset:1024 sc1
 s_waitcnt vmcnt(3)
 v_cmp_gt_u32 vcc, 2, v3
 s_nop 0
 s_cbranch_vccnz .Lps_72
.Lpb_73:
 s_add_u32 s85, s73, 0x8000
 buffer_load_dwordx4 v[216:219], v2, s[4:7], s85 offen sc1
 buffer_load_dwordx4 v[220:223], v2, s[4:7], s85 offen offset:1024 sc1
 s_waitcnt lgkmcnt(0)
 s_barrier
 ds_read_b128 v[60:63], v11
 ds_read_b128 v[64:67], v11 offset:4096
 ds_read_b128 v[68:71], v11 offset:8192
 ds_read_b128 v[112:115], v11 offset:12288
 buffer_load_dwordx4 v[224:227], v2, s[4:7], s85 offen offset:2048 sc1
 buffer_load_dwordx4 v[228:231], v2, s[4:7], s85 offen offset:3072 sc1
 s_add_u32 s85, s73, 0x9000
 buffer_load_dwordx4 v[232:235], v2, s[4:7], s85 offen sc1
 buffer_load_dwordx4 v[236:239], v2, s[4:7], s85 offen offset:1024 sc1
 buffer_load_dwordx4 v[240:243], v2, s[4:7], s85 offen offset:2048 sc1
 buffer_load_dwordx4 v[244:247], v2, s[4:7], s85 offen offset:3072 sc1
 ds_read_b128 v[184:187], v2
 ds_read_b128 v[188:191], v2 offset:1024
 ds_read_b128 v[192:195], v2 offset:2048
 ds_read_b128 v[196:199], v2 offset:3072
 ds_read_b128 v[200:203], v2 offset:4096
 ds_read_b128 v[204:207], v2 offset:5120
 s_add_u32 s91, s71, 0x0
 v_lshlrev_b32 v104, 16, v16
 v_and_b32 v105, 0xffff0000, v16
 v_lshlrev_b32 v106, 16, v17
 v_and_b32 v107, 0xffff0000, v17
 s_waitcnt lgkmcnt(8)
 v_pk_add_f32 v[60:61], v[60:61], v[64:65]
 s_waitcnt lgkmcnt(6)
 v_pk_add_f32 v[68:69], v[68:69], v[112:113]
 v_pk_add_f32 v[62:63], v[62:63], v[66:67]
 v_pk_add_f32 v[70:71], v[70:71], v[114:115]
 v_pk_add_f32 v[60:61], v[60:61], v[68:69]
 v_pk_add_f32 v[62:63], v[62:63], v[70:71]
 v_pk_add_f32 v[104:105], v[104:105], v[60:61]
 v_pk_add_f32 v[106:107], v[106:107], v[62:63]
 v_cvt_pk_bf16_f32 v16, v104, v105
 v_cvt_pk_bf16_f32 v17, v106, v107
 buffer_store_dwordx2 v[16:17], v12, s[4:7], s91 offen offset:1024 sc1
 v_add_f32 v110, v104, v105
 v_mul_f32 v111, v104, v104
 v_add_f32 v110, v110, v106
 v_fmac_f32 v111, v105, v105
 v_add_f32 v110, v110, v107
 v_fmac_f32 v111, v106, v106
 v_fmac_f32 v111, v107, v107
 v_add_f32_dpp v110, v110, v110 row_ror:8 row_mask:0xf bank_mask:0xf
 s_nop 0
 v_add_f32_dpp v110, v111, v111 row_ror:8 row_mask:0xf bank_mask:0xc
 s_nop 1
 v_add_f32_dpp v110, v110, v110 row_half_mirror row_mask:0xf bank_mask:0xf
 s_nop 1
 v_add_f32_dpp v110, v110, v110 quad_perm:[1,0,3,2] row_mask:0xf bank_mask:0xf
 s_nop 1
 v_add_f32_dpp v110, v110, v110 quad_perm:[2,3,0,1] row_mask:0xf bank_mask:0xf
 buffer_store_dword v110, v14, s[4:7], s72 offen sc1
 ds_read_b128 v[208:211], v2 offset:6144
 s_waitcnt vmcnt(9) lgkmcnt(1)
 v_mfma_f32_16x16x32_bf16 v[128:131], v[184:187], v[216:219], 0
 s_add_u32 s85, s73, 0xa000
 buffer_load_dwordx4 v[248:251], v2, s[4:7], s85 offen sc1
 s_waitcnt vmcnt(9)
 v_mfma_f32_16x16x32_bf16 v[156:159], v[184:187], v[220:223], 0
 ds_read_b128 v[212:215], v2 offset:7168
 v_mfma_f32_16x16x32_bf16 v[132:135], v[188:191], v[216:219], 0
 v_mfma_f32_16x16x32_bf16 v[160:163], v[188:191], v[220:223], 0
 ds_read_b128 v[184:187], v2 offset:8192
 v_mfma_f32_16x16x32_bf16 v[136:139], v[192:195], v[216:219], 0
 buffer_load_dwordx4 v[30:33], v2, s[4:7], s74 offen offset:3072 sc1
 v_mfma_f32_16x16x32_bf16 v[164:167], v[192:195], v[220:223], 0
 ds_read_b128 v[188:191], v2 offset:9216
 v_mfma_f32_16x16x32_bf16 v[140:143], v[196:199], v[216:219], 0
 v_mfma_f32_16x16x32_bf16 v[168:171], v[196:199], v[220:223], 0
 ds_read_b128 v[192:195], v2 offset:10240
 v_mfma_f32_16x16x32_bf16 v[144:147], v[200:203], v[216:219], 0
 buffer_load_dwordx4 v[252:255], v2, s[4:7], s85 offen offset:1024 sc1
 v_mfma_f32_16x16x32_bf16 v[172:175], v[200:203], v[220:223], 0
 ds_read_b128 v[196:199], v2 offset:11264
 v_mfma_f32_16x16x32_bf16 v[148:151], v[204:207], v[216:219], 0
 v_mfma_f32_16x16x32_bf16 v[176:179], v[204:207], v[220:223], 0
 buffer_load_dwordx4 v[34:37], v2, s[4:7], s74 offen offset:2048 sc1
 ds_read_b128 v[200:203], v2 offset:12288
 s_waitcnt lgkmcnt(5)
 v_mfma_f32_16x16x32_bf16 v[152:155], v[208:211], v[216:219], 0
 v_mfma_f32_16x16x32_bf16 v[180:183], v[208:211], v[220:223], 0
 ds_read_b128 v[204:207], v2 offset:13312
 s_waitcnt vmcnt(11)
 v_mfma_f32_16x16x32_bf16 v[128:131], v[212:215], v[224:227], v[128:131]
 buffer_load_dwordx4 v[216:219], v2, s[4:7], s85 offen offset:2048 sc1
 s_waitcnt vmcnt(11)
 v_mfma_f32_16x16x32_bf16 v[156:159], v[212:215], v[228:231], v[156:159]
 ds_read_b128 v[208:211], v2 offset:14336
 s_waitcnt lgkmcnt(5)
 v_mfma_f32_16x16x32_bf16 v[132:135], v[184:187], v[224:227], v[132:135]
 v_mfma_f32_16x16x32_bf16 v[160:163], v[184:187], v[228:231], v[160:163]
 ds_read_b128 v[212:215], v2 offset:15360
 v_mfma_f32_16x16x32_bf16 v[136:139], v[188:191], v[224:227], v[136:139]
 s_add_u32 m0, s16, 86016
 s_mul_i32 s89, s50, 28672
 s_add_u32 s89, s89, s16
 s_add_u32 s89, s89, 0x700000
 buffer_load_dwordx4 v2, s[4:7], s89 offen sc1 lds
 v_mfma_f32_16x16x32_bf16 v[164:167], v[188:191], v[228:231], v[164:167]
 ds_read_b128 v[184:187], v2 offset:16384
 s_waitcnt lgkmcnt(5)
 v_mfma_f32_16x16x32_bf16 v[140:143], v[192:195], v[224:227], v[140:143]
 v_mfma_f32_16x16x32_bf16 v[168:171], v[192:195], v[228:231], v[168:171]
 ds_read_b128 v[188:191], v2 offset:17408
 v_mfma_f32_16x16x32_bf16 v[144:147], v[196:199], v[224:227], v[144:147]
 buffer_load_dwordx4 v[220:223], v2, s[4:7], s85 offen offset:3072 sc1
 v_mfma_f32_16x16x32_bf16 v[172:175], v[196:199], v[228:231], v[172:175]
 ds_read_b128 v[192:195], v2 offset:18432
 s_waitcnt lgkmcnt(5)
 v_mfma_f32_16x16x32_bf16 v[148:151], v[200:203], v[224:227], v[148:151]
 v_mfma_f32_16x16x32_bf16 v[176:179], v[200:203], v[228:231], v[176:179]
 buffer_load_dwordx4 v[72:75], v29, s[4:7], s79 offen sc1
 ds_read_b128 v[196:199], v2 offset:19456
 v_mfma_f32_16x16x32_bf16 v[152:155], v[204:207], v[224:227], v[152:155]
 v_mfma_f32_16x16x32_bf16 v[180:183], v[204:207], v[228:231], v[180:183]
 ds_read_b128 v[200:203], v2 offset:20480
 s_waitcnt vmcnt(13) lgkmcnt(5)
 v_mfma_f32_16x16x32_bf16 v[128:131], v[208:211], v[232:235], v[128:131]
 s_add_u32 s85, s73, 0xb000
 buffer_load_dwordx4 v[224:227], v2, s[4:7], s85 offen sc1
 s_waitcnt vmcnt(13)
 v_mfma_f32_16x16x32_bf16 v[156:159], v[208:211], v[236:239], v[156:159]
 ds_read_b128 v[204:207], v2 offset:21504
 v_mfma_f32_16x16x32_bf16 v[132:135], v[212:215], v[232:235], v[132:135]
 v_mov_b32 v5, 4
 s_waitcnt vmcnt(9)
 buffer_store_dword v5, off, s[4:7], s67 offset:1024 sc1
 v_mfma_f32_16x16x32_bf16 v[160:163], v[212:215], v[236:239], v[160:163]
 ds_read_b128 v[208:211], v2 offset:22528
 s_waitcnt lgkmcnt(4)
 v_mfma_f32_16x16x32_bf16 v[136:139], v[184:187], v[232:235], v[136:139]
 buffer_load_dwordx4 v2, s[4:7], s89 offen offset:1024 sc1 lds
 v_mfma_f32_16x16x32_bf16 v[164:167], v[184:187], v[236:239], v[164:167]
 ds_read_b128 v[212:215], v2 offset:23552
 v_mfma_f32_16x16x32_bf16 v[140:143], v[188:191], v[232:235], v[140:143]
 v_mfma_f32_16x16x32_bf16 v[168:171], v[188:191], v[236:239], v[168:171]
 ds_read_b128 v[184:187], v2 offset:24576
 v_mfma_f32_16x16x32_bf16 v[144:147], v[192:195], v[232:235], v[144:147]
 buffer_load_dwordx4 v[228:231], v2, s[4:7], s85 offen offset:1024 sc1
 s_waitcnt vmcnt(10)
 v_add_f32 v38, v30, v32
 v_mfma_f32_16x16x32_bf16 v[172:175], v[192:195], v[236:239], v[172:175]
 ds_read_b128 v[188:191], v2 offset:25600
 v_add_f32 v44, v31, v33
 s_waitcnt lgkmcnt(4)
 v_mfma_f32_16x16x32_bf16 v[148:151], v[196:199], v[232:235], v[148:151]
 v_mfma_f32_16x16x32_bf16 v[176:179], v[196:199], v[236:239], v[176:179]
 buffer_load_dwordx4 v[76:79], v29, s[4:7], s79 offen offset:64 sc1
 ds_read_b128 v[192:195], v2 offset:26624
 v_permlane32_swap_b32 v38, v44
 v_mfma_f32_16x16x32_bf16 v[152:155], v[200:203], v[232:235], v[152:155]
 v_add_f32 v38, v38, v44
 v_mov_b32 v24, v38
 v_mfma_f32_16x16x32_bf16 v[180:183], v[200:203], v[236:239], v[180:183]
 ds_read_b128 v[196:199], v2 offset:27648
 v_permlane16_swap_b32 v38, v24
 v_mfma_f32_16x16x32_bf16 v[128:131], v[204:207], v[240:243], v[128:131]
 buffer_load_dwordx4 v[232:235], v2, s[4:7], s85 offen offset:2048 sc1
 v_mfma_f32_16x16x32_bf16 v[156:159], v[204:207], v[244:247], v[156:159]
 ds_read_b128 v[200:203], v2 offset:28672
 v_add_f32 v38, v38, v24
 s_waitcnt lgkmcnt(4)
 v_mfma_f32_16x16x32_bf16 v[132:135], v[208:211], v[240:243], v[132:135]
 v_mov_b32 v44, v38
 v_mfma_f32_16x16x32_bf16 v[160:163], v[208:211], v[244:247], v[160:163]
 ds_read_b128 v[204:207], v2 offset:29696
 v_permlane32_swap_b32 v38, v44
 v_mul_f32 v38, s84, v38
 v_mfma_f32_16x16x32_bf16 v[136:139], v[212:215], v[240:243], v[136:139]
 buffer_load_dwordx4 v2, s[4:7], s89 offen offset:2048 sc1 lds
 v_mul_f32 v44, s84, v44
 v_mfma_f32_16x16x32_bf16 v[164:167], v[212:215], v[244:247], v[164:167]
 ds_read_b128 v[208:211], v2 offset:30720
 v_fmac_f32 v44, v38, v38
 v_mfma_f32_16x16x32_bf16 v[140:143], v[184:187], v[240:243], v[140:143]
 v_min_f32 v44, 0, v44
 v_mfma_f32_16x16x32_bf16 v[168:171], v[184:187], v[244:247], v[168:171]
 ds_read_b128 v[212:215], v2 offset:31744
 v_sub_f32 v44, 0x3727c5ac, v44
 s_waitcnt lgkmcnt(4)
 v_mfma_f32_16x16x32_bf16 v[144:147], v[188:191], v[240:243], v[144:147]
 buffer_load_dwordx4 v[236:239], v2, s[4:7], s85 offen offset:3072 sc1
 v_rsq_f32 v24, v44
 v_mfma_f32_16x16x32_bf16 v[172:175], v[188:191], v[244:247], v[172:175]
 ds_read_b128 v[184:187], v2 offset:32768
 v_mfma_f32_16x16x32_bf16 v[148:151], v[192:195], v[240:243], v[148:151]
 v_mul_f32 v40, 0xc0135761, v24
 v_mul_f32 v25, v24, v24
 v_mfma_f32_16x16x32_bf16 v[176:179], v[192:195], v[244:247], v[176:179]
 buffer_load_dwordx4 v[80:83], v29, s[4:7], s79 offen offset:128 sc1
 ds_read_b128 v[188:191], v2 offset:33792
 v_mfma_f32_16x16x32_bf16 v[152:155], v[196:199], v[240:243], v[152:155]
 v_mul_f32 v25, v25, v24
 v_mul_f32 v42, 0xbdd2d3e8, v25
 v_mfma_f32_16x16x32_bf16 v[180:183], v[196:199], v[244:247], v[180:183]
 ds_read_b128 v[192:195], v2 offset:34816
 s_waitcnt vmcnt(13)
 v_add_f32 v39, v34, v36
 s_waitcnt lgkmcnt(4)
 v_mfma_f32_16x16x32_bf16 v[128:131], v[200:203], v[248:251], v[128:131]
 s_add_u32 s85, s73, 0xc000
 buffer_load_dwordx4 v[240:243], v2, s[4:7], s85 offen sc1
 v_add_f32 v45, v35, v37
 v_mfma_f32_16x16x32_bf16 v[156:159], v[200:203], v[252:255], v[156:159]
 ds_read_b128 v[196:199], v2 offset:35840
 v_permlane32_swap_b32 v39, v45
 v_mfma_f32_16x16x32_bf16 v[132:135], v[204:207], v[248:251], v[132:135]
 buffer_load_dword v3, v6, s[4:7], s65 offen sc1
 v_add_f32 v39, v39, v45
 v_mfma_f32_16x16x32_bf16 v[160:163], v[204:207], v[252:255], v[160:163]
 ds_read_b128 v[200:203], v2 offset:36864
 v_mfma_f32_16x16x32_bf16 v[136:139], v[208:211], v[248:251], v[136:139]
 buffer_load_dwordx4 v2, s[4:7], s89 offen offset:3072 sc1 lds
 v_mov_b32 v24, v39
 v_mfma_f32_16x16x32_bf16 v[164:167], v[208:211], v[252:255], v[164:167]
 ds_read_b128 v[204:207], v2 offset:37888
 v_permlane16_swap_b32 v39, v24
 s_waitcnt lgkmcnt(4)
 v_mfma_f32_16x16x32_bf16 v[140:143], v[212:215], v[248:251], v[140:143]
 v_add_f32 v39, v39, v24
 v_mov_b32 v45, v39
 v_mfma_f32_16x16x32_bf16 v[168:171], v[212:215], v[252:255], v[168:171]
 ds_read_b128 v[208:211], v2 offset:38912
 v_permlane32_swap_b32 v39, v45
 v_mfma_f32_16x16x32_bf16 v[144:147], v[184:187], v[248:251], v[144:147]
 buffer_load_dwordx4 v[244:247], v2, s[4:7], s85 offen offset:1024 sc1
 v_mul_f32 v39, s84, v39
 v_mfma_f32_16x16x32_bf16 v[172:175], v[184:187], v[252:255], v[172:175]
 ds_read_b128 v[212:215], v2 offset:39936
 v_mul_f32 v45, s84, v45
 v_mfma_f32_16x16x32_bf16 v[148:151], v[188:191], v[248:251], v[148:151]
 v_fmac_f32 v45, v39, v39
 v_min_f32 v45, 0, v45
 v_mfma_f32_16x16x32_bf16 v[176:179], v[188:191], v[252:255], v[176:179]
 buffer_load_dwordx4 v[84:87], v29, s[4:7], s79 offen offset:192 sc1
 ds_read_b128 v[184:187], v2 offset:40960
 s_waitcnt lgkmcnt(4)
 v_mfma_f32_16x16x32_bf16 v[152:155], v[192:195], v[248:251], v[152:155]
 v_sub_f32 v45, 0x3727c5ac, v45
 v_mfma_f32_16x16x32_bf16 v[180:183], v[192:195], v[252:255], v[180:183]
 ds_read_b128 v[188:191], v2 offset:41984
 v_rsq_f32 v24, v45
 s_waitcnt vmcnt(17)
 v_mfma_f32_16x16x32_bf16 v[128:131], v[196:199], v[216:219], v[128:131]
 buffer_load_dwordx4 v[248:251], v2, s[4:7], s85 offen offset:2048 sc1
 s_waitcnt vmcnt(16)
 v_mfma_f32_16x16x32_bf16 v[156:159], v[196:199], v[220:223], v[156:159]
 ds_read_b128 v[192:195], v2 offset:43008
 v_mul_f32 v41, 0xc0135761, v24
 v_mfma_f32_16x16x32_bf16 v[132:135], v[200:203], v[216:219], v[132:135]
 v_mul_f32 v25, v24, v24
 v_mfma_f32_16x16x32_bf16 v[160:163], v[200:203], v[220:223], v[160:163]
 ds_read_b128 v[196:199], v2 offset:44032
 v_mul_f32 v25, v25, v24
 s_waitcnt lgkmcnt(4)
 v_mfma_f32_16x16x32_bf16 v[136:139], v[204:207], v[216:219], v[136:139]
 s_add_u32 m0, s16, 90112
 s_mul_i32 s89, s50, 28672
 s_add_u32 s89, s89, s16
 s_add_u32 s89, s89, 0x701000
 buffer_load_dwordx4 v2, s[4:7], s89 offen sc1 lds
 v_mfma_f32_16x16x32_bf16 v[164:167], v[204:207], v[220:223], v[164:167]
 ds_read_b128 v[200:203], v2 offset:45056
 v_mul_f32 v43, 0xbdd2d3e8, v25
 v_mfma_f32_16x16x32_bf16 v[140:143], v[208:211], v[216:219], v[140:143]
 v_mfma_f32_16x16x32_bf16 v[168:171], v[208:211], v[220:223], v[168:171]
 ds_read_b128 v[204:207], v2 offset:46080
 v_mfma_f32_16x16x32_bf16 v[144:147], v[212:215], v[216:219], v[144:147]
 buffer_load_dwordx4 v[252:255], v2, s[4:7], s85 offen offset:3072 sc1
 v_mfma_f32_16x16x32_bf16 v[172:175], v[212:215], v[220:223], v[172:175]
 ds_read_b128 v[208:211], v2 offset:47104
 v_cmp_gt_u32 vcc, 32, v1
 s_nop 1
 v_cndmask_b32 v46, v41, v40, vcc
 v_cndmask_b32 v47, v43, v42, vcc
 v_cndmask_b32 v48, v45, v44, vcc
 s_waitcnt lgkmcnt(4)
 v_mfma_f32_16x16x32_bf16 v[148:151], v[184:187], v[216:219], v[148:151]
 v_mfma_f32_16x16x32_bf16 v[176:179], v[184:187], v[220:223], v[176:179]
 buffer_load_dwordx4 v[88:91], v29, s[4:7], s79 offen offset:256 sc1
 ds_read_b128 v[212:215], v2 offset:48128
 v_mfma_f32_16x16x32_bf16 v[152:155], v[188:191], v[216:219], v[152:155]
 v_mfma_f32_16x16x32_bf16 v[180:183], v[188:191], v[220:223], v[180:183]
 ds_read_b128 v[184:187], v2 offset:49152
 s_waitcnt vmcnt(17)
 v_mfma_f32_16x16x32_bf16 v[128:131], v[192:195], v[224:227], v[128:131]
 s_add_u32 s85, s73, 0xd000
 buffer_load_dwordx4 v[216:219], v2, s[4:7], s85 offen sc1
 s_waitcnt vmcnt(15)
 v_mfma_f32_16x16x32_bf16 v[156:159], v[192:195], v[228:231], v[156:159]
 ds_read_b128 v[188:191], v2 offset:50176
 s_waitcnt lgkmcnt(4)
 v_mfma_f32_16x16x32_bf16 v[132:135], v[196:199], v[224:227], v[132:135]
 v_mfma_f32_16x16x32_bf16 v[160:163], v[196:199], v[228:231], v[160:163]
 ds_read_b128 v[192:195], v2 offset:51200
 v_mfma_f32_16x16x32_bf16 v[136:139], v[200:203], v[224:227], v[136:139]
 buffer_load_dwordx4 v2, s[4:7], s89 offen offset:1024 sc1 lds
 v_mfma_f32_16x16x32_bf16 v[164:167], v[200:203], v[228:231], v[164:167]
 ds_read_b128 v[196:199], v2 offset:52224
 v_mfma_f32_16x16x32_bf16 v[140:143], v[204:207], v[224:227], v[140:143]
 v_fmac_f32 v128, v72, v38
 v_fmac_f32 v129, v73, v38
 v_mfma_f32_16x16x32_bf16 v[168:171], v[204:207], v[228:231], v[168:171]
 v_fmac_f32 v130, v74, v38
 v_fmac_f32 v131, v75, v38
 ds_read_b128 v[200:203], v2 offset:53248
 s_waitcnt lgkmcnt(4)
 v_mfma_f32_16x16x32_bf16 v[144:147], v[208:211], v[224:227], v[144:147]
 buffer_load_dwordx4 v[220:223], v2, s[4:7], s85 offen offset:1024 sc1
 v_fmac_f32 v156, v72, v39
 v_fmac_f32 v157, v73, v39
 v_mfma_f32_16x16x32_bf16 v[172:175], v[208:211], v[228:231], v[172:175]
 v_fmac_f32 v158, v74, v39
 v_fmac_f32 v159, v75, v39
 ds_read_b128 v[204:207], v2 offset:54272
 v_mfma_f32_16x16x32_bf16 v[148:151], v[212:215], v[224:227], v[148:151]
 v_mfma_f32_16x16x32_bf16 v[176:179], v[212:215], v[228:231], v[176:179]
 buffer_load_dwordx4 v2, s[4:7], s89 offen offset:2048 sc1 lds
 ds_read_b128 v[208:211], v2 offset:55296
 v_mfma_f32_16x16x32_bf16 v[152:155], v[184:187], v[224:227], v[152:155]
 v_mfma_f32_16x16x32_bf16 v[180:183], v[184:187], v[228:231], v[180:183]
 ds_read_b128 v[212:215], v2 offset:56320
 s_waitcnt vmcnt(16) lgkmcnt(4)
 v_mfma_f32_16x16x32_bf16 v[128:131], v[188:191], v[232:235], v[128:131]
 buffer_load_dwordx4 v[224:227], v2, s[4:7], s85 offen offset:2048 sc1
 s_waitcnt vmcnt(15)
 v_mfma_f32_16x16x32_bf16 v[156:159], v[188:191], v[236:239], v[156:159]
 ds_read_b128 v[184:187], v26
 v_mfma_f32_16x16x32_bf16 v[132:135], v[192:195], v[232:235], v[132:135]
 v_mfma_f32_16x16x32_bf16 v[160:163], v[192:195], v[236:239], v[160:163]
 s_waitcnt vmcnt(12)
 v_cmp_gt_u32 vcc, 4, v3
 s_nop 0
 s_cbranch_vccnz .Lps_74
.Lpb_75:
 ds_read_b128 v[188:191], v26 offset:1024
 v_mfma_f32_16x16x32_bf16 v[136:139], v[196:199], v[232:235], v[136:139]
 buffer_load_dwordx4 v[30:33], v2, s[4:7], s74 offen offset:1024 sc1
 v_mfma_f32_16x16x32_bf16 v[164:167], v[196:199], v[236:239], v[164:167]
 s_lshl_b32 s87, s48, 7
 s_add_u32 s87, s87, s61
 s_cmp_eq_u32 s50, 0
 s_cselect_b32 s87, s87, 0x2000000
 v_mov_b32 v5, 1
 buffer_store_dword v5, v6, s[4:7], s87 offen offset:2560 sc1
 ds_read_b128 v[192:195], v26 offset:2048
 s_waitcnt lgkmcnt(4)
 v_mfma_f32_16x16x32_bf16 v[140:143], v[200:203], v[232:235], v[140:143]
 v_mfma_f32_16x16x32_bf16 v[168:171], v[200:203], v[236:239], v[168:171]
 ds_read_b128 v[196:199], v26 offset:3072
 v_mfma_f32_16x16x32_bf16 v[144:147], v[204:207], v[232:235], v[144:147]
 buffer_load_dwordx4 v[228:231], v2, s[4:7], s85 offen offset:3072 sc1
 v_fmac_f32 v132, v76, v38
 v_fmac_f32 v133, v77, v38
 v_mfma_f32_16x16x32_bf16 v[172:175], v[204:207], v[236:239], v[172:175]
 v_fmac_f32 v134, v78, v38
 v_fmac_f32 v135, v79, v38
 ds_read_b128 v[200:203], v26 offset:4096
 v_mfma_f32_16x16x32_bf16 v[148:151], v[208:211], v[232:235], v[148:151]
 v_fmac_f32 v160, v76, v39
 v_fmac_f32 v161, v77, v39
 v_mfma_f32_16x16x32_bf16 v[176:179], v[208:211], v[236:239], v[176:179]
 buffer_load_dwordx4 v[34:37], v2, s[4:7], s74 offen sc1
 v_fmac_f32 v162, v78, v39
 v_fmac_f32 v163, v79, v39
 ds_read_b128 v[204:207], v26 offset:5120
 s_waitcnt lgkmcnt(4)
 v_mfma_f32_16x16x32_bf16 v[152:155], v[212:215], v[232:235], v[152:155]
 v_mfma_f32_16x16x32_bf16 v[180:183], v[212:215], v[236:239], v[180:183]
 ds_read_b128 v[208:211], v26 offset:6144
 v_mfma_f32_16x16x32_bf16 v[128:131], v[184:187], v[240:243], v[128:131]
 s_add_u32 s85, s73, 0xe000
 buffer_load_dwordx4 v[232:235], v2, s[4:7], s85 offen sc1
 s_waitcnt vmcnt(15)
 v_mfma_f32_16x16x32_bf16 v[156:159], v[184:187], v[244:247], v[156:159]
 ds_read_b128 v[212:215], v26 offset:7168
 v_mfma_f32_16x16x32_bf16 v[132:135], v[188:191], v[240:243], v[132:135]
 v_mfma_f32_16x16x32_bf16 v[160:163], v[188:191], v[244:247], v[160:163]
 ds_read_b128 v[184:187], v26 offset:8192
 s_waitcnt lgkmcnt(4)
 v_mfma_f32_16x16x32_bf16 v[136:139], v[192:195], v[240:243], v[136:139]
 buffer_load_dwordx4 v[92:95], v29, s[4:7], s79 offen offset:320 sc1
 v_mfma_f32_16x16x32_bf16 v[164:167], v[192:195], v[244:247], v[164:167]
 ds_read_b128 v[188:191], v26 offset:9216
 v_mfma_f32_16x16x32_bf16 v[140:143], v[196:199], v[240:243], v[140:143]
 v_mfma_f32_16x16x32_bf16 v[168:171], v[196:199], v[244:247], v[168:171]
 ds_read_b128 v[192:195], v26 offset:10240
 v_mfma_f32_16x16x32_bf16 v[144:147], v[200:203], v[240:243], v[144:147]
 s_mov_b64 exec, 0xfff0000
 s_mov_b32 s87, 0x0
 buffer_load_dword v0, v8, s[4:7], s87 offen
 s_mov_b64 exec, -1
 buffer_load_dwordx4 v[236:239], v2, s[4:7], s85 offen offset:1024 sc1
 v_mfma_f32_16x16x32_bf16 v[172:175], v[200:203], v[244:247], v[172:175]
 ds_read_b128 v[196:199], v26 offset:11264
 s_waitcnt lgkmcnt(5)
 v_mfma_f32_16x16x32_bf16 v[148:151], v[204:207], v[240:243], v[148:151]
 v_fmac_f32 v136, v80, v38
 v_fmac_f32 v137, v81, v38
 v_mfma_f32_16x16x32_bf16 v[176:179], v[204:207], v[244:247], v[176:179]
 buffer_load_dwordx4 v[96:99], v29, s[4:7], s79 offen offset:384 sc1
 v_fmac_f32 v138, v82, v38
 v_fmac_f32 v139, v83, v38
 ds_read_b128 v[200:203], v26 offset:12288
 v_mfma_f32_16x16x32_bf16 v[152:155], v[208:211], v[240:243], v[152:155]
 v_fmac_f32 v164, v80, v39
 v_fmac_f32 v165, v81, v39
 v_mfma_f32_16x16x32_bf16 v[180:183], v[208:211], v[244:247], v[180:183]
 v_fmac_f32 v166, v82, v39
 v_fmac_f32 v167, v83, v39
 ds_read_b128 v[204:207], v26 offset:13312
 s_waitcnt vmcnt(17) lgkmcnt(4)
 v_mfma_f32_16x16x32_bf16 v[128:131], v[212:215], v[248:251], v[128:131]
 buffer_load_dwordx4 v[240:243], v2, s[4:7], s85 offen offset:2048 sc1
 v_fmac_f32 v168, v84, v39
 v_fmac_f32 v169, v85, v39
 s_waitcnt vmcnt(16)
 v_mfma_f32_16x16x32_bf16 v[156:159], v[212:215], v[252:255], v[156:159]
 v_fmac_f32 v170, v86, v39
 v_fmac_f32 v171, v87, v39
 ds_read_b128 v[208:211], v26 offset:14336
 v_mfma_f32_16x16x32_bf16 v[132:135], v[184:187], v[248:251], v[132:135]
 v_mfma_f32_16x16x32_bf16 v[160:163], v[184:187], v[252:255], v[160:163]
 ds_read_b128 v[212:215], v26 offset:15360
 v_mfma_f32_16x16x32_bf16 v[136:139], v[188:191], v[248:251], v[136:139]
 s_add_u32 s91, s78, 0x4000
 buffer_load_dwordx4 a[240:243], v2, s[4:7], s91 offen sc1
 v_mfma_f32_16x16x32_bf16 v[164:167], v[188:191], v[252:255], v[164:167]
 ds_read_b128 v[184:187], v26 offset:16384
 s_waitcnt lgkmcnt(4)
 v_mfma_f32_16x16x32_bf16 v[140:143], v[192:195], v[248:251], v[140:143]
 v_mfma_f32_16x16x32_bf16 v[168:171], v[192:195], v[252:255], v[168:171]
 ds_read_b128 v[188:191], v26 offset:17408
 v_mfma_f32_16x16x32_bf16 v[144:147], v[196:199], v[248:251], v[144:147]
 buffer_load_dwordx4 v[244:247], v2, s[4:7], s85 offen offset:3072 sc1
 v_mfma_f32_16x16x32_bf16 v[172:175], v[196:199], v[252:255], v[172:175]
 ds_read_b128 v[192:195], v26 offset:18432
 v_mfma_f32_16x16x32_bf16 v[148:151], v[200:203], v[248:251], v[148:151]
 s_waitcnt vmcnt(11)
 v_add_f32 v49, v30, v32
 v_add_f32 v54, v31, v33
 v_mfma_f32_16x16x32_bf16 v[176:179], v[200:203], v[252:255], v[176:179]
 s_add_u32 s91, s78, 0x4000
 buffer_load_dwordx4 a[244:247], v2, s[4:7], s91 offen offset:1024 sc1
 ds_read_b128 v[196:199], v26 offset:19456
 v_permlane32_swap_b32 v49, v54
 s_waitcnt lgkmcnt(4)
 v_mfma_f32_16x16x32_bf16 v[152:155], v[204:207], v[248:251], v[152:155]
 v_fmac_f32 v140, v84, v38
 v_fmac_f32 v141, v85, v38
 v_add_f32 v49, v49, v54
 v_mfma_f32_16x16x32_bf16 v[180:183], v[204:207], v[252:255], v[180:183]
 v_fmac_f32 v142, v86, v38
 v_fmac_f32 v143, v87, v38
 ds_read_b128 v[200:203], v26 offset:20480
 v_mfma_f32_16x16x32_bf16 v[128:131], v[208:211], v[216:219], v[128:131]
 s_add_u32 s85, s73, 0xf000
 buffer_load_dwordx4 v[248:251], v2, s[4:7], s85 offen sc1
 v_fmac_f32 v144, v88, v38
 v_fmac_f32 v145, v89, v38
 v_mfma_f32_16x16x32_bf16 v[156:159], v[208:211], v[220:223], v[156:159]
 v_fmac_f32 v146, v90, v38
 v_fmac_f32 v147, v91, v38
 ds_read_b128 v[204:207], v26 offset:21504
 v_mfma_f32_16x16x32_bf16 v[132:135], v[212:215], v[216:219], v[132:135]
 v_fmac_f32 v172, v88, v39
 v_fmac_f32 v173, v89, v39
 v_mfma_f32_16x16x32_bf16 v[160:163], v[212:215], v[220:223], v[160:163]
 v_fmac_f32 v174, v90, v39
 v_fmac_f32 v175, v91, v39
 ds_read_b128 v[208:211], v26 offset:22528
 s_waitcnt lgkmcnt(3)
 v_mfma_f32_16x16x32_bf16 v[136:139], v[184:187], v[216:219], v[136:139]
 s_add_u32 s91, s78, 0x4000
 buffer_load_dwordx4 a[248:251], v2, s[4:7], s91 offen offset:2048 sc1
 v_mfma_f32_16x16x32_bf16 v[164:167], v[184:187], v[220:223], v[164:167]
 ds_read_b128 v[212:215], v26 offset:23552
 v_mov_b32 v24, v49
 v_mfma_f32_16x16x32_bf16 v[140:143], v[188:191], v[216:219], v[140:143]
 v_mfma_f32_16x16x32_bf16 v[168:171], v[188:191], v[220:223], v[168:171]
 ds_read_b128 v[184:187], v26 offset:24576
 v_permlane16_swap_b32 v49, v24
 v_add_f32 v49, v49, v24
 v_mfma_f32_16x16x32_bf16 v[144:147], v[192:195], v[216:219], v[144:147]
 buffer_load_dwordx4 v[252:255], v2, s[4:7], s85 offen offset:1024 sc1
 v_mov_b32 v54, v49
 v_mfma_f32_16x16x32_bf16 v[172:175], v[192:195], v[220:223], v[172:175]
 ds_read_b128 v[188:191], v26 offset:25600
 v_permlane32_swap_b32 v49, v54
 v_mul_f32 v49, s84, v49
 v_mfma_f32_16x16x32_bf16 v[148:151], v[196:199], v[216:219], v[148:151]
 s_barrier
 v_mul_f32 v54, s84, v54
 v_fmac_f32 v54, v49, v49
 v_mfma_f32_16x16x32_bf16 v[176:179], v[196:199], v[220:223], v[176:179]
 s_add_u32 s91, s78, 0x5000
 buffer_load_dwordx4 a[252:255], v2, s[4:7], s91 offen sc1
 ds_read_b128 v[192:195], v26 offset:26624
 s_waitcnt lgkmcnt(4)
 v_mfma_f32_16x16x32_bf16 v[152:155], v[200:203], v[216:219], v[152:155]
 v_min_f32 v54, 0, v54
 v_sub_f32 v54, 0x3727c5ac, v54
 v_mfma_f32_16x16x32_bf16 v[180:183], v[200:203], v[220:223], v[180:183]
 ds_read_b128 v[196:199], v26 offset:27648
 v_rsq_f32 v24, v54
 v_mfma_f32_16x16x32_bf16 v[128:131], v[204:207], v[224:227], v[128:131]
 buffer_load_dwordx4 v[216:219], v2, s[4:7], s85 offen offset:2048 sc1
 v_mul_f32 v50, 0xc0135761, v24
 v_mul_f32 v25, v24, v24
 s_waitcnt vmcnt(15)
 v_mfma_f32_16x16x32_bf16 v[156:159], v[204:207], v[228:231], v[156:159]
 ds_read_b128 v[200:203], v26 offset:28672
 v_mul_f32 v25, v25, v24
 v_mul_f32 v52, 0xbdd2d3e8, v25
 v_mfma_f32_16x16x32_bf16 v[132:135], v[208:211], v[224:227], v[132:135]
 s_waitcnt vmcnt(12)
 v_fmac_f32 v148, v92, v38
 v_fmac_f32 v149, v93, v38
 v_mfma_f32_16x16x32_bf16 v[160:163], v[208:211], v[228:231], v[160:163]
 v_fmac_f32 v150, v94, v38
 v_fmac_f32 v151, v95, v38
 ds_read_b128 v[204:207], v26 offset:29696
 s_waitcnt lgkmcnt(3)
 v_mfma_f32_16x16x32_bf16 v[136:139], v[212:215], v[224:227], v[136:139]
 s_add_u32 m0, s80, 16384
 s_add_u32 s91, s78, 0xc00
 buffer_load_dwordx4 v2, s[4:7], s91 offen sc1 lds
 v_fmac_f32 v176, v92, v39
 v_fmac_f32 v177, v93, v39
 v_mfma_f32_16x16x32_bf16 v[164:167], v[212:215], v[228:231], v[164:167]
 v_fmac_f32 v178, v94, v39
 v_fmac_f32 v179, v95, v39
 ds_read_b128 v[208:211], v26 offset:30720
 v_mfma_f32_16x16x32_bf16 v[140:143], v[184:187], v[224:227], v[140:143]
 v_add_f32 v59, v34, v36
 v_mfma_f32_16x16x32_bf16 v[168:171], v[184:187], v[228:231], v[168:171]
 ds_read_b128 v[212:215], v26 offset:31744
 v_add_f32 v55, v35, v37
 v_mfma_f32_16x16x32_bf16 v[144:147], v[188:191], v[224:227], v[144:147]
 buffer_load_dwordx4 v[220:223], v2, s[4:7], s85 offen offset:3072 sc1
 v_permlane32_swap_b32 v59, v55
 v_add_f32 v59, v59, v55
 v_mfma_f32_16x16x32_bf16 v[172:175], v[188:191], v[228:231], v[172:175]
 ds_read_b128 v[184:187], v26 offset:32768
 v_mov_b32 v24, v59
 v_mfma_f32_16x16x32_bf16 v[148:151], v[192:195], v[224:227], v[148:151]
 v_mfma_f32_16x16x32_bf16 v[176:179], v[192:195], v[228:231], v[176:179]
 s_add_u32 m0, s80, 17408
 s_add_u32 s91, s78, 0x1c00
 buffer_load_dwordx4 v2, s[4:7], s91 offen sc1 lds
 ds_read_b128 v[188:191], v26 offset:33792
 v_permlane16_swap_b32 v59, v24
 s_waitcnt lgkmcnt(4)
 v_mfma_f32_16x16x32_bf16 v[152:155], v[196:199], v[224:227], v[152:155]
 v_add_f32 v59, v59, v24
 v_mov_b32 v55, v59
 v_mfma_f32_16x16x32_bf16 v[180:183], v[196:199], v[228:231], v[180:183]
 ds_read_b128 v[192:195], v26 offset:34816
 v_permlane32_swap_b32 v59, v55
 v_mul_f32 v59, s84, v59
 v_mfma_f32_16x16x32_bf16 v[128:131], v[200:203], v[232:235], v[128:131]
 s_add_u32 s85, s73, 0x0
 buffer_load_dwordx4 v[224:227], v2, s[4:7], s85 offen sc1
 v_mul_f32 v55, s84, v55
 v_fmac_f32 v55, v59, v59
 s_waitcnt vmcnt(14)
 v_mfma_f32_16x16x32_bf16 v[156:159], v[200:203], v[236:239], v[156:159]
 ds_read_b128 v[196:199], v26 offset:35840
 v_min_f32 v55, 0, v55
 v_mfma_f32_16x16x32_bf16 v[132:135], v[204:207], v[232:235], v[132:135]
 s_mov_b64 exec, 0x3fff
 s_mov_b32 s87, 0x400000
 buffer_load_dword v0, v8, s[4:7], s87 offen
 s_mov_b64 exec, -1
 v_sub_f32 v55, 0x3727c5ac, v55
 v_mfma_f32_16x16x32_bf16 v[160:163], v[204:207], v[236:239], v[160:163]
 ds_read_b128 v[200:203], v26 offset:36864
 v_rsq_f32 v24, v55
 s_waitcnt lgkmcnt(3)
 v_mfma_f32_16x16x32_bf16 v[136:139], v[208:211], v[232:235], v[136:139]
 s_waitcnt vmcnt(14)
 v_fmac_f32 v152, v96, v38
 v_fmac_f32 v153, v97, v38
 v_mfma_f32_16x16x32_bf16 v[164:167], v[208:211], v[236:239], v[164:167]
 v_fmac_f32 v154, v98, v38
 v_fmac_f32 v155, v99, v38
 ds_read_b128 v[204:207], v26 offset:37888
 v_mfma_f32_16x16x32_bf16 v[140:143], v[212:215], v[232:235], v[140:143]
 v_fmac_f32 v180, v96, v39
 v_fmac_f32 v181, v97, v39
 v_mfma_f32_16x16x32_bf16 v[168:171], v[212:215], v[236:239], v[168:171]
 v_fmac_f32 v182, v98, v39
 v_fmac_f32 v183, v99, v39
 ds_read_b128 v[208:211], v26 offset:38912
 v_mfma_f32_16x16x32_bf16 v[144:147], v[184:187], v[232:235], v[144:147]
 buffer_load_dwordx4 v[228:231], v2, s[4:7], s85 offen offset:1024 sc1
 v_mul_f32 v51, 0xc0135761, v24
 v_mfma_f32_16x16x32_bf16 v[172:175], v[184:187], v[236:239], v[172:175]
 ds_read_b128 v[212:215], v26 offset:39936
 v_mul_f32 v25, v24, v24
 v_mul_f32 v25, v25, v24
 v_mfma_f32_16x16x32_bf16 v[148:151], v[188:191], v[232:235], v[148:151]
 v_mul_f32 v53, 0xbdd2d3e8, v25
 v_mfma_f32_16x16x32_bf16 v[176:179], v[188:191], v[236:239], v[176:179]
 s_add_u32 m0, s80, 18432
 s_add_u32 s91, s78, 0x2c00
 buffer_load_dwordx4 v2, s[4:7], s91 offen sc1 lds
 ds_read_b128 v[184:187], v26 offset:40960
 s_waitcnt lgkmcnt(4)
 v_mfma_f32_16x16x32_bf16 v[152:155], v[192:195], v[232:235], v[152:155]
 v_cmp_gt_u32 vcc, 32, v1
 s_nop 1
 v_cndmask_b32 v56, v51, v50, vcc
 v_cndmask_b32 v57, v53, v52, vcc
 v_cndmask_b32 v58, v55, v54, vcc
 v_mfma_f32_16x16x32_bf16 v[180:183], v[192:195], v[236:239], v[180:183]
 ds_read_b128 v[188:191], v26 offset:41984
 s_waitcnt vmcnt(15)
 v_mfma_f32_16x16x32_bf16 v[128:131], v[196:199], v[240:243], v[128:131]
 buffer_load_dwordx4 v[232:235], v2, s[4:7], s85 offen offset:2048 sc1
 s_waitcnt vmcnt(14)
 v_mfma_f32_16x16x32_bf16 v[156:159], v[196:199], v[244:247], v[156:159]
 ds_read_b128 v[192:195], v26 offset:43008
 v_mul_f32 v100, v72, v59
 v_mul_f32 v72, v72, v49
 v_mfma_f32_16x16x32_bf16 v[132:135], v[200:203], v[240:243], v[132:135]
 v_mul_f32 v101, v73, v59
 v_mul_f32 v73, v73, v49
 v_mfma_f32_16x16x32_bf16 v[160:163], v[200:203], v[244:247], v[160:163]
 ds_read_b128 v[196:199], v26 offset:44032
 v_mul_f32 v102, v74, v59
 v_mul_f32 v74, v74, v49
 s_waitcnt lgkmcnt(3)
 v_mfma_f32_16x16x32_bf16 v[136:139], v[204:207], v[240:243], v[136:139]
 s_add_u32 m0, s80, 19456
 s_add_u32 s91, s78, 0x3c00
 buffer_load_dwordx4 v2, s[4:7], s91 offen sc1 lds
 v_mfma_f32_16x16x32_bf16 v[164:167], v[204:207], v[244:247], v[164:167]
 ds_read_b128 v[200:203], v26 offset:45056
 v_mul_f32 v103, v75, v59
 v_mul_f32 v75, v75, v49
 v_mfma_f32_16x16x32_bf16 v[140:143], v[208:211], v[240:243], v[140:143]
 v_mul_f32 v104, v76, v59
 v_mul_f32 v76, v76, v49
 v_mfma_f32_16x16x32_bf16 v[168:171], v[208:211], v[244:247], v[168:171]
 ds_read_b128 v[204:207], v26 offset:46080
 v_mul_f32 v105, v77, v59
 v_mul_f32 v77, v77, v49
 v_mfma_f32_16x16x32_bf16 v[144:147], v[212:215], v[240:243], v[144:147]
 buffer_load_dwordx4 v[236:239], v2, s[4:7], s85 offen offset:3072 sc1
 v_mul_f32 v106, v78, v59
 v_mfma_f32_16x16x32_bf16 v[172:175], v[212:215], v[244:247], v[172:175]
 ds_read_b128 v[208:211], v26 offset:47104
 v_mul_f32 v78, v78, v49
 v_mul_f32 v107, v79, v59
 v_mfma_f32_16x16x32_bf16 v[148:151], v[184:187], v[240:243], v[148:151]
 v_mul_f32 v79, v79, v49
 v_mul_f32 v108, v80, v59
 v_mfma_f32_16x16x32_bf16 v[176:179], v[184:187], v[244:247], v[176:179]
 s_add_u32 m0, s80, 32768
 s_add_u32 s91, s78, 0x4c00
 buffer_load_dwordx4 v2, s[4:7], s91 offen sc1 lds
 ds_read_b128 v[212:215], v26 offset:48128
 s_waitcnt lgkmcnt(3)
 v_mfma_f32_16x16x32_bf16 v[152:155], v[188:191], v[240:243], v[152:155]
 v_mul_f32 v80, v80, v49
 v_mul_f32 v109, v81, v59
 v_mul_f32 v81, v81, v49
 v_mfma_f32_16x16x32_bf16 v[180:183], v[188:191], v[244:247], v[180:183]
 ds_read_b128 v[184:187], v26 offset:49152
 v_mul_f32 v110, v82, v59
 s_waitcnt vmcnt(15)
 v_mfma_f32_16x16x32_bf16 v[128:131], v[192:195], v[248:251], v[128:131]
 s_add_u32 s85, s73, 0x1000
 buffer_load_dwordx4 v[240:243], v2, s[4:7], s85 offen sc1
 v_mul_f32 v82, v82, v49
 s_waitcnt vmcnt(14)
 v_mfma_f32_16x16x32_bf16 v[156:159], v[192:195], v[252:255], v[156:159]
 ds_read_b128 v[188:191], v26 offset:50176
 v_mul_f32 v111, v83, v59
 v_mul_f32 v83, v83, v49
 v_mfma_f32_16x16x32_bf16 v[132:135], v[196:199], v[248:251], v[132:135]
 v_mul_f32 v112, v84, v59
 v_mul_f32 v84, v84, v49
 v_mfma_f32_16x16x32_bf16 v[160:163], v[196:199], v[252:255], v[160:163]
 ds_read_b128 v[192:195], v26 offset:51200
 v_mul_f32 v113, v85, v59
 v_mul_f32 v85, v85, v49
 v_mfma_f32_16x16x32_bf16 v[136:139], v[200:203], v[248:251], v[136:139]
 s_add_u32 m0, s80, 33792
 s_add_u32 s91, s78, 0x5c00
 buffer_load_dwordx4 v2, s[4:7], s91 offen sc1 lds
 s_mov_b64 exec, 0xfffc000
 s_mov_b32 s87, 0x400000
 buffer_load_dword v0, v8, s[4:7], s87 offen
 s_mov_b64 exec, -1
 v_mfma_f32_16x16x32_bf16 v[164:167], v[200:203], v[252:255], v[164:167]
 ds_read_b128 v[196:199], v26 offset:52224
 s_waitcnt lgkmcnt(3)
 v_mfma_f32_16x16x32_bf16 v[140:143], v[204:207], v[248:251], v[140:143]
 v_mul_f32 v114, v86, v59
 v_mul_f32 v86, v86, v49
 v_mfma_f32_16x16x32_bf16 v[168:171], v[204:207], v[252:255], v[168:171]
 ds_read_b128 v[200:203], v26 offset:53248
 v_mul_f32 v115, v87, v59
 v_mul_f32 v87, v87, v49
 v_mfma_f32_16x16x32_bf16 v[144:147], v[208:211], v[248:251], v[144:147]
 buffer_load_dwordx4 v[244:247], v2, s[4:7], s85 offen offset:1024 sc1
 v_mul_f32 v116, v88, v59
 v_mfma_f32_16x16x32_bf16 v[172:175], v[208:211], v[252:255], v[172:175]
 ds_read_b128 v[204:207], v26 offset:54272
 v_mul_f32 v88, v88, v49
 v_mfma_f32_16x16x32_bf16 v[148:151], v[212:215], v[248:251], v[148:151]
 v_mul_f32 v117, v89, v59
 v_mul_f32 v89, v89, v49
 v_mul_f32 v118, v90, v59
 v_mfma_f32_16x16x32_bf16 v[176:179], v[212:215], v[252:255], v[176:179]
 s_add_u32 m0, s80, 34816
 s_add_u32 s91, s78, 0x6c00
 buffer_load_dwordx4 v2, s[4:7], s91 offen sc1 lds
 ds_read_b128 v[208:211], v26 offset:55296
 v_mfma_f32_16x16x32_bf16 v[152:155], v[184:187], v[248:251], v[152:155]
 v_mul_f32 v90, v90, v49
 v_mul_f32 v119, v91, v59
 v_mfma_f32_16x16x32_bf16 v[180:183], v[184:187], v[252:255], v[180:183]
 ds_read_b128 v[212:215], v26 offset:56320
 v_mul_f32 v91, v91, v49
 s_waitcnt vmcnt(16) lgkmcnt(4)
 v_mfma_f32_16x16x32_bf16 v[128:131], v[188:191], v[216:219], v[128:131]
 buffer_load_dwordx4 v[248:251], v2, s[4:7], s85 offen offset:2048 sc1
 v_mul_f32 v120, v92, v59
 s_waitcnt vmcnt(15)
 v_mfma_f32_16x16x32_bf16 v[156:159], v[188:191], v[220:223], v[156:159]
 ds_read_b128 v[184:187], v2
 v_mul_f32 v92, v92, v49
 v_mul_f32 v121, v93, v59
 v_mfma_f32_16x16x32_bf16 v[132:135], v[192:195], v[216:219], v[132:135]
 v_mul_f32 v93, v93, v49
 v_mul_f32 v122, v94, v59
 v_mfma_f32_16x16x32_bf16 v[160:163], v[192:195], v[220:223], v[160:163]
 ds_read_b128 v[188:191], v2 offset:1024
 v_mul_f32 v94, v94, v49
 v_mfma_f32_16x16x32_bf16 v[136:139], v[196:199], v[216:219], v[136:139]
 s_add_u32 m0, s80, 35840
 s_add_u32 s91, s78, 0x7c00
 buffer_load_dwordx4 v2, s[4:7], s91 offen sc1 lds
 v_mul_f32 v123, v95, v59
 v_mfma_f32_16x16x32_bf16 v[164:167], v[196:199], v[220:223], v[164:167]
 ds_read_b128 v[192:195], v2 offset:2048
 v_mul_f32 v95, v95, v49
 s_waitcnt lgkmcnt(3)
 v_mfma_f32_16x16x32_bf16 v[140:143], v[200:203], v[216:219], v[140:143]
 v_mul_f32 v124, v96, v59
 v_mul_f32 v96, v96, v49
 v_mfma_f32_16x16x32_bf16 v[168:171], v[200:203], v[220:223], v[168:171]
 ds_read_b128 v[196:199], v2 offset:3072
 v_mul_f32 v125, v97, v59
 v_mfma_f32_16x16x32_bf16 v[144:147], v[204:207], v[216:219], v[144:147]
 buffer_load_dwordx4 v[252:255], v2, s[4:7], s85 offen offset:3072 sc1
 v_mul_f32 v97, v97, v49
 v_mfma_f32_16x16x32_bf16 v[172:175], v[204:207], v[220:223], v[172:175]
 ds_read_b128 v[200:203], v2 offset:4096
 v_mul_f32 v126, v98, v59
 v_mul_f32 v98, v98, v49
 v_mfma_f32_16x16x32_bf16 v[148:151], v[208:211], v[216:219], v[148:151]
 v_mul_f32 v127, v99, v59
 v_mfma_f32_16x16x32_bf16 v[176:179], v[208:211], v[220:223], v[176:179]
 ds_read_b128 v[204:207], v2 offset:5120
 v_mul_f32 v99, v99, v49
 v_mfma_f32_16x16x32_bf16 v[152:155], v[212:215], v[216:219], v[152:155]
 v_mfma_f32_16x16x32_bf16 v[180:183], v[212:215], v[220:223], v[180:183]
 ds_read_b128 v[208:211], v2 offset:6144
 s_waitcnt vmcnt(15) lgkmcnt(4)
 v_mfma_f32_16x16x32_bf16 v[72:75], v[184:187], v[224:227], v[72:75]
 s_add_u32 s85, s73, 0x2000
 buffer_load_dwordx4 v[216:219], v2, s[4:7], s85 offen sc1
 s_waitcnt vmcnt(14)
 v_mfma_f32_16x16x32_bf16 v[100:103], v[184:187], v[228:231], v[100:103]
 ds_read_b128 v[212:215], v2 offset:7168
 v_mfma_f32_16x16x32_bf16 v[76:79], v[188:191], v[224:227], v[76:79]
 v_mfma_f32_16x16x32_bf16 v[104:107], v[188:191], v[228:231], v[104:107]
 ds_read_b128 v[184:187], v2 offset:8192
 v_mfma_f32_16x16x32_bf16 v[80:83], v[192:195], v[224:227], v[80:83]
 s_add_u32 m0, s80, 0
 s_add_u32 s91, s78, 0x9800
 buffer_load_dwordx4 v2, s[4:7], s91 offen sc1 lds
 v_permlane32_swap_b32 v152, v180
 v_mfma_f32_16x16x32_bf16 v[108:111], v[192:195], v[228:231], v[108:111]
 ds_read_b128 v[188:191], v2 offset:9216
 v_permlane32_swap_b32 v153, v181
 v_permlane32_swap_b32 v154, v182
 s_waitcnt lgkmcnt(4)
 v_mfma_f32_16x16x32_bf16 v[84:87], v[196:199], v[224:227], v[84:87]
 v_permlane32_swap_b32 v155, v183
 s_add_u32 s90, s75, 0x0
 v_mul_f32 v60, v152, v152
 v_mfma_f32_16x16x32_bf16 v[112:115], v[196:199], v[228:231], v[112:115]
 ds_read_b128 v[192:195], v2 offset:10240
 v_mul_f32 v61, v153, v153
 v_mfma_f32_16x16x32_bf16 v[88:91], v[200:203], v[224:227], v[88:91]
 buffer_load_dwordx4 v[220:223], v2, s[4:7], s85 offen offset:1024 sc1
 v_mul_f32 v62, v154, v154
 v_mfma_f32_16x16x32_bf16 v[116:119], v[200:203], v[228:231], v[116:119]
 ds_read_b128 v[196:199], v2 offset:11264
 v_mul_f32 v63, v155, v155
 v_fma_f32 v60, v60, v47, v46
 v_mfma_f32_16x16x32_bf16 v[92:95], v[204:207], v[224:227], v[92:95]
 v_fma_f32 v61, v61, v47, v46
 v_fma_f32 v62, v62, v47, v46
 v_mfma_f32_16x16x32_bf16 v[120:123], v[204:207], v[228:231], v[120:123]
 ds_read_b128 v[200:203], v2 offset:12288
 v_fma_f32 v63, v63, v47, v46
 s_waitcnt lgkmcnt(3)
 v_mfma_f32_16x16x32_bf16 v[96:99], v[208:211], v[224:227], v[96:99]
 v_mul_f32 v60, v60, v152
 v_mul_f32 v61, v61, v153
 v_mfma_f32_16x16x32_bf16 v[124:127], v[208:211], v[228:231], v[124:127]
 ds_read_b128 v[204:207], v2 offset:13312
 v_mul_f32 v62, v62, v154
 v_mul_f32 v63, v63, v155
 s_waitcnt vmcnt(14)
 v_mfma_f32_16x16x32_bf16 v[72:75], v[212:215], v[232:235], v[72:75]
 buffer_load_dwordx4 v[224:227], v2, s[4:7], s85 offen offset:2048 sc1
 v_exp_f32 v60, v60
 s_waitcnt vmcnt(13)
 v_mfma_f32_16x16x32_bf16 v[100:103], v[212:215], v[236:239], v[100:103]
 ds_read_b128 v[208:211], v2 offset:14336
 v_mfma_f32_16x16x32_bf16 v[76:79], v[184:187], v[232:235], v[76:79]
 v_mul_f32 v64, v152, v180
 v_exp_f32 v61, v61
 v_mfma_f32_16x16x32_bf16 v[104:107], v[184:187], v[236:239], v[104:107]
 ds_read_b128 v[212:215], v2 offset:15360
 v_mul_f32 v65, v153, v181
 v_mfma_f32_16x16x32_bf16 v[80:83], v[188:191], v[232:235], v[80:83]
 s_add_u32 m0, s80, 1024
 s_add_u32 s91, s78, 0x9c00
 buffer_load_dwordx4 v2, s[4:7], s91 offen sc1 lds
 v_mfma_f32_16x16x32_bf16 v[108:111], v[188:191], v[236:239], v[108:111]
 ds_read_b128 v[184:187], v2 offset:16384
 v_exp_f32 v62, v62
 s_waitcnt lgkmcnt(3)
 v_mfma_f32_16x16x32_bf16 v[84:87], v[192:195], v[232:235], v[84:87]
 v_mul_f32 v66, v154, v182
 v_exp_f32 v63, v63
 v_mfma_f32_16x16x32_bf16 v[112:115], v[192:195], v[236:239], v[112:115]
 ds_read_b128 v[188:191], v2 offset:17408
 v_mfma_f32_16x16x32_bf16 v[88:91], v[196:199], v[232:235], v[88:91]
 buffer_load_dwordx4 v[228:231], v2, s[4:7], s85 offen offset:3072 sc1
 v_mul_f32 v67, v155, v183
 v_fma_f32 v60, v60, v48, v48
 v_mfma_f32_16x16x32_bf16 v[116:119], v[196:199], v[236:239], v[116:119]
 ds_read_b128 v[192:195], v2 offset:18432
 v_rcp_f32 v60, v60
 v_mfma_f32_16x16x32_bf16 v[92:95], v[200:203], v[232:235], v[92:95]
 v_fma_f32 v61, v61, v48, v48
 v_mfma_f32_16x16x32_bf16 v[120:123], v[200:203], v[236:239], v[120:123]
 ds_read_b128 v[196:199], v2 offset:19456
 v_rcp_f32 v61, v61
 v_mfma_f32_16x16x32_bf16 v[96:99], v[204:207], v[232:235], v[96:99]
 v_fma_f32 v62, v62, v48, v48
 v_mfma_f32_16x16x32_bf16 v[124:127], v[204:207], v[236:239], v[124:127]
 ds_read_b128 v[200:203], v2 offset:20480
 v_rcp_f32 v62, v62
 s_waitcnt vmcnt(13) lgkmcnt(4)
 v_mfma_f32_16x16x32_bf16 v[72:75], v[208:211], v[240:243], v[72:75]
 s_add_u32 s85, s73, 0x3000
 buffer_load_dwordx4 v[232:235], v2, s[4:7], s85 offen sc1
 v_fma_f32 v63, v63, v48, v48
 s_waitcnt vmcnt(11)
 v_mfma_f32_16x16x32_bf16 v[100:103], v[208:211], v[244:247], v[100:103]
 ds_read_b128 v[204:207], v2 offset:21504
 v_rcp_f32 v63, v63
 v_mfma_f32_16x16x32_bf16 v[76:79], v[212:215], v[240:243], v[76:79]
 v_mul_f32 v60, v60, v64
 v_mfma_f32_16x16x32_bf16 v[104:107], v[212:215], v[244:247], v[104:107]
 ds_read_b128 v[208:211], v2 offset:22528
 v_mul_f32 v61, v61, v65
 v_mul_f32 v62, v62, v66
 v_mfma_f32_16x16x32_bf16 v[80:83], v[184:187], v[240:243], v[80:83]
 s_add_u32 m0, s80, 2048
 s_add_u32 s91, s78, 0xa000
 buffer_load_dwordx4 v2, s[4:7], s91 offen sc1 lds
 v_mfma_f32_16x16x32_bf16 v[108:111], v[184:187], v[244:247], v[108:111]
 ds_read_b128 v[212:215], v2 offset:23552
 v_mul_f32 v63, v63, v67
 v_cvt_pk_bf16_f32 v68, v60, v61
 s_waitcnt lgkmcnt(3)
 v_mfma_f32_16x16x32_bf16 v[84:87], v[188:191], v[240:243], v[84:87]
 v_cvt_pk_bf16_f32 v69, v62, v63
 buffer_store_dwordx2 v[68:69], v28, s[4:7], s90 offen offset:1536 sc1
 v_mfma_f32_16x16x32_bf16 v[112:115], v[188:191], v[244:247], v[112:115]
 ds_read_b128 v[184:187], v2 offset:24576
 s_add_u32 s91, s78, 0x7000
 buffer_load_dwordx4 v[152:155], v2, s[4:7], s91 offen offset:1024 sc1
 v_mfma_f32_16x16x32_bf16 v[88:91], v[192:195], v[240:243], v[88:91]
 buffer_load_dwordx4 v[236:239], v2, s[4:7], s85 offen offset:1024 sc1
 s_add_u32 s90, s75, 0xe000
 v_mul_f32 v60, v128, v128
 v_mfma_f32_16x16x32_bf16 v[116:119], v[192:195], v[244:247], v[116:119]
 ds_read_b128 v[188:191], v2 offset:25600
 v_mul_f32 v61, v129, v129
 v_mfma_f32_16x16x32_bf16 v[92:95], v[196:199], v[240:243], v[92:95]
 v_mul_f32 v62, v130, v130
 v_mul_f32 v63, v131, v131
 v_fma_f32 v60, v60, v42, v40
 v_mfma_f32_16x16x32_bf16 v[120:123], v[196:199], v[244:247], v[120:123]
 ds_read_b128 v[192:195], v2 offset:26624
 v_fma_f32 v61, v61, v42, v40
 v_mfma_f32_16x16x32_bf16 v[96:99], v[200:203], v[240:243], v[96:99]
 v_fma_f32 v62, v62, v42, v40
 v_fma_f32 v63, v63, v42, v40
 v_mfma_f32_16x16x32_bf16 v[124:127], v[200:203], v[244:247], v[124:127]
 ds_read_b128 v[196:199], v2 offset:27648
 v_mul_f32 v60, v60, v128
 s_waitcnt vmcnt(13) lgkmcnt(4)
 v_mfma_f32_16x16x32_bf16 v[72:75], v[204:207], v[248:251], v[72:75]
 buffer_load_dwordx4 v[240:243], v2, s[4:7], s85 offen offset:2048 sc1
 v_mul_f32 v61, v61, v129
 v_mul_f32 v62, v62, v130
 s_waitcnt vmcnt(12)
 v_mfma_f32_16x16x32_bf16 v[100:103], v[204:207], v[252:255], v[100:103]
 ds_read_b128 v[200:203], v2 offset:28672
 v_mul_f32 v63, v63, v131
 v_mfma_f32_16x16x32_bf16 v[76:79], v[208:211], v[248:251], v[76:79]
 v_exp_f32 v60, v60
 v_mfma_f32_16x16x32_bf16 v[104:107], v[208:211], v[252:255], v[104:107]
 ds_read_b128 v[204:207], v2 offset:29696
 v_mul_f32 v64, v128, v132
 v_mfma_f32_16x16x32_bf16 v[80:83], v[212:215], v[248:251], v[80:83]
 s_add_u32 m0, s80, 3072
 s_add_u32 s91, s78, 0xa400
 buffer_load_dwordx4 v2, s[4:7], s91 offen sc1 lds
 v_exp_f32 v61, v61
 v_mfma_f32_16x16x32_bf16 v[108:111], v[212:215], v[252:255], v[108:111]
 ds_read_b128 v[208:211], v2 offset:30720
 s_waitcnt lgkmcnt(3)
 v_mfma_f32_16x16x32_bf16 v[84:87], v[184:187], v[248:251], v[84:87]
 v_mul_f32 v65, v129, v133
 v_exp_f32 v62, v62
 v_mfma_f32_16x16x32_bf16 v[112:115], v[184:187], v[252:255], v[112:115]
 ds_read_b128 v[212:215], v2 offset:31744
 s_add_u32 s91, s78, 0x9000
 buffer_load_dwordx4 v[180:183], v2, s[4:7], s91 offen offset:1024 sc1
 v_mfma_f32_16x16x32_bf16 v[88:91], v[188:191], v[248:251], v[88:91]
 buffer_load_dwordx4 v[244:247], v2, s[4:7], s85 offen offset:3072 sc1
 v_mul_f32 v66, v130, v134
 v_mfma_f32_16x16x32_bf16 v[116:119], v[188:191], v[252:255], v[116:119]
 ds_read_b128 v[184:187], v2 offset:32768
 v_exp_f32 v63, v63
 v_mfma_f32_16x16x32_bf16 v[92:95], v[192:195], v[248:251], v[92:95]
 v_mul_f32 v67, v131, v135
 v_fma_f32 v60, v60, v44, v44
 v_mfma_f32_16x16x32_bf16 v[120:123], v[192:195], v[252:255], v[120:123]
 ds_read_b128 v[188:191], v2 offset:33792
 v_mfma_f32_16x16x32_bf16 v[96:99], v[196:199], v[248:251], v[96:99]
 v_rcp_f32 v60, v60
 v_fma_f32 v61, v61, v44, v44
 v_mfma_f32_16x16x32_bf16 v[124:127], v[196:199], v[252:255], v[124:127]
 ds_read_b128 v[192:195], v2 offset:34816
 v_rcp_f32 v61, v61
 s_waitcnt vmcnt(14) lgkmcnt(4)
 v_mfma_f32_16x16x32_bf16 v[72:75], v[200:203], v[216:219], v[72:75]
 s_add_u32 s85, s73, 0x4000
 buffer_load_dwordx4 v[248:251], v2, s[4:7], s85 offen sc1
 s_waitcnt vmcnt(13)
 v_mfma_f32_16x16x32_bf16 v[100:103], v[200:203], v[220:223], v[100:103]
 ds_read_b128 v[196:199], v2 offset:35840
 v_fma_f32 v62, v62, v44, v44
 v_mfma_f32_16x16x32_bf16 v[76:79], v[204:207], v[216:219], v[76:79]
 v_rcp_f32 v62, v62
 v_fma_f32 v63, v63, v44, v44
 v_mfma_f32_16x16x32_bf16 v[104:107], v[204:207], v[220:223], v[104:107]
 ds_read_b128 v[200:203], v2 offset:36864
 v_mfma_f32_16x16x32_bf16 v[80:83], v[208:211], v[216:219], v[80:83]
 v_rcp_f32 v63, v63
 v_mul_f32 v60, v60, v64
 v_mfma_f32_16x16x32_bf16 v[108:111], v[208:211], v[220:223], v[108:111]
 ds_read_b128 v[204:207], v2 offset:37888
 v_mul_f32 v61, v61, v65
 s_waitcnt lgkmcnt(3)
 v_mfma_f32_16x16x32_bf16 v[84:87], v[212:215], v[216:219], v[84:87]
 v_mul_f32 v62, v62, v66
 v_mul_f32 v63, v63, v67
 v_mfma_f32_16x16x32_bf16 v[112:115], v[212:215], v[220:223], v[112:115]
 ds_read_b128 v[208:211], v2 offset:38912
 v_cvt_pk_bf16_f32 v34, v60, v61
 v_cvt_pk_bf16_f32 v35, v62, v63
 v_mfma_f32_16x16x32_bf16 v[88:91], v[184:187], v[216:219], v[88:91]
 buffer_load_dwordx4 v[252:255], v2, s[4:7], s85 offen offset:1024 sc1
 s_add_u32 s91, s78, 0x5000
 buffer_load_dwordx4 v[128:131], v2, s[4:7], s91 offen offset:1024 sc1
 v_mfma_f32_16x16x32_bf16 v[116:119], v[184:187], v[220:223], v[116:119]
 ds_read_b128 v[212:215], v2 offset:39936
 v_mul_f32 v60, v136, v136
 v_mfma_f32_16x16x32_bf16 v[92:95], v[188:191], v[216:219], v[92:95]
 v_mul_f32 v61, v137, v137
 v_mul_f32 v62, v138, v138
 v_mfma_f32_16x16x32_bf16 v[120:123], v[188:191], v[220:223], v[120:123]
 ds_read_b128 v[184:187], v2 offset:40960
 v_mul_f32 v63, v139, v139
 v_mfma_f32_16x16x32_bf16 v[96:99], v[192:195], v[216:219], v[96:99]
 v_fma_f32 v60, v60, v42, v40
 v_fma_f32 v61, v61, v42, v40
 v_fma_f32 v62, v62, v42, v40
 v_mfma_f32_16x16x32_bf16 v[124:127], v[192:195], v[220:223], v[124:127]
 ds_read_b128 v[188:191], v2 offset:41984
 v_fma_f32 v63, v63, v42, v40
 s_waitcnt vmcnt(14) lgkmcnt(4)
 v_mfma_f32_16x16x32_bf16 v[72:75], v[196:199], v[224:227], v[72:75]
 buffer_load_dwordx4 v[216:219], v2, s[4:7], s85 offen offset:2048 sc1
 v_mul_f32 v60, v60, v136
 s_waitcnt vmcnt(13)
 v_mfma_f32_16x16x32_bf16 v[100:103], v[196:199], v[228:231], v[100:103]
 ds_read_b128 v[192:195], v2 offset:43008
 v_mul_f32 v61, v61, v137
 v_mfma_f32_16x16x32_bf16 v[76:79], v[200:203], v[224:227], v[76:79]
 v_mul_f32 v62, v62, v138
 v_mul_f32 v63, v63, v139
 v_mfma_f32_16x16x32_bf16 v[104:107], v[200:203], v[228:231], v[104:107]
 ds_read_b128 v[196:199], v2 offset:44032
 v_exp_f32 v60, v60
 v_mfma_f32_16x16x32_bf16 v[80:83], v[204:207], v[224:227], v[80:83]
 v_mul_f32 v64, v136, v140
 v_exp_f32 v61, v61
 v_mfma_f32_16x16x32_bf16 v[108:111], v[204:207], v[228:231], v[108:111]
 ds_read_b128 v[200:203], v2 offset:45056
 s_waitcnt lgkmcnt(3)
 v_mfma_f32_16x16x32_bf16 v[84:87], v[208:211], v[224:227], v[84:87]
 v_mul_f32 v65, v137, v141
 v_exp_f32 v62, v62
 v_mfma_f32_16x16x32_bf16 v[112:115], v[208:211], v[228:231], v[112:115]
 ds_read_b128 v[204:207], v2 offset:46080
 v_mul_f32 v66, v138, v142
 v_mfma_f32_16x16x32_bf16 v[88:91], v[212:215], v[224:227], v[88:91]
 buffer_load_dwordx4 v[220:223], v2, s[4:7], s85 offen offset:3072 sc1
 s_add_u32 s91, s78, 0x5000
 buffer_load_dwordx4 v[132:135], v2, s[4:7], s91 offen offset:2048 sc1
 v_mfma_f32_16x16x32_bf16 v[116:119], v[212:215], v[228:231], v[116:119]
 ds_read_b128 v[208:211], v2 offset:47104
 v_exp_f32 v63, v63
 v_mfma_f32_16x16x32_bf16 v[92:95], v[184:187], v[224:227], v[92:95]
 v_mul_f32 v67, v139, v143
 v_mfma_f32_16x16x32_bf16 v[120:123], v[184:187], v[228:231], v[120:123]
 ds_read_b128 v[212:215], v2 offset:48128
 v_fma_f32 v60, v60, v44, v44
 v_mfma_f32_16x16x32_bf16 v[96:99], v[188:191], v[224:227], v[96:99]
 v_rcp_f32 v60, v60
 v_fma_f32 v61, v61, v44, v44
 v_mfma_f32_16x16x32_bf16 v[124:127], v[188:191], v[228:231], v[124:127]
 ds_read_b128 v[184:187], v2 offset:49152
 s_waitcnt vmcnt(14) lgkmcnt(4)
 v_mfma_f32_16x16x32_bf16 v[72:75], v[192:195], v[232:235], v[72:75]
 s_add_u32 s85, s73, 0x5000
 buffer_load_dwordx4 v[224:227], v2, s[4:7], s85 offen sc1
 v_rcp_f32 v61, v61
 s_waitcnt vmcnt(11)
 v_mfma_f32_16x16x32_bf16 v[100:103], v[192:195], v[236:239], v[100:103]
 ds_read_b128 v[188:191], v2 offset:50176
 v_fma_f32 v62, v62, v44, v44
 v_mfma_f32_16x16x32_bf16 v[76:79], v[196:199], v[232:235], v[76:79]
 v_rcp_f32 v62, v62
 v_mfma_f32_16x16x32_bf16 v[104:107], v[196:199], v[236:239], v[104:107]
 ds_read_b128 v[192:195], v2 offset:51200
 v_fma_f32 v63, v63, v44, v44
 v_mfma_f32_16x16x32_bf16 v[80:83], v[200:203], v[232:235], v[80:83]
 v_rcp_f32 v63, v63
 v_mfma_f32_16x16x32_bf16 v[108:111], v[200:203], v[236:239], v[108:111]
 ds_read_b128 v[196:199], v2 offset:52224
 v_mul_f32 v60, v60, v64
 v_mul_f32 v61, v61, v65
 s_waitcnt lgkmcnt(3)
 v_mfma_f32_16x16x32_bf16 v[84:87], v[204:207], v[232:235], v[84:87]
 v_mul_f32 v62, v62, v66
 v_mul_f32 v63, v63, v67
 v_mfma_f32_16x16x32_bf16 v[112:115], v[204:207], v[236:239], v[112:115]
 ds_read_b128 v[200:203], v2 offset:53248
 v_cvt_pk_bf16_f32 v36, v60, v61
 v_mfma_f32_16x16x32_bf16 v[88:91], v[208:211], v[232:235], v[88:91]
 buffer_load_dwordx4 v[228:231], v2, s[4:7], s85 offen offset:1024 sc1
 v_cvt_pk_bf16_f32 v37, v62, v63
 v_mfma_f32_16x16x32_bf16 v[116:119], v[208:211], v[236:239], v[116:119]
 ds_read_b128 v[204:207], v2 offset:54272
 buffer_store_dwordx4 v[34:37], v2, s[4:7], s90 offen sc1
 v_mfma_f32_16x16x32_bf16 v[92:95], v[212:215], v[232:235], v[92:95]
 s_add_u32 s91, s78, 0x6000
 buffer_load_dwordx4 v[136:139], v2, s[4:7], s91 offen sc1
 v_mul_f32 v60, v144, v144
 v_mul_f32 v61, v145, v145
 v_mfma_f32_16x16x32_bf16 v[120:123], v[212:215], v[236:239], v[120:123]
 ds_read_b128 v[208:211], v2 offset:55296
 v_mul_f32 v62, v146, v146
 v_mfma_f32_16x16x32_bf16 v[96:99], v[184:187], v[232:235], v[96:99]
 v_mul_f32 v63, v147, v147
 v_fma_f32 v60, v60, v42, v40
 v_mfma_f32_16x16x32_bf16 v[124:127], v[184:187], v[236:239], v[124:127]
 ds_read_b128 v[212:215], v2 offset:56320
 v_fma_f32 v61, v61, v42, v40
 s_waitcnt vmcnt(13) lgkmcnt(4)
 v_mfma_f32_16x16x32_bf16 v[72:75], v[188:191], v[240:243], v[72:75]
 buffer_load_dwordx4 v[232:235], v2, s[4:7], s85 offen offset:2048 sc1
 v_fma_f32 v62, v62, v42, v40
 s_waitcnt vmcnt(11)
 v_mfma_f32_16x16x32_bf16 v[100:103], v[188:191], v[244:247], v[100:103]
 ds_read_b128 v[184:187], v26
 v_fma_f32 v63, v63, v42, v40
 v_mul_f32 v60, v60, v144
 v_mfma_f32_16x16x32_bf16 v[76:79], v[192:195], v[240:243], v[76:79]
 v_mul_f32 v61, v61, v145
 v_mul_f32 v62, v62, v146
 v_mfma_f32_16x16x32_bf16 v[104:107], v[192:195], v[244:247], v[104:107]
 ds_read_b128 v[188:191], v26 offset:1024
 v_mul_f32 v63, v63, v147
 v_mfma_f32_16x16x32_bf16 v[80:83], v[196:199], v[240:243], v[80:83]
 v_exp_f32 v60, v60
 v_mfma_f32_16x16x32_bf16 v[108:111], v[196:199], v[244:247], v[108:111]
 ds_read_b128 v[192:195], v26 offset:2048
 v_mul_f32 v64, v144, v148
 s_waitcnt lgkmcnt(3)
 v_mfma_f32_16x16x32_bf16 v[84:87], v[200:203], v[240:243], v[84:87]
 v_exp_f32 v61, v61
 v_mul_f32 v65, v145, v149
 v_mfma_f32_16x16x32_bf16 v[112:115], v[200:203], v[244:247], v[112:115]
 ds_read_b128 v[196:199], v26 offset:3072
 v_mfma_f32_16x16x32_bf16 v[88:91], v[204:207], v[240:243], v[88:91]
 buffer_load_dwordx4 v[236:239], v2, s[4:7], s85 offen offset:3072 sc1
 v_exp_f32 v62, v62
 v_mfma_f32_16x16x32_bf16 v[116:119], v[204:207], v[244:247], v[116:119]
 ds_read_b128 v[200:203], v26 offset:4096
 v_mul_f32 v66, v146, v150
 v_mfma_f32_16x16x32_bf16 v[92:95], v[208:211], v[240:243], v[92:95]
 s_add_u32 s91, s78, 0x6000
 buffer_load_dwordx4 v[140:143], v2, s[4:7], s91 offen offset:1024 sc1
 v_mfma_f32_16x16x32_bf16 v[120:123], v[208:211], v[244:247], v[120:123]
 ds_read_b128 v[204:207], v26 offset:5120
 v_exp_f32 v63, v63
 v_mfma_f32_16x16x32_bf16 v[96:99], v[212:215], v[240:243], v[96:99]
 v_mul_f32 v67, v147, v151
 v_fma_f32 v60, v60, v44, v44
 v_mfma_f32_16x16x32_bf16 v[124:127], v[212:215], v[244:247], v[124:127]
 ds_read_b128 v[208:211], v26 offset:6144
 v_rcp_f32 v60, v60
 s_waitcnt vmcnt(12) lgkmcnt(4)
 v_mfma_f32_16x16x32_bf16 v[72:75], v[184:187], v[248:251], v[72:75]
 s_add_u32 s85, s73, 0x6000
 buffer_load_dwordx4 v[240:243], v2, s[4:7], s85 offen sc1
 s_waitcnt vmcnt(12)
 v_mfma_f32_16x16x32_bf16 v[100:103], v[184:187], v[252:255], v[100:103]
 ds_read_b128 v[212:215], v26 offset:7168
 v_fma_f32 v61, v61, v44, v44
 v_mfma_f32_16x16x32_bf16 v[76:79], v[188:191], v[248:251], v[76:79]
 v_rcp_f32 v61, v61
 v_fma_f32 v62, v62, v44, v44
 v_mfma_f32_16x16x32_bf16 v[104:107], v[188:191], v[252:255], v[104:107]
 ds_read_b128 v[184:187], v26 offset:8192
 v_mfma_f32_16x16x32_bf16 v[80:83], v[192:195], v[248:251], v[80:83]
 v_rcp_f32 v62, v62
 v_fma_f32 v63, v63, v44, v44
 v_mfma_f32_16x16x32_bf16 v[108:111], v[192:195], v[252:255], v[108:111]
 ds_read_b128 v[188:191], v26 offset:9216
 s_waitcnt lgkmcnt(4)
 v_mfma_f32_16x16x32_bf16 v[84:87], v[196:199], v[248:251], v[84:87]
 v_rcp_f32 v63, v63
 v_mul_f32 v60, v60, v64
 v_mfma_f32_16x16x32_bf16 v[112:115], v[196:199], v[252:255], v[112:115]
 ds_read_b128 v[192:195], v26 offset:10240
 v_mul_f32 v61, v61, v65
 v_mfma_f32_16x16x32_bf16 v[88:91], v[200:203], v[248:251], v[88:91]
 buffer_load_dwordx4 v[244:247], v2, s[4:7], s85 offen offset:1024 sc1
 v_mul_f32 v62, v62, v66
 v_mfma_f32_16x16x32_bf16 v[116:119], v[200:203], v[252:255], v[116:119]
 ds_read_b128 v[196:199], v26 offset:11264
 v_mul_f32 v63, v63, v67
 v_mfma_f32_16x16x32_bf16 v[92:95], v[204:207], v[248:251], v[92:95]
 v_cvt_pk_bf16_f32 v70, v60, v61
 v_cvt_pk_bf16_f32 v71, v62, v63
 buffer_store_dwordx2 v[70:71], v27, s[4:7], s90 offen offset:1024 sc1
 v_mfma_f32_16x16x32_bf16 v[120:123], v[204:207], v[252:255], v[120:123]
 ds_read_b128 v[200:203], v26 offset:12288
 s_add_u32 s91, s78, 0x6000
 buffer_load_dwordx4 v[144:147], v2, s[4:7], s91 offen offset:2048 sc1
 s_waitcnt lgkmcnt(4)
 v_mfma_f32_16x16x32_bf16 v[96:99], v[208:211], v[248:251], v[96:99]
 s_add_u32 s90, s75, 0x0
 v_mul_f32 v60, v156, v156
 v_mfma_f32_16x16x32_bf16 v[124:127], v[208:211], v[252:255], v[124:127]
 ds_read_b128 v[204:207], v26 offset:13312
 v_mul_f32 v61, v157, v157
 v_mul_f32 v62, v158, v158
 s_waitcnt vmcnt(13)
 v_mfma_f32_16x16x32_bf16 v[72:75], v[212:215], v[216:219], v[72:75]
 buffer_load_dwordx4 v[248:251], v2, s[4:7], s85 offen offset:2048 sc1
 v_mul_f32 v63, v159, v159
 s_waitcnt vmcnt(13)
 v_mfma_f32_16x16x32_bf16 v[100:103], v[212:215], v[220:223], v[100:103]
 ds_read_b128 v[208:211], v26 offset:14336
 v_fma_f32 v60, v60, v43, v41
 v_mfma_f32_16x16x32_bf16 v[76:79], v[184:187], v[216:219], v[76:79]
 v_fma_f32 v61, v61, v43, v41
 v_fma_f32 v62, v62, v43, v41
 v_mfma_f32_16x16x32_bf16 v[104:107], v[184:187], v[220:223], v[104:107]
 ds_read_b128 v[212:215], v26 offset:15360
 v_fma_f32 v63, v63, v43, v41
 s_waitcnt lgkmcnt(3)
 v_mfma_f32_16x16x32_bf16 v[80:83], v[188:191], v[216:219], v[80:83]
 v_mul_f32 v60, v60, v156
 v_mul_f32 v61, v61, v157
 v_mfma_f32_16x16x32_bf16 v[108:111], v[188:191], v[220:223], v[108:111]
 ds_read_b128 v[184:187], v26 offset:16384
 v_mul_f32 v62, v62, v158
 v_mul_f32 v63, v63, v159
 v_mfma_f32_16x16x32_bf16 v[84:87], v[192:195], v[216:219], v[84:87]
 v_exp_f32 v60, v60
 v_mfma_f32_16x16x32_bf16 v[112:115], v[192:195], v[220:223], v[112:115]
 ds_read_b128 v[188:191], v26 offset:17408
 v_mul_f32 v64, v156, v160
 v_mfma_f32_16x16x32_bf16 v[88:91], v[196:199], v[216:219], v[88:91]
 buffer_load_dwordx4 v[252:255], v2, s[4:7], s85 offen offset:3072 sc1
 v_exp_f32 v61, v61
 v_mfma_f32_16x16x32_bf16 v[116:119], v[196:199], v[220:223], v[116:119]
 ds_read_b128 v[192:195], v26 offset:18432
 v_mfma_f32_16x16x32_bf16 v[92:95], v[200:203], v[216:219], v[92:95]
 v_mul_f32 v65, v157, v161
 v_exp_f32 v62, v62
 v_mfma_f32_16x16x32_bf16 v[120:123], v[200:203], v[220:223], v[120:123]
 ds_read_b128 v[196:199], v26 offset:19456
 s_waitcnt lgkmcnt(4)
 v_mfma_f32_16x16x32_bf16 v[96:99], v[204:207], v[216:219], v[96:99]
 s_add_u32 s91, s78, 0x7000
 buffer_load_dwordx4 v[148:151], v2, s[4:7], s91 offen sc1
 v_mul_f32 v66, v158, v162
 v_mfma_f32_16x16x32_bf16 v[124:127], v[204:207], v[220:223], v[124:127]
 ds_read_b128 v[200:203], v26 offset:20480
 v_exp_f32 v63, v63
 s_waitcnt vmcnt(13)
 v_mfma_f32_16x16x32_bf16 v[72:75], v[208:211], v[224:227], v[72:75]
 s_add_u32 s85, s73, 0x7000
 buffer_load_dwordx4 v[216:219], v2, s[4:7], s85 offen sc1
 s_waitcnt vmcnt(13)
 v_mfma_f32_16x16x32_bf16 v[100:103], v[208:211], v[228:231], v[100:103]
 ds_read_b128 v[204:207], v26 offset:21504
 v_mul_f32 v67, v159, v163
 v_fma_f32 v60, v60, v45, v45
 v_mfma_f32_16x16x32_bf16 v[76:79], v[212:215], v[224:227], v[76:79]
 v_rcp_f32 v60, v60
 v_mfma_f32_16x16x32_bf16 v[104:107], v[212:215], v[228:231], v[104:107]
 ds_read_b128 v[208:211], v26 offset:22528
 v_fma_f32 v61, v61, v45, v45
 s_waitcnt lgkmcnt(3)
 v_mfma_f32_16x16x32_bf16 v[80:83], v[184:187], v[224:227], v[80:83]
 v_rcp_f32 v61, v61
 v_mfma_f32_16x16x32_bf16 v[108:111], v[184:187], v[228:231], v[108:111]
 ds_read_b128 v[212:215], v26 offset:23552
 v_fma_f32 v62, v62, v45, v45
 v_mfma_f32_16x16x32_bf16 v[84:87], v[188:191], v[224:227], v[84:87]
 v_rcp_f32 v62, v62
 v_mfma_f32_16x16x32_bf16 v[112:115], v[188:191], v[228:231], v[112:115]
 ds_read_b128 v[184:187], v26 offset:24576
 v_fma_f32 v63, v63, v45, v45
 v_mfma_f32_16x16x32_bf16 v[88:91], v[192:195], v[224:227], v[88:91]
 buffer_load_dwordx4 v[220:223], v2, s[4:7], s85 offen offset:1024 sc1
 v_rcp_f32 v63, v63
 v_mfma_f32_16x16x32_bf16 v[116:119], v[192:195], v[228:231], v[116:119]
 ds_read_b128 v[188:191], v26 offset:25600
 v_mul_f32 v60, v60, v64
 v_mfma_f32_16x16x32_bf16 v[92:95], v[196:199], v[224:227], v[92:95]
 v_and_b32 v30, 12, v6
 v_lshlrev_b32 v30, 5, v30
 v_lshrrev_b32 v31, 4, v6
 v_lshl_add_u32 v30, v31, 12, v30
 s_mov_b32 s86, 0x8b0000
 buffer_load_dword v3, v30, s[4:7], s86 offen offset:2560 sc1
 v_mul_f32 v61, v61, v65
 v_mul_f32 v62, v62, v66
 v_mfma_f32_16x16x32_bf16 v[120:123], v[196:199], v[228:231], v[120:123]
 ds_read_b128 v[192:195], v26 offset:26624
 v_mul_f32 v63, v63, v67
 s_waitcnt lgkmcnt(3)
 v_mfma_f32_16x16x32_bf16 v[96:99], v[200:203], v[224:227], v[96:99]
 v_cvt_pk_bf16_f32 v34, v60, v61
 v_cvt_pk_bf16_f32 v35, v62, v63
 v_mfma_f32_16x16x32_bf16 v[124:127], v[200:203], v[228:231], v[124:127]
 ds_read_b128 v[196:199], v26 offset:27648
 s_add_u32 s91, s78, 0x7000
 buffer_load_dwordx4 v[156:159], v2, s[4:7], s91 offen offset:2048 sc1
 s_waitcnt vmcnt(13)
 v_mfma_f32_16x16x32_bf16 v[72:75], v[204:207], v[232:235], v[72:75]
 buffer_load_dwordx4 v[224:227], v2, s[4:7], s85 offen offset:2048 sc1
 s_waitcnt vmcnt(13)
 v_mfma_f32_16x16x32_bf16 v[100:103], v[204:207], v[236:239], v[100:103]
 ds_read_b128 v[200:203], v26 offset:28672
 v_mov_b32 v5, 1
 s_waitcnt vmcnt(9)
 buffer_store_dword v5, off, s[4:7], s68 sc1
 v_mfma_f32_16x16x32_bf16 v[76:79], v[208:211], v[232:235], v[76:79]
 v_mul_f32 v60, v164, v164
 v_mfma_f32_16x16x32_bf16 v[104:107], v[208:211], v[236:239], v[104:107]
 ds_read_b128 v[204:207], v26 offset:29696
 v_mul_f32 v61, v165, v165
 v_mfma_f32_16x16x32_bf16 v[80:83], v[212:215], v[232:235], v[80:83]
 v_mul_f32 v62, v166, v166
 v_mul_f32 v63, v167, v167
 v_mfma_f32_16x16x32_bf16 v[108:111], v[212:215], v[236:239], v[108:111]
 ds_read_b128 v[208:211], v26 offset:30720
 v_fma_f32 v60, v60, v43, v41
 s_waitcnt lgkmcnt(4)
 v_mfma_f32_16x16x32_bf16 v[84:87], v[184:187], v[232:235], v[84:87]
 v_fma_f32 v61, v61, v43, v41
 v_fma_f32 v62, v62, v43, v41
 v_mfma_f32_16x16x32_bf16 v[112:115], v[184:187], v[236:239], v[112:115]
 ds_read_b128 v[212:215], v26 offset:31744
 v_fma_f32 v63, v63, v43, v41
 v_mfma_f32_16x16x32_bf16 v[88:91], v[188:191], v[232:235], v[88:91]
 buffer_load_dwordx4 v[228:231], v2, s[4:7], s85 offen offset:3072 sc1
 v_mul_f32 v60, v60, v164
 v_mul_f32 v61, v61, v165
 v_mfma_f32_16x16x32_bf16 v[116:119], v[188:191], v[236:239], v[116:119]
 ds_read_b128 v[184:187], v26 offset:32768
 v_mul_f32 v62, v62, v166
 v_mfma_f32_16x16x32_bf16 v[92:95], v[192:195], v[232:235], v[92:95]
 v_mul_f32 v63, v63, v167
 v_mfma_f32_16x16x32_bf16 v[120:123], v[192:195], v[236:239], v[120:123]
 ds_read_b128 v[188:191], v26 offset:33792
 v_exp_f32 v60, v60
 s_waitcnt lgkmcnt(4)
 v_mfma_f32_16x16x32_bf16 v[96:99], v[196:199], v[232:235], v[96:99]
 v_mul_f32 v64, v164, v168
 v_mfma_f32_16x16x32_bf16 v[124:127], v[196:199], v[236:239], v[124:127]
 ds_read_b128 v[192:195], v26 offset:34816
 v_exp_f32 v61, v61
 v_mfma_f32_16x16x32_bf16 v[72:75], v[200:203], v[240:243], v[72:75]
 v_mul_f32 v65, v165, v169
 v_mfma_f32_16x16x32_bf16 v[100:103], v[200:203], v[244:247], v[100:103]
 s_add_u32 s91, s78, 0xc000
 buffer_load_dwordx4 v[232:235], v2, s[4:7], s91 offen offset:2048 sc1
 ds_read_b128 v[196:199], v26 offset:35840
 v_exp_f32 v62, v62
 v_mfma_f32_16x16x32_bf16 v[76:79], v[204:207], v[240:243], v[76:79]
 v_mul_f32 v66, v166, v170
 s_add_u32 s91, s78, 0x8000
 buffer_load_dwordx4 v[160:163], v2, s[4:7], s91 offen sc1
 v_mfma_f32_16x16x32_bf16 v[104:107], v[204:207], v[244:247], v[104:107]
 ds_read_b128 v[200:203], v26 offset:36864
 s_waitcnt lgkmcnt(4)
 v_mfma_f32_16x16x32_bf16 v[80:83], v[208:211], v[240:243], v[80:83]
 v_exp_f32 v63, v63
 v_mul_f32 v67, v167, v171
 v_mfma_f32_16x16x32_bf16 v[108:111], v[208:211], v[244:247], v[108:111]
 ds_read_b128 v[204:207], v26 offset:37888
 v_fma_f32 v60, v60, v45, v45
 v_mfma_f32_16x16x32_bf16 v[84:87], v[212:215], v[240:243], v[84:87]
 v_rcp_f32 v60, v60
 v_mfma_f32_16x16x32_bf16 v[112:115], v[212:215], v[244:247], v[112:115]
 ds_read_b128 v[208:211], v26 offset:38912
 v_fma_f32 v61, v61, v45, v45
 v_mfma_f32_16x16x32_bf16 v[88:91], v[184:187], v[240:243], v[88:91]
 s_add_u32 s91, s78, 0xc000
 buffer_load_dwordx4 v[236:239], v2, s[4:7], s91 offen offset:3072 sc1
 v_rcp_f32 v61, v61
 v_mfma_f32_16x16x32_bf16 v[116:119], v[184:187], v[244:247], v[116:119]
 ds_read_b128 v[212:215], v26 offset:39936
 v_fma_f32 v62, v62, v45, v45
 s_waitcnt lgkmcnt(4)
 v_mfma_f32_16x16x32_bf16 v[92:95], v[188:191], v[240:243], v[92:95]
 v_rcp_f32 v62, v62
 v_mfma_f32_16x16x32_bf16 v[120:123], v[188:191], v[244:247], v[120:123]
 ds_read_b128 v[184:187], v26 offset:40960
 v_fma_f32 v63, v63, v45, v45
 v_mfma_f32_16x16x32_bf16 v[96:99], v[192:195], v[240:243], v[96:99]
 v_rcp_f32 v63, v63
 v_mfma_f32_16x16x32_bf16 v[124:127], v[192:195], v[244:247], v[124:127]
 ds_read_b128 v[188:191], v26 offset:41984
 v_mul_f32 v60, v60, v64
 s_waitcnt vmcnt(12)
 v_mfma_f32_16x16x32_bf16 v[72:75], v[196:199], v[248:251], v[72:75]
 v_mul_f32 v61, v61, v65
 v_mul_f32 v62, v62, v66
 s_waitcnt vmcnt(11)
 v_mfma_f32_16x16x32_bf16 v[100:103], v[196:199], v[252:255], v[100:103]
 s_add_u32 s91, s78, 0xd000
 buffer_load_dwordx4 v[240:243], v2, s[4:7], s91 offen sc1
 ds_read_b128 v[192:195], v26 offset:43008
 v_mul_f32 v63, v63, v67
 s_waitcnt lgkmcnt(3)
 v_mfma_f32_16x16x32_bf16 v[76:79], v[200:203], v[248:251], v[76:79]
 v_cvt_pk_bf16_f32 v36, v60, v61
 v_cvt_pk_bf16_f32 v37, v62, v63
 v_mfma_f32_16x16x32_bf16 v[104:107], v[200:203], v[252:255], v[104:107]
 ds_read_b128 v[196:199], v26 offset:44032
 buffer_store_dwordx4 v[34:37], v2, s[4:7], s90 offen sc1
 v_mfma_f32_16x16x32_bf16 v[80:83], v[204:207], v[248:251], v[80:83]
 s_add_u32 s91, s78, 0x8000
 buffer_load_dwordx4 v[164:167], v2, s[4:7], s91 offen offset:1024 sc1
 v_mul_f32 v60, v172, v172
 v_mfma_f32_16x16x32_bf16 v[108:111], v[204:207], v[252:255], v[108:111]
 ds_read_b128 v[200:203], v26 offset:45056
 v_mul_f32 v61, v173, v173
 v_mfma_f32_16x16x32_bf16 v[84:87], v[208:211], v[248:251], v[84:87]
 v_mul_f32 v62, v174, v174
 v_mul_f32 v63, v175, v175
 v_mfma_f32_16x16x32_bf16 v[112:115], v[208:211], v[252:255], v[112:115]
 ds_read_b128 v[204:207], v26 offset:46080
 v_fma_f32 v60, v60, v43, v41
 v_mfma_f32_16x16x32_bf16 v[88:91], v[212:215], v[248:251], v[88:91]
 s_add_u32 s91, s78, 0xd000
 buffer_load_dwordx4 v[244:247], v2, s[4:7], s91 offen offset:1024 sc1
 v_fma_f32 v61, v61, v43, v41
 v_fma_f32 v62, v62, v43, v41
 v_mfma_f32_16x16x32_bf16 v[116:119], v[212:215], v[252:255], v[116:119]
 ds_read_b128 v[208:211], v26 offset:47104
 v_fma_f32 v63, v63, v43, v41
 s_waitcnt lgkmcnt(4)
 v_mfma_f32_16x16x32_bf16 v[92:95], v[184:187], v[248:251], v[92:95]
 v_mul_f32 v60, v60, v172
 v_mul_f32 v61, v61, v173
 v_mfma_f32_16x16x32_bf16 v[120:123], v[184:187], v[252:255], v[120:123]
 ds_read_b128 v[212:215], v26 offset:48128
 v_mul_f32 v62, v62, v174
 v_mfma_f32_16x16x32_bf16 v[96:99], v[188:191], v[248:251], v[96:99]
 v_mul_f32 v63, v63, v175
 v_exp_f32 v60, v60
 v_mfma_f32_16x16x32_bf16 v[124:127], v[188:191], v[252:255], v[124:127]
 ds_read_b128 v[184:187], v26 offset:49152
 s_waitcnt vmcnt(13)
 v_mfma_f32_16x16x32_bf16 v[72:75], v[192:195], v[216:219], v[72:75]
 v_mul_f32 v64, v172, v176
 s_waitcnt vmcnt(12)
 v_mfma_f32_16x16x32_bf16 v[100:103], v[192:195], v[220:223], v[100:103]
 s_add_u32 s91, s78, 0xd000
 buffer_load_dwordx4 v[248:251], v2, s[4:7], s91 offen offset:2048 sc1
 ds_read_b128 v[188:191], v26 offset:50176
 v_exp_f32 v61, v61
 s_waitcnt lgkmcnt(3)
 v_mfma_f32_16x16x32_bf16 v[76:79], v[196:199], v[216:219], v[76:79]
 v_mul_f32 v65, v173, v177
 v_mfma_f32_16x16x32_bf16 v[104:107], v[196:199], v[220:223], v[104:107]
 ds_read_b128 v[192:195], v26 offset:51200
 v_exp_f32 v62, v62
 v_mfma_f32_16x16x32_bf16 v[80:83], v[200:203], v[216:219], v[80:83]
 v_mul_f32 v66, v174, v178
 v_mfma_f32_16x16x32_bf16 v[108:111], v[200:203], v[220:223], v[108:111]
 ds_read_b128 v[196:199], v26 offset:52224
 s_add_u32 s91, s78, 0x8000
 buffer_load_dwordx4 v[168:171], v2, s[4:7], s91 offen offset:2048 sc1
 v_mfma_f32_16x16x32_bf16 v[84:87], v[204:207], v[216:219], v[84:87]
 v_exp_f32 v63, v63
 v_mfma_f32_16x16x32_bf16 v[112:115], v[204:207], v[220:223], v[112:115]
 ds_read_b128 v[200:203], v26 offset:53248
 v_mul_f32 v67, v175, v179
 v_mfma_f32_16x16x32_bf16 v[88:91], v[208:211], v[216:219], v[88:91]
 s_add_u32 s91, s78, 0xd000
 buffer_load_dwordx4 v[252:255], v2, s[4:7], s91 offen offset:3072 sc1
 v_fma_f32 v60, v60, v45, v45
 v_mfma_f32_16x16x32_bf16 v[116:119], v[208:211], v[220:223], v[116:119]
 ds_read_b128 v[204:207], v26 offset:54272
 v_rcp_f32 v60, v60
 s_waitcnt lgkmcnt(4)
 v_mfma_f32_16x16x32_bf16 v[92:95], v[212:215], v[216:219], v[92:95]
 v_fma_f32 v61, v61, v45, v45
 v_mfma_f32_16x16x32_bf16 v[120:123], v[212:215], v[220:223], v[120:123]
 ds_read_b128 v[208:211], v26 offset:55296
 v_rcp_f32 v61, v61
 v_mfma_f32_16x16x32_bf16 v[96:99], v[184:187], v[216:219], v[96:99]
 v_fma_f32 v62, v62, v45, v45
 v_mfma_f32_16x16x32_bf16 v[124:127], v[184:187], v[220:223], v[124:127]
 ds_read_b128 v[212:215], v26 offset:56320
 v_rcp_f32 v62, v62
 s_waitcnt vmcnt(12)
 v_mfma_f32_16x16x32_bf16 v[72:75], v[188:191], v[224:227], v[72:75]
 v_cmp_gt_u32 vcc, 1, v3
 s_nop 0
 s_cbranch_vccnz .Lps_76
.Lpb_77:
 v_fma_f32 v63, v63, v45, v45
 s_waitcnt vmcnt(10)
 v_mfma_f32_16x16x32_bf16 v[100:103], v[188:191], v[228:231], v[100:103]
 s_add_u32 s91, s78, 0xb000
 buffer_load_dwordx4 v[216:219], v2, s[4:7], s91 offen offset:2048 sc1
 v_rcp_f32 v63, v63
 s_waitcnt lgkmcnt(2)
 v_mfma_f32_16x16x32_bf16 v[76:79], v[192:195], v[224:227], v[76:79]
 v_mul_f32 v60, v60, v64
 v_mfma_f32_16x16x32_bf16 v[104:107], v[192:195], v[228:231], v[104:107]
 v_mul_f32 v61, v61, v65
 v_mul_f32 v62, v62, v66
 v_mfma_f32_16x16x32_bf16 v[80:83], v[196:199], v[224:227], v[80:83]
 v_mul_f32 v63, v63, v67
 v_cvt_pk_bf16_f32 v70, v60, v61
 v_mfma_f32_16x16x32_bf16 v[108:111], v[196:199], v[228:231], v[108:111]
 v_cvt_pk_bf16_f32 v71, v62, v63
 buffer_store_dwordx2 v[70:71], v27, s[4:7], s90 offen offset:1024 sc1
 v_mfma_f32_16x16x32_bf16 v[84:87], v[200:203], v[224:227], v[84:87]
 buffer_load_dword v3, v7, s[4:7], s66 offen sc1
 s_add_u32 s91, s78, 0x8000
 buffer_load_dwordx4 v[172:175], v2, s[4:7], s91 offen offset:3072 sc1
 v_mfma_f32_16x16x32_bf16 v[112:115], v[200:203], v[228:231], v[112:115]
 s_add_u32 s91, s78, 0x9000
 buffer_load_dwordx4 v[176:179], v2, s[4:7], s91 offen sc1
 v_mfma_f32_16x16x32_bf16 v[88:91], v[204:207], v[224:227], v[88:91]
 s_add_u32 s91, s78, 0xb000
 buffer_load_dwordx4 v[220:223], v2, s[4:7], s91 offen offset:3072 sc1
 v_mfma_f32_16x16x32_bf16 v[116:119], v[204:207], v[228:231], v[116:119]
 s_waitcnt lgkmcnt(0)
 v_mfma_f32_16x16x32_bf16 v[92:95], v[208:211], v[224:227], v[92:95]
 v_mfma_f32_16x16x32_bf16 v[120:123], v[208:211], v[228:231], v[120:123]
 v_mfma_f32_16x16x32_bf16 v[96:99], v[212:215], v[224:227], v[96:99]
 v_mfma_f32_16x16x32_bf16 v[124:127], v[212:215], v[228:231], v[124:127]
 v_add_u32 v24, s80, v2
 ds_read_b128 v[184:187], v24
 ds_read_b128 v[188:191], v24 offset:1024
 ds_read_b128 v[192:195], v24 offset:2048
 ds_read_b128 v[196:199], v24 offset:3072
 s_nop 2
 v_permlane32_swap_b32 v96, v124
 v_permlane32_swap_b32 v97, v125
 v_permlane32_swap_b32 v98, v126
 v_permlane32_swap_b32 v99, v127
 s_add_u32 s91, s78, 0xa000
 buffer_load_dwordx4 v[200:203], v2, s[4:7], s91 offen offset:2048 sc1
 s_add_u32 s90, s75, 0x400000
 v_pk_mul_f32 v[60:61], v[96:97], v[96:97]
 v_pk_mul_f32 v[62:63], v[98:99], v[98:99]
 v_pk_fma_f32 v[60:61], v[60:61], v[56:57], v[56:57] op_sel:[0,1,0] op_sel_hi:[1,1,0]
 v_pk_fma_f32 v[62:63], v[62:63], v[56:57], v[56:57] op_sel:[0,1,0] op_sel_hi:[1,1,0]
 v_pk_mul_f32 v[60:61], v[60:61], v[96:97]
 v_pk_mul_f32 v[62:63], v[62:63], v[98:99]
 v_exp_f32 v60, v60
 v_exp_f32 v61, v61
 v_exp_f32 v62, v62
 v_exp_f32 v63, v63
 s_add_u32 s91, s78, 0xa000
 buffer_load_dwordx4 v[204:207], v2, s[4:7], s91 offen offset:3072 sc1
 v_pk_mul_f32 v[64:65], v[96:97], v[124:125]
 v_pk_mul_f32 v[66:67], v[98:99], v[126:127]
 v_pk_fma_f32 v[60:61], v[60:61], v[58:59], v[58:59] op_sel:[0,0,0] op_sel_hi:[1,0,0]
 v_pk_fma_f32 v[62:63], v[62:63], v[58:59], v[58:59] op_sel:[0,0,0] op_sel_hi:[1,0,0]
 v_rcp_f32 v60, v60
 v_rcp_f32 v61, v61
 v_rcp_f32 v62, v62
 v_rcp_f32 v63, v63
 v_pk_mul_f32 v[60:61], v[60:61], v[64:65]
 s_add_u32 s91, s78, 0xb000
 buffer_load_dwordx4 v[208:211], v2, s[4:7], s91 offen sc1
 v_pk_mul_f32 v[62:63], v[62:63], v[66:67]
 v_cvt_pk_bf16_f32 v68, v60, v61
 v_cvt_pk_bf16_f32 v69, v62, v63
 buffer_store_dwordx2 v[68:69], v28, s[4:7], s90 offen offset:1536 sc1
 s_add_u32 s90, s75, 0x40e000
 v_pk_mul_f32 v[60:61], v[72:73], v[72:73]
 v_pk_mul_f32 v[62:63], v[74:75], v[74:75]
 v_pk_fma_f32 v[60:61], v[60:61], v[52:53], v[50:51] op_sel:[0,0,0] op_sel_hi:[1,0,0]
 v_pk_fma_f32 v[62:63], v[62:63], v[52:53], v[50:51] op_sel:[0,0,0] op_sel_hi:[1,0,0]
 v_pk_mul_f32 v[60:61], v[60:61], v[72:73]
 v_pk_mul_f32 v[62:63], v[62:63], v[74:75]
 v_exp_f32 v60, v60
 v_exp_f32 v61, v61
 s_add_u32 s91, s78, 0xb000
 buffer_load_dwordx4 v[212:215], v2, s[4:7], s91 offen offset:1024 sc1
 v_exp_f32 v62, v62
 v_exp_f32 v63, v63
 v_pk_mul_f32 v[64:65], v[72:73], v[76:77]
 v_pk_mul_f32 v[66:67], v[74:75], v[78:79]
 v_pk_fma_f32 v[60:61], v[60:61], v[54:55], v[54:55] op_sel:[0,0,0] op_sel_hi:[1,0,0]
 v_pk_fma_f32 v[62:63], v[62:63], v[54:55], v[54:55] op_sel:[0,0,0] op_sel_hi:[1,0,0]
 v_rcp_f32 v60, v60
 v_rcp_f32 v61, v61
 v_rcp_f32 v62, v62
 s_add_u32 s91, s78, 0xc000
 buffer_load_dwordx4 v[224:227], v2, s[4:7], s91 offen sc1
 v_rcp_f32 v63, v63
 v_pk_mul_f32 v[60:61], v[60:61], v[64:65]
 v_pk_mul_f32 v[62:63], v[62:63], v[66:67]
 v_cvt_pk_bf16_f32 v34, v60, v61
 v_cvt_pk_bf16_f32 v35, v62, v63
 v_pk_mul_f32 v[60:61], v[80:81], v[80:81]
 v_pk_mul_f32 v[62:63], v[82:83], v[82:83]
 v_pk_fma_f32 v[60:61], v[60:61], v[52:53], v[50:51] op_sel:[0,0,0] op_sel_hi:[1,0,0]
 v_pk_fma_f32 v[62:63], v[62:63], v[52:53], v[50:51] op_sel:[0,0,0] op_sel_hi:[1,0,0]
 v_pk_mul_f32 v[60:61], v[60:61], v[80:81]
 v_pk_mul_f32 v[62:63], v[62:63], v[82:83]
 v_exp_f32 v60, v60
 s_add_u32 s91, s78, 0xc000
 buffer_load_dwordx4 v[228:231], v2, s[4:7], s91 offen offset:1024 sc1
 v_exp_f32 v61, v61
 v_exp_f32 v62, v62
 v_exp_f32 v63, v63
 v_pk_mul_f32 v[64:65], v[80:81], v[84:85]
 v_pk_mul_f32 v[66:67], v[82:83], v[86:87]
 v_pk_fma_f32 v[60:61], v[60:61], v[54:55], v[54:55] op_sel:[0,0,0] op_sel_hi:[1,0,0]
 v_pk_fma_f32 v[62:63], v[62:63], v[54:55], v[54:55] op_sel:[0,0,0] op_sel_hi:[1,0,0]
 v_rcp_f32 v60, v60
 v_rcp_f32 v61, v61
 v_rcp_f32 v62, v62
 v_rcp_f32 v63, v63
 v_pk_mul_f32 v[60:61], v[60:61], v[64:65]
 v_pk_mul_f32 v[62:63], v[62:63], v[66:67]
 v_cvt_pk_bf16_f32 v36, v60, v61
 v_cvt_pk_bf16_f32 v37, v62, v63
 buffer_store_dwordx4 v[34:37], v2, s[4:7], s90 offen sc1
 v_pk_mul_f32 v[60:61], v[88:89], v[88:89]
 v_pk_mul_f32 v[62:63], v[90:91], v[90:91]
 v_pk_fma_f32 v[60:61], v[60:61], v[52:53], v[50:51] op_sel:[0,0,0] op_sel_hi:[1,0,0]
 v_pk_fma_f32 v[62:63], v[62:63], v[52:53], v[50:51] op_sel:[0,0,0] op_sel_hi:[1,0,0]
 v_pk_mul_f32 v[60:61], v[60:61], v[88:89]
 v_pk_mul_f32 v[62:63], v[62:63], v[90:91]
 v_exp_f32 v60, v60
 v_exp_f32 v61, v61
 v_exp_f32 v62, v62
 v_exp_f32 v63, v63
 v_mov_b32 v5, 2
 s_waitcnt vmcnt(12)
 buffer_store_dword v5, off, s[4:7], s68 sc1
 s_waitcnt vmcnt(12)
 v_cmp_gt_u32 vcc, 1, v3
 s_nop 0
 s_cbranch_vccnz .Lps_78
.Lpb_79:
 s_add_u32 s85, s76, 0xe000
 buffer_load_dwordx4 v[72:75], v2, s[4:7], s85 offen sc1
 v_pk_mul_f32 v[64:65], v[88:89], v[92:93]
 v_pk_mul_f32 v[66:67], v[90:91], v[94:95]
 v_pk_fma_f32 v[60:61], v[60:61], v[54:55], v[54:55] op_sel:[0,0,0] op_sel_hi:[1,0,0]
 v_pk_fma_f32 v[62:63], v[62:63], v[54:55], v[54:55] op_sel:[0,0,0] op_sel_hi:[1,0,0]
 v_rcp_f32 v60, v60
 v_rcp_f32 v61, v61
 v_rcp_f32 v62, v62
 v_rcp_f32 v63, v63
 v_pk_mul_f32 v[60:61], v[60:61], v[64:65]
 buffer_load_dwordx4 v[76:79], v2, s[4:7], s85 offen offset:1024 sc1
 v_pk_mul_f32 v[62:63], v[62:63], v[66:67]
 v_cvt_pk_bf16_f32 v70, v60, v61
 v_cvt_pk_bf16_f32 v71, v62, v63
 buffer_store_dwordx2 v[70:71], v27, s[4:7], s90 offen offset:1024 sc1
 s_add_u32 s90, s75, 0x400000
 v_pk_mul_f32 v[60:61], v[100:101], v[100:101]
 v_pk_mul_f32 v[62:63], v[102:103], v[102:103]
 v_pk_fma_f32 v[60:61], v[60:61], v[52:53], v[50:51] op_sel:[0,1,1] op_sel_hi:[1,1,1]
 v_pk_fma_f32 v[62:63], v[62:63], v[52:53], v[50:51] op_sel:[0,1,1] op_sel_hi:[1,1,1]
 v_pk_mul_f32 v[60:61], v[60:61], v[100:101]
 v_pk_mul_f32 v[62:63], v[62:63], v[102:103]
 v_exp_f32 v60, v60
 v_exp_f32 v61, v61
 buffer_load_dwordx4 v[80:83], v2, s[4:7], s85 offen offset:2048 sc1
 v_exp_f32 v62, v62
 v_exp_f32 v63, v63
 v_pk_mul_f32 v[64:65], v[100:101], v[104:105]
 v_pk_mul_f32 v[66:67], v[102:103], v[106:107]
 v_pk_fma_f32 v[60:61], v[60:61], v[54:55], v[54:55] op_sel:[0,1,1] op_sel_hi:[1,1,1]
 v_pk_fma_f32 v[62:63], v[62:63], v[54:55], v[54:55] op_sel:[0,1,1] op_sel_hi:[1,1,1]
 v_rcp_f32 v60, v60
 v_rcp_f32 v61, v61
 v_rcp_f32 v62, v62
 buffer_load_dwordx4 v[84:87], v2, s[4:7], s85 offen offset:3072 sc1
 v_rcp_f32 v63, v63
 v_pk_mul_f32 v[60:61], v[60:61], v[64:65]
 v_pk_mul_f32 v[62:63], v[62:63], v[66:67]
 v_cvt_pk_bf16_f32 v34, v60, v61
 v_cvt_pk_bf16_f32 v35, v62, v63
 v_pk_mul_f32 v[60:61], v[108:109], v[108:109]
 v_pk_mul_f32 v[62:63], v[110:111], v[110:111]
 v_pk_fma_f32 v[60:61], v[60:61], v[52:53], v[50:51] op_sel:[0,1,1] op_sel_hi:[1,1,1]
 v_pk_fma_f32 v[62:63], v[62:63], v[52:53], v[50:51] op_sel:[0,1,1] op_sel_hi:[1,1,1]
 v_pk_mul_f32 v[60:61], v[60:61], v[108:109]
 v_pk_mul_f32 v[62:63], v[62:63], v[110:111]
 v_exp_f32 v60, v60
 s_add_u32 s85, s76, 0xf000
 buffer_load_dwordx4 v[88:91], v2, s[4:7], s85 offen sc1
 v_exp_f32 v61, v61
 v_exp_f32 v62, v62
 v_exp_f32 v63, v63
 v_pk_mul_f32 v[64:65], v[108:109], v[112:113]
 v_pk_mul_f32 v[66:67], v[110:111], v[114:115]
 v_pk_fma_f32 v[60:61], v[60:61], v[54:55], v[54:55] op_sel:[0,1,1] op_sel_hi:[1,1,1]
 v_pk_fma_f32 v[62:63], v[62:63], v[54:55], v[54:55] op_sel:[0,1,1] op_sel_hi:[1,1,1]
 v_rcp_f32 v60, v60
 v_rcp_f32 v61, v61
 buffer_load_dwordx4 v[92:95], v2, s[4:7], s85 offen offset:1024 sc1
 v_rcp_f32 v62, v62
 v_rcp_f32 v63, v63
 v_pk_mul_f32 v[60:61], v[60:61], v[64:65]
 v_pk_mul_f32 v[62:63], v[62:63], v[66:67]
 v_cvt_pk_bf16_f32 v36, v60, v61
 v_cvt_pk_bf16_f32 v37, v62, v63
 buffer_store_dwordx4 v[34:37], v2, s[4:7], s90 offen sc1
 v_mov_b32 v5, 3
 s_waitcnt vmcnt(5)
 buffer_store_dword v5, off, s[4:7], s68 sc1
 v_pk_mul_f32 v[60:61], v[116:117], v[116:117]
 v_pk_mul_f32 v[62:63], v[118:119], v[118:119]
 v_pk_fma_f32 v[60:61], v[60:61], v[52:53], v[50:51] op_sel:[0,1,1] op_sel_hi:[1,1,1]
 v_pk_fma_f32 v[62:63], v[62:63], v[52:53], v[50:51] op_sel:[0,1,1] op_sel_hi:[1,1,1]
 buffer_load_dwordx4 v[96:99], v2, s[4:7], s85 offen offset:2048 sc1
 v_pk_mul_f32 v[60:61], v[60:61], v[116:117]
 v_pk_mul_f32 v[62:63], v[62:63], v[118:119]
 v_exp_f32 v60, v60
 v_exp_f32 v61, v61
 v_exp_f32 v62, v62
 v_exp_f32 v63, v63
 v_pk_mul_f32 v[64:65], v[116:117], v[120:121]
 v_pk_mul_f32 v[66:67], v[118:119], v[122:123]
 v_pk_fma_f32 v[60:61], v[60:61], v[54:55], v[54:55] op_sel:[0,1,1] op_sel_hi:[1,1,1]
 buffer_load_dwordx4 v[100:103], v2, s[4:7], s85 offen offset:3072 sc1
 v_pk_fma_f32 v[62:63], v[62:63], v[54:55], v[54:55] op_sel:[0,1,1] op_sel_hi:[1,1,1]
 v_rcp_f32 v60, v60
 v_rcp_f32 v61, v61
 v_rcp_f32 v62, v62
 v_rcp_f32 v63, v63
 v_pk_mul_f32 v[60:61], v[60:61], v[64:65]
 v_pk_mul_f32 v[62:63], v[62:63], v[66:67]
 v_cvt_pk_bf16_f32 v70, v60, v61
 v_cvt_pk_bf16_f32 v71, v62, v63
 buffer_store_dwordx2 v[70:71], v27, s[4:7], s90 offen offset:1024 sc1
 v_add_u32 v24, s80, v2
 v_and_b32 v8, 0x3ff, v13
 v_lshrrev_b32 v5, 11, v13
 v_lshl_add_u32 v8, v5, 10, v8
 ds_read_b128 v[36:39], v24 offset:16384
 v_mfma_f32_16x16x32_bf16 v[112:115], a[192:195], v[72:75], 0
 s_add_u32 s85, s76, 0x10000
 buffer_load_dwordx4 v[104:107], v2, s[4:7], s85 offen sc1
 buffer_load_dword v3, v7, s[4:7], s66 offen sc1
 v_mfma_f32_16x16x32_bf16 v[116:119], a[196:199], v[72:75], 0
 ds_read_b128 v[40:43], v24 offset:17408
 v_mfma_f32_16x16x32_bf16 v[120:123], a[200:203], v[72:75], 0
 s_waitcnt lgkmcnt(1)
 v_mfma_f32_16x16x32_bf16 v[124:127], v[36:39], v[72:75], 0
 v_mfma_f32_16x16x32_bf16 v[112:115], a[204:207], v[76:79], v[112:115]
 buffer_load_dwordx4 v[72:75], v2, s[4:7], s85 offen offset:1024 sc1
 v_mfma_f32_16x16x32_bf16 v[116:119], a[208:211], v[76:79], v[116:119]
 ds_read_b128 v[36:39], v24 offset:18432
 v_mfma_f32_16x16x32_bf16 v[120:123], a[212:215], v[76:79], v[120:123]
 s_waitcnt lgkmcnt(1)
 v_mfma_f32_16x16x32_bf16 v[124:127], v[40:43], v[76:79], v[124:127]
 s_waitcnt vmcnt(11)
 v_mfma_f32_16x16x32_bf16 v[112:115], a[216:219], v[80:83], v[112:115]
 buffer_load_dwordx4 v[76:79], v2, s[4:7], s85 offen offset:2048 sc1
 v_mfma_f32_16x16x32_bf16 v[116:119], a[220:223], v[80:83], v[116:119]
 ds_read_b128 v[40:43], v24 offset:19456
 v_mfma_f32_16x16x32_bf16 v[120:123], a[224:227], v[80:83], v[120:123]
 s_waitcnt lgkmcnt(1)
 v_mfma_f32_16x16x32_bf16 v[124:127], v[36:39], v[80:83], v[124:127]
 s_waitcnt vmcnt(11)
 v_mfma_f32_16x16x32_bf16 v[112:115], a[228:231], v[84:87], v[112:115]
 buffer_load_dwordx4 v[80:83], v2, s[4:7], s85 offen offset:3072 sc1
 v_mfma_f32_16x16x32_bf16 v[116:119], a[232:235], v[84:87], v[116:119]
 ds_read_b128 v[36:39], v24 offset:32768
 v_mfma_f32_16x16x32_bf16 v[120:123], a[236:239], v[84:87], v[120:123]
 s_waitcnt lgkmcnt(1)
 v_mfma_f32_16x16x32_bf16 v[124:127], v[40:43], v[84:87], v[124:127]
 s_waitcnt vmcnt(11)
 v_mfma_f32_16x16x32_bf16 v[112:115], a[240:243], v[88:91], v[112:115]
 s_add_u32 s85, s76, 0x11000
 buffer_load_dwordx4 v[84:87], v2, s[4:7], s85 offen sc1
 v_mfma_f32_16x16x32_bf16 v[116:119], a[244:247], v[88:91], v[116:119]
 ds_read_b128 v[40:43], v24 offset:33792
 v_mfma_f32_16x16x32_bf16 v[120:123], a[248:251], v[88:91], v[120:123]
 s_waitcnt lgkmcnt(1)
 v_mfma_f32_16x16x32_bf16 v[124:127], v[36:39], v[88:91], v[124:127]
 s_waitcnt vmcnt(11)
 v_mfma_f32_16x16x32_bf16 v[112:115], a[252:255], v[92:95], v[112:115]
 buffer_load_dwordx4 v[88:91], v2, s[4:7], s85 offen offset:1024 sc1
 v_mfma_f32_16x16x32_bf16 v[116:119], v[128:131], v[92:95], v[116:119]
 ds_read_b128 v[36:39], v24 offset:34816
 v_mfma_f32_16x16x32_bf16 v[120:123], v[132:135], v[92:95], v[120:123]
 s_waitcnt lgkmcnt(1)
 v_mfma_f32_16x16x32_bf16 v[124:127], v[40:43], v[92:95], v[124:127]
 s_waitcnt vmcnt(9)
 v_mfma_f32_16x16x32_bf16 v[112:115], v[136:139], v[96:99], v[112:115]
 s_waitcnt vmcnt(5)
 v_cmp_gt_u32 vcc, 2, v3
 s_nop 0
 s_cbranch_vccnz .Lps_80
.Lpb_81:
 s_add_u32 s85, s76, 0x0
 buffer_load_dwordx4 v[92:95], v2, s[4:7], s85 offen sc1
 v_mfma_f32_16x16x32_bf16 v[116:119], v[140:143], v[96:99], v[116:119]
 ds_read_b128 v[40:43], v24 offset:35840
 v_mfma_f32_16x16x32_bf16 v[120:123], v[144:147], v[96:99], v[120:123]
 s_waitcnt lgkmcnt(1)
 v_mfma_f32_16x16x32_bf16 v[124:127], v[36:39], v[96:99], v[124:127]
 v_mfma_f32_16x16x32_bf16 v[112:115], v[148:151], v[100:103], v[112:115]
 v_mov_b32 v5, 4
 buffer_store_dword v5, off, s[4:7], s68 sc1
 buffer_load_dwordx4 v[96:99], v2, s[4:7], s85 offen offset:1024 sc1
 v_mfma_f32_16x16x32_bf16 v[116:119], v[152:155], v[100:103], v[116:119]
 v_mfma_f32_16x16x32_bf16 v[120:123], v[156:159], v[100:103], v[120:123]
 s_waitcnt lgkmcnt(0)
 v_mfma_f32_16x16x32_bf16 v[124:127], v[40:43], v[100:103], v[124:127]
 v_mfma_f32_16x16x32_bf16 v[112:115], v[160:163], v[104:107], v[112:115]
 buffer_load_dwordx4 v[100:103], v2, s[4:7], s85 offen offset:2048 sc1
 v_mfma_f32_16x16x32_bf16 v[116:119], v[164:167], v[104:107], v[116:119]
 v_mfma_f32_16x16x32_bf16 v[120:123], v[168:171], v[104:107], v[120:123]
 v_mfma_f32_16x16x32_bf16 v[124:127], v[172:175], v[104:107], v[124:127]
 s_waitcnt vmcnt(8)
 v_mfma_f32_16x16x32_bf16 v[112:115], v[176:179], v[72:75], v[112:115]
 buffer_load_dwordx4 v[104:107], v2, s[4:7], s85 offen offset:3072 sc1
 v_mfma_f32_16x16x32_bf16 v[116:119], v[180:183], v[72:75], v[116:119]
 v_mfma_f32_16x16x32_bf16 v[120:123], v[184:187], v[72:75], v[120:123]
 v_mfma_f32_16x16x32_bf16 v[124:127], v[188:191], v[72:75], v[124:127]
 s_waitcnt vmcnt(8)
 v_mfma_f32_16x16x32_bf16 v[112:115], v[192:195], v[76:79], v[112:115]
 s_add_u32 s85, s76, 0x1000
 buffer_load_dwordx4 v[72:75], v2, s[4:7], s85 offen sc1
 v_mfma_f32_16x16x32_bf16 v[116:119], v[196:199], v[76:79], v[116:119]
 v_mfma_f32_16x16x32_bf16 v[120:123], v[200:203], v[76:79], v[120:123]
 v_mfma_f32_16x16x32_bf16 v[124:127], v[204:207], v[76:79], v[124:127]
 s_waitcnt vmcnt(8)
 v_mfma_f32_16x16x32_bf16 v[112:115], v[208:211], v[80:83], v[112:115]
 buffer_load_dwordx4 v[76:79], v2, s[4:7], s85 offen offset:1024 sc1
 v_mfma_f32_16x16x32_bf16 v[116:119], v[212:215], v[80:83], v[116:119]
 v_mfma_f32_16x16x32_bf16 v[120:123], v[216:219], v[80:83], v[120:123]
 v_mfma_f32_16x16x32_bf16 v[124:127], v[220:223], v[80:83], v[124:127]
 s_waitcnt vmcnt(8)
 v_mfma_f32_16x16x32_bf16 v[112:115], v[224:227], v[84:87], v[112:115]
 buffer_load_dwordx4 v[80:83], v2, s[4:7], s85 offen offset:2048 sc1
 buffer_load_dword v3, v7, s[4:7], s66 offen sc1
 v_mfma_f32_16x16x32_bf16 v[116:119], v[228:231], v[84:87], v[116:119]
 ds_read_b128 v[36:39], v24 offset:16384
 v_mfma_f32_16x16x32_bf16 v[120:123], v[232:235], v[84:87], v[120:123]
 s_barrier
 v_mfma_f32_16x16x32_bf16 v[124:127], v[236:239], v[84:87], v[124:127]
 s_waitcnt vmcnt(9)
 v_mfma_f32_16x16x32_bf16 v[112:115], v[240:243], v[88:91], v[112:115]
 buffer_load_dwordx4 v[84:87], v2, s[4:7], s85 offen offset:3072 sc1
 v_mfma_f32_16x16x32_bf16 v[116:119], v[244:247], v[88:91], v[116:119]
 v_mfma_f32_16x16x32_bf16 v[120:123], v[248:251], v[88:91], v[120:123]
 v_mfma_f32_16x16x32_bf16 v[124:127], v[252:255], v[88:91], v[124:127]
 s_waitcnt vmcnt(9)
 v_mfma_f32_16x16x32_bf16 v[60:63], a[192:195], v[92:95], 0
 s_add_u32 s85, s76, 0x2000
 buffer_load_dwordx4 v[88:91], v2, s[4:7], s85 offen sc1
 v_mfma_f32_16x16x32_bf16 v[64:67], a[196:199], v[92:95], 0
 ds_read_b128 v[40:43], v24 offset:17408
 v_mfma_f32_16x16x32_bf16 v[68:71], a[200:203], v[92:95], 0
 s_waitcnt lgkmcnt(1)
 v_mfma_f32_16x16x32_bf16 v[108:111], v[36:39], v[92:95], 0
 s_waitcnt vmcnt(8)
 v_mfma_f32_16x16x32_bf16 v[60:63], a[204:207], v[96:99], v[60:63]
 buffer_load_dwordx4 v[92:95], v2, s[4:7], s85 offen offset:1024 sc1
 v_mfma_f32_16x16x32_bf16 v[64:67], a[208:211], v[96:99], v[64:67]
 ds_write_b128 v9, v[112:115]
 ds_read_b128 v[36:39], v24 offset:18432
 v_mfma_f32_16x16x32_bf16 v[68:71], a[212:215], v[96:99], v[68:71]
 s_waitcnt lgkmcnt(2)
 v_mfma_f32_16x16x32_bf16 v[108:111], v[40:43], v[96:99], v[108:111]
 ds_write_b128 v10, v[116:119]
 s_waitcnt vmcnt(8)
 v_mfma_f32_16x16x32_bf16 v[60:63], a[216:219], v[100:103], v[60:63]
 buffer_load_dwordx4 v[96:99], v2, s[4:7], s85 offen offset:2048 sc1
 v_mfma_f32_16x16x32_bf16 v[64:67], a[220:223], v[100:103], v[64:67]
 ds_write_b128 v9, v[120:123] offset:128
 ds_read_b128 v[40:43], v24 offset:19456
 v_mfma_f32_16x16x32_bf16 v[68:71], a[224:227], v[100:103], v[68:71]
 s_waitcnt lgkmcnt(3)
 v_mfma_f32_16x16x32_bf16 v[108:111], v[36:39], v[100:103], v[108:111]
 ds_write_b128 v10, v[124:127] offset:128
 s_waitcnt vmcnt(8)
 v_mfma_f32_16x16x32_bf16 v[60:63], a[228:231], v[104:107], v[60:63]
 buffer_load_dwordx4 v[100:103], v2, s[4:7], s85 offen offset:3072 sc1
 v_mfma_f32_16x16x32_bf16 v[64:67], a[232:235], v[104:107], v[64:67]
 ds_read_b128 v[36:39], v24 offset:32768
 v_mfma_f32_16x16x32_bf16 v[68:71], a[236:239], v[104:107], v[68:71]
 s_waitcnt lgkmcnt(2)
 v_mfma_f32_16x16x32_bf16 v[108:111], v[40:43], v[104:107], v[108:111]
 s_waitcnt vmcnt(8)
 v_mfma_f32_16x16x32_bf16 v[60:63], a[240:243], v[72:75], v[60:63]
 s_add_u32 s85, s76, 0x3000
 buffer_load_dwordx4 v[104:107], v2, s[4:7], s85 offen sc1
 v_mfma_f32_16x16x32_bf16 v[64:67], a[244:247], v[72:75], v[64:67]
 ds_read_b128 v[40:43], v24 offset:33792
 v_mfma_f32_16x16x32_bf16 v[68:71], a[248:251], v[72:75], v[68:71]
 s_waitcnt lgkmcnt(1)
 v_mfma_f32_16x16x32_bf16 v[108:111], v[36:39], v[72:75], v[108:111]
 s_waitcnt vmcnt(8)
 v_mfma_f32_16x16x32_bf16 v[60:63], a[252:255], v[76:79], v[60:63]
 s_barrier
 buffer_load_dwordx4 v[72:75], v2, s[4:7], s85 offen offset:1024 sc1
 v_mfma_f32_16x16x32_bf16 v[64:67], v[128:131], v[76:79], v[64:67]
 ds_read_b128 v[44:47], v11
 ds_read_b128 v[36:39], v24 offset:34816
 v_mfma_f32_16x16x32_bf16 v[68:71], v[132:135], v[76:79], v[68:71]
 ds_read_b128 v[48:51], v11 offset:4096
 s_waitcnt lgkmcnt(3)
 v_mfma_f32_16x16x32_bf16 v[108:111], v[40:43], v[76:79], v[108:111]
 ds_read_b128 v[52:55], v11 offset:8192
 s_waitcnt vmcnt(8)
 v_mfma_f32_16x16x32_bf16 v[60:63], v[136:139], v[80:83], v[60:63]
 ds_read_b128 v[56:59], v11 offset:12288
 s_waitcnt vmcnt(7)
 v_cmp_gt_u32 vcc, 3, v3
 s_nop 0
 s_cbranch_vccnz .Lps_82
.Lpb_83:
 s_add_u32 s85, s76, 0x40e000
 buffer_load_dwordx4 v[76:79], v2, s[4:7], s85 offen sc1
 v_mfma_f32_16x16x32_bf16 v[64:67], v[140:143], v[80:83], v[64:67]
 ds_read_b128 v[40:43], v24 offset:35840
 v_mfma_f32_16x16x32_bf16 v[68:71], v[144:147], v[80:83], v[68:71]
 s_waitcnt lgkmcnt(4)
 v_mfma_f32_16x16x32_bf16 v[108:111], v[36:39], v[80:83], v[108:111]
 s_waitcnt vmcnt(7)
 v_mfma_f32_16x16x32_bf16 v[60:63], v[148:151], v[84:87], v[60:63]
 buffer_load_dwordx4 v[80:83], v2, s[4:7], s85 offen offset:1024 sc1
 v_mfma_f32_16x16x32_bf16 v[64:67], v[152:155], v[84:87], v[64:67]
 s_add_u32 s90, s71, 0xc000
 v_lshlrev_b32 v32, 16, v22
 v_and_b32 v33, 0xffff0000, v22
 v_mfma_f32_16x16x32_bf16 v[68:71], v[156:159], v[84:87], v[68:71]
 v_lshlrev_b32 v34, 16, v23
 v_and_b32 v35, 0xffff0000, v23
 s_waitcnt lgkmcnt(0)
 v_mfma_f32_16x16x32_bf16 v[108:111], v[40:43], v[84:87], v[108:111]
 v_add_f32 v44, v44, v48
 v_add_f32 v52, v52, v56
 s_waitcnt vmcnt(7)
 v_mfma_f32_16x16x32_bf16 v[60:63], v[160:163], v[88:91], v[60:63]
 buffer_load_dwordx4 v[84:87], v2, s[4:7], s85 offen offset:2048 sc1
 v_add_f32 v45, v45, v49
 v_add_f32 v53, v53, v57
 v_mfma_f32_16x16x32_bf16 v[64:67], v[164:167], v[88:91], v[64:67]
 v_add_f32 v46, v46, v50
 v_add_f32 v54, v54, v58
 v_mfma_f32_16x16x32_bf16 v[68:71], v[168:171], v[88:91], v[68:71]
 v_add_f32 v47, v47, v51
 v_add_f32 v55, v55, v59
 v_mfma_f32_16x16x32_bf16 v[108:111], v[172:175], v[88:91], v[108:111]
 v_add_f32 v44, v44, v52
 v_add_f32 v45, v45, v53
 s_waitcnt vmcnt(7)
 v_mfma_f32_16x16x32_bf16 v[60:63], v[176:179], v[92:95], v[60:63]
 buffer_load_dwordx4 v[88:91], v2, s[4:7], s85 offen offset:3072 sc1
 v_add_f32 v46, v46, v54
 v_mfma_f32_16x16x32_bf16 v[64:67], v[180:183], v[92:95], v[64:67]
 v_add_f32 v47, v47, v55
 v_add_f32 v32, v32, v44
 v_mfma_f32_16x16x32_bf16 v[68:71], v[184:187], v[92:95], v[68:71]
 v_add_f32 v33, v33, v45
 v_add_f32 v34, v34, v46
 v_add_f32 v35, v35, v47
 v_mfma_f32_16x16x32_bf16 v[108:111], v[188:191], v[92:95], v[108:111]
 v_cvt_pk_bf16_f32 v22, v32, v33
 v_cvt_pk_bf16_f32 v23, v34, v35
 s_waitcnt vmcnt(7)
 v_mfma_f32_16x16x32_bf16 v[60:63], v[192:195], v[96:99], v[60:63]
 s_add_u32 s85, s76, 0x40f000
 buffer_load_dwordx4 v[92:95], v2, s[4:7], s85 offen sc1
 v_mfma_f32_16x16x32_bf16 v[64:67], v[196:199], v[96:99], v[64:67]
 buffer_store_dwordx2 v[22:23], v8, s[4:7], s90 offen sc1
 v_add_f32 v28, v32, v33
 v_mul_f32 v29, v32, v32
 v_mfma_f32_16x16x32_bf16 v[68:71], v[200:203], v[96:99], v[68:71]
 v_add_f32 v28, v28, v34
 v_fmac_f32 v29, v33, v33
 v_mfma_f32_16x16x32_bf16 v[108:111], v[204:207], v[96:99], v[108:111]
 v_add_f32 v28, v28, v35
 v_fmac_f32 v29, v34, v34
 s_waitcnt vmcnt(8)
 v_mfma_f32_16x16x32_bf16 v[60:63], v[208:211], v[100:103], v[60:63]
 buffer_load_dwordx4 v[96:99], v2, s[4:7], s85 offen offset:1024 sc1
 v_fmac_f32 v29, v35, v35
 v_mfma_f32_16x16x32_bf16 v[64:67], v[212:215], v[100:103], v[64:67]
 v_add_f32_dpp v28, v28, v28 row_ror:8 row_mask:0xf bank_mask:0xf
 v_mfma_f32_16x16x32_bf16 v[68:71], v[216:219], v[100:103], v[68:71]
 v_add_f32_dpp v28, v29, v29 row_ror:8 row_mask:0xf bank_mask:0xc
 v_mfma_f32_16x16x32_bf16 v[108:111], v[220:223], v[100:103], v[108:111]
 s_waitcnt vmcnt(8)
 v_mfma_f32_16x16x32_bf16 v[60:63], v[224:227], v[104:107], v[60:63]
 buffer_load_dwordx4 v[100:103], v2, s[4:7], s85 offen offset:2048 sc1
 buffer_load_dword v3, v7, s[4:7], s66 offen sc1
 v_add_f32_dpp v28, v28, v28 row_half_mirror row_mask:0xf bank_mask:0xf
 v_mfma_f32_16x16x32_bf16 v[64:67], v[228:231], v[104:107], v[64:67]
 ds_read_b128 v[36:39], v24 offset:16384
 v_add_f32_dpp v28, v28, v28 quad_perm:[1,0,3,2] row_mask:0xf bank_mask:0xf
 v_mfma_f32_16x16x32_bf16 v[68:71], v[232:235], v[104:107], v[68:71]
 v_mfma_f32_16x16x32_bf16 v[108:111], v[236:239], v[104:107], v[108:111]
 v_add_f32_dpp v28, v28, v28 quad_perm:[2,3,0,1] row_mask:0xf bank_mask:0xf
 buffer_store_dword v28, v14, s[4:7], s59 offen offset:3072 sc1
 v_mov_b32 v27, v28
 s_lshl_b32 s91, s49, 2
 s_add_u32 s91, s91, s51
 s_lshl_b32 s88, s91, 14
 s_add_u32 s88, s88, 0x600000
 s_cmp_eq_u32 s51, 3
 s_cselect_b32 s90, 0x2000000, s88
 buffer_store_dwordx2 v[22:23], v8, s[4:7], s90 offen sc1
 s_waitcnt vmcnt(11)
 v_mfma_f32_16x16x32_bf16 v[60:63], v[240:243], v[72:75], v[60:63]
 buffer_load_dwordx4 v[104:107], v2, s[4:7], s85 offen offset:3072 sc1
 v_mfma_f32_16x16x32_bf16 v[64:67], v[244:247], v[72:75], v[64:67]
 v_mfma_f32_16x16x32_bf16 v[68:71], v[248:251], v[72:75], v[68:71]
 v_mfma_f32_16x16x32_bf16 v[108:111], v[252:255], v[72:75], v[108:111]
 s_barrier
 s_waitcnt vmcnt(11)
 v_mfma_f32_16x16x32_bf16 v[112:115], a[192:195], v[76:79], 0
 s_add_u32 s85, s76, 0x410000
 buffer_load_dwordx4 v[72:75], v2, s[4:7], s85 offen sc1
 v_mfma_f32_16x16x32_bf16 v[116:119], a[196:199], v[76:79], 0
 ds_read_b128 v[40:43], v24 offset:17408
 v_mfma_f32_16x16x32_bf16 v[120:123], a[200:203], v[76:79], 0
 s_waitcnt lgkmcnt(1)
 v_mfma_f32_16x16x32_bf16 v[124:127], v[36:39], v[76:79], 0
 s_waitcnt vmcnt(11)
 v_mfma_f32_16x16x32_bf16 v[112:115], a[204:207], v[80:83], v[112:115]
 buffer_load_dwordx4 v[76:79], v2, s[4:7], s85 offen offset:1024 sc1
 v_mfma_f32_16x16x32_bf16 v[116:119], a[208:211], v[80:83], v[116:119]
 ds_write_b128 v9, v[60:63]
 ds_read_b128 v[36:39], v24 offset:18432
 v_mfma_f32_16x16x32_bf16 v[120:123], a[212:215], v[80:83], v[120:123]
 s_waitcnt lgkmcnt(2)
 v_mfma_f32_16x16x32_bf16 v[124:127], v[40:43], v[80:83], v[124:127]
 ds_write_b128 v10, v[64:67]
 s_waitcnt vmcnt(11)
 v_mfma_f32_16x16x32_bf16 v[112:115], a[216:219], v[84:87], v[112:115]
 buffer_load_dwordx4 v[80:83], v2, s[4:7], s85 offen offset:2048 sc1
 v_mfma_f32_16x16x32_bf16 v[116:119], a[220:223], v[84:87], v[116:119]
 ds_write_b128 v9, v[68:71] offset:128
 ds_read_b128 v[40:43], v24 offset:19456
 v_mfma_f32_16x16x32_bf16 v[120:123], a[224:227], v[84:87], v[120:123]
 s_waitcnt lgkmcnt(3)
 v_mfma_f32_16x16x32_bf16 v[124:127], v[36:39], v[84:87], v[124:127]
 ds_write_b128 v10, v[108:111] offset:128
 s_waitcnt vmcnt(11)
 v_mfma_f32_16x16x32_bf16 v[112:115], a[228:231], v[88:91], v[112:115]
 buffer_load_dwordx4 v[84:87], v2, s[4:7], s85 offen offset:3072 sc1
 v_mfma_f32_16x16x32_bf16 v[116:119], a[232:235], v[88:91], v[116:119]
 ds_read_b128 v[36:39], v24 offset:32768
 v_mfma_f32_16x16x32_bf16 v[120:123], a[236:239], v[88:91], v[120:123]
 s_waitcnt lgkmcnt(2)
 v_mfma_f32_16x16x32_bf16 v[124:127], v[40:43], v[88:91], v[124:127]
 s_waitcnt vmcnt(11)
 v_mfma_f32_16x16x32_bf16 v[112:115], a[240:243], v[92:95], v[112:115]
 v_mov_b32 v5, 1
 s_waitcnt vmcnt(5)
 buffer_store_dword v5, off, s[4:7], s67 sc1
 s_add_u32 s85, s76, 0x411000
 buffer_load_dwordx4 v[88:91], v2, s[4:7], s85 offen sc1
 v_mfma_f32_16x16x32_bf16 v[116:119], a[244:247], v[92:95], v[116:119]
 ds_read_b128 v[40:43], v24 offset:33792
 v_mfma_f32_16x16x32_bf16 v[120:123], a[248:251], v[92:95], v[120:123]
 s_waitcnt lgkmcnt(1)
 v_mfma_f32_16x16x32_bf16 v[124:127], v[36:39], v[92:95], v[124:127]
 v_mfma_f32_16x16x32_bf16 v[112:115], a[252:255], v[96:99], v[112:115]
 s_barrier
 buffer_load_dwordx4 v[92:95], v2, s[4:7], s85 offen offset:1024 sc1
 v_mfma_f32_16x16x32_bf16 v[116:119], v[128:131], v[96:99], v[116:119]
 ds_read_b128 v[44:47], v11
 ds_read_b128 v[36:39], v24 offset:34816
 v_mfma_f32_16x16x32_bf16 v[120:123], v[132:135], v[96:99], v[120:123]
 ds_read_b128 v[48:51], v11 offset:4096
 s_waitcnt lgkmcnt(3)
 v_mfma_f32_16x16x32_bf16 v[124:127], v[40:43], v[96:99], v[124:127]
 ds_read_b128 v[52:55], v11 offset:8192
 v_mfma_f32_16x16x32_bf16 v[112:115], v[136:139], v[100:103], v[112:115]
 ds_read_b128 v[56:59], v11 offset:12288
 v_cmp_gt_u32 vcc, 4, v3
 s_nop 0
 s_cbranch_vccnz .Lps_84
.Lpb_85:
 s_add_u32 s85, s76, 0x400000
 buffer_load_dwordx4 v[96:99], v2, s[4:7], s85 offen sc1
 v_mfma_f32_16x16x32_bf16 v[116:119], v[140:143], v[100:103], v[116:119]
 ds_read_b128 v[40:43], v24 offset:35840
 v_mfma_f32_16x16x32_bf16 v[120:123], v[144:147], v[100:103], v[120:123]
 s_waitcnt lgkmcnt(4)
 v_mfma_f32_16x16x32_bf16 v[124:127], v[36:39], v[100:103], v[124:127]
 s_waitcnt vmcnt(8)
 v_mfma_f32_16x16x32_bf16 v[112:115], v[148:151], v[104:107], v[112:115]
 buffer_load_dwordx4 v[100:103], v2, s[4:7], s85 offen offset:1024 sc1
 v_mfma_f32_16x16x32_bf16 v[116:119], v[152:155], v[104:107], v[116:119]
 s_add_u32 s90, s71, 0x8000
 v_lshlrev_b32 v32, 16, v20
 v_and_b32 v33, 0xffff0000, v20
 v_mfma_f32_16x16x32_bf16 v[120:123], v[156:159], v[104:107], v[120:123]
 v_lshlrev_b32 v34, 16, v21
 v_and_b32 v35, 0xffff0000, v21
 s_waitcnt lgkmcnt(0)
 v_mfma_f32_16x16x32_bf16 v[124:127], v[40:43], v[104:107], v[124:127]
 v_add_f32 v44, v44, v48
 v_add_f32 v52, v52, v56
 s_waitcnt vmcnt(8)
 v_mfma_f32_16x16x32_bf16 v[112:115], v[160:163], v[72:75], v[112:115]
 buffer_load_dwordx4 v[104:107], v2, s[4:7], s85 offen offset:2048 sc1
 v_add_f32 v45, v45, v49
 v_mfma_f32_16x16x32_bf16 v[116:119], v[164:167], v[72:75], v[116:119]
 v_add_f32 v53, v53, v57
 v_add_f32 v46, v46, v50
 v_mfma_f32_16x16x32_bf16 v[120:123], v[168:171], v[72:75], v[120:123]
 v_add_f32 v54, v54, v58
 v_add_f32 v47, v47, v51
 v_mfma_f32_16x16x32_bf16 v[124:127], v[172:175], v[72:75], v[124:127]
 v_add_f32 v55, v55, v59
 v_add_f32 v44, v44, v52
 s_waitcnt vmcnt(8)
 v_mfma_f32_16x16x32_bf16 v[112:115], v[176:179], v[76:79], v[112:115]
 buffer_load_dwordx4 v[72:75], v2, s[4:7], s85 offen offset:3072 sc1
 v_add_f32 v45, v45, v53
 v_mfma_f32_16x16x32_bf16 v[116:119], v[180:183], v[76:79], v[116:119]
 v_add_f32 v46, v46, v54
 v_add_f32 v47, v47, v55
 v_mfma_f32_16x16x32_bf16 v[120:123], v[184:187], v[76:79], v[120:123]
 v_add_f32 v32, v32, v44
 v_add_f32 v33, v33, v45
 v_mfma_f32_16x16x32_bf16 v[124:127], v[188:191], v[76:79], v[124:127]
 v_add_f32 v34, v34, v46
 v_add_f32 v35, v35, v47
 s_waitcnt vmcnt(8)
 v_mfma_f32_16x16x32_bf16 v[112:115], v[192:195], v[80:83], v[112:115]
 s_add_u32 s85, s76, 0x401000
 buffer_load_dwordx4 v[76:79], v2, s[4:7], s85 offen sc1
 v_mfma_f32_16x16x32_bf16 v[116:119], v[196:199], v[80:83], v[116:119]
 v_cvt_pk_bf16_f32 v20, v32, v33
 v_cvt_pk_bf16_f32 v21, v34, v35
 v_mfma_f32_16x16x32_bf16 v[120:123], v[200:203], v[80:83], v[120:123]
 buffer_store_dwordx2 v[20:21], v8, s[4:7], s90 offen sc1
 v_add_f32 v28, v32, v33
 v_mfma_f32_16x16x32_bf16 v[124:127], v[204:207], v[80:83], v[124:127]
 v_mul_f32 v29, v32, v32
 v_add_f32 v28, v28, v34
 s_waitcnt vmcnt(9)
 v_mfma_f32_16x16x32_bf16 v[112:115], v[208:211], v[84:87], v[112:115]
 buffer_load_dword v3, v6, s[4:7], s63 offen sc1
 buffer_load_dwordx4 v[80:83], v2, s[4:7], s85 offen offset:1024 sc1
 v_mfma_f32_16x16x32_bf16 v[116:119], v[212:215], v[84:87], v[116:119]
 v_fmac_f32 v29, v33, v33
 v_add_f32 v28, v28, v35
 v_mfma_f32_16x16x32_bf16 v[120:123], v[216:219], v[84:87], v[120:123]
 v_fmac_f32 v29, v34, v34
 v_fmac_f32 v29, v35, v35
 v_mfma_f32_16x16x32_bf16 v[124:127], v[220:223], v[84:87], v[124:127]
 v_add_f32_dpp v28, v28, v28 row_ror:8 row_mask:0xf bank_mask:0xf
 s_waitcnt vmcnt(9)
 v_mfma_f32_16x16x32_bf16 v[112:115], v[224:227], v[88:91], v[112:115]
 buffer_load_dwordx4 v[84:87], v2, s[4:7], s85 offen offset:2048 sc1
 v_add_f32_dpp v28, v29, v29 row_ror:8 row_mask:0xf bank_mask:0xc
 v_mfma_f32_16x16x32_bf16 v[116:119], v[228:231], v[88:91], v[116:119]
 ds_read_b128 v[36:39], v24 offset:16384
 v_add_f32_dpp v28, v28, v28 row_half_mirror row_mask:0xf bank_mask:0xf
 v_mfma_f32_16x16x32_bf16 v[120:123], v[232:235], v[88:91], v[120:123]
 v_mfma_f32_16x16x32_bf16 v[124:127], v[236:239], v[88:91], v[124:127]
 v_add_f32_dpp v28, v28, v28 quad_perm:[1,0,3,2] row_mask:0xf bank_mask:0xf
 s_nop 1
 v_add_f32_dpp v28, v28, v28 quad_perm:[2,3,0,1] row_mask:0xf bank_mask:0xf
 buffer_store_dword v28, v14, s[4:7], s59 offen offset:2048 sc1
 s_waitcnt vmcnt(10)
 v_mfma_f32_16x16x32_bf16 v[112:115], v[240:243], v[92:95], v[112:115]
 buffer_load_dwordx4 v[88:91], v2, s[4:7], s85 offen offset:3072 sc1
 v_mfma_f32_16x16x32_bf16 v[116:119], v[244:247], v[92:95], v[116:119]
 v_mfma_f32_16x16x32_bf16 v[120:123], v[248:251], v[92:95], v[120:123]
 v_mfma_f32_16x16x32_bf16 v[124:127], v[252:255], v[92:95], v[124:127]
 s_barrier
 s_waitcnt vmcnt(10)
 v_mfma_f32_16x16x32_bf16 v[60:63], a[192:195], v[96:99], 0
 s_add_u32 s85, s76, 0x402000
 buffer_load_dwordx4 v[92:95], v2, s[4:7], s85 offen sc1
 v_mfma_f32_16x16x32_bf16 v[64:67], a[196:199], v[96:99], 0
 ds_read_b128 v[40:43], v24 offset:17408
 v_mfma_f32_16x16x32_bf16 v[68:71], a[200:203], v[96:99], 0
 s_waitcnt lgkmcnt(1)
 v_mfma_f32_16x16x32_bf16 v[108:111], v[36:39], v[96:99], 0
 s_waitcnt vmcnt(10)
 v_mfma_f32_16x16x32_bf16 v[60:63], a[204:207], v[100:103], v[60:63]
 buffer_load_dwordx4 v[96:99], v2, s[4:7], s85 offen offset:1024 sc1
 v_mfma_f32_16x16x32_bf16 v[64:67], a[208:211], v[100:103], v[64:67]
 ds_write_b128 v9, v[112:115]
 ds_read_b128 v[36:39], v24 offset:18432
 v_mfma_f32_16x16x32_bf16 v[68:71], a[212:215], v[100:103], v[68:71]
 s_waitcnt lgkmcnt(2)
 v_mfma_f32_16x16x32_bf16 v[108:111], v[40:43], v[100:103], v[108:111]
 ds_write_b128 v10, v[116:119]
 s_waitcnt vmcnt(10)
 v_mfma_f32_16x16x32_bf16 v[60:63], a[216:219], v[104:107], v[60:63]
 buffer_load_dwordx4 v[100:103], v2, s[4:7], s85 offen offset:2048 sc1
 v_mfma_f32_16x16x32_bf16 v[64:67], a[220:223], v[104:107], v[64:67]
 ds_write_b128 v9, v[120:123] offset:128
 ds_read_b128 v[40:43], v24 offset:19456
 v_mfma_f32_16x16x32_bf16 v[68:71], a[224:227], v[104:107], v[68:71]
 s_waitcnt lgkmcnt(3)
 v_mfma_f32_16x16x32_bf16 v[108:111], v[36:39], v[104:107], v[108:111]
 ds_write_b128 v10, v[124:127] offset:128
 s_waitcnt vmcnt(10)
 v_mfma_f32_16x16x32_bf16 v[60:63], a[228:231], v[72:75], v[60:63]
 buffer_load_dwordx4 v[104:107], v2, s[4:7], s85 offen offset:3072 sc1
 v_mfma_f32_16x16x32_bf16 v[64:67], a[232:235], v[72:75], v[64:67]
 ds_read_b128 v[36:39], v24 offset:32768
 v_mfma_f32_16x16x32_bf16 v[68:71], a[236:239], v[72:75], v[68:71]
 s_waitcnt lgkmcnt(2)
 v_mfma_f32_16x16x32_bf16 v[108:111], v[40:43], v[72:75], v[108:111]
 s_lshl_b32 s57, s48, 12
 s_add_u32 s57, s57, s71
 s_add_u32 s89, s57, 0xc000
 s_waitcnt vmcnt(8)
 v_cmp_gt_u32 vcc, 1, v3
 s_nop 0
 s_cbranch_vccnz .Lps_86
.Lpb_87:
 s_waitcnt lgkmcnt(0)
 v_mfma_f32_16x16x32_bf16 v[60:63], a[240:243], v[76:79], v[60:63]
 v_mov_b32 v5, 2
 s_waitcnt vmcnt(5)
 buffer_store_dword v5, off, s[4:7], s67 sc1
 s_add_u32 m0, s80, 16384
 v_xor_b32 v25, 16, v15
 buffer_load_dwordx4 v15, s[4:7], s89 offen sc1 lds
 s_add_u32 s85, s76, 0x403000
 buffer_load_dwordx4 v[72:75], v2, s[4:7], s85 offen sc1
 v_mfma_f32_16x16x32_bf16 v[64:67], a[244:247], v[76:79], v[64:67]
 ds_read_b128 v[40:43], v24 offset:33792
 v_mfma_f32_16x16x32_bf16 v[68:71], a[248:251], v[76:79], v[68:71]
 v_mfma_f32_16x16x32_bf16 v[108:111], v[36:39], v[76:79], v[108:111]
 v_xor_b32 v26, 32, v15
 buffer_load_dwordx4 v25, s[4:7], s89 offen offset:1024 sc1 lds
 v_mfma_f32_16x16x32_bf16 v[60:63], a[252:255], v[80:83], v[60:63]
 s_barrier
 buffer_load_dwordx4 v[76:79], v2, s[4:7], s85 offen offset:1024 sc1
 v_mfma_f32_16x16x32_bf16 v[64:67], v[128:131], v[80:83], v[64:67]
 ds_read_b128 v[44:47], v11
 ds_read_b128 v[36:39], v24 offset:34816
 v_mfma_f32_16x16x32_bf16 v[68:71], v[132:135], v[80:83], v[68:71]
 ds_read_b128 v[48:51], v11 offset:4096
 v_xor_b32 v25, 48, v15
 buffer_load_dwordx4 v26, s[4:7], s89 offen offset:2048 sc1 lds
 s_waitcnt lgkmcnt(3)
 v_mfma_f32_16x16x32_bf16 v[108:111], v[40:43], v[80:83], v[108:111]
 ds_read_b128 v[52:55], v11 offset:8192
 v_mfma_f32_16x16x32_bf16 v[60:63], v[136:139], v[84:87], v[60:63]
 ds_read_b128 v[56:59], v11 offset:12288
 v_mfma_f32_16x16x32_bf16 v[64:67], v[140:143], v[84:87], v[64:67]
 buffer_load_dwordx4 v25, s[4:7], s89 offen offset:3072 sc1 lds
 ds_read_b128 v[40:43], v24 offset:35840
 v_mfma_f32_16x16x32_bf16 v[68:71], v[144:147], v[84:87], v[68:71]
 s_waitcnt lgkmcnt(4)
 v_mfma_f32_16x16x32_bf16 v[108:111], v[36:39], v[84:87], v[108:111]
 s_waitcnt vmcnt(11)
 v_mfma_f32_16x16x32_bf16 v[60:63], v[148:151], v[88:91], v[60:63]
 v_mfma_f32_16x16x32_bf16 v[64:67], v[152:155], v[88:91], v[64:67]
 s_add_u32 s90, s71, 0x4000
 v_lshlrev_b32 v32, 16, v18
 v_and_b32 v33, 0xffff0000, v18
 v_mfma_f32_16x16x32_bf16 v[68:71], v[156:159], v[88:91], v[68:71]
 v_lshlrev_b32 v34, 16, v19
 v_and_b32 v35, 0xffff0000, v19
 s_waitcnt lgkmcnt(0)
 v_mfma_f32_16x16x32_bf16 v[108:111], v[40:43], v[88:91], v[108:111]
 v_add_f32 v44, v44, v48
 v_add_f32 v52, v52, v56
 v_add_f32 v45, v45, v49
 s_waitcnt vmcnt(10)
 v_mfma_f32_16x16x32_bf16 v[60:63], v[160:163], v[92:95], v[60:63]
 v_add_f32 v53, v53, v57
 v_add_f32 v46, v46, v50
 v_mfma_f32_16x16x32_bf16 v[64:67], v[164:167], v[92:95], v[64:67]
 v_add_f32 v54, v54, v58
 v_add_f32 v47, v47, v51
 v_mfma_f32_16x16x32_bf16 v[68:71], v[168:171], v[92:95], v[68:71]
 v_add_f32 v55, v55, v59
 v_add_f32 v44, v44, v52
 v_add_f32 v45, v45, v53
 v_mfma_f32_16x16x32_bf16 v[108:111], v[172:175], v[92:95], v[108:111]
 v_add_f32 v46, v46, v54
 v_add_f32 v47, v47, v55
 s_waitcnt vmcnt(9)
 v_mfma_f32_16x16x32_bf16 v[60:63], v[176:179], v[96:99], v[60:63]
 v_add_f32 v32, v32, v44
 v_add_f32 v33, v33, v45
 v_mfma_f32_16x16x32_bf16 v[64:67], v[180:183], v[96:99], v[64:67]
 v_add_f32 v34, v34, v46
 v_add_f32 v35, v35, v47
 v_cvt_pk_bf16_f32 v18, v32, v33
 v_mfma_f32_16x16x32_bf16 v[68:71], v[184:187], v[96:99], v[68:71]
 v_cvt_pk_bf16_f32 v19, v34, v35
 buffer_store_dwordx2 v[18:19], v8, s[4:7], s90 offen sc1
 v_mfma_f32_16x16x32_bf16 v[108:111], v[188:191], v[96:99], v[108:111]
 v_add_f32 v28, v32, v33
 v_mul_f32 v29, v32, v32
 s_waitcnt vmcnt(9)
 v_mfma_f32_16x16x32_bf16 v[60:63], v[192:195], v[100:103], v[60:63]
 v_add_f32 v28, v28, v34
 v_fmac_f32 v29, v33, v33
 v_mfma_f32_16x16x32_bf16 v[64:67], v[196:199], v[100:103], v[64:67]
 v_add_f32 v28, v28, v35
 v_fmac_f32 v29, v34, v34
 v_mfma_f32_16x16x32_bf16 v[68:71], v[200:203], v[100:103], v[68:71]
 v_fmac_f32 v29, v35, v35
 v_add_f32_dpp v28, v28, v28 row_ror:8 row_mask:0xf bank_mask:0xf
 v_mfma_f32_16x16x32_bf16 v[108:111], v[204:207], v[100:103], v[108:111]
 v_add_f32_dpp v28, v29, v29 row_ror:8 row_mask:0xf bank_mask:0xc
 s_waitcnt vmcnt(8)
 v_mfma_f32_16x16x32_bf16 v[60:63], v[208:211], v[104:107], v[60:63]
 buffer_load_dword v3, v6, s[4:7], s63 offen sc1
 v_add_f32_dpp v28, v28, v28 row_half_mirror row_mask:0xf bank_mask:0xf
 v_mfma_f32_16x16x32_bf16 v[64:67], v[212:215], v[104:107], v[64:67]
 s_nop 0
 v_add_f32_dpp v28, v28, v28 quad_perm:[1,0,3,2] row_mask:0xf bank_mask:0xf
 s_nop 1
 v_add_f32_dpp v28, v28, v28 quad_perm:[2,3,0,1] row_mask:0xf bank_mask:0xf
 buffer_store_dword v28, v14, s[4:7], s59 offen offset:1024 sc1
 v_mfma_f32_16x16x32_bf16 v[68:71], v[216:219], v[104:107], v[68:71]
 v_mfma_f32_16x16x32_bf16 v[108:111], v[220:223], v[104:107], v[108:111]
 s_waitcnt vmcnt(7)
 v_mfma_f32_16x16x32_bf16 v[60:63], v[224:227], v[72:75], v[60:63]
 s_lshl_b32 s87, s91, 10
 s_add_u32 s87, s87, 0x8a0000
 s_cmp_eq_u32 s51, 3
 s_cselect_b32 s86, s88, 0x2000000
 s_cselect_b32 s87, s87, 0x2000000
 s_cselect_b32 s91, s67, 0x2000000
 buffer_store_dwordx2 v[22:23], v8, s[4:7], s86 offen sc1
 buffer_store_dword v27, v14, s[4:7], s87 offen sc1
 v_mfma_f32_16x16x32_bf16 v[64:67], v[228:231], v[72:75], v[64:67]
 v_mfma_f32_16x16x32_bf16 v[68:71], v[232:235], v[72:75], v[68:71]
 v_mfma_f32_16x16x32_bf16 v[108:111], v[236:239], v[72:75], v[108:111]
 s_waitcnt vmcnt(7)
 v_mfma_f32_16x16x32_bf16 v[60:63], v[240:243], v[76:79], v[60:63]
 v_mfma_f32_16x16x32_bf16 v[64:67], v[244:247], v[76:79], v[64:67]
 v_mfma_f32_16x16x32_bf16 v[68:71], v[248:251], v[76:79], v[68:71]
 v_mfma_f32_16x16x32_bf16 v[108:111], v[252:255], v[76:79], v[108:111]
 s_waitcnt vmcnt(5)
 s_barrier
 s_lshl_b32 s58, s48, 12
 s_add_u32 s58, s58, s88
 s_sub_u32 s58, s58, 16384
 s_cmp_eq_u32 s55, 1
 s_cselect_b32 s58, s57, s58
.Lloop_s:
 v_and_b32 v24, 15, v1
 v_lshrrev_b32 v25, 4, v1
 v_xor_b32 v26, v25, v24
 v_lshlrev_b32 v26, 4, v26
 v_lshl_add_u32 v26, v24, 10, v26
 v_add_u32 v30, 114688, v26
 v_xor_b32 v31, 64, v30
 v_xor_b32 v32, 128, v30
 v_xor_b32 v33, 192, v30
 ds_read_b128 v[216:219], v30 offset:16384
 ds_read_b128 v[220:223], v31 offset:16384
 ds_read_b128 v[224:227], v32 offset:16384
 ds_read_b128 v[228:231], v33 offset:16384
 ds_write_b128 v9, v[60:63]
 ds_write_b128 v10, v[64:67]
 ds_write_b128 v9, v[68:71] offset:128
 ds_write_b128 v10, v[108:111] offset:128
 buffer_load_dwordx4 v[208:211], v2, s[4:7], s59 offen offset:3072 sc1
 ds_read_b128 v[232:235], v30 offset:16640
 s_waitcnt lgkmcnt(8)
 v_mfma_f32_16x16x32_bf16 v[112:115], a[0:3], v[216:219], 0
 v_mfma_f32_16x16x32_bf16 v[116:119], a[64:67], v[216:219], 0
 v_mfma_f32_16x16x32_bf16 v[120:123], a[128:131], v[216:219], 0
 s_add_u32 s87, s57, 0x8000
 s_waitcnt vmcnt(4)
 v_cmp_gt_u32 vcc, 2, v3
 s_nop 0
 s_cbranch_vccnz .Lps_90
.Lpb_91:
 s_add_u32 m0, s80, 32768
 v_xor_b32 v27, 16, v15
 buffer_load_dwordx4 v15, s[4:7], s87 offen sc1 lds
 ds_read_b128 v[236:239], v31 offset:16640
 s_waitcnt lgkmcnt(8)
 v_mfma_f32_16x16x32_bf16 v[112:115], a[4:7], v[220:223], v[112:115]
 v_mfma_f32_16x16x32_bf16 v[116:119], a[68:71], v[220:223], v[116:119]
 v_mfma_f32_16x16x32_bf16 v[120:123], a[132:135], v[220:223], v[120:123]
 v_xor_b32 v28, 32, v15
 buffer_load_dwordx4 v27, s[4:7], s87 offen offset:1024 sc1 lds
 ds_read_b128 v[216:219], v32 offset:16640
 s_waitcnt lgkmcnt(7)
 v_mfma_f32_16x16x32_bf16 v[112:115], a[8:11], v[224:227], v[112:115]
 v_mov_b32 v5, 3
 s_waitcnt vmcnt(5)
 buffer_store_dword v5, off, s[4:7], s67 sc1
 v_mfma_f32_16x16x32_bf16 v[116:119], a[72:75], v[224:227], v[116:119]
 v_mfma_f32_16x16x32_bf16 v[120:123], a[136:139], v[224:227], v[120:123]
 v_xor_b32 v27, 48, v15
 buffer_load_dwordx4 v28, s[4:7], s87 offen offset:2048 sc1 lds
 s_waitcnt lgkmcnt(2)
 s_barrier
 ds_read_b128 v[220:223], v33 offset:16640
 v_mfma_f32_16x16x32_bf16 v[112:115], a[12:15], v[228:231], v[112:115]
 ds_read_b128 v[44:47], v11
 v_mfma_f32_16x16x32_bf16 v[116:119], a[76:79], v[228:231], v[116:119]
 ds_read_b128 v[48:51], v11 offset:4096
 v_mfma_f32_16x16x32_bf16 v[120:123], a[140:143], v[228:231], v[120:123]
 buffer_load_dwordx4 v27, s[4:7], s87 offen offset:3072 sc1 lds
 ds_read_b128 v[52:55], v11 offset:8192
 ds_read_b128 v[224:227], v30 offset:16896
 v_mfma_f32_16x16x32_bf16 v[112:115], a[16:19], v[232:235], v[112:115]
 ds_read_b128 v[56:59], v11 offset:12288
 v_mfma_f32_16x16x32_bf16 v[116:119], a[80:83], v[232:235], v[116:119]
 v_mfma_f32_16x16x32_bf16 v[120:123], a[144:147], v[232:235], v[120:123]
 v_lshlrev_b32 v29, 4, v25
 s_lshl_b32 s90, s48, 8
 s_add_u32 s90, s90, s79
 buffer_load_dwordx4 v[192:195], v29, s[4:7], s90 offen offset:512 sc1
 ds_read_b128 v[228:231], v31 offset:16896
 s_waitcnt lgkmcnt(7)
 v_mfma_f32_16x16x32_bf16 v[112:115], a[20:23], v[236:239], v[112:115]
 v_mfma_f32_16x16x32_bf16 v[116:119], a[84:87], v[236:239], v[116:119]
 v_mfma_f32_16x16x32_bf16 v[120:123], a[148:151], v[236:239], v[120:123]
 buffer_load_dwordx4 v[196:199], v29, s[4:7], s90 offen offset:576 sc1
 ds_read_b128 v[232:235], v32 offset:16896
 v_lshlrev_b32 v36, 16, v16
 v_mfma_f32_16x16x32_bf16 v[112:115], a[24:27], v[216:219], v[112:115]
 v_and_b32 v37, 0xffff0000, v16
 v_lshlrev_b32 v38, 16, v17
 v_and_b32 v39, 0xffff0000, v17
 v_mfma_f32_16x16x32_bf16 v[116:119], a[88:91], v[216:219], v[116:119]
 s_waitcnt lgkmcnt(4)
 v_add_f32 v44, v44, v48
 s_waitcnt lgkmcnt(2)
 v_add_f32 v52, v52, v56
 v_add_f32 v45, v45, v49
 v_mfma_f32_16x16x32_bf16 v[120:123], a[152:155], v[216:219], v[120:123]
 buffer_load_dwordx4 v[200:203], v29, s[4:7], s90 offen offset:640 sc1
 ds_read_b128 v[236:239], v33 offset:16896
 v_add_f32 v53, v53, v57
 v_mfma_f32_16x16x32_bf16 v[112:115], a[28:31], v[220:223], v[112:115]
 v_add_f32 v46, v46, v50
 v_add_f32 v54, v54, v58
 v_add_f32 v47, v47, v51
 v_mfma_f32_16x16x32_bf16 v[116:119], a[92:95], v[220:223], v[116:119]
 v_add_f32 v55, v55, v59
 v_add_f32 v44, v44, v52
 v_add_f32 v45, v45, v53
 v_mfma_f32_16x16x32_bf16 v[120:123], a[156:159], v[220:223], v[120:123]
 ds_read_b128 v[216:219], v30 offset:17152
 v_add_f32 v46, v46, v54
 v_add_f32 v47, v47, v55
 v_mfma_f32_16x16x32_bf16 v[112:115], a[32:35], v[224:227], v[112:115]
 v_add_f32 v36, v36, v44
 v_add_f32 v37, v37, v45
 v_add_f32 v38, v38, v46
 v_mfma_f32_16x16x32_bf16 v[116:119], a[96:99], v[224:227], v[116:119]
 v_add_f32 v39, v39, v47
 v_cvt_pk_bf16_f32 v16, v36, v37
 v_cvt_pk_bf16_f32 v17, v38, v39
 v_mfma_f32_16x16x32_bf16 v[120:123], a[160:163], v[224:227], v[120:123]
 ds_read_b128 v[220:223], v31 offset:17152
 buffer_store_dwordx2 v[16:17], v8, s[4:7], s71 offen sc1
 s_waitcnt lgkmcnt(2)
 v_mfma_f32_16x16x32_bf16 v[112:115], a[36:39], v[228:231], v[112:115]
 v_add_f32 v40, v36, v37
 v_mul_f32 v41, v36, v36
 v_add_f32 v40, v40, v38
 v_mfma_f32_16x16x32_bf16 v[116:119], a[100:103], v[228:231], v[116:119]
 buffer_load_dword v3, v6, s[4:7], s63 offen sc1
 v_fmac_f32 v41, v37, v37
 v_add_f32 v40, v40, v39
 v_mfma_f32_16x16x32_bf16 v[120:123], a[164:167], v[228:231], v[120:123]
 ds_read_b128 v[224:227], v32 offset:17152
 v_fmac_f32 v41, v38, v38
 v_fmac_f32 v41, v39, v39
 v_mfma_f32_16x16x32_bf16 v[112:115], a[40:43], v[232:235], v[112:115]
 v_add_f32_dpp v40, v40, v40 row_ror:8 row_mask:0xf bank_mask:0xf
 v_mfma_f32_16x16x32_bf16 v[116:119], a[104:107], v[232:235], v[116:119]
 v_add_f32_dpp v40, v41, v41 row_ror:8 row_mask:0xf bank_mask:0xc
 v_mfma_f32_16x16x32_bf16 v[120:123], a[168:171], v[232:235], v[120:123]
 ds_read_b128 v[228:231], v33 offset:17152
 v_add_f32_dpp v40, v40, v40 row_half_mirror row_mask:0xf bank_mask:0xf
 s_nop 1
 v_add_f32_dpp v40, v40, v40 quad_perm:[1,0,3,2] row_mask:0xf bank_mask:0xf
 s_nop 1
 v_add_f32_dpp v40, v40, v40 quad_perm:[2,3,0,1] row_mask:0xf bank_mask:0xf
 buffer_store_dword v40, v14, s[4:7], s59 offen sc1
 v_mfma_f32_16x16x32_bf16 v[112:115], a[44:47], v[236:239], v[112:115]
 v_mfma_f32_16x16x32_bf16 v[116:119], a[108:111], v[236:239], v[116:119]
 buffer_load_dwordx4 v[204:207], v2, s[4:7], s59 offen offset:2048 sc1
 s_waitcnt vmcnt(12)
 v_add_f32 v35, v208, v210
 v_add_f32 v36, v209, v211
 v_mfma_f32_16x16x32_bf16 v[120:123], a[172:175], v[236:239], v[120:123]
 v_lshlrev_b32 v94, 2, v25
 v_permlane32_swap_b32 v35, v36
 v_add_f32 v35, v35, v36
 v_sub_u32 v94, v94, v24
 s_waitcnt lgkmcnt(1)
 v_mfma_f32_16x16x32_bf16 v[112:115], a[48:51], v[216:219], v[112:115]
 v_mov_b32 v26, v35
 v_mov_b32 v95, 0x3f80
 v_sub_u32 v42, 0, v94
 v_mfma_f32_16x16x32_bf16 v[116:119], a[112:115], v[216:219], v[116:119]
 v_lshlrev_b32 v43, 4, v42
 v_permlane16_swap_b32 v35, v26
 v_lshlrev_b32 v92, v43, v95
 v_mfma_f32_16x16x32_bf16 v[120:123], a[176:179], v[216:219], v[120:123]
 s_waitcnt vmcnt(7) lgkmcnt(0)
 s_barrier
 ds_read_b128 v[232:235], v30 offset:32768
 ds_read_b128 v[236:239], v31 offset:32768
 v_mfma_f32_16x16x32_bf16 v[112:115], a[52:55], v[220:223], v[112:115]
 v_add_f32 v35, v35, v26
 v_lshrrev_b32 v42, 1, v42
 v_mov_b32 v36, v35
 v_mfma_f32_16x16x32_bf16 v[116:119], a[116:119], v[220:223], v[116:119]
 v_min_u32 v42, 1, v42
 v_add_u32 v42, -1, v42
 v_and_b32 v92, v92, v42
 v_mfma_f32_16x16x32_bf16 v[120:123], a[180:183], v[220:223], v[120:123]
 ds_read_b128 v[216:219], v32 offset:32768
 v_permlane32_swap_b32 v35, v36
 v_sub_u32 v42, -2, v94
 v_mfma_f32_16x16x32_bf16 v[112:115], a[56:59], v[224:227], v[112:115]
 v_mul_f32 v35, s84, v35
 v_lshlrev_b32 v43, 4, v42
 v_mul_f32 v36, s84, v36
 v_mfma_f32_16x16x32_bf16 v[116:119], a[120:123], v[224:227], v[116:119]
 v_lshlrev_b32 v93, v43, v95
 v_fmac_f32 v36, v35, v35
 v_lshrrev_b32 v42, 1, v42
 v_mfma_f32_16x16x32_bf16 v[120:123], a[184:187], v[224:227], v[120:123]
 v_mov_b32 v5, 1
 buffer_store_dword v5, off, s[4:7], s91 offset:2048 sc1
 ds_read_b128 v[220:223], v33 offset:32768
 v_mfma_f32_16x16x32_bf16 v[112:115], a[60:63], v[228:231], v[112:115]
 v_min_f32 v36, 0, v36
 v_min_u32 v42, 1, v42
 v_mfma_f32_16x16x32_bf16 v[116:119], a[124:127], v[228:231], v[116:119]
 v_sub_f32 v36, 0x3727c5ac, v36
 v_add_u32 v42, -1, v42
 v_mfma_f32_16x16x32_bf16 v[120:123], a[188:191], v[228:231], v[120:123]
 v_rsq_f32 v37, v36
 v_and_b32 v93, v93, v42
 ds_read_b128 v[224:227], v30 offset:33024
 s_waitcnt lgkmcnt(2)
 v_mfma_f32_16x16x32_bf16 v[240:243], a[0:3], v[232:235], 0
 v_mov_b32 v64, 0x3f803f80
 v_mov_b32 v65, 0x3f803f80
 v_mov_b32 v66, 0x3f803f80
 v_mfma_f32_16x16x32_bf16 v[244:247], a[64:67], v[232:235], 0
 v_mov_b32 v67, 0x3f803f80
 v_lshrrev_b32 v52, 1, v25
 v_lshlrev_b32 v34, 8, v52
 v_mfma_f32_16x16x32_bf16 v[248:251], a[128:131], v[232:235], 0
 ds_read_b128 v[228:231], v31 offset:33024
 v_lshl_add_u32 v34, v24, 4, v34
 v_and_b32 v52, 1, v25
 v_mfma_f32_16x16x32_bf16 v[240:243], a[4:7], v[236:239], v[240:243]
 v_lshl_add_u32 v34, v52, 3, v34
 s_mul_i32 s94, s55, 0xff800000
 s_mov_b32 s95, 0xff800000
 v_add_u32 v96, -9, v94
 v_mfma_f32_16x16x32_bf16 v[244:247], a[68:71], v[236:239], v[244:247]
 v_ashrrev_i32 v96, 31, v96
 v_and_b32 v96, s95, v96
 v_or_b32 v60, s94, v96
 v_mfma_f32_16x16x32_bf16 v[248:251], a[132:135], v[236:239], v[248:251]
 s_add_u32 s87, s57, 0x4000
 s_waitcnt vmcnt(3)
 v_cmp_gt_u32 vcc, 3, v3
 s_nop 0
 s_cbranch_vccnz .Lps_92
.Lpb_93:
 s_add_u32 m0, s80, 0
 v_xor_b32 v27, 16, v15
 buffer_load_dwordx4 v15, s[4:7], s87 offen sc1 lds
 ds_read_b128 v[232:235], v32 offset:33024
 v_mfma_f32_16x16x32_bf16 v[240:243], a[8:11], v[216:219], v[240:243]
 v_add_u32 v53, 7, v94
 v_mfma_f32_16x16x32_bf16 v[244:247], a[72:75], v[216:219], v[244:247]
 v_fmac_f32 v120, v200, v35
 v_sub_u32 v56, 0, v94
 v_fmac_f32 v121, v201, v35
 v_mfma_f32_16x16x32_bf16 v[248:251], a[136:139], v[216:219], v[248:251]
 v_xor_b32 v28, 32, v15
 buffer_load_dwordx4 v27, s[4:7], s87 offen offset:1024 sc1 lds
 ds_read_b128 v[236:239], v33 offset:33024
 s_waitcnt lgkmcnt(2)
 v_mfma_f32_16x16x32_bf16 v[240:243], a[12:15], v[220:223], v[240:243]
 v_or_b32 v56, v56, v53
 v_fmac_f32 v122, v202, v35
 v_ashrrev_i32 v56, 31, v56
 v_mfma_f32_16x16x32_bf16 v[244:247], a[76:79], v[220:223], v[244:247]
 v_mov_b32 v5, 4
 s_waitcnt vmcnt(4)
 buffer_store_dword v5, off, s[4:7], s67 sc1
 v_mfma_f32_16x16x32_bf16 v[248:251], a[140:143], v[220:223], v[248:251]
 v_xor_b32 v27, 48, v15
 buffer_load_dwordx4 v28, s[4:7], s87 offen offset:2048 sc1 lds
 ds_read_b128 v[216:219], v30 offset:33280
 v_mfma_f32_16x16x32_bf16 v[240:243], a[16:19], v[224:227], v[240:243]
 v_fmac_f32 v123, v203, v35
 v_and_b32 v56, s95, v56
 v_mfma_f32_16x16x32_bf16 v[244:247], a[80:83], v[224:227], v[244:247]
 v_mul_f32 v120, v120, v37
 v_add_u32 v97, -8, v94
 v_mul_f32 v121, v121, v37
 v_mfma_f32_16x16x32_bf16 v[248:251], a[144:147], v[224:227], v[248:251]
 buffer_load_dwordx4 v27, s[4:7], s87 offen offset:3072 sc1 lds
 ds_read_b128 v[220:223], v31 offset:33280
 v_ashrrev_i32 v97, 31, v97
 v_mfma_f32_16x16x32_bf16 v[240:243], a[20:23], v[228:231], v[240:243]
 v_mul_f32 v122, v122, v37
 v_and_b32 v97, s95, v97
 v_mul_f32 v123, v123, v37
 v_mfma_f32_16x16x32_bf16 v[244:247], a[84:87], v[228:231], v[244:247]
 v_or_b32 v61, s94, v97
 v_cvt_pk_bf16_f32 v40, v120, v121
 v_add_u32 v53, 8, v94
 v_mfma_f32_16x16x32_bf16 v[248:251], a[148:151], v[228:231], v[248:251]
 ds_read_b128 v[224:227], v32 offset:33280
 v_cvt_pk_bf16_f32 v41, v122, v123
 v_sub_u32 v57, -1, v94
 s_waitcnt lgkmcnt(2)
 v_mfma_f32_16x16x32_bf16 v[240:243], a[24:27], v[232:235], v[240:243]
 buffer_load_dwordx4 v[212:215], v2, s[4:7], s59 offen offset:1024 sc1
 s_add_u32 s91, s77, 0x0
 buffer_load_dwordx4 v[128:131], v2, s[4:7], s91 offen sc1
 v_mfma_f32_16x16x32_bf16 v[244:247], a[88:91], v[232:235], v[244:247]
 s_waitcnt vmcnt(8)
 v_add_f32 v124, v204, v206
 v_fmac_f32 v116, v196, v35
 v_or_b32 v57, v57, v53
 v_mfma_f32_16x16x32_bf16 v[248:251], a[152:155], v[232:235], v[248:251]
 ds_read_b128 v[228:231], v33 offset:33280
 v_add_f32 v36, v205, v207
 v_fmac_f32 v117, v197, v35
 v_mfma_f32_16x16x32_bf16 v[240:243], a[28:31], v[236:239], v[240:243]
 v_ashrrev_i32 v57, 31, v57
 v_mfma_f32_16x16x16_bf16 v[120:123], v[40:41], v[92:93], 0
 v_mfma_f32_16x16x32_bf16 v[244:247], a[92:95], v[236:239], v[244:247]
 buffer_load_dwordx4 v[132:135], v2, s[4:7], s91 offen offset:1024 sc1
 v_and_b32 v57, s95, v57
 v_add_u32 v98, -7, v94
 v_mfma_f32_16x16x32_bf16 v[248:251], a[156:159], v[236:239], v[248:251]
 ds_read_b128 v[232:235], v30 offset:33536
 v_permlane32_swap_b32 v124, v36
 v_mfma_f32_16x16x32_bf16 v[240:243], a[32:35], v[216:219], v[240:243]
 v_fmac_f32 v118, v198, v35
 v_ashrrev_i32 v98, 31, v98
 v_add_f32 v124, v124, v36
 v_mfma_f32_16x16x32_bf16 v[244:247], a[96:99], v[216:219], v[244:247]
 v_fmac_f32 v119, v199, v35
 v_and_b32 v98, s95, v98
 v_mov_b32 v26, v124
 v_mfma_f32_16x16x32_bf16 v[248:251], a[160:163], v[216:219], v[248:251]
 buffer_load_dwordx4 v[136:139], v2, s[4:7], s91 offen offset:2048 sc1
 ds_read_b128 v[236:239], v31 offset:33536
 v_mul_f32 v116, v116, v37
 s_waitcnt lgkmcnt(2)
 v_mfma_f32_16x16x32_bf16 v[240:243], a[36:39], v[220:223], v[240:243]
 v_or_b32 v62, s94, v98
 v_mul_f32 v117, v117, v37
 v_add_u32 v53, 9, v94
 v_mfma_f32_16x16x32_bf16 v[244:247], a[100:103], v[220:223], v[244:247]
 v_mul_f32 v118, v118, v37
 v_sub_u32 v58, -2, v94
 v_mfma_f32_16x16x32_bf16 v[248:251], a[164:167], v[220:223], v[248:251]
 ds_read_b128 v[216:219], v32 offset:33536
 v_permlane16_swap_b32 v124, v26
 v_mul_f32 v119, v119, v37
 v_mfma_f32_16x16x32_bf16 v[240:243], a[40:43], v[224:227], v[240:243]
 buffer_load_dwordx4 v[140:143], v2, s[4:7], s91 offen offset:3072 sc1
 buffer_load_dword v3, v6, s[4:7], s63 offen sc1
 v_or_b32 v58, v58, v53
 v_mfma_f32_16x16x32_bf16 v[244:247], a[104:107], v[224:227], v[244:247]
 v_add_f32 v124, v124, v26
 v_cvt_pk_bf16_f32 v80, v116, v117
 v_ashrrev_i32 v58, 31, v58
 v_mfma_f32_16x16x32_bf16 v[248:251], a[168:171], v[224:227], v[248:251]
 ds_read_b128 v[220:223], v33 offset:33536
 v_mov_b32 v36, v124
 v_mfma_f32_16x16x32_bf16 v[240:243], a[44:47], v[228:231], v[240:243]
 v_cvt_pk_bf16_f32 v81, v118, v119
 v_and_b32 v58, s95, v58
 v_fmac_f32 v112, v192, v35
 v_mfma_f32_16x16x32_bf16 v[244:247], a[108:111], v[228:231], v[244:247]
 s_add_u32 s91, s77, 0x1000
 buffer_load_dwordx4 v[144:147], v2, s[4:7], s91 offen sc1
 v_add_u32 v99, -6, v94
 v_mfma_f32_16x16x32_bf16 v[248:251], a[172:175], v[228:231], v[248:251]
 v_fmac_f32 v113, v193, v35
 v_ashrrev_i32 v99, 31, v99
 v_permlane32_swap_b32 v124, v36
 s_waitcnt lgkmcnt(1)
 v_mfma_f32_16x16x32_bf16 v[240:243], a[48:51], v[232:235], v[240:243]
 v_fmac_f32 v114, v194, v35
 v_and_b32 v99, s95, v99
 v_mul_f32 v124, s84, v124
 v_mfma_f32_16x16x32_bf16 v[244:247], a[112:115], v[232:235], v[244:247]
 v_fmac_f32 v115, v195, v35
 v_or_b32 v63, s94, v99
 v_mfma_f32_16x16x32_bf16 v[248:251], a[176:179], v[232:235], v[248:251]
 buffer_load_dwordx4 v[148:151], v2, s[4:7], s91 offen offset:1024 sc1
 s_waitcnt vmcnt(8) lgkmcnt(0)
 s_barrier
 ds_read_b128 v[224:227], v30
 ds_read_b128 v[228:231], v31
 v_mfma_f32_16x16x32_bf16 v[240:243], a[52:55], v[236:239], v[240:243]
 v_mul_f32 v36, s84, v36
 v_mfma_f32_16x16x32_bf16 v[244:247], a[116:119], v[236:239], v[244:247]
 v_cvt_pk_bf16_f32 v68, v112, v113
 v_add_u32 v53, 10, v94
 v_fmac_f32 v36, v124, v124
 v_mfma_f32_16x16x32_bf16 v[248:251], a[180:183], v[236:239], v[248:251]
 ds_read_b128 v[232:235], v32
 v_cvt_pk_bf16_f32 v69, v114, v115
 v_mfma_f32_16x16x32_bf16 v[240:243], a[56:59], v[216:219], v[240:243]
 buffer_load_dwordx4 v[152:155], v2, s[4:7], s91 offen offset:2048 sc1
 v_sub_u32 v59, -3, v94
 v_mfma_f32_16x16x32_bf16 v[244:247], a[120:123], v[216:219], v[244:247]
 v_min_f32 v36, 0, v36
 v_mul_f32 v38, 0x3eb8aa3b, v37
 v_or_b32 v59, v59, v53
 v_mfma_f32_16x16x32_bf16 v[248:251], a[184:187], v[216:219], v[248:251]
 ds_read_b128 v[236:239], v33
 v_sub_f32 v36, 0x3727c5ac, v36
 v_cvt_pk_bf16_f32 v90, v120, v121
 v_mfma_f32_16x16x32_bf16 v[240:243], a[60:63], v[220:223], v[240:243]
 v_ashrrev_i32 v59, 31, v59
 v_mfma_f32_16x16x32_bf16 v[244:247], a[124:127], v[220:223], v[244:247]
 buffer_load_dwordx4 v[156:159], v2, s[4:7], s91 offen offset:3072 sc1
 v_rsq_f32 v125, v36
 v_mfma_f32_16x16x32_bf16 v[248:251], a[188:191], v[220:223], v[248:251]
 v_cvt_pk_bf16_f32 v91, v122, v123
 v_and_b32 v59, s95, v59
 ds_read_b128 v[216:219], v30 offset:256
 s_waitcnt lgkmcnt(2)
 v_mfma_f32_16x16x32_bf16 v[112:115], a[0:3], v[224:227], 0
 s_waitcnt vmcnt(9)
 v_add_f32 v35, v212, v214
 v_add_f32 v36, v213, v215
 v_mfma_f32_16x16x32_bf16 v[116:119], a[64:67], v[224:227], 0
 v_mfma_f32_16x16x32_bf16 v[120:123], a[128:131], v[224:227], 0
 ds_read_b128 v[220:223], v31 offset:256
 v_permlane32_swap_b32 v35, v36
 v_fmac_f32 v248, v200, v124
 v_fmac_f32 v249, v201, v124
 v_mfma_f32_16x16x32_bf16 v[112:115], a[4:7], v[228:231], v[112:115]
 v_fmac_f32 v250, v202, v124
 v_fmac_f32 v251, v203, v124
 v_mul_f32 v248, v248, v125
 v_mfma_f32_16x16x32_bf16 v[116:119], a[68:71], v[228:231], v[116:119]
 v_mul_f32 v249, v249, v125
 v_mul_f32 v250, v250, v125
 v_mul_f32 v251, v251, v125
 v_mfma_f32_16x16x32_bf16 v[120:123], a[132:135], v[228:231], v[120:123]
 ds_read_b128 v[224:227], v32 offset:256
 v_cvt_pk_bf16_f32 v40, v248, v249
 v_cvt_pk_bf16_f32 v41, v250, v251
 v_mfma_f32_16x16x32_bf16 v[112:115], a[8:11], v[232:235], v[112:115]
 v_fmac_f32 v244, v196, v124
 v_fmac_f32 v245, v197, v124
 v_mfma_f32_16x16x16_bf16 v[248:251], v[40:41], v[92:93], 0
 v_mfma_f32_16x16x32_bf16 v[116:119], a[72:75], v[232:235], v[116:119]
 s_add_u32 s87, s57, 0x0
 s_waitcnt vmcnt(4)
 v_cmp_gt_u32 vcc, 4, v3
 s_nop 0
 s_cbranch_vccnz .Lps_94
.Lpb_95:
 s_add_u32 m0, s80, 16384
 v_xor_b32 v27, 16, v15
 buffer_load_dwordx4 v15, s[4:7], s87 offen sc1 lds
 v_mfma_f32_16x16x32_bf16 v[120:123], a[136:139], v[232:235], v[120:123]
 ds_read_b128 v[228:231], v33 offset:256
 v_fmac_f32 v246, v198, v124
 s_waitcnt lgkmcnt(2)
 v_mfma_f32_16x16x32_bf16 v[112:115], a[12:15], v[236:239], v[112:115]
 v_fmac_f32 v247, v199, v124
 v_mul_f32 v244, v244, v125
 v_mul_f32 v245, v245, v125
 v_mfma_f32_16x16x32_bf16 v[116:119], a[76:79], v[236:239], v[116:119]
 v_xor_b32 v28, 32, v15
 buffer_load_dwordx4 v27, s[4:7], s87 offen offset:1024 sc1 lds
 v_mul_f32 v246, v246, v125
 v_mfma_f32_16x16x32_bf16 v[120:123], a[140:143], v[236:239], v[120:123]
 ds_read_b128 v[232:235], v30 offset:512
 v_mul_f32 v247, v247, v125
 v_cvt_pk_bf16_f32 v78, v244, v245
 v_cvt_pk_bf16_f32 v79, v246, v247
 v_mfma_f32_16x16x32_bf16 v[112:115], a[16:19], v[216:219], v[112:115]
 v_mfma_f32_16x16x16_bf16 v[104:107], v[80:81], v[68:69], v[56:59]
 v_add_f32 v35, v35, v36
 v_mfma_f32_16x16x32_bf16 v[116:119], a[80:83], v[216:219], v[116:119]
 v_xor_b32 v27, 48, v15
 buffer_load_dwordx4 v28, s[4:7], s87 offen offset:2048 sc1 lds
 v_mfma_f32_16x16x32_bf16 v[120:123], a[144:147], v[216:219], v[120:123]
 ds_read_b128 v[236:239], v31 offset:512
 v_mfma_f32_16x16x16_bf16 v[100:103], v[78:79], v[68:69], v[96:99]
 v_fmac_f32 v240, v192, v124
 v_mfma_f32_16x16x32_bf16 v[112:115], a[20:23], v[220:223], v[112:115]
 v_fmac_f32 v241, v193, v124
 v_fmac_f32 v242, v194, v124
 v_fmac_f32 v243, v195, v124
 v_mfma_f32_16x16x32_bf16 v[116:119], a[84:87], v[220:223], v[116:119]
 buffer_load_dwordx4 v27, s[4:7], s87 offen offset:3072 sc1 lds
 v_cvt_pk_bf16_f32 v70, v240, v241
 v_cvt_pk_bf16_f32 v71, v242, v243
 v_mfma_f32_16x16x32_bf16 v[120:123], a[148:151], v[220:223], v[120:123]
 ds_read_b128 v[216:219], v32 offset:512
 v_mul_f32 v39, 0x3eb8aa3b, v125
 v_cvt_pk_bf16_f32 v88, v248, v249
 s_waitcnt lgkmcnt(2)
 v_mfma_f32_16x16x32_bf16 v[112:115], a[24:27], v[224:227], v[112:115]
 v_cvt_pk_bf16_f32 v89, v250, v251
 v_max3_f32 v24, v104, v105, v106
 v_max3_f32 v24, v24, v107, v100
 v_mfma_f32_16x16x32_bf16 v[116:119], a[88:91], v[224:227], v[116:119]
 v_max3_f32 v24, v24, v101, v102
 v_max_f32 v24, v24, v103
 v_mov_b32 v25, v24
 v_mfma_f32_16x16x32_bf16 v[120:123], a[152:155], v[224:227], v[120:123]
 buffer_load_dwordx4 v[208:211], v2, s[4:7], s59 offen sc1
 buffer_load_dword v3, v6, s[4:7], s62 offen sc1
 ds_read_b128 v[220:223], v33 offset:512
 v_permlane32_swap_b32 v24, v25
 v_mfma_f32_16x16x32_bf16 v[112:115], a[28:31], v[228:231], v[112:115]
 v_max_f32 v24, v24, v25
 v_mov_b32 v25, v24
 v_mov_b32 v26, v35
 v_mfma_f32_16x16x32_bf16 v[116:119], a[92:95], v[228:231], v[116:119]
 v_permlane16_swap_b32 v24, v25
 v_max_f32 v24, v24, v25
 v_mul_f32 v24, v24, v38
 v_mfma_f32_16x16x32_bf16 v[120:123], a[156:159], v[228:231], v[120:123]
 s_add_u32 s91, s77, 0x2000
 buffer_load_dwordx4 v[160:163], v2, s[4:7], s91 offen sc1
 ds_read_b128 v[224:227], v30 offset:768
 v_mfma_f32_16x16x32_bf16 v[112:115], a[32:35], v[232:235], v[112:115]
 v_fma_f32 v100, v100, v38, -v24
 v_exp_f32 v100, v100
 v_fma_f32 v101, v101, v38, -v24
 v_mfma_f32_16x16x32_bf16 v[116:119], a[96:99], v[232:235], v[116:119]
 v_exp_f32 v101, v101
 v_fma_f32 v102, v102, v38, -v24
 v_mfma_f32_16x16x32_bf16 v[120:123], a[160:163], v[232:235], v[120:123]
 ds_read_b128 v[228:231], v31 offset:768
 v_exp_f32 v102, v102
 s_waitcnt lgkmcnt(2)
 v_mfma_f32_16x16x32_bf16 v[112:115], a[36:39], v[236:239], v[112:115]
 buffer_load_dwordx4 v[164:167], v2, s[4:7], s91 offen offset:1024 sc1
 v_fma_f32 v103, v103, v38, -v24
 v_mfma_f32_16x16x32_bf16 v[116:119], a[100:103], v[236:239], v[116:119]
 v_exp_f32 v103, v103
 v_fma_f32 v104, v104, v38, -v24
 v_cvt_pk_bf16_f32 v108, v100, v101
 v_mfma_f32_16x16x32_bf16 v[120:123], a[164:167], v[236:239], v[120:123]
 ds_read_b128 v[232:235], v32 offset:768
 v_exp_f32 v104, v104
 v_mfma_f32_16x16x32_bf16 v[112:115], a[40:43], v[216:219], v[112:115]
 v_fma_f32 v105, v105, v38, -v24
 v_exp_f32 v105, v105
 v_mfma_f32_16x16x32_bf16 v[116:119], a[104:107], v[216:219], v[116:119]
 v_fma_f32 v106, v106, v38, -v24
 v_cvt_pk_bf16_f32 v109, v102, v103
 v_mfma_f32_16x16x32_bf16 v[120:123], a[168:171], v[216:219], v[120:123]
 buffer_load_dwordx4 v[168:171], v2, s[4:7], s91 offen offset:2048 sc1
 ds_read_b128 v[236:239], v33 offset:768
 v_exp_f32 v106, v106
 v_mfma_f32_16x16x32_bf16 v[112:115], a[44:47], v[220:223], v[112:115]
 v_fma_f32 v107, v107, v38, -v24
 v_exp_f32 v107, v107
 v_mfma_f32_16x16x32_bf16 v[116:119], a[108:111], v[220:223], v[116:119]
 v_cvt_pk_bf16_f32 v110, v104, v105
 s_add_u32 s90, s69, 0xc000
 v_cvt_pk_bf16_f32 v111, v106, v107
 v_mfma_f32_16x16x32_bf16 v[120:123], a[172:175], v[220:223], v[120:123]
 v_permlane16_swap_b32 v35, v26
 v_mfma_f32_16x16x32_bf16 v[48:51], v[64:67], v[108:111], 0
 s_waitcnt lgkmcnt(1)
 v_mfma_f32_16x16x32_bf16 v[112:115], a[48:51], v[224:227], v[112:115]
 v_mfma_f32_16x16x32_bf16 v[44:47], v[88:91], v[108:111], 0
 v_add_f32 v35, v35, v26
 v_mfma_f32_16x16x32_bf16 v[116:119], a[112:115], v[224:227], v[116:119]
 buffer_load_dwordx4 v[172:175], v2, s[4:7], s91 offen offset:3072 sc1
 v_mov_b32 v36, v35
 v_mfma_f32_16x16x32_bf16 v[120:123], a[176:179], v[224:227], v[120:123]
 s_waitcnt vmcnt(6) lgkmcnt(0)
 s_barrier
 ds_read_b128 v[216:219], v30 offset:16384
 ds_read_b128 v[220:223], v31 offset:16384
 v_mfma_f32_16x16x32_bf16 v[112:115], a[52:55], v[228:231], v[112:115]
 v_rcp_f32 v24, v48
 v_permlane32_swap_b32 v35, v36
 v_mfma_f32_16x16x32_bf16 v[116:119], a[116:119], v[228:231], v[116:119]
 v_mul_f32 v52, v44, v24
 v_mul_f32 v35, s84, v35
 v_mul_f32 v53, v45, v24
 v_mfma_f32_16x16x32_bf16 v[120:123], a[180:183], v[228:231], v[120:123]
 ds_read_b128 v[224:227], v32 offset:16384
 v_mul_f32 v36, s84, v36
 v_mul_f32 v54, v46, v24
 v_mfma_f32_16x16x32_bf16 v[112:115], a[56:59], v[232:235], v[112:115]
 s_add_u32 s91, s77, 0x3000
 buffer_load_dwordx4 v[176:179], v2, s[4:7], s91 offen sc1
 v_fmac_f32 v36, v35, v35
 v_mfma_f32_16x16x32_bf16 v[116:119], a[120:123], v[232:235], v[116:119]
 v_mul_f32 v55, v47, v24
 v_min_f32 v36, 0, v36
 v_cvt_pk_bf16_f32 v42, v52, v53
 v_mfma_f32_16x16x32_bf16 v[120:123], a[184:187], v[232:235], v[120:123]
 ds_read_b128 v[228:231], v33 offset:16384
 v_sub_f32 v36, 0x3727c5ac, v36
 v_mfma_f32_16x16x32_bf16 v[112:115], a[60:63], v[236:239], v[112:115]
 v_cvt_pk_bf16_f32 v43, v54, v55
 v_rsq_f32 v37, v36
 v_mfma_f32_16x16x32_bf16 v[116:119], a[124:127], v[236:239], v[116:119]
 s_waitcnt vmcnt(5)
 v_cmp_gt_u32 vcc, 1, v3
 s_nop 0
 s_cbranch_vccnz .Lps_88
.Lpb_89:
 s_add_u32 m0, s80, 32768
 v_xor_b32 v27, 16, v15
 buffer_load_dwordx4 v15, s[4:7], s58 offen sc1 lds
 v_mfma_f32_16x16x32_bf16 v[120:123], a[188:191], v[236:239], v[120:123]
 buffer_store_dwordx2 v[42:43], v34, s[4:7], s90 offen sc1
 ds_read_b128 v[232:235], v30 offset:16640
 s_waitcnt lgkmcnt(2)
 v_mfma_f32_16x16x32_bf16 v[240:243], a[0:3], v[216:219], 0
 v_add_f32 v124, v208, v210
 v_add_f32 v36, v209, v211
 v_mfma_f32_16x16x32_bf16 v[244:247], a[64:67], v[216:219], 0
 v_xor_b32 v28, 32, v15
 buffer_load_dwordx4 v27, s[4:7], s58 offen offset:1024 sc1 lds
 v_permlane32_swap_b32 v124, v36
 v_fmac_f32 v120, v200, v35
 v_mfma_f32_16x16x32_bf16 v[248:251], a[128:131], v[216:219], 0
 ds_read_b128 v[236:239], v31 offset:16640
 v_fmac_f32 v121, v201, v35
 v_fmac_f32 v122, v202, v35
 v_fmac_f32 v123, v203, v35
 v_mfma_f32_16x16x32_bf16 v[240:243], a[4:7], v[220:223], v[240:243]
 v_mul_f32 v120, v120, v37
 v_mul_f32 v121, v121, v37
 v_mul_f32 v122, v122, v37
 v_mfma_f32_16x16x32_bf16 v[244:247], a[68:71], v[220:223], v[244:247]
 v_xor_b32 v27, 48, v15
 buffer_load_dwordx4 v28, s[4:7], s58 offen offset:2048 sc1 lds
 v_mul_f32 v123, v123, v37
 v_cvt_pk_bf16_f32 v40, v120, v121
 v_mfma_f32_16x16x32_bf16 v[248:251], a[132:135], v[220:223], v[248:251]
 ds_read_b128 v[216:219], v32 offset:16640
 v_cvt_pk_bf16_f32 v41, v122, v123
 v_fmac_f32 v116, v196, v35
 v_mfma_f32_16x16x32_bf16 v[240:243], a[8:11], v[224:227], v[240:243]
 v_fmac_f32 v117, v197, v35
 v_mfma_f32_16x16x16_bf16 v[120:123], v[40:41], v[92:93], 0
 v_fmac_f32 v118, v198, v35
 v_mfma_f32_16x16x32_bf16 v[244:247], a[72:75], v[224:227], v[244:247]
 buffer_load_dwordx4 v27, s[4:7], s58 offen offset:3072 sc1 lds
 v_fmac_f32 v119, v199, v35
 v_mul_f32 v116, v116, v37
 v_mfma_f32_16x16x32_bf16 v[248:251], a[136:139], v[224:227], v[248:251]
 ds_read_b128 v[220:223], v33 offset:16640
 v_mul_f32 v117, v117, v37
 v_mul_f32 v118, v118, v37
 v_mul_f32 v119, v119, v37
 s_waitcnt lgkmcnt(2)
 v_mfma_f32_16x16x32_bf16 v[240:243], a[12:15], v[228:231], v[240:243]
 v_cvt_pk_bf16_f32 v76, v116, v117
 v_cvt_pk_bf16_f32 v77, v118, v119
 v_mfma_f32_16x16x32_bf16 v[244:247], a[76:79], v[228:231], v[244:247]
 v_mfma_f32_16x16x16_bf16 v[104:107], v[78:79], v[70:71], v[56:59]
 v_add_f32 v124, v124, v36
 v_mfma_f32_16x16x16_bf16 v[100:103], v[76:77], v[70:71], v[96:99]
 v_mfma_f32_16x16x32_bf16 v[248:251], a[140:143], v[228:231], v[248:251]
 buffer_load_dwordx4 v[204:207], v2, s[4:7], s60 offen sc1
 ds_read_b128 v[224:227], v30 offset:16896
 v_mfma_f32_16x16x32_bf16 v[240:243], a[16:19], v[232:235], v[240:243]
 v_fmac_f32 v112, v192, v35
 v_fmac_f32 v113, v193, v35
 v_fmac_f32 v114, v194, v35
 v_fmac_f32 v115, v195, v35
 v_mfma_f32_16x16x32_bf16 v[244:247], a[80:83], v[232:235], v[244:247]
 v_cvt_pk_bf16_f32 v68, v112, v113
 v_cvt_pk_bf16_f32 v69, v114, v115
 v_mul_f32 v38, 0x3eb8aa3b, v37
 v_mfma_f32_16x16x32_bf16 v[248:251], a[144:147], v[232:235], v[248:251]
 ds_read_b128 v[228:231], v31 offset:16896
 v_cvt_pk_bf16_f32 v86, v120, v121
 v_cvt_pk_bf16_f32 v87, v122, v123
 v_max3_f32 v24, v104, v105, v106
 v_mfma_f32_16x16x32_bf16 v[240:243], a[20:23], v[236:239], v[240:243]
 buffer_load_dwordx4 v[180:183], v2, s[4:7], s91 offen offset:1024 sc1
 v_max3_f32 v24, v24, v107, v100
 v_max3_f32 v24, v24, v101, v102
 v_mfma_f32_16x16x32_bf16 v[244:247], a[84:87], v[236:239], v[244:247]
 v_max_f32 v24, v24, v103
 v_mov_b32 v25, v24
 v_mov_b32 v26, v124
 v_mfma_f32_16x16x32_bf16 v[248:251], a[148:151], v[236:239], v[248:251]
 ds_read_b128 v[232:235], v32 offset:16896
 v_permlane32_swap_b32 v24, v25
 v_max_f32 v24, v24, v25
 v_mov_b32 v25, v24
 s_waitcnt lgkmcnt(2)
 v_mfma_f32_16x16x32_bf16 v[240:243], a[24:27], v[216:219], v[240:243]
 v_permlane16_swap_b32 v124, v26
 v_permlane16_swap_b32 v24, v25
 v_max_f32 v24, v24, v25
 v_mfma_f32_16x16x32_bf16 v[244:247], a[88:91], v[216:219], v[244:247]
 v_mul_f32 v24, v24, v39
 v_fma_f32 v100, v100, v39, -v24
 v_exp_f32 v100, v100
 v_mfma_f32_16x16x32_bf16 v[248:251], a[152:155], v[216:219], v[248:251]
 ds_read_b128 v[236:239], v33 offset:16896
 v_fma_f32 v101, v101, v39, -v24
 v_exp_f32 v101, v101
 v_mfma_f32_16x16x32_bf16 v[240:243], a[28:31], v[220:223], v[240:243]
 buffer_load_dwordx4 v[184:187], v2, s[4:7], s91 offen offset:2048 sc1
 v_mov_b32 v5, 5
 s_waitcnt vmcnt(6)
 buffer_store_dword v5, off, s[4:7], s67 offset:512 sc1
 v_mfma_f32_16x16x32_bf16 v[244:247], a[92:95], v[220:223], v[244:247]
 v_fma_f32 v102, v102, v39, -v24
 v_mfma_f32_16x16x32_bf16 v[248:251], a[156:159], v[220:223], v[248:251]
 ds_read_b128 v[216:219], v30 offset:17152
 v_exp_f32 v102, v102
 v_fma_f32 v103, v103, v39, -v24
 v_mfma_f32_16x16x32_bf16 v[240:243], a[32:35], v[224:227], v[240:243]
 v_exp_f32 v103, v103
 v_fma_f32 v104, v104, v39, -v24
 v_mfma_f32_16x16x32_bf16 v[244:247], a[96:99], v[224:227], v[244:247]
 v_cvt_pk_bf16_f32 v108, v100, v101
 v_exp_f32 v104, v104
 v_mfma_f32_16x16x32_bf16 v[248:251], a[160:163], v[224:227], v[248:251]
 ds_read_b128 v[220:223], v31 offset:17152
 v_fma_f32 v105, v105, v39, -v24
 v_exp_f32 v105, v105
 s_waitcnt lgkmcnt(2)
 v_mfma_f32_16x16x32_bf16 v[240:243], a[36:39], v[228:231], v[240:243]
 buffer_load_dwordx4 v[188:191], v2, s[4:7], s91 offen offset:3072 sc1
 v_fma_f32 v106, v106, v39, -v24
 v_cvt_pk_bf16_f32 v109, v102, v103
 v_mfma_f32_16x16x32_bf16 v[244:247], a[100:103], v[228:231], v[244:247]
 v_exp_f32 v106, v106
 v_fma_f32 v107, v107, v39, -v24
 v_mfma_f32_16x16x32_bf16 v[248:251], a[164:167], v[228:231], v[248:251]
 ds_read_b128 v[224:227], v32 offset:17152
 v_exp_f32 v107, v107
 v_mfma_f32_16x16x32_bf16 v[240:243], a[40:43], v[232:235], v[240:243]
 v_cvt_pk_bf16_f32 v110, v104, v105
 s_add_u32 s90, s69, 0x8000
 v_cvt_pk_bf16_f32 v111, v106, v107
 v_add_f32 v124, v124, v26
 v_mfma_f32_16x16x32_bf16 v[244:247], a[104:107], v[232:235], v[244:247]
 v_mfma_f32_16x16x32_bf16 v[48:51], v[64:67], v[108:111], 0
 v_mfma_f32_16x16x32_bf16 v[44:47], v[86:89], v[108:111], 0
 v_mfma_f32_16x16x32_bf16 v[248:251], a[168:171], v[232:235], v[248:251]
 ds_read_b128 v[228:231], v33 offset:17152
 v_mov_b32 v36, v124
 v_mfma_f32_16x16x32_bf16 v[240:243], a[44:47], v[236:239], v[240:243]
 v_mfma_f32_16x16x32_bf16 v[244:247], a[108:111], v[236:239], v[244:247]
 v_permlane32_swap_b32 v124, v36
 v_mul_f32 v124, s84, v124
 v_rcp_f32 v24, v48
 v_mfma_f32_16x16x32_bf16 v[248:251], a[172:175], v[236:239], v[248:251]
 v_mul_f32 v52, v44, v24
 v_mul_f32 v53, v45, v24
 v_mul_f32 v36, s84, v36
 v_mul_f32 v54, v46, v24
 s_waitcnt lgkmcnt(1)
 v_mfma_f32_16x16x32_bf16 v[240:243], a[48:51], v[216:219], v[240:243]
 v_fmac_f32 v36, v124, v124
 v_mul_f32 v55, v47, v24
 v_min_f32 v36, 0, v36
 v_mfma_f32_16x16x32_bf16 v[244:247], a[112:115], v[216:219], v[244:247]
 v_cvt_pk_bf16_f32 v42, v52, v53
 v_sub_f32 v36, 0x3727c5ac, v36
 v_cvt_pk_bf16_f32 v43, v54, v55
 v_mfma_f32_16x16x32_bf16 v[248:251], a[176:179], v[216:219], v[248:251]
 s_waitcnt vmcnt(5) lgkmcnt(0)
 s_barrier
 ds_read_b128 v[232:235], v30 offset:32768
 ds_read_b128 v[236:239], v31 offset:32768
 v_mfma_f32_16x16x32_bf16 v[240:243], a[52:55], v[220:223], v[240:243]
 v_rsq_f32 v125, v36
 buffer_store_dwordx2 v[42:43], v34, s[4:7], s90 offen sc1
 v_mfma_f32_16x16x32_bf16 v[244:247], a[116:119], v[220:223], v[244:247]
 v_mfma_f32_16x16x32_bf16 v[248:251], a[180:183], v[220:223], v[248:251]
 ds_read_b128 v[216:219], v32 offset:32768
 v_mfma_f32_16x16x32_bf16 v[240:243], a[56:59], v[224:227], v[240:243]
 buffer_load_dword v3, v7, s[4:7], s64 offen sc1
 v_mfma_f32_16x16x32_bf16 v[244:247], a[120:123], v[224:227], v[244:247]
 v_mfma_f32_16x16x32_bf16 v[248:251], a[184:187], v[224:227], v[248:251]
 ds_read_b128 v[220:223], v33 offset:32768
 v_mfma_f32_16x16x32_bf16 v[240:243], a[60:63], v[228:231], v[240:243]
 v_mfma_f32_16x16x32_bf16 v[244:247], a[124:127], v[228:231], v[244:247]
 v_mfma_f32_16x16x32_bf16 v[248:251], a[188:191], v[228:231], v[248:251]
 ds_read_b128 v[224:227], v30 offset:33024
 s_waitcnt lgkmcnt(4)
 v_mfma_f32_16x16x32_bf16 v[116:119], a[64:67], v[232:235], 0
 s_waitcnt vmcnt(6)
 v_add_f32 v35, v204, v206
 v_add_f32 v36, v205, v207
 v_mfma_f32_16x16x32_bf16 v[120:123], a[128:131], v[232:235], 0
 s_add_u32 s89, s78, 0x0
 buffer_load_dwordx4 a[0:3], v2, s[4:7], s89 offen offset:3072 sc1
 ds_read_b128 v[228:231], v31 offset:33024
 v_fmac_f32 v248, v200, v124
 v_fmac_f32 v249, v201, v124
 v_fmac_f32 v250, v202, v124
 s_waitcnt lgkmcnt(3)
 v_mfma_f32_16x16x32_bf16 v[116:119], a[68:71], v[236:239], v[116:119]
 v_fmac_f32 v251, v203, v124
 v_mul_f32 v248, v248, v125
 v_mul_f32 v249, v249, v125
 v_mul_f32 v250, v250, v125
 v_mfma_f32_16x16x32_bf16 v[120:123], a[132:135], v[236:239], v[120:123]
 s_add_u32 s89, s78, 0x1000
 buffer_load_dwordx4 a[4:7], v2, s[4:7], s89 offen offset:3072 sc1
 ds_read_b128 v[232:235], v32 offset:33024
 v_mul_f32 v251, v251, v125
 v_cvt_pk_bf16_f32 v40, v248, v249
 v_mfma_f32_16x16x32_bf16 v[116:119], a[72:75], v[216:219], v[116:119]
 v_cvt_pk_bf16_f32 v41, v250, v251
 v_fmac_f32 v244, v196, v124
 v_fmac_f32 v245, v197, v124
 v_mfma_f32_16x16x16_bf16 v[248:251], v[40:41], v[92:93], 0
 v_mfma_f32_16x16x32_bf16 v[120:123], a[136:139], v[216:219], v[120:123]
 ds_read_b128 v[236:239], v33 offset:33024
 v_fmac_f32 v246, v198, v124
 v_fmac_f32 v247, v199, v124
 v_mul_f32 v244, v244, v125
 s_waitcnt lgkmcnt(2)
 v_mfma_f32_16x16x32_bf16 v[116:119], a[76:79], v[220:223], v[116:119]
 s_add_u32 s89, s78, 0x2000
 buffer_load_dwordx4 a[8:11], v2, s[4:7], s89 offen offset:3072 sc1
 v_mul_f32 v245, v245, v125
 v_mul_f32 v246, v246, v125
 v_mul_f32 v247, v247, v125
 v_cvt_pk_bf16_f32 v74, v244, v245
 v_mfma_f32_16x16x32_bf16 v[120:123], a[140:143], v[220:223], v[120:123]
 ds_read_b128 v[216:219], v30 offset:33280
 v_cvt_pk_bf16_f32 v75, v246, v247
 v_mfma_f32_16x16x16_bf16 v[104:107], v[76:77], v[68:69], v[56:59]
 v_mfma_f32_16x16x32_bf16 v[116:119], a[80:83], v[224:227], v[116:119]
 s_add_u32 s89, s78, 0x3000
 buffer_load_dwordx4 a[12:15], v2, s[4:7], s89 offen offset:3072 sc1
 v_mfma_f32_16x16x16_bf16 v[100:103], v[74:75], v[68:69], v[96:99]
 v_fmac_f32 v240, v192, v124
 v_mfma_f32_16x16x32_bf16 v[120:123], a[144:147], v[224:227], v[120:123]
 v_mov_b32 v5, 6
 s_waitcnt vmcnt(5)
 buffer_store_dword v5, off, s[4:7], s67 offset:512 sc1
 ds_read_b128 v[220:223], v31 offset:33280
 v_mfma_f32_16x16x32_bf16 v[116:119], a[84:87], v[228:231], v[116:119]
 v_fmac_f32 v241, v193, v124
 v_fmac_f32 v242, v194, v124
 v_fmac_f32 v243, v195, v124
 v_cvt_pk_bf16_f32 v70, v240, v241
 v_cvt_pk_bf16_f32 v71, v242, v243
 v_mfma_f32_16x16x32_bf16 v[120:123], a[148:151], v[228:231], v[120:123]
 s_add_u32 s89, s78, 0x4000
 buffer_load_dwordx4 a[16:19], v2, s[4:7], s89 offen offset:3072 sc1
 ds_read_b128 v[224:227], v32 offset:33280
 v_mul_f32 v39, 0x3eb8aa3b, v125
 v_cvt_pk_bf16_f32 v84, v248, v249
 s_waitcnt lgkmcnt(2)
 v_mfma_f32_16x16x32_bf16 v[116:119], a[88:91], v[232:235], v[116:119]
 v_cvt_pk_bf16_f32 v85, v250, v251
 v_max3_f32 v24, v104, v105, v106
 v_max3_f32 v24, v24, v107, v100
 v_max3_f32 v24, v24, v101, v102
 v_mfma_f32_16x16x32_bf16 v[120:123], a[152:155], v[232:235], v[120:123]
 ds_read_b128 v[228:231], v33 offset:33280
 v_max_f32 v24, v24, v103
 v_mov_b32 v25, v24
 v_permlane32_swap_b32 v35, v36
 v_add_f32 v35, v35, v36
 v_mfma_f32_16x16x32_bf16 v[116:119], a[92:95], v[236:239], v[116:119]
 s_add_u32 s89, s78, 0x5000
 buffer_load_dwordx4 a[20:23], v2, s[4:7], s89 offen offset:1024 sc1
 v_permlane32_swap_b32 v24, v25
 v_max_f32 v24, v24, v25
 v_mov_b32 v25, v24
 v_mfma_f32_16x16x32_bf16 v[120:123], a[156:159], v[236:239], v[120:123]
 s_add_u32 s85, s70, 0xc000
 s_waitcnt vmcnt(7)
 v_cmp_gt_u32 vcc, 5, v3
 s_nop 0
 s_cbranch_vccnz .Lps_96
.Lpb_97:
 ds_read_b128 v[232:235], v30 offset:33536
 v_permlane16_swap_b32 v24, v25
 v_mfma_f32_16x16x32_bf16 v[116:119], a[96:99], v[216:219], v[116:119]
 v_max_f32 v24, v24, v25
 v_mul_f32 v24, v24, v38
 v_fma_f32 v100, v100, v38, -v24
 v_exp_f32 v100, v100
 v_mfma_f32_16x16x32_bf16 v[120:123], a[160:163], v[216:219], v[120:123]
 buffer_load_dwordx4 v[212:215], v2, s[4:7], s85 offen sc1
 ds_read_b128 v[236:239], v31 offset:33536
 v_fma_f32 v101, v101, v38, -v24
 s_waitcnt lgkmcnt(2)
 v_mfma_f32_16x16x32_bf16 v[116:119], a[100:103], v[220:223], v[116:119]
 v_exp_f32 v101, v101
 v_fma_f32 v102, v102, v38, -v24
 v_exp_f32 v102, v102
 v_mfma_f32_16x16x32_bf16 v[120:123], a[164:167], v[220:223], v[120:123]
 ds_read_b128 v[216:219], v32 offset:33536
 v_fma_f32 v103, v103, v38, -v24
 v_exp_f32 v103, v103
 v_mfma_f32_16x16x32_bf16 v[116:119], a[104:107], v[224:227], v[116:119]
 buffer_load_dwordx4 v[124:127], v2, s[4:7], s85 offen offset:1024 sc1
 v_fma_f32 v104, v104, v38, -v24
 v_cvt_pk_bf16_f32 v108, v100, v101
 v_exp_f32 v104, v104
 v_mfma_f32_16x16x32_bf16 v[120:123], a[168:171], v[224:227], v[120:123]
 ds_read_b128 v[220:223], v33 offset:33536
 v_fma_f32 v105, v105, v38, -v24
 v_exp_f32 v105, v105
 v_mfma_f32_16x16x32_bf16 v[116:119], a[108:111], v[228:231], v[116:119]
 v_fma_f32 v106, v106, v38, -v24
 v_cvt_pk_bf16_f32 v109, v102, v103
 v_exp_f32 v106, v106
 v_mfma_f32_16x16x32_bf16 v[120:123], a[172:175], v[228:231], v[120:123]
 buffer_load_dwordx4 v[252:255], v2, s[4:7], s85 offen offset:2048 sc1
 buffer_load_dword v3, v7, s[4:7], s64 offen sc1
 v_fma_f32 v107, v107, v38, -v24
 s_waitcnt lgkmcnt(2)
 v_mfma_f32_16x16x32_bf16 v[116:119], a[112:115], v[232:235], v[116:119]
 v_exp_f32 v107, v107
 v_cvt_pk_bf16_f32 v110, v104, v105
 s_add_u32 s90, s69, 0x4000
 v_cvt_pk_bf16_f32 v111, v106, v107
 v_mfma_f32_16x16x32_bf16 v[120:123], a[176:179], v[232:235], v[120:123]
 v_mov_b32 v26, v35
 v_mfma_f32_16x16x32_bf16 v[48:51], v[64:67], v[108:111], 0
 v_mfma_f32_16x16x32_bf16 v[44:47], v[84:87], v[108:111], 0
 v_mfma_f32_16x16x32_bf16 v[116:119], a[116:119], v[236:239], v[116:119]
 buffer_load_dwordx4 v[240:243], v2, s[4:7], s85 offen offset:3072 sc1
 v_permlane16_swap_b32 v35, v26
 v_add_f32 v35, v35, v26
 v_mfma_f32_16x16x32_bf16 v[120:123], a[180:183], v[236:239], v[120:123]
 v_mov_b32 v36, v35
 s_waitcnt lgkmcnt(0)
 v_mfma_f32_16x16x32_bf16 v[116:119], a[120:123], v[216:219], v[116:119]
 v_rcp_f32 v24, v48
 v_permlane32_swap_b32 v35, v36
 v_mul_f32 v52, v44, v24
 v_mul_f32 v35, s84, v35
 v_mfma_f32_16x16x32_bf16 v[120:123], a[184:187], v[216:219], v[120:123]
 v_mul_f32 v53, v45, v24
 v_mul_f32 v36, s84, v36
 v_mul_f32 v54, v46, v24
 v_fmac_f32 v36, v35, v35
 v_mul_f32 v55, v47, v24
 v_mfma_f32_16x16x32_bf16 v[116:119], a[124:127], v[220:223], v[116:119]
 v_min_f32 v36, 0, v36
 v_cvt_pk_bf16_f32 v42, v52, v53
 v_sub_f32 v36, 0x3727c5ac, v36
 v_mfma_f32_16x16x32_bf16 v[120:123], a[188:191], v[220:223], v[120:123]
 v_cvt_pk_bf16_f32 v43, v54, v55
 v_rsq_f32 v37, v36
 buffer_store_dwordx2 v[42:43], v34, s[4:7], s90 offen sc1
 s_add_u32 s85, s70, 0x8000
 s_waitcnt vmcnt(2)
 v_cmp_gt_u32 vcc, 6, v3
 s_nop 0
 s_cbranch_vccnz .Lps_98
.Lpb_99:
 buffer_load_dwordx4 v[216:219], v2, s[4:7], s85 offen sc1
 v_mfma_f32_16x16x32_bf16 v[244:247], v[128:131], v[212:215], 0
 v_mfma_f32_16x16x32_bf16 v[248:251], v[132:135], v[212:215], 0
 buffer_load_dwordx4 v[220:223], v2, s[4:7], s85 offen offset:1024 sc1
 v_mfma_f32_16x16x32_bf16 v[232:235], v[136:139], v[212:215], 0
 v_mfma_f32_16x16x32_bf16 v[236:239], v[140:143], v[212:215], 0
 buffer_load_dwordx4 v[224:227], v2, s[4:7], s85 offen offset:2048 sc1
 v_fmac_f32 v120, v200, v35
 v_fmac_f32 v121, v201, v35
 v_fmac_f32 v122, v202, v35
 v_mfma_f32_16x16x32_bf16 v[244:247], v[144:147], v[124:127], v[244:247]
 v_fmac_f32 v123, v203, v35
 v_mul_f32 v120, v120, v37
 v_mul_f32 v121, v121, v37
 v_mul_f32 v122, v122, v37
 v_mfma_f32_16x16x32_bf16 v[248:251], v[148:151], v[124:127], v[248:251]
 buffer_load_dwordx4 v[228:231], v2, s[4:7], s85 offen offset:3072 sc1
 v_mul_f32 v123, v123, v37
 v_cvt_pk_bf16_f32 v40, v120, v121
 v_cvt_pk_bf16_f32 v41, v122, v123
 v_mfma_f32_16x16x32_bf16 v[232:235], v[152:155], v[124:127], v[232:235]
 v_fmac_f32 v116, v196, v35
 v_fmac_f32 v117, v197, v35
 v_mfma_f32_16x16x16_bf16 v[120:123], v[40:41], v[92:93], 0
 v_mfma_f32_16x16x32_bf16 v[236:239], v[156:159], v[124:127], v[236:239]
 v_fmac_f32 v118, v198, v35
 v_fmac_f32 v119, v199, v35
 v_mul_f32 v116, v116, v37
 v_mfma_f32_16x16x32_bf16 v[244:247], v[160:163], v[252:255], v[244:247]
 s_add_u32 s89, s78, 0x5000
 buffer_load_dwordx4 a[24:27], v2, s[4:7], s89 offen offset:2048 sc1
 v_mul_f32 v117, v117, v37
 v_mul_f32 v118, v118, v37
 v_mfma_f32_16x16x32_bf16 v[248:251], v[164:167], v[252:255], v[248:251]
 v_mov_b32 v5, 7
 s_waitcnt vmcnt(5)
 buffer_store_dword v5, off, s[4:7], s67 offset:512 sc1
 v_mul_f32 v119, v119, v37
 v_mfma_f32_16x16x32_bf16 v[232:235], v[168:171], v[252:255], v[232:235]
 v_cvt_pk_bf16_f32 v72, v116, v117
 v_cvt_pk_bf16_f32 v73, v118, v119
 v_mfma_f32_16x16x16_bf16 v[104:107], v[74:75], v[70:71], v[56:59]
 v_mfma_f32_16x16x32_bf16 v[236:239], v[172:175], v[252:255], v[236:239]
 s_add_u32 s89, s78, 0x5000
 buffer_load_dwordx4 a[28:31], v2, s[4:7], s89 offen offset:3072 sc1
 v_mfma_f32_16x16x32_bf16 v[244:247], v[176:179], v[240:243], v[244:247]
 v_mfma_f32_16x16x16_bf16 v[100:103], v[72:73], v[70:71], v[60:63]
 v_cvt_pk_bf16_f32 v82, v120, v121
 v_cvt_pk_bf16_f32 v83, v122, v123
 v_mfma_f32_16x16x32_bf16 v[248:251], v[180:183], v[240:243], v[248:251]
 v_mfma_f32_16x16x32_bf16 v[232:235], v[184:187], v[240:243], v[232:235]
 s_add_u32 s89, s78, 0x6000
 buffer_load_dwordx4 a[32:35], v2, s[4:7], s89 offen sc1
 v_mfma_f32_16x16x32_bf16 v[236:239], v[188:191], v[240:243], v[236:239]
 v_max3_f32 v24, v104, v105, v106
 v_max3_f32 v24, v24, v107, v100
 v_max3_f32 v24, v24, v101, v102
 v_max_f32 v24, v24, v103
 s_waitcnt vmcnt(7)
 v_mfma_f32_16x16x32_bf16 v[96:99], v[128:131], v[216:219], 0
 v_mov_b32 v25, v24
 v_mfma_f32_16x16x32_bf16 v[192:195], v[132:135], v[216:219], 0
 s_add_u32 s89, s78, 0x6000
 buffer_load_dwordx4 a[36:39], v2, s[4:7], s89 offen offset:1024 sc1
 v_permlane32_swap_b32 v24, v25
 v_max_f32 v24, v24, v25
 v_mov_b32 v25, v24
 v_mfma_f32_16x16x32_bf16 v[196:199], v[136:139], v[216:219], 0
 v_mfma_f32_16x16x32_bf16 v[200:203], v[140:143], v[216:219], 0
 v_permlane16_swap_b32 v24, v25
 v_max_f32 v24, v24, v25
 v_mul_f32 v24, v24, v39
 v_fma_f32 v100, v100, v39, -v24
 s_waitcnt vmcnt(7)
 v_mfma_f32_16x16x32_bf16 v[96:99], v[144:147], v[220:223], v[96:99]
 s_add_u32 s89, s78, 0x6000
 buffer_load_dwordx4 a[40:43], v2, s[4:7], s89 offen offset:2048 sc1
 v_exp_f32 v100, v100
 v_fma_f32 v101, v101, v39, -v24
 v_mfma_f32_16x16x32_bf16 v[192:195], v[148:151], v[220:223], v[192:195]
 ds_write_b128 v9, v[244:247]
 v_exp_f32 v101, v101
 v_fma_f32 v102, v102, v39, -v24
 v_mfma_f32_16x16x32_bf16 v[196:199], v[152:155], v[220:223], v[196:199]
 v_exp_f32 v102, v102
 v_fma_f32 v103, v103, v39, -v24
 v_exp_f32 v103, v103
 v_mfma_f32_16x16x32_bf16 v[200:203], v[156:159], v[220:223], v[200:203]
 v_fma_f32 v104, v104, v39, -v24
 v_cvt_pk_bf16_f32 v108, v100, v101
 v_exp_f32 v104, v104
 s_waitcnt vmcnt(7)
 v_mfma_f32_16x16x32_bf16 v[96:99], v[160:163], v[224:227], v[96:99]
 buffer_load_dword v3, v7, s[4:7], s64 offen sc1
 ds_write_b128 v10, v[248:251]
 v_fma_f32 v105, v105, v39, -v24
 v_mfma_f32_16x16x32_bf16 v[192:195], v[164:167], v[224:227], v[192:195]
 v_exp_f32 v105, v105
 v_fma_f32 v106, v106, v39, -v24
 v_cvt_pk_bf16_f32 v109, v102, v103
 v_mfma_f32_16x16x32_bf16 v[196:199], v[168:171], v[224:227], v[196:199]
 v_exp_f32 v106, v106
 v_fma_f32 v107, v107, v39, -v24
 v_exp_f32 v107, v107
 v_mfma_f32_16x16x32_bf16 v[200:203], v[172:175], v[224:227], v[200:203]
 ds_write_b128 v9, v[232:235] offset:128
 v_cvt_pk_bf16_f32 v110, v104, v105
 s_add_u32 s90, s69, 0x0
 v_cvt_pk_bf16_f32 v111, v106, v107
 s_waitcnt vmcnt(7)
 v_mfma_f32_16x16x32_bf16 v[96:99], v[176:179], v[228:231], v[96:99]
 v_mfma_f32_16x16x32_bf16 v[192:195], v[180:183], v[228:231], v[192:195]
 v_mfma_f32_16x16x32_bf16 v[48:51], v[64:67], v[108:111], 0
 v_mfma_f32_16x16x32_bf16 v[44:47], v[82:85], v[108:111], 0
 v_mfma_f32_16x16x32_bf16 v[196:199], v[184:187], v[228:231], v[196:199]
 ds_write_b128 v10, v[236:239] offset:128
 v_mfma_f32_16x16x32_bf16 v[200:203], v[188:191], v[228:231], v[200:203]
 s_nop 3
 v_rcp_f32 v24, v48
 s_nop 0
 v_mul_f32 v52, v44, v24
 v_mul_f32 v53, v45, v24
 v_mul_f32 v54, v46, v24
 v_mul_f32 v55, v47, v24
 v_cvt_pk_bf16_f32 v42, v52, v53
 v_cvt_pk_bf16_f32 v43, v54, v55
 buffer_store_dwordx2 v[42:43], v34, s[4:7], s90 offen sc1
 ds_write_b128 v9, v[96:99] offset:16384
 ds_write_b128 v10, v[192:195] offset:16384
 ds_write_b128 v9, v[196:199] offset:16512
 ds_write_b128 v10, v[200:203] offset:16512
 s_add_u32 s89, s78, 0x6000
 buffer_load_dwordx4 a[44:47], v2, s[4:7], s89 offen offset:3072 sc1
 v_add_u32 v26, 57344, v2
 v_and_b32 v24, 15, v1
 v_lshrrev_b32 v25, 4, v1
 v_lshlrev_b32 v29, 4, v25
 s_add_u32 s89, s78, 0x7000
 buffer_load_dwordx4 a[48:51], v2, s[4:7], s89 offen sc1
 v_and_b32 v28, 1, v25
 v_lshlrev_b32 v28, 3, v28
 v_lshl_add_u32 v28, v24, 4, v28
 v_lshrrev_b32 v25, 1, v25
 s_add_u32 s89, s78, 0x7000
 buffer_load_dwordx4 a[52:55], v2, s[4:7], s89 offen offset:1024 sc1
 v_lshl_add_u32 v27, v25, 8, v28
 v_xor_b32 v25, 1, v25
 v_mul_u32_u24 v25, 57344, v25
 v_add_u32 v28, v28, v25
 s_waitcnt lgkmcnt(0)
 s_barrier
 ds_read_b128 v[212:215], v11
 ds_read_b128 v[124:127], v11 offset:4096
 ds_read_b128 v[252:255], v11 offset:8192
 ds_read_b128 v[240:243], v11 offset:12288
 ds_read_b128 v[216:219], v11 offset:16384
 ds_read_b128 v[220:223], v11 offset:20480
 ds_read_b128 v[224:227], v11 offset:24576
 ds_read_b128 v[228:231], v11 offset:28672
 s_add_u32 s85, s70, 0x4000
 s_waitcnt vmcnt(4)
 v_cmp_gt_u32 vcc, 7, v3
 s_nop 0
 s_cbranch_vccnz .Lps_100
.Lpb_101:
 buffer_load_dwordx4 v[44:47], v2, s[4:7], s85 offen sc1
 buffer_load_dwordx4 v[48:51], v2, s[4:7], s85 offen offset:1024 sc1
 v_mov_b32 v5, 8
 s_waitcnt vmcnt(5)
 buffer_store_dword v5, off, s[4:7], s67 offset:512 sc1
 s_add_u32 s90, s71, 0x8000
 s_add_u32 s91, s71, 0x8000
 v_lshlrev_b32 v100, 16, v22
 v_lshlrev_b32 v104, 16, v20
 v_and_b32 v101, 0xffff0000, v22
 v_and_b32 v105, 0xffff0000, v20
 buffer_load_dwordx4 v[52:55], v2, s[4:7], s85 offen offset:2048 sc1
 v_lshlrev_b32 v102, 16, v23
 v_lshlrev_b32 v106, 16, v21
 v_and_b32 v103, 0xffff0000, v23
 v_and_b32 v107, 0xffff0000, v21
 s_waitcnt lgkmcnt(6)
 v_pk_add_f32 v[212:213], v[212:213], v[124:125]
 s_waitcnt lgkmcnt(2)
 v_pk_add_f32 v[216:217], v[216:217], v[220:221]
 v_pk_add_f32 v[252:253], v[252:253], v[240:241]
 s_waitcnt lgkmcnt(0)
 v_pk_add_f32 v[224:225], v[224:225], v[228:229]
 v_pk_add_f32 v[214:215], v[214:215], v[126:127]
 v_pk_add_f32 v[218:219], v[218:219], v[222:223]
 buffer_load_dwordx4 v[56:59], v2, s[4:7], s85 offen offset:3072 sc1
 v_pk_add_f32 v[254:255], v[254:255], v[242:243]
 v_pk_add_f32 v[226:227], v[226:227], v[230:231]
 v_pk_add_f32 v[212:213], v[212:213], v[252:253]
 v_pk_add_f32 v[216:217], v[216:217], v[224:225]
 v_pk_add_f32 v[214:215], v[214:215], v[254:255]
 v_pk_add_f32 v[218:219], v[218:219], v[226:227]
 v_pk_add_f32 v[100:101], v[100:101], v[212:213]
 v_pk_add_f32 v[104:105], v[104:105], v[216:217]
 v_pk_add_f32 v[102:103], v[102:103], v[214:215]
 v_pk_add_f32 v[106:107], v[106:107], v[218:219]
 v_cvt_pk_bf16_f32 v22, v100, v101
 v_cvt_pk_bf16_f32 v20, v104, v105
 v_cvt_pk_bf16_f32 v23, v102, v103
 v_cvt_pk_bf16_f32 v21, v106, v107
 buffer_store_dwordx2 v[22:23], v12, s[4:7], s90 offen sc1
 buffer_store_dwordx2 v[20:21], v12, s[4:7], s91 offen offset:1024 sc1
 v_add_f32 v108, v100, v101
 v_add_f32 v110, v104, v105
 v_mul_f32 v109, v100, v100
 v_mul_f32 v111, v104, v104
 v_add_f32 v108, v108, v102
 v_add_f32 v110, v110, v106
 v_fmac_f32 v109, v101, v101
 v_fmac_f32 v111, v105, v105
 v_add_f32 v108, v108, v103
 v_add_f32 v110, v110, v107
 v_fmac_f32 v109, v102, v102
 v_fmac_f32 v111, v106, v106
 v_fmac_f32 v109, v103, v103
 v_fmac_f32 v111, v107, v107
 v_add_f32_dpp v108, v108, v108 row_ror:8 row_mask:0xf bank_mask:0xf
 v_add_f32_dpp v110, v110, v110 row_ror:8 row_mask:0xf bank_mask:0xf
 v_add_f32_dpp v108, v109, v109 row_ror:8 row_mask:0xf bank_mask:0xc
 v_add_f32_dpp v110, v111, v111 row_ror:8 row_mask:0xf bank_mask:0xc
 s_nop 0
 v_add_f32_dpp v108, v108, v108 row_half_mirror row_mask:0xf bank_mask:0xf
 v_add_f32_dpp v110, v110, v110 row_half_mirror row_mask:0xf bank_mask:0xf
 s_nop 0
 v_add_f32_dpp v108, v108, v108 quad_perm:[1,0,3,2] row_mask:0xf bank_mask:0xf
 v_add_f32_dpp v110, v110, v110 quad_perm:[1,0,3,2] row_mask:0xf bank_mask:0xf
 s_nop 0
 v_add_f32_dpp v108, v108, v108 quad_perm:[2,3,0,1] row_mask:0xf bank_mask:0xf
 v_add_f32_dpp v110, v110, v110 quad_perm:[2,3,0,1] row_mask:0xf bank_mask:0xf
 buffer_store_dword v108, v14, s[4:7], s72 offen offset:3072 sc1
 buffer_store_dword v110, v14, s[4:7], s72 offen offset:2048 sc1
 buffer_load_dword v3, v7, s[4:7], s64 offen sc1
 s_waitcnt vmcnt(9)
 v_mfma_f32_16x16x32_bf16 v[116:119], v[128:131], v[44:47], 0
 v_mfma_f32_16x16x32_bf16 v[120:123], v[132:135], v[44:47], 0
 v_mfma_f32_16x16x32_bf16 v[204:207], v[136:139], v[44:47], 0
 s_add_u32 s89, s78, 0x7000
 buffer_load_dwordx4 a[56:59], v2, s[4:7], s89 offen offset:2048 sc1
 v_mfma_f32_16x16x32_bf16 v[208:211], v[140:143], v[44:47], 0
 s_waitcnt vmcnt(9)
 v_mfma_f32_16x16x32_bf16 v[116:119], v[144:147], v[48:51], v[116:119]
 v_mfma_f32_16x16x32_bf16 v[120:123], v[148:151], v[48:51], v[120:123]
 v_mfma_f32_16x16x32_bf16 v[204:207], v[152:155], v[48:51], v[204:207]
 s_add_u32 s89, s78, 0x7000
 buffer_load_dwordx4 a[60:63], v2, s[4:7], s89 offen offset:3072 sc1
 v_mfma_f32_16x16x32_bf16 v[208:211], v[156:159], v[48:51], v[208:211]
 s_waitcnt vmcnt(8)
 v_mfma_f32_16x16x32_bf16 v[116:119], v[160:163], v[52:55], v[116:119]
 v_mfma_f32_16x16x32_bf16 v[120:123], v[164:167], v[52:55], v[120:123]
 v_mfma_f32_16x16x32_bf16 v[204:207], v[168:171], v[52:55], v[204:207]
 s_add_u32 s89, s78, 0x8000
 buffer_load_dwordx4 a[64:67], v2, s[4:7], s89 offen sc1
 v_mfma_f32_16x16x32_bf16 v[208:211], v[172:175], v[52:55], v[208:211]
 s_waitcnt vmcnt(8)
 v_mfma_f32_16x16x32_bf16 v[116:119], v[176:179], v[56:59], v[116:119]
 v_mfma_f32_16x16x32_bf16 v[120:123], v[180:183], v[56:59], v[120:123]
 v_mfma_f32_16x16x32_bf16 v[204:207], v[184:187], v[56:59], v[204:207]
 s_add_u32 s89, s78, 0x8000
 buffer_load_dwordx4 a[68:71], v2, s[4:7], s89 offen offset:1024 sc1
 v_mfma_f32_16x16x32_bf16 v[208:211], v[188:191], v[56:59], v[208:211]
 v_mov_b32 v5, 6
 s_waitcnt vmcnt(5)
 buffer_store_dword v5, off, s[4:7], s67 offset:1024 sc1
 s_add_u32 s85, s70, 0x0
 s_waitcnt vmcnt(5)
 v_cmp_gt_u32 vcc, 8, v3
 s_nop 0
 s_cbranch_vccnz .Lps_102
.Lpb_103:
 buffer_load_dwordx4 v[60:63], v2, s[4:7], s85 offen sc1
 buffer_load_dwordx4 v[64:67], v2, s[4:7], s85 offen offset:1024 sc1
 buffer_load_dwordx4 v[68:71], v2, s[4:7], s85 offen offset:2048 sc1
 buffer_load_dwordx4 v[112:115], v2, s[4:7], s85 offen offset:3072 sc1
 ds_write_b128 v9, v[116:119] offset:32768
 ds_write_b128 v10, v[120:123] offset:32768
 ds_write_b128 v9, v[204:207] offset:32896
 ds_write_b128 v10, v[208:211] offset:32896
 s_add_u32 s89, s78, 0x8000
 buffer_load_dwordx4 a[72:75], v2, s[4:7], s89 offen offset:2048 sc1
 s_add_u32 s89, s78, 0x8000
 buffer_load_dwordx4 a[76:79], v2, s[4:7], s89 offen offset:3072 sc1
 s_add_u32 s89, s78, 0x9000
 buffer_load_dwordx4 a[80:83], v2, s[4:7], s89 offen sc1
 s_waitcnt lgkmcnt(0)
 s_barrier
 ds_read_b128 v[44:47], v11 offset:32768
 ds_read_b128 v[48:51], v11 offset:36864
 ds_read_b128 v[52:55], v11 offset:40960
 ds_read_b128 v[56:59], v11 offset:45056
 s_waitcnt vmcnt(6)
 v_mfma_f32_16x16x32_bf16 v[192:195], v[128:131], v[60:63], 0
 v_lshlrev_b32 v100, 16, v18
 v_and_b32 v101, 0xffff0000, v18
 v_mfma_f32_16x16x32_bf16 v[196:199], v[132:135], v[60:63], 0
 v_lshlrev_b32 v102, 16, v19
 v_and_b32 v103, 0xffff0000, v19
 v_mfma_f32_16x16x32_bf16 v[200:203], v[136:139], v[60:63], 0
 buffer_load_dword v3, v6, s[4:7], s65 offen sc1
 s_waitcnt lgkmcnt(2)
 v_add_f32 v44, v44, v48
 v_mfma_f32_16x16x32_bf16 v[124:127], v[140:143], v[60:63], 0
 s_waitcnt lgkmcnt(0)
 v_add_f32 v52, v52, v56
 v_add_f32 v45, v45, v49
 s_waitcnt vmcnt(6)
 v_mfma_f32_16x16x32_bf16 v[192:195], v[144:147], v[64:67], v[192:195]
 s_add_u32 s89, s78, 0x9000
 buffer_load_dwordx4 a[84:87], v2, s[4:7], s89 offen offset:1024 sc1
 v_add_f32 v53, v53, v57
 v_mfma_f32_16x16x32_bf16 v[196:199], v[148:151], v[64:67], v[196:199]
 v_add_f32 v46, v46, v50
 v_add_f32 v54, v54, v58
 v_mfma_f32_16x16x32_bf16 v[200:203], v[152:155], v[64:67], v[200:203]
 v_add_f32 v47, v47, v51
 v_add_f32 v55, v55, v59
 v_mfma_f32_16x16x32_bf16 v[124:127], v[156:159], v[64:67], v[124:127]
 s_add_u32 s89, s78, 0x9000
 buffer_load_dwordx4 a[88:91], v2, s[4:7], s89 offen offset:2048 sc1
 v_add_f32 v44, v44, v52
 s_waitcnt vmcnt(7)
 v_mfma_f32_16x16x32_bf16 v[192:195], v[160:163], v[68:71], v[192:195]
 v_add_f32 v45, v45, v53
 v_add_f32 v46, v46, v54
 v_mfma_f32_16x16x32_bf16 v[196:199], v[164:167], v[68:71], v[196:199]
 v_add_f32 v47, v47, v55
 v_add_f32 v100, v100, v44
 v_mfma_f32_16x16x32_bf16 v[200:203], v[168:171], v[68:71], v[200:203]
 s_add_u32 s89, s78, 0x9000
 buffer_load_dwordx4 a[92:95], v2, s[4:7], s89 offen offset:3072 sc1
 v_add_f32 v101, v101, v45
 v_mfma_f32_16x16x32_bf16 v[124:127], v[172:175], v[68:71], v[124:127]
 v_add_f32 v102, v102, v46
 v_add_f32 v103, v103, v47
 s_waitcnt vmcnt(7)
 v_mfma_f32_16x16x32_bf16 v[192:195], v[176:179], v[112:115], v[192:195]
 v_cvt_pk_bf16_f32 v18, v100, v101
 v_cvt_pk_bf16_f32 v19, v102, v103
 v_mfma_f32_16x16x32_bf16 v[196:199], v[180:183], v[112:115], v[196:199]
 s_add_u32 s89, s78, 0xa000
 buffer_load_dwordx4 a[96:99], v2, s[4:7], s89 offen sc1
 v_mfma_f32_16x16x32_bf16 v[200:203], v[184:187], v[112:115], v[200:203]
 buffer_store_dwordx2 v[18:19], v12, s[4:7], s71 offen sc1
 v_add_f32 v108, v100, v101
 v_mfma_f32_16x16x32_bf16 v[124:127], v[188:191], v[112:115], v[124:127]
 s_add_u32 s89, s78, 0xa000
 buffer_load_dwordx4 a[100:103], v2, s[4:7], s89 offen offset:1024 sc1
 v_mul_f32 v109, v100, v100
 v_add_f32 v108, v108, v102
 v_fmac_f32 v109, v101, v101
 v_add_f32 v108, v108, v103
 v_fmac_f32 v109, v102, v102
 v_fmac_f32 v109, v103, v103
 v_add_f32_dpp v108, v108, v108 row_ror:8 row_mask:0xf bank_mask:0xf
 ds_write_b128 v9, v[192:195]
 ds_write_b128 v10, v[196:199]
 ds_write_b128 v9, v[200:203] offset:128
 ds_write_b128 v10, v[124:127] offset:128
 v_add_f32_dpp v108, v109, v109 row_ror:8 row_mask:0xf bank_mask:0xc
 s_nop 1
 v_add_f32_dpp v108, v108, v108 row_half_mirror row_mask:0xf bank_mask:0xf
 s_nop 1
 v_add_f32_dpp v108, v108, v108 quad_perm:[1,0,3,2] row_mask:0xf bank_mask:0xf
 s_nop 1
 v_add_f32_dpp v108, v108, v108 quad_perm:[2,3,0,1] row_mask:0xf bank_mask:0xf
 buffer_store_dword v108, v14, s[4:7], s72 offen offset:1024 sc1
 s_waitcnt vmcnt(7)
 v_cmp_gt_u32 vcc, 6, v3
 s_nop 0
 s_cbranch_vccnz .Lps_104
.Lpb_105:
 s_add_u32 s85, s73, 0x8000
 buffer_load_dwordx4 v[216:219], v2, s[4:7], s85 offen sc1
 buffer_load_dwordx4 v[220:223], v2, s[4:7], s85 offen offset:1024 sc1
 s_waitcnt lgkmcnt(0)
 s_barrier
 ds_read_b128 v[60:63], v11
 ds_read_b128 v[64:67], v11 offset:4096
 ds_read_b128 v[68:71], v11 offset:8192
 ds_read_b128 v[112:115], v11 offset:12288
 buffer_load_dwordx4 v[224:227], v2, s[4:7], s85 offen offset:2048 sc1
 buffer_load_dwordx4 v[228:231], v2, s[4:7], s85 offen offset:3072 sc1
 s_add_u32 s85, s73, 0x9000
 buffer_load_dwordx4 v[232:235], v2, s[4:7], s85 offen sc1
 buffer_load_dwordx4 v[236:239], v2, s[4:7], s85 offen offset:1024 sc1
 buffer_load_dwordx4 v[240:243], v2, s[4:7], s85 offen offset:2048 sc1
 buffer_load_dwordx4 v[244:247], v2, s[4:7], s85 offen offset:3072 sc1
 ds_read_b128 v[184:187], v2
 ds_read_b128 v[188:191], v2 offset:1024
 ds_read_b128 v[192:195], v2 offset:2048
 ds_read_b128 v[196:199], v2 offset:3072
 ds_read_b128 v[200:203], v2 offset:4096
 ds_read_b128 v[204:207], v2 offset:5120
 s_add_u32 s91, s71, 0x0
 v_lshlrev_b32 v104, 16, v16
 v_and_b32 v105, 0xffff0000, v16
 v_lshlrev_b32 v106, 16, v17
 v_and_b32 v107, 0xffff0000, v17
 s_waitcnt lgkmcnt(8)
 v_pk_add_f32 v[60:61], v[60:61], v[64:65]
 s_waitcnt lgkmcnt(6)
 v_pk_add_f32 v[68:69], v[68:69], v[112:113]
 v_pk_add_f32 v[62:63], v[62:63], v[66:67]
 v_pk_add_f32 v[70:71], v[70:71], v[114:115]
 v_pk_add_f32 v[60:61], v[60:61], v[68:69]
 v_pk_add_f32 v[62:63], v[62:63], v[70:71]
 v_pk_add_f32 v[104:105], v[104:105], v[60:61]
 v_pk_add_f32 v[106:107], v[106:107], v[62:63]
 v_cvt_pk_bf16_f32 v16, v104, v105
 v_cvt_pk_bf16_f32 v17, v106, v107
 buffer_store_dwordx2 v[16:17], v12, s[4:7], s91 offen offset:1024 sc1
 v_add_f32 v110, v104, v105
 v_mul_f32 v111, v104, v104
 v_add_f32 v110, v110, v106
 v_fmac_f32 v111, v105, v105
 v_add_f32 v110, v110, v107
 v_fmac_f32 v111, v106, v106
 v_fmac_f32 v111, v107, v107
 v_add_f32_dpp v110, v110, v110 row_ror:8 row_mask:0xf bank_mask:0xf
 s_nop 0
 v_add_f32_dpp v110, v111, v111 row_ror:8 row_mask:0xf bank_mask:0xc
 s_nop 1
 v_add_f32_dpp v110, v110, v110 row_half_mirror row_mask:0xf bank_mask:0xf
 s_nop 1
 v_add_f32_dpp v110, v110, v110 quad_perm:[1,0,3,2] row_mask:0xf bank_mask:0xf
 s_nop 1
 v_add_f32_dpp v110, v110, v110 quad_perm:[2,3,0,1] row_mask:0xf bank_mask:0xf
 buffer_store_dword v110, v14, s[4:7], s72 offen sc1
 ds_read_b128 v[208:211], v2 offset:6144
 s_waitcnt vmcnt(9) lgkmcnt(1)
 v_mfma_f32_16x16x32_bf16 v[128:131], v[184:187], v[216:219], 0
 s_add_u32 s85, s73, 0xa000
 buffer_load_dwordx4 v[248:251], v2, s[4:7], s85 offen sc1
 s_waitcnt vmcnt(9)
 v_mfma_f32_16x16x32_bf16 v[156:159], v[184:187], v[220:223], 0
 ds_read_b128 v[212:215], v2 offset:7168
 v_mfma_f32_16x16x32_bf16 v[132:135], v[188:191], v[216:219], 0
 v_mfma_f32_16x16x32_bf16 v[160:163], v[188:191], v[220:223], 0
 ds_read_b128 v[184:187], v2 offset:8192
 v_mfma_f32_16x16x32_bf16 v[136:139], v[192:195], v[216:219], 0
 buffer_load_dwordx4 v[30:33], v2, s[4:7], s74 offen offset:3072 sc1
 v_mfma_f32_16x16x32_bf16 v[164:167], v[192:195], v[220:223], 0
 ds_read_b128 v[188:191], v2 offset:9216
 v_mfma_f32_16x16x32_bf16 v[140:143], v[196:199], v[216:219], 0
 v_mfma_f32_16x16x32_bf16 v[168:171], v[196:199], v[220:223], 0
 ds_read_b128 v[192:195], v2 offset:10240
 v_mfma_f32_16x16x32_bf16 v[144:147], v[200:203], v[216:219], 0
 buffer_load_dwordx4 v[252:255], v2, s[4:7], s85 offen offset:1024 sc1
 v_mfma_f32_16x16x32_bf16 v[172:175], v[200:203], v[220:223], 0
 ds_read_b128 v[196:199], v2 offset:11264
 v_mfma_f32_16x16x32_bf16 v[148:151], v[204:207], v[216:219], 0
 v_mfma_f32_16x16x32_bf16 v[176:179], v[204:207], v[220:223], 0
 buffer_load_dwordx4 v[34:37], v2, s[4:7], s74 offen offset:2048 sc1
 ds_read_b128 v[200:203], v2 offset:12288
 s_waitcnt lgkmcnt(5)
 v_mfma_f32_16x16x32_bf16 v[152:155], v[208:211], v[216:219], 0
 v_mfma_f32_16x16x32_bf16 v[180:183], v[208:211], v[220:223], 0
 ds_read_b128 v[204:207], v2 offset:13312
 s_waitcnt vmcnt(11)
 v_mfma_f32_16x16x32_bf16 v[128:131], v[212:215], v[224:227], v[128:131]
 buffer_load_dwordx4 v[216:219], v2, s[4:7], s85 offen offset:2048 sc1
 s_waitcnt vmcnt(11)
 v_mfma_f32_16x16x32_bf16 v[156:159], v[212:215], v[228:231], v[156:159]
 ds_read_b128 v[208:211], v2 offset:14336
 s_waitcnt lgkmcnt(5)
 v_mfma_f32_16x16x32_bf16 v[132:135], v[184:187], v[224:227], v[132:135]
 v_mfma_f32_16x16x32_bf16 v[160:163], v[184:187], v[228:231], v[160:163]
 ds_read_b128 v[212:215], v2 offset:15360
 v_mfma_f32_16x16x32_bf16 v[136:139], v[188:191], v[224:227], v[136:139]
 buffer_load_dwordx4 v[72:75], v29, s[4:7], s79 offen sc1
 v_mfma_f32_16x16x32_bf16 v[164:167], v[188:191], v[228:231], v[164:167]
 ds_read_b128 v[184:187], v2 offset:16384
 s_waitcnt lgkmcnt(5)
 v_mfma_f32_16x16x32_bf16 v[140:143], v[192:195], v[224:227], v[140:143]
 v_mfma_f32_16x16x32_bf16 v[168:171], v[192:195], v[228:231], v[168:171]
 ds_read_b128 v[188:191], v2 offset:17408
 v_mfma_f32_16x16x32_bf16 v[144:147], v[196:199], v[224:227], v[144:147]
 buffer_load_dwordx4 v[220:223], v2, s[4:7], s85 offen offset:3072 sc1
 v_mfma_f32_16x16x32_bf16 v[172:175], v[196:199], v[228:231], v[172:175]
 ds_read_b128 v[192:195], v2 offset:18432
 s_waitcnt lgkmcnt(5)
 v_mfma_f32_16x16x32_bf16 v[148:151], v[200:203], v[224:227], v[148:151]
 v_mfma_f32_16x16x32_bf16 v[176:179], v[200:203], v[228:231], v[176:179]
 buffer_load_dwordx4 v[76:79], v29, s[4:7], s79 offen offset:64 sc1
 ds_read_b128 v[196:199], v2 offset:19456
 v_mfma_f32_16x16x32_bf16 v[152:155], v[204:207], v[224:227], v[152:155]
 v_mfma_f32_16x16x32_bf16 v[180:183], v[204:207], v[228:231], v[180:183]
 ds_read_b128 v[200:203], v2 offset:20480
 s_waitcnt vmcnt(13) lgkmcnt(5)
 v_mfma_f32_16x16x32_bf16 v[128:131], v[208:211], v[232:235], v[128:131]
 s_add_u32 s85, s73, 0xb000
 buffer_load_dwordx4 v[224:227], v2, s[4:7], s85 offen sc1
 s_waitcnt vmcnt(13)
 v_mfma_f32_16x16x32_bf16 v[156:159], v[208:211], v[236:239], v[156:159]
 ds_read_b128 v[204:207], v2 offset:21504
 v_mfma_f32_16x16x32_bf16 v[132:135], v[212:215], v[232:235], v[132:135]
 v_mov_b32 v5, 8
 s_waitcnt vmcnt(9)
 buffer_store_dword v5, off, s[4:7], s67 offset:1024 sc1
 v_mfma_f32_16x16x32_bf16 v[160:163], v[212:215], v[236:239], v[160:163]
 ds_read_b128 v[208:211], v2 offset:22528
 s_waitcnt lgkmcnt(4)
 v_mfma_f32_16x16x32_bf16 v[136:139], v[184:187], v[232:235], v[136:139]
 buffer_load_dwordx4 v[80:83], v29, s[4:7], s79 offen offset:128 sc1
 v_mfma_f32_16x16x32_bf16 v[164:167], v[184:187], v[236:239], v[164:167]
 ds_read_b128 v[212:215], v2 offset:23552
 v_mfma_f32_16x16x32_bf16 v[140:143], v[188:191], v[232:235], v[140:143]
 v_mfma_f32_16x16x32_bf16 v[168:171], v[188:191], v[236:239], v[168:171]
 ds_read_b128 v[184:187], v2 offset:24576
 v_mfma_f32_16x16x32_bf16 v[144:147], v[192:195], v[232:235], v[144:147]
 buffer_load_dwordx4 v[228:231], v2, s[4:7], s85 offen offset:1024 sc1
 s_waitcnt vmcnt(10)
 v_add_f32 v38, v30, v32
 v_mfma_f32_16x16x32_bf16 v[172:175], v[192:195], v[236:239], v[172:175]
 ds_read_b128 v[188:191], v2 offset:25600
 v_add_f32 v44, v31, v33
 s_waitcnt lgkmcnt(4)
 v_mfma_f32_16x16x32_bf16 v[148:151], v[196:199], v[232:235], v[148:151]
 v_mfma_f32_16x16x32_bf16 v[176:179], v[196:199], v[236:239], v[176:179]
 buffer_load_dwordx4 v[84:87], v29, s[4:7], s79 offen offset:192 sc1
 ds_read_b128 v[192:195], v2 offset:26624
 v_permlane32_swap_b32 v38, v44
 v_mfma_f32_16x16x32_bf16 v[152:155], v[200:203], v[232:235], v[152:155]
 v_add_f32 v38, v38, v44
 v_mfma_f32_16x16x32_bf16 v[180:183], v[200:203], v[236:239], v[180:183]
 ds_read_b128 v[196:199], v2 offset:27648
 v_mov_b32 v24, v38
 v_mfma_f32_16x16x32_bf16 v[128:131], v[204:207], v[240:243], v[128:131]
 buffer_load_dwordx4 v[232:235], v2, s[4:7], s85 offen offset:2048 sc1
 v_permlane16_swap_b32 v38, v24
 v_mfma_f32_16x16x32_bf16 v[156:159], v[204:207], v[244:247], v[156:159]
 ds_read_b128 v[200:203], v2 offset:28672
 v_add_f32 v38, v38, v24
 s_waitcnt lgkmcnt(4)
 v_mfma_f32_16x16x32_bf16 v[132:135], v[208:211], v[240:243], v[132:135]
 v_mov_b32 v44, v38
 v_mfma_f32_16x16x32_bf16 v[160:163], v[208:211], v[244:247], v[160:163]
 ds_read_b128 v[204:207], v2 offset:29696
 v_permlane32_swap_b32 v38, v44
 v_mul_f32 v38, s84, v38
 v_mfma_f32_16x16x32_bf16 v[136:139], v[212:215], v[240:243], v[136:139]
 buffer_load_dwordx4 v[88:91], v29, s[4:7], s79 offen offset:256 sc1
 v_mfma_f32_16x16x32_bf16 v[164:167], v[212:215], v[244:247], v[164:167]
 ds_read_b128 v[208:211], v2 offset:30720
 v_mul_f32 v44, s84, v44
 v_mfma_f32_16x16x32_bf16 v[140:143], v[184:187], v[240:243], v[140:143]
 v_fmac_f32 v44, v38, v38
 v_min_f32 v44, 0, v44
 v_mfma_f32_16x16x32_bf16 v[168:171], v[184:187], v[244:247], v[168:171]
 ds_read_b128 v[212:215], v2 offset:31744
 v_sub_f32 v44, 0x3727c5ac, v44
 s_waitcnt lgkmcnt(4)
 v_mfma_f32_16x16x32_bf16 v[144:147], v[188:191], v[240:243], v[144:147]
 buffer_load_dwordx4 v[236:239], v2, s[4:7], s85 offen offset:3072 sc1
 v_mfma_f32_16x16x32_bf16 v[172:175], v[188:191], v[244:247], v[172:175]
 ds_read_b128 v[184:187], v2 offset:32768
 v_rsq_f32 v24, v44
 v_mfma_f32_16x16x32_bf16 v[148:151], v[192:195], v[240:243], v[148:151]
 v_mul_f32 v40, 0xc0135761, v24
 v_mfma_f32_16x16x32_bf16 v[176:179], v[192:195], v[244:247], v[176:179]
 buffer_load_dwordx4 v[92:95], v29, s[4:7], s79 offen offset:320 sc1
 ds_read_b128 v[188:191], v2 offset:33792
 v_mfma_f32_16x16x32_bf16 v[152:155], v[196:199], v[240:243], v[152:155]
 v_mul_f32 v25, v24, v24
 v_mul_f32 v25, v25, v24
 v_mfma_f32_16x16x32_bf16 v[180:183], v[196:199], v[244:247], v[180:183]
 ds_read_b128 v[192:195], v2 offset:34816
 v_mul_f32 v42, 0xbdd2d3e8, v25
 s_waitcnt lgkmcnt(4)
 v_mfma_f32_16x16x32_bf16 v[128:131], v[200:203], v[248:251], v[128:131]
 s_add_u32 s85, s73, 0xc000
 buffer_load_dwordx4 v[240:243], v2, s[4:7], s85 offen sc1
 s_waitcnt vmcnt(14)
 v_add_f32 v39, v34, v36
 v_mfma_f32_16x16x32_bf16 v[156:159], v[200:203], v[252:255], v[156:159]
 ds_read_b128 v[196:199], v2 offset:35840
 v_mfma_f32_16x16x32_bf16 v[132:135], v[204:207], v[248:251], v[132:135]
 v_add_f32 v45, v35, v37
 v_mfma_f32_16x16x32_bf16 v[160:163], v[204:207], v[252:255], v[160:163]
 ds_read_b128 v[200:203], v2 offset:36864
 v_permlane32_swap_b32 v39, v45
 v_mfma_f32_16x16x32_bf16 v[136:139], v[208:211], v[248:251], v[136:139]
 buffer_load_dwordx4 v[96:99], v29, s[4:7], s79 offen offset:384 sc1
 v_add_f32 v39, v39, v45
 v_mfma_f32_16x16x32_bf16 v[164:167], v[208:211], v[252:255], v[164:167]
 ds_read_b128 v[204:207], v2 offset:37888
 v_mov_b32 v24, v39
 s_waitcnt lgkmcnt(4)
 v_mfma_f32_16x16x32_bf16 v[140:143], v[212:215], v[248:251], v[140:143]
 v_mfma_f32_16x16x32_bf16 v[168:171], v[212:215], v[252:255], v[168:171]
 ds_read_b128 v[208:211], v2 offset:38912
 v_permlane16_swap_b32 v39, v24
 v_add_f32 v39, v39, v24
 v_mfma_f32_16x16x32_bf16 v[144:147], v[184:187], v[248:251], v[144:147]
 buffer_load_dwordx4 v[244:247], v2, s[4:7], s85 offen offset:1024 sc1
 v_mfma_f32_16x16x32_bf16 v[172:175], v[184:187], v[252:255], v[172:175]
 ds_read_b128 v[212:215], v2 offset:39936
 v_mov_b32 v45, v39
 v_mfma_f32_16x16x32_bf16 v[148:151], v[188:191], v[248:251], v[148:151]
 buffer_load_dword v3, v6, s[4:7], s65 offen sc1
 v_permlane32_swap_b32 v39, v45
 v_mfma_f32_16x16x32_bf16 v[176:179], v[188:191], v[252:255], v[176:179]
 s_add_u32 s91, s78, 0xa000
 buffer_load_dwordx4 a[104:107], v2, s[4:7], s91 offen offset:2048 sc1
 ds_read_b128 v[184:187], v2 offset:40960
 s_waitcnt lgkmcnt(4)
 v_mfma_f32_16x16x32_bf16 v[152:155], v[192:195], v[248:251], v[152:155]
 v_mul_f32 v39, s84, v39
 v_mul_f32 v45, s84, v45
 v_mfma_f32_16x16x32_bf16 v[180:183], v[192:195], v[252:255], v[180:183]
 ds_read_b128 v[188:191], v2 offset:41984
 v_fmac_f32 v45, v39, v39
 s_waitcnt vmcnt(17)
 v_mfma_f32_16x16x32_bf16 v[128:131], v[196:199], v[216:219], v[128:131]
 buffer_load_dwordx4 v[248:251], v2, s[4:7], s85 offen offset:2048 sc1
 s_waitcnt vmcnt(16)
 v_mfma_f32_16x16x32_bf16 v[156:159], v[196:199], v[220:223], v[156:159]
 ds_read_b128 v[192:195], v2 offset:43008
 v_min_f32 v45, 0, v45
 v_mfma_f32_16x16x32_bf16 v[132:135], v[200:203], v[216:219], v[132:135]
 v_sub_f32 v45, 0x3727c5ac, v45
 v_rsq_f32 v24, v45
 v_mfma_f32_16x16x32_bf16 v[160:163], v[200:203], v[220:223], v[160:163]
 ds_read_b128 v[196:199], v2 offset:44032
 s_waitcnt lgkmcnt(4)
 v_mfma_f32_16x16x32_bf16 v[136:139], v[204:207], v[216:219], v[136:139]
 v_mul_f32 v41, 0xc0135761, v24
 v_mfma_f32_16x16x32_bf16 v[164:167], v[204:207], v[220:223], v[164:167]
 ds_read_b128 v[200:203], v2 offset:45056
 v_mul_f32 v25, v24, v24
 v_mfma_f32_16x16x32_bf16 v[140:143], v[208:211], v[216:219], v[140:143]
 v_mul_f32 v25, v25, v24
 v_mul_f32 v43, 0xbdd2d3e8, v25
 v_mfma_f32_16x16x32_bf16 v[168:171], v[208:211], v[220:223], v[168:171]
 ds_read_b128 v[204:207], v2 offset:46080
 v_mfma_f32_16x16x32_bf16 v[144:147], v[212:215], v[216:219], v[144:147]
 buffer_load_dwordx4 v[252:255], v2, s[4:7], s85 offen offset:3072 sc1
 v_mfma_f32_16x16x32_bf16 v[172:175], v[212:215], v[220:223], v[172:175]
 ds_read_b128 v[208:211], v2 offset:47104
 s_waitcnt lgkmcnt(4)
 v_mfma_f32_16x16x32_bf16 v[148:151], v[184:187], v[216:219], v[148:151]
 v_cmp_gt_u32 vcc, 32, v1
 s_nop 1
 v_cndmask_b32 v46, v41, v40, vcc
 v_cndmask_b32 v47, v43, v42, vcc
 v_cndmask_b32 v48, v45, v44, vcc
 v_mfma_f32_16x16x32_bf16 v[176:179], v[184:187], v[220:223], v[176:179]
 ds_read_b128 v[212:215], v2 offset:48128
 v_mfma_f32_16x16x32_bf16 v[152:155], v[188:191], v[216:219], v[152:155]
 v_mfma_f32_16x16x32_bf16 v[180:183], v[188:191], v[220:223], v[180:183]
 ds_read_b128 v[184:187], v2 offset:49152
 s_waitcnt vmcnt(15)
 v_mfma_f32_16x16x32_bf16 v[128:131], v[192:195], v[224:227], v[128:131]
 s_add_u32 s85, s73, 0xd000
 buffer_load_dwordx4 v[216:219], v2, s[4:7], s85 offen sc1
 s_waitcnt vmcnt(13)
 v_mfma_f32_16x16x32_bf16 v[156:159], v[192:195], v[228:231], v[156:159]
 ds_read_b128 v[188:191], v2 offset:50176
 s_waitcnt lgkmcnt(4)
 v_mfma_f32_16x16x32_bf16 v[132:135], v[196:199], v[224:227], v[132:135]
 v_mfma_f32_16x16x32_bf16 v[160:163], v[196:199], v[228:231], v[160:163]
 ds_read_b128 v[192:195], v2 offset:51200
 v_mfma_f32_16x16x32_bf16 v[136:139], v[200:203], v[224:227], v[136:139]
 s_add_u32 s91, s78, 0xa000
 buffer_load_dwordx4 a[108:111], v2, s[4:7], s91 offen offset:3072 sc1
 v_mfma_f32_16x16x32_bf16 v[164:167], v[200:203], v[228:231], v[164:167]
 ds_read_b128 v[196:199], v2 offset:52224
 v_mfma_f32_16x16x32_bf16 v[140:143], v[204:207], v[224:227], v[140:143]
 v_fmac_f32 v128, v72, v38
 v_fmac_f32 v129, v73, v38
 v_mfma_f32_16x16x32_bf16 v[168:171], v[204:207], v[228:231], v[168:171]
 v_fmac_f32 v130, v74, v38
 v_fmac_f32 v131, v75, v38
 ds_read_b128 v[200:203], v2 offset:53248
 s_waitcnt lgkmcnt(4)
 v_mfma_f32_16x16x32_bf16 v[144:147], v[208:211], v[224:227], v[144:147]
 buffer_load_dwordx4 v[220:223], v2, s[4:7], s85 offen offset:1024 sc1
 v_fmac_f32 v156, v72, v39
 v_fmac_f32 v157, v73, v39
 v_mfma_f32_16x16x32_bf16 v[172:175], v[208:211], v[228:231], v[172:175]
 v_fmac_f32 v158, v74, v39
 v_fmac_f32 v159, v75, v39
 ds_read_b128 v[204:207], v2 offset:54272
 v_mfma_f32_16x16x32_bf16 v[148:151], v[212:215], v[224:227], v[148:151]
 v_mfma_f32_16x16x32_bf16 v[176:179], v[212:215], v[228:231], v[176:179]
 ds_read_b128 v[208:211], v2 offset:55296
 v_mfma_f32_16x16x32_bf16 v[152:155], v[184:187], v[224:227], v[152:155]
 v_mfma_f32_16x16x32_bf16 v[180:183], v[184:187], v[228:231], v[180:183]
 ds_read_b128 v[212:215], v2 offset:56320
 s_waitcnt vmcnt(13) lgkmcnt(4)
 v_mfma_f32_16x16x32_bf16 v[128:131], v[188:191], v[232:235], v[128:131]
 buffer_load_dwordx4 v[224:227], v2, s[4:7], s85 offen offset:2048 sc1
 s_waitcnt vmcnt(12)
 v_mfma_f32_16x16x32_bf16 v[156:159], v[188:191], v[236:239], v[156:159]
 ds_read_b128 v[184:187], v26
 v_mfma_f32_16x16x32_bf16 v[132:135], v[192:195], v[232:235], v[132:135]
 v_mfma_f32_16x16x32_bf16 v[160:163], v[192:195], v[236:239], v[160:163]
 s_waitcnt vmcnt(7)
 v_cmp_gt_u32 vcc, 8, v3
 s_nop 0
 s_cbranch_vccnz .Lps_106
.Lpb_107:
 ds_read_b128 v[188:191], v26 offset:1024
 v_mfma_f32_16x16x32_bf16 v[136:139], v[196:199], v[232:235], v[136:139]
 buffer_load_dwordx4 v[30:33], v2, s[4:7], s74 offen offset:1024 sc1
 v_mfma_f32_16x16x32_bf16 v[164:167], v[196:199], v[236:239], v[164:167]
 ds_read_b128 v[192:195], v26 offset:2048
 s_waitcnt lgkmcnt(5)
 v_mfma_f32_16x16x32_bf16 v[140:143], v[200:203], v[232:235], v[140:143]
 v_mfma_f32_16x16x32_bf16 v[168:171], v[200:203], v[236:239], v[168:171]
 ds_read_b128 v[196:199], v26 offset:3072
 v_mfma_f32_16x16x32_bf16 v[144:147], v[204:207], v[232:235], v[144:147]
 buffer_load_dwordx4 v[228:231], v2, s[4:7], s85 offen offset:3072 sc1
 v_fmac_f32 v132, v76, v38
 v_fmac_f32 v133, v77, v38
 v_mfma_f32_16x16x32_bf16 v[172:175], v[204:207], v[236:239], v[172:175]
 v_fmac_f32 v134, v78, v38
 v_fmac_f32 v135, v79, v38
 ds_read_b128 v[200:203], v26 offset:4096
 s_waitcnt lgkmcnt(4)
 v_mfma_f32_16x16x32_bf16 v[148:151], v[208:211], v[232:235], v[148:151]
 v_fmac_f32 v160, v76, v39
 v_fmac_f32 v161, v77, v39
 v_mfma_f32_16x16x32_bf16 v[176:179], v[208:211], v[236:239], v[176:179]
 buffer_load_dwordx4 v[34:37], v2, s[4:7], s74 offen sc1
 v_fmac_f32 v162, v78, v39
 v_fmac_f32 v163, v79, v39
 ds_read_b128 v[204:207], v26 offset:5120
 v_mfma_f32_16x16x32_bf16 v[152:155], v[212:215], v[232:235], v[152:155]
 v_mfma_f32_16x16x32_bf16 v[180:183], v[212:215], v[236:239], v[180:183]
 ds_read_b128 v[208:211], v26 offset:6144
 v_mfma_f32_16x16x32_bf16 v[128:131], v[184:187], v[240:243], v[128:131]
 s_add_u32 s85, s73, 0xe000
 buffer_load_dwordx4 v[232:235], v2, s[4:7], s85 offen sc1
 v_mfma_f32_16x16x32_bf16 v[156:159], v[184:187], v[244:247], v[156:159]
 ds_read_b128 v[212:215], v26 offset:7168
 s_waitcnt lgkmcnt(4)
 v_mfma_f32_16x16x32_bf16 v[132:135], v[188:191], v[240:243], v[132:135]
 v_mfma_f32_16x16x32_bf16 v[160:163], v[188:191], v[244:247], v[160:163]
 ds_read_b128 v[184:187], v26 offset:8192
 v_mfma_f32_16x16x32_bf16 v[136:139], v[192:195], v[240:243], v[136:139]
 v_mfma_f32_16x16x32_bf16 v[164:167], v[192:195], v[244:247], v[164:167]
 ds_read_b128 v[188:191], v26 offset:9216
 v_mfma_f32_16x16x32_bf16 v[140:143], v[196:199], v[240:243], v[140:143]
 v_mfma_f32_16x16x32_bf16 v[168:171], v[196:199], v[244:247], v[168:171]
 ds_read_b128 v[192:195], v26 offset:10240
 s_waitcnt lgkmcnt(6)
 v_mfma_f32_16x16x32_bf16 v[144:147], v[200:203], v[240:243], v[144:147]
 buffer_load_dwordx4 v[236:239], v2, s[4:7], s85 offen offset:1024 sc1
 v_mfma_f32_16x16x32_bf16 v[172:175], v[200:203], v[244:247], v[172:175]
 ds_read_b128 v[196:199], v26 offset:11264
 s_waitcnt lgkmcnt(5)
 v_mfma_f32_16x16x32_bf16 v[148:151], v[204:207], v[240:243], v[148:151]
 v_fmac_f32 v136, v80, v38
 v_fmac_f32 v137, v81, v38
 v_mfma_f32_16x16x32_bf16 v[176:179], v[204:207], v[244:247], v[176:179]
 s_add_u32 s91, s78, 0xb000
 buffer_load_dwordx4 a[112:115], v2, s[4:7], s91 offen sc1
 v_fmac_f32 v138, v82, v38
 v_fmac_f32 v139, v83, v38
 ds_read_b128 v[200:203], v26 offset:12288
 v_mfma_f32_16x16x32_bf16 v[152:155], v[208:211], v[240:243], v[152:155]
 v_fmac_f32 v164, v80, v39
 v_fmac_f32 v165, v81, v39
 v_mfma_f32_16x16x32_bf16 v[180:183], v[208:211], v[244:247], v[180:183]
 v_fmac_f32 v166, v82, v39
 v_fmac_f32 v167, v83, v39
 ds_read_b128 v[204:207], v26 offset:13312
 s_waitcnt vmcnt(11) lgkmcnt(4)
 v_mfma_f32_16x16x32_bf16 v[128:131], v[212:215], v[248:251], v[128:131]
 buffer_load_dwordx4 v[240:243], v2, s[4:7], s85 offen offset:2048 sc1
 v_fmac_f32 v168, v84, v39
 v_fmac_f32 v169, v85, v39
 s_waitcnt vmcnt(11)
 v_mfma_f32_16x16x32_bf16 v[156:159], v[212:215], v[252:255], v[156:159]
 v_fmac_f32 v170, v86, v39
 v_fmac_f32 v171, v87, v39
 ds_read_b128 v[208:211], v26 offset:14336
 v_mfma_f32_16x16x32_bf16 v[132:135], v[184:187], v[248:251], v[132:135]
 v_mfma_f32_16x16x32_bf16 v[160:163], v[184:187], v[252:255], v[160:163]
 ds_read_b128 v[212:215], v26 offset:15360
 v_mfma_f32_16x16x32_bf16 v[136:139], v[188:191], v[248:251], v[136:139]
 v_mfma_f32_16x16x32_bf16 v[164:167], v[188:191], v[252:255], v[164:167]
 ds_read_b128 v[184:187], v26 offset:16384
 s_waitcnt lgkmcnt(4)
 v_mfma_f32_16x16x32_bf16 v[140:143], v[192:195], v[248:251], v[140:143]
 v_mfma_f32_16x16x32_bf16 v[168:171], v[192:195], v[252:255], v[168:171]
 ds_read_b128 v[188:191], v26 offset:17408
 v_mfma_f32_16x16x32_bf16 v[144:147], v[196:199], v[248:251], v[144:147]
 buffer_load_dwordx4 v[244:247], v2, s[4:7], s85 offen offset:3072 sc1
 v_mfma_f32_16x16x32_bf16 v[172:175], v[196:199], v[252:255], v[172:175]
 ds_read_b128 v[192:195], v26 offset:18432
 v_mfma_f32_16x16x32_bf16 v[148:151], v[200:203], v[248:251], v[148:151]
 s_waitcnt vmcnt(7)
 v_add_f32 v49, v30, v32
 v_add_f32 v54, v31, v33
 v_mfma_f32_16x16x32_bf16 v[176:179], v[200:203], v[252:255], v[176:179]
 ds_read_b128 v[196:199], v26 offset:19456
 v_permlane32_swap_b32 v49, v54
 v_add_f32 v49, v49, v54
 s_waitcnt lgkmcnt(5)
 v_mfma_f32_16x16x32_bf16 v[152:155], v[204:207], v[248:251], v[152:155]
 v_fmac_f32 v140, v84, v38
 v_fmac_f32 v141, v85, v38
 v_mfma_f32_16x16x32_bf16 v[180:183], v[204:207], v[252:255], v[180:183]
 v_fmac_f32 v142, v86, v38
 v_fmac_f32 v143, v87, v38
 ds_read_b128 v[200:203], v26 offset:20480
 v_mfma_f32_16x16x32_bf16 v[128:131], v[208:211], v[216:219], v[128:131]
 s_add_u32 s85, s73, 0xf000
 buffer_load_dwordx4 v[248:251], v2, s[4:7], s85 offen sc1
 v_fmac_f32 v144, v88, v38
 v_fmac_f32 v145, v89, v38
 v_mfma_f32_16x16x32_bf16 v[156:159], v[208:211], v[220:223], v[156:159]
 v_fmac_f32 v146, v90, v38
 v_fmac_f32 v147, v91, v38
 ds_read_b128 v[204:207], v26 offset:21504
 s_waitcnt lgkmcnt(3)
 v_mfma_f32_16x16x32_bf16 v[132:135], v[212:215], v[216:219], v[132:135]
 v_fmac_f32 v172, v88, v39
 v_fmac_f32 v173, v89, v39
 v_mfma_f32_16x16x32_bf16 v[160:163], v[212:215], v[220:223], v[160:163]
 v_fmac_f32 v174, v90, v39
 v_fmac_f32 v175, v91, v39
 ds_read_b128 v[208:211], v26 offset:22528
 v_mfma_f32_16x16x32_bf16 v[136:139], v[184:187], v[216:219], v[136:139]
 s_add_u32 s91, s78, 0xb000
 buffer_load_dwordx4 a[116:119], v2, s[4:7], s91 offen offset:1024 sc1
 v_mfma_f32_16x16x32_bf16 v[164:167], v[184:187], v[220:223], v[164:167]
 ds_read_b128 v[212:215], v26 offset:23552
 v_mfma_f32_16x16x32_bf16 v[140:143], v[188:191], v[216:219], v[140:143]
 v_mov_b32 v24, v49
 v_mfma_f32_16x16x32_bf16 v[168:171], v[188:191], v[220:223], v[168:171]
 ds_read_b128 v[184:187], v26 offset:24576
 v_permlane16_swap_b32 v49, v24
 v_add_f32 v49, v49, v24
 v_mfma_f32_16x16x32_bf16 v[144:147], v[192:195], v[216:219], v[144:147]
 buffer_load_dwordx4 v[252:255], v2, s[4:7], s85 offen offset:1024 sc1
 v_mov_b32 v54, v49
 v_mfma_f32_16x16x32_bf16 v[172:175], v[192:195], v[220:223], v[172:175]
 ds_read_b128 v[188:191], v26 offset:25600
 v_permlane32_swap_b32 v49, v54
 v_mul_f32 v49, s84, v49
 s_waitcnt lgkmcnt(4)
 v_mfma_f32_16x16x32_bf16 v[148:151], v[196:199], v[216:219], v[148:151]
 v_mul_f32 v54, s84, v54
 v_fmac_f32 v54, v49, v49
 v_mfma_f32_16x16x32_bf16 v[176:179], v[196:199], v[220:223], v[176:179]
 ds_read_b128 v[192:195], v26 offset:26624
 v_min_f32 v54, 0, v54
 v_sub_f32 v54, 0x3727c5ac, v54
 v_mfma_f32_16x16x32_bf16 v[152:155], v[200:203], v[216:219], v[152:155]
 v_rsq_f32 v24, v54
 v_mfma_f32_16x16x32_bf16 v[180:183], v[200:203], v[220:223], v[180:183]
 ds_read_b128 v[196:199], v26 offset:27648
 v_mul_f32 v50, 0xc0135761, v24
 v_mul_f32 v25, v24, v24
 v_mfma_f32_16x16x32_bf16 v[128:131], v[204:207], v[224:227], v[128:131]
 buffer_load_dwordx4 v[216:219], v2, s[4:7], s85 offen offset:2048 sc1
 v_mul_f32 v25, v25, v24
 s_waitcnt vmcnt(10)
 v_mfma_f32_16x16x32_bf16 v[156:159], v[204:207], v[228:231], v[156:159]
 ds_read_b128 v[200:203], v26 offset:28672
 v_mul_f32 v52, 0xbdd2d3e8, v25
 s_waitcnt lgkmcnt(3)
 v_mfma_f32_16x16x32_bf16 v[132:135], v[208:211], v[224:227], v[132:135]
 v_fmac_f32 v148, v92, v38
 v_fmac_f32 v149, v93, v38
 s_waitcnt vmcnt(9)
 v_add_f32 v59, v34, v36
 v_mfma_f32_16x16x32_bf16 v[160:163], v[208:211], v[228:231], v[160:163]
 v_fmac_f32 v150, v94, v38
 v_fmac_f32 v151, v95, v38
 ds_read_b128 v[204:207], v26 offset:29696
 v_mfma_f32_16x16x32_bf16 v[136:139], v[212:215], v[224:227], v[136:139]
 v_fmac_f32 v176, v92, v39
 v_fmac_f32 v177, v93, v39
 v_mfma_f32_16x16x32_bf16 v[164:167], v[212:215], v[228:231], v[164:167]
 v_fmac_f32 v178, v94, v39
 v_fmac_f32 v179, v95, v39
 ds_read_b128 v[208:211], v26 offset:30720
 v_mfma_f32_16x16x32_bf16 v[140:143], v[184:187], v[224:227], v[140:143]
 v_add_f32 v55, v35, v37
 v_mfma_f32_16x16x32_bf16 v[168:171], v[184:187], v[228:231], v[168:171]
 ds_read_b128 v[212:215], v26 offset:31744
 v_permlane32_swap_b32 v59, v55
 v_mfma_f32_16x16x32_bf16 v[144:147], v[188:191], v[224:227], v[144:147]
 buffer_load_dwordx4 v[220:223], v2, s[4:7], s85 offen offset:3072 sc1
 v_add_f32 v59, v59, v55
 v_mov_b32 v24, v59
 v_mfma_f32_16x16x32_bf16 v[172:175], v[188:191], v[228:231], v[172:175]
 ds_read_b128 v[184:187], v26 offset:32768
 v_permlane16_swap_b32 v59, v24
 s_waitcnt lgkmcnt(4)
 v_mfma_f32_16x16x32_bf16 v[148:151], v[192:195], v[224:227], v[148:151]
 v_add_f32 v59, v59, v24
 v_mov_b32 v55, v59
 v_mfma_f32_16x16x32_bf16 v[176:179], v[192:195], v[228:231], v[176:179]
 s_add_u32 s91, s78, 0xb000
 buffer_load_dwordx4 a[120:123], v2, s[4:7], s91 offen offset:2048 sc1
 ds_read_b128 v[188:191], v26 offset:33792
 v_mfma_f32_16x16x32_bf16 v[152:155], v[196:199], v[224:227], v[152:155]
 v_permlane32_swap_b32 v59, v55
 v_mul_f32 v59, s84, v59
 v_mul_f32 v55, s84, v55
 v_mfma_f32_16x16x32_bf16 v[180:183], v[196:199], v[228:231], v[180:183]
 ds_read_b128 v[192:195], v26 offset:34816
 v_fmac_f32 v55, v59, v59
 s_waitcnt vmcnt(10)
 v_mfma_f32_16x16x32_bf16 v[128:131], v[200:203], v[232:235], v[128:131]
 s_add_u32 s85, s73, 0x0
 buffer_load_dwordx4 v[224:227], v2, s[4:7], s85 offen sc1
 v_min_f32 v55, 0, v55
 s_waitcnt vmcnt(10)
 v_mfma_f32_16x16x32_bf16 v[156:159], v[200:203], v[236:239], v[156:159]
 ds_read_b128 v[196:199], v26 offset:35840
 v_sub_f32 v55, 0x3727c5ac, v55
 s_waitcnt lgkmcnt(3)
 v_mfma_f32_16x16x32_bf16 v[132:135], v[204:207], v[232:235], v[132:135]
 v_rsq_f32 v24, v55
 v_mfma_f32_16x16x32_bf16 v[160:163], v[204:207], v[236:239], v[160:163]
 ds_read_b128 v[200:203], v26 offset:36864
 v_mul_f32 v51, 0xc0135761, v24
 v_mul_f32 v25, v24, v24
 v_mfma_f32_16x16x32_bf16 v[136:139], v[208:211], v[232:235], v[136:139]
 v_fmac_f32 v152, v96, v38
 v_fmac_f32 v153, v97, v38
 v_mfma_f32_16x16x32_bf16 v[164:167], v[208:211], v[236:239], v[164:167]
 v_fmac_f32 v154, v98, v38
 v_fmac_f32 v155, v99, v38
 ds_read_b128 v[204:207], v26 offset:37888
 v_mfma_f32_16x16x32_bf16 v[140:143], v[212:215], v[232:235], v[140:143]
 v_fmac_f32 v180, v96, v39
 v_fmac_f32 v181, v97, v39
 v_mfma_f32_16x16x32_bf16 v[168:171], v[212:215], v[236:239], v[168:171]
 v_fmac_f32 v182, v98, v39
 v_fmac_f32 v183, v99, v39
 ds_read_b128 v[208:211], v26 offset:38912
 v_mfma_f32_16x16x32_bf16 v[144:147], v[184:187], v[232:235], v[144:147]
 buffer_load_dwordx4 v[228:231], v2, s[4:7], s85 offen offset:1024 sc1
 v_mfma_f32_16x16x32_bf16 v[172:175], v[184:187], v[236:239], v[172:175]
 ds_read_b128 v[212:215], v26 offset:39936
 s_waitcnt lgkmcnt(4)
 v_mfma_f32_16x16x32_bf16 v[148:151], v[188:191], v[232:235], v[148:151]
 v_mul_f32 v25, v25, v24
 v_mul_f32 v53, 0xbdd2d3e8, v25
 v_mfma_f32_16x16x32_bf16 v[176:179], v[188:191], v[236:239], v[176:179]
 ds_read_b128 v[184:187], v26 offset:40960
 v_mfma_f32_16x16x32_bf16 v[152:155], v[192:195], v[232:235], v[152:155]
 v_cmp_gt_u32 vcc, 32, v1
 s_nop 1
 v_cndmask_b32 v56, v51, v50, vcc
 v_cndmask_b32 v57, v53, v52, vcc
 v_cndmask_b32 v58, v55, v54, vcc
 v_mfma_f32_16x16x32_bf16 v[180:183], v[192:195], v[236:239], v[180:183]
 ds_read_b128 v[188:191], v26 offset:41984
 s_waitcnt vmcnt(9)
 v_mfma_f32_16x16x32_bf16 v[128:131], v[196:199], v[240:243], v[128:131]
 buffer_load_dwordx4 v[232:235], v2, s[4:7], s85 offen offset:2048 sc1
 s_waitcnt vmcnt(9)
 v_mfma_f32_16x16x32_bf16 v[156:159], v[196:199], v[244:247], v[156:159]
 ds_read_b128 v[192:195], v26 offset:43008
 v_mul_f32 v100, v72, v59
 s_waitcnt lgkmcnt(4)
 v_mfma_f32_16x16x32_bf16 v[132:135], v[200:203], v[240:243], v[132:135]
 v_mul_f32 v72, v72, v49
 v_mul_f32 v101, v73, v59
 v_mul_f32 v73, v73, v49
 v_mfma_f32_16x16x32_bf16 v[160:163], v[200:203], v[244:247], v[160:163]
 ds_read_b128 v[196:199], v26 offset:44032
 v_mul_f32 v102, v74, v59
 v_mfma_f32_16x16x32_bf16 v[136:139], v[204:207], v[240:243], v[136:139]
 s_add_u32 s91, s78, 0xb000
 buffer_load_dwordx4 a[124:127], v2, s[4:7], s91 offen offset:3072 sc1
 v_mul_f32 v74, v74, v49
 v_mfma_f32_16x16x32_bf16 v[164:167], v[204:207], v[244:247], v[164:167]
 ds_read_b128 v[200:203], v26 offset:45056
 v_mul_f32 v103, v75, v59
 v_mfma_f32_16x16x32_bf16 v[140:143], v[208:211], v[240:243], v[140:143]
 v_mul_f32 v75, v75, v49
 v_mul_f32 v104, v76, v59
 v_mul_f32 v76, v76, v49
 v_mfma_f32_16x16x32_bf16 v[168:171], v[208:211], v[244:247], v[168:171]
 ds_read_b128 v[204:207], v26 offset:46080
 v_mul_f32 v105, v77, v59
 s_waitcnt lgkmcnt(3)
 v_mfma_f32_16x16x32_bf16 v[144:147], v[212:215], v[240:243], v[144:147]
 buffer_load_dwordx4 v[236:239], v2, s[4:7], s85 offen offset:3072 sc1
 v_mul_f32 v77, v77, v49
 v_mfma_f32_16x16x32_bf16 v[172:175], v[212:215], v[244:247], v[172:175]
 ds_read_b128 v[208:211], v26 offset:47104
 v_mul_f32 v106, v78, v59
 v_mfma_f32_16x16x32_bf16 v[148:151], v[184:187], v[240:243], v[148:151]
 v_mul_f32 v78, v78, v49
 v_mul_f32 v107, v79, v59
 v_mul_f32 v79, v79, v49
 v_mfma_f32_16x16x32_bf16 v[176:179], v[184:187], v[244:247], v[176:179]
 ds_read_b128 v[212:215], v26 offset:48128
 v_mul_f32 v108, v80, v59
 v_mfma_f32_16x16x32_bf16 v[152:155], v[188:191], v[240:243], v[152:155]
 v_mul_f32 v80, v80, v49
 v_mul_f32 v109, v81, v59
 v_mfma_f32_16x16x32_bf16 v[180:183], v[188:191], v[244:247], v[180:183]
 ds_read_b128 v[184:187], v26 offset:49152
 v_mul_f32 v81, v81, v49
 s_waitcnt vmcnt(10)
 v_mfma_f32_16x16x32_bf16 v[128:131], v[192:195], v[248:251], v[128:131]
 s_add_u32 s85, s73, 0x1000
 buffer_load_dwordx4 v[240:243], v2, s[4:7], s85 offen sc1
 v_mul_f32 v110, v82, v59
 s_waitcnt vmcnt(9)
 v_mfma_f32_16x16x32_bf16 v[156:159], v[192:195], v[252:255], v[156:159]
 ds_read_b128 v[188:191], v26 offset:50176
 v_mul_f32 v82, v82, v49
 v_mul_f32 v111, v83, v59
 s_waitcnt lgkmcnt(3)
 v_mfma_f32_16x16x32_bf16 v[132:135], v[196:199], v[248:251], v[132:135]
 v_mul_f32 v83, v83, v49
 v_mul_f32 v112, v84, v59
 v_mfma_f32_16x16x32_bf16 v[160:163], v[196:199], v[252:255], v[160:163]
 ds_read_b128 v[192:195], v26 offset:51200
 v_mul_f32 v84, v84, v49
 v_mfma_f32_16x16x32_bf16 v[136:139], v[200:203], v[248:251], v[136:139]
 v_mul_f32 v113, v85, v59
 v_mul_f32 v85, v85, v49
 v_mfma_f32_16x16x32_bf16 v[164:167], v[200:203], v[252:255], v[164:167]
 ds_read_b128 v[196:199], v26 offset:52224
 v_mul_f32 v114, v86, v59
 v_mul_f32 v86, v86, v49
 v_mfma_f32_16x16x32_bf16 v[140:143], v[204:207], v[248:251], v[140:143]
 v_mul_f32 v115, v87, v59
 v_mul_f32 v87, v87, v49
 v_mfma_f32_16x16x32_bf16 v[168:171], v[204:207], v[252:255], v[168:171]
 ds_read_b128 v[200:203], v26 offset:53248
 v_mul_f32 v116, v88, v59
 v_mfma_f32_16x16x32_bf16 v[144:147], v[208:211], v[248:251], v[144:147]
 buffer_load_dwordx4 v[244:247], v2, s[4:7], s85 offen offset:1024 sc1
 v_mul_f32 v88, v88, v49
 v_mfma_f32_16x16x32_bf16 v[172:175], v[208:211], v[252:255], v[172:175]
 ds_read_b128 v[204:207], v26 offset:54272
 v_mul_f32 v117, v89, v59
 s_waitcnt lgkmcnt(4)
 v_mfma_f32_16x16x32_bf16 v[148:151], v[212:215], v[248:251], v[148:151]
 v_mul_f32 v89, v89, v49
 v_mul_f32 v118, v90, v59
 v_mfma_f32_16x16x32_bf16 v[176:179], v[212:215], v[252:255], v[176:179]
 s_add_u32 s91, s78, 0xc000
 buffer_load_dwordx4 a[128:131], v2, s[4:7], s91 offen sc1
 ds_read_b128 v[208:211], v26 offset:55296
 v_mfma_f32_16x16x32_bf16 v[152:155], v[184:187], v[248:251], v[152:155]
 v_mul_f32 v90, v90, v49
 v_mul_f32 v119, v91, v59
 v_mul_f32 v91, v91, v49
 v_mfma_f32_16x16x32_bf16 v[180:183], v[184:187], v[252:255], v[180:183]
 ds_read_b128 v[212:215], v26 offset:56320
 v_mul_f32 v120, v92, v59
 s_waitcnt vmcnt(10)
 v_mfma_f32_16x16x32_bf16 v[128:131], v[188:191], v[216:219], v[128:131]
 buffer_load_dwordx4 v[248:251], v2, s[4:7], s85 offen offset:2048 sc1
 v_mul_f32 v92, v92, v49
 s_waitcnt vmcnt(10)
 v_mfma_f32_16x16x32_bf16 v[156:159], v[188:191], v[220:223], v[156:159]
 ds_read_b128 v[184:187], v2
 v_mul_f32 v121, v93, v59
 s_waitcnt lgkmcnt(3)
 v_mfma_f32_16x16x32_bf16 v[132:135], v[192:195], v[216:219], v[132:135]
 v_mul_f32 v93, v93, v49
 v_mul_f32 v122, v94, v59
 v_mfma_f32_16x16x32_bf16 v[160:163], v[192:195], v[220:223], v[160:163]
 ds_read_b128 v[188:191], v2 offset:1024
 v_mul_f32 v94, v94, v49
 v_mfma_f32_16x16x32_bf16 v[136:139], v[196:199], v[216:219], v[136:139]
 v_mul_f32 v123, v95, v59
 v_mul_f32 v95, v95, v49
 v_mfma_f32_16x16x32_bf16 v[164:167], v[196:199], v[220:223], v[164:167]
 ds_read_b128 v[192:195], v2 offset:2048
 v_mul_f32 v124, v96, v59
 v_mfma_f32_16x16x32_bf16 v[140:143], v[200:203], v[216:219], v[140:143]
 v_mul_f32 v96, v96, v49
 v_mul_f32 v125, v97, v59
 v_mfma_f32_16x16x32_bf16 v[168:171], v[200:203], v[220:223], v[168:171]
 ds_read_b128 v[196:199], v2 offset:3072
 v_mul_f32 v97, v97, v49
 v_mfma_f32_16x16x32_bf16 v[144:147], v[204:207], v[216:219], v[144:147]
 buffer_load_dwordx4 v[252:255], v2, s[4:7], s85 offen offset:3072 sc1
 v_mul_f32 v126, v98, v59
 v_mfma_f32_16x16x32_bf16 v[172:175], v[204:207], v[220:223], v[172:175]
 ds_read_b128 v[200:203], v2 offset:4096
 s_waitcnt lgkmcnt(4)
 v_mfma_f32_16x16x32_bf16 v[148:151], v[208:211], v[216:219], v[148:151]
 v_mul_f32 v98, v98, v49
 v_mul_f32 v127, v99, v59
 v_mul_f32 v99, v99, v49
 v_mfma_f32_16x16x32_bf16 v[176:179], v[208:211], v[220:223], v[176:179]
 ds_read_b128 v[204:207], v2 offset:5120
 v_mfma_f32_16x16x32_bf16 v[152:155], v[212:215], v[216:219], v[152:155]
 v_mfma_f32_16x16x32_bf16 v[180:183], v[212:215], v[220:223], v[180:183]
 ds_read_b128 v[208:211], v2 offset:6144
 s_waitcnt vmcnt(9)
 v_mfma_f32_16x16x32_bf16 v[72:75], v[184:187], v[224:227], v[72:75]
 s_add_u32 s85, s73, 0x2000
 buffer_load_dwordx4 v[216:219], v2, s[4:7], s85 offen sc1
 s_waitcnt vmcnt(9)
 v_mfma_f32_16x16x32_bf16 v[100:103], v[184:187], v[228:231], v[100:103]
 ds_read_b128 v[212:215], v2 offset:7168
 s_waitcnt lgkmcnt(4)
 v_mfma_f32_16x16x32_bf16 v[76:79], v[188:191], v[224:227], v[76:79]
 v_mfma_f32_16x16x32_bf16 v[104:107], v[188:191], v[228:231], v[104:107]
 ds_read_b128 v[184:187], v2 offset:8192
 v_mfma_f32_16x16x32_bf16 v[80:83], v[192:195], v[224:227], v[80:83]
 s_add_u32 s91, s78, 0xc000
 buffer_load_dwordx4 a[132:135], v2, s[4:7], s91 offen offset:1024 sc1
 v_permlane32_swap_b32 v152, v180
 v_permlane32_swap_b32 v153, v181
 v_mfma_f32_16x16x32_bf16 v[108:111], v[192:195], v[228:231], v[108:111]
 ds_read_b128 v[188:191], v2 offset:9216
 v_permlane32_swap_b32 v154, v182
 v_mfma_f32_16x16x32_bf16 v[84:87], v[196:199], v[224:227], v[84:87]
 v_permlane32_swap_b32 v155, v183
 s_add_u32 s90, s75, 0x0
 v_mul_f32 v60, v152, v152
 v_mfma_f32_16x16x32_bf16 v[112:115], v[196:199], v[228:231], v[112:115]
 ds_read_b128 v[192:195], v2 offset:10240
 v_mul_f32 v61, v153, v153
 s_waitcnt lgkmcnt(4)
 v_mfma_f32_16x16x32_bf16 v[88:91], v[200:203], v[224:227], v[88:91]
 buffer_load_dwordx4 v[220:223], v2, s[4:7], s85 offen offset:1024 sc1
 v_mul_f32 v62, v154, v154
 v_mfma_f32_16x16x32_bf16 v[116:119], v[200:203], v[228:231], v[116:119]
 ds_read_b128 v[196:199], v2 offset:11264
 v_mul_f32 v63, v155, v155
 v_fma_f32 v60, v60, v47, v46
 v_mfma_f32_16x16x32_bf16 v[92:95], v[204:207], v[224:227], v[92:95]
 v_fma_f32 v61, v61, v47, v46
 v_fma_f32 v62, v62, v47, v46
 v_mfma_f32_16x16x32_bf16 v[120:123], v[204:207], v[228:231], v[120:123]
 ds_read_b128 v[200:203], v2 offset:12288
 v_fma_f32 v63, v63, v47, v46
 v_mfma_f32_16x16x32_bf16 v[96:99], v[208:211], v[224:227], v[96:99]
 v_mul_f32 v60, v60, v152
 v_mul_f32 v61, v61, v153
 v_mfma_f32_16x16x32_bf16 v[124:127], v[208:211], v[228:231], v[124:127]
 ds_read_b128 v[204:207], v2 offset:13312
 v_mul_f32 v62, v62, v154
 v_mul_f32 v63, v63, v155
 s_waitcnt vmcnt(10) lgkmcnt(3)
 v_mfma_f32_16x16x32_bf16 v[72:75], v[212:215], v[232:235], v[72:75]
 buffer_load_dwordx4 v[224:227], v2, s[4:7], s85 offen offset:2048 sc1
 v_exp_f32 v60, v60
 s_waitcnt vmcnt(9)
 v_mfma_f32_16x16x32_bf16 v[100:103], v[212:215], v[236:239], v[100:103]
 ds_read_b128 v[208:211], v2 offset:14336
 v_mfma_f32_16x16x32_bf16 v[76:79], v[184:187], v[232:235], v[76:79]
 v_mul_f32 v64, v152, v180
 v_exp_f32 v61, v61
 v_mfma_f32_16x16x32_bf16 v[104:107], v[184:187], v[236:239], v[104:107]
 ds_read_b128 v[212:215], v2 offset:15360
 v_mul_f32 v65, v153, v181
 v_mfma_f32_16x16x32_bf16 v[80:83], v[188:191], v[232:235], v[80:83]
 v_exp_f32 v62, v62
 v_mfma_f32_16x16x32_bf16 v[108:111], v[188:191], v[236:239], v[108:111]
 ds_read_b128 v[184:187], v2 offset:16384
 v_mul_f32 v66, v154, v182
 v_mfma_f32_16x16x32_bf16 v[84:87], v[192:195], v[232:235], v[84:87]
 v_exp_f32 v63, v63
 v_mul_f32 v67, v155, v183
 v_mfma_f32_16x16x32_bf16 v[112:115], v[192:195], v[236:239], v[112:115]
 ds_read_b128 v[188:191], v2 offset:17408
 v_fma_f32 v60, v60, v48, v48
 s_waitcnt lgkmcnt(4)
 v_mfma_f32_16x16x32_bf16 v[88:91], v[196:199], v[232:235], v[88:91]
 buffer_load_dwordx4 v[228:231], v2, s[4:7], s85 offen offset:3072 sc1
 v_rcp_f32 v60, v60
 v_mfma_f32_16x16x32_bf16 v[116:119], v[196:199], v[236:239], v[116:119]
 ds_read_b128 v[192:195], v2 offset:18432
 v_mfma_f32_16x16x32_bf16 v[92:95], v[200:203], v[232:235], v[92:95]
 v_fma_f32 v61, v61, v48, v48
 v_rcp_f32 v61, v61
 v_mfma_f32_16x16x32_bf16 v[120:123], v[200:203], v[236:239], v[120:123]
 s_add_u32 s91, s78, 0xc000
 buffer_load_dwordx4 a[136:139], v2, s[4:7], s91 offen offset:2048 sc1
 ds_read_b128 v[196:199], v2 offset:19456
 v_mfma_f32_16x16x32_bf16 v[96:99], v[204:207], v[232:235], v[96:99]
 v_fma_f32 v62, v62, v48, v48
 v_mfma_f32_16x16x32_bf16 v[124:127], v[204:207], v[236:239], v[124:127]
 ds_read_b128 v[200:203], v2 offset:20480
 v_rcp_f32 v62, v62
 s_waitcnt vmcnt(10) lgkmcnt(4)
 v_mfma_f32_16x16x32_bf16 v[72:75], v[208:211], v[240:243], v[72:75]
 s_add_u32 s85, s73, 0x3000
 buffer_load_dwordx4 v[232:235], v2, s[4:7], s85 offen sc1
 v_fma_f32 v63, v63, v48, v48
 s_waitcnt vmcnt(10)
 v_mfma_f32_16x16x32_bf16 v[100:103], v[208:211], v[244:247], v[100:103]
 ds_read_b128 v[204:207], v2 offset:21504
 v_rcp_f32 v63, v63
 v_mfma_f32_16x16x32_bf16 v[76:79], v[212:215], v[240:243], v[76:79]
 v_mul_f32 v60, v60, v64
 v_mfma_f32_16x16x32_bf16 v[104:107], v[212:215], v[244:247], v[104:107]
 ds_read_b128 v[208:211], v2 offset:22528
 v_mul_f32 v61, v61, v65
 v_mul_f32 v62, v62, v66
 v_mfma_f32_16x16x32_bf16 v[80:83], v[184:187], v[240:243], v[80:83]
 v_mul_f32 v63, v63, v67
 v_cvt_pk_bf16_f32 v68, v60, v61
 v_mfma_f32_16x16x32_bf16 v[108:111], v[184:187], v[244:247], v[108:111]
 ds_read_b128 v[212:215], v2 offset:23552
 v_cvt_pk_bf16_f32 v69, v62, v63
 s_waitcnt lgkmcnt(3)
 v_mfma_f32_16x16x32_bf16 v[84:87], v[188:191], v[240:243], v[84:87]
 buffer_store_dwordx2 v[68:69], v28, s[4:7], s90 offen offset:1536 sc1
 s_add_u32 s90, s75, 0xe000
 v_mul_f32 v60, v128, v128
 v_mfma_f32_16x16x32_bf16 v[112:115], v[188:191], v[244:247], v[112:115]
 ds_read_b128 v[184:187], v2 offset:24576
 v_mul_f32 v61, v129, v129
 v_mfma_f32_16x16x32_bf16 v[88:91], v[192:195], v[240:243], v[88:91]
 buffer_load_dwordx4 v[236:239], v2, s[4:7], s85 offen offset:1024 sc1
 v_mul_f32 v62, v130, v130
 v_mul_f32 v63, v131, v131
 v_mfma_f32_16x16x32_bf16 v[116:119], v[192:195], v[244:247], v[116:119]
 ds_read_b128 v[188:191], v2 offset:25600
 v_fma_f32 v60, v60, v42, v40
 v_mfma_f32_16x16x32_bf16 v[92:95], v[196:199], v[240:243], v[92:95]
 v_fma_f32 v61, v61, v42, v40
 v_fma_f32 v62, v62, v42, v40
 v_mfma_f32_16x16x32_bf16 v[120:123], v[196:199], v[244:247], v[120:123]
 ds_read_b128 v[192:195], v2 offset:26624
 v_fma_f32 v63, v63, v42, v40
 v_mfma_f32_16x16x32_bf16 v[96:99], v[200:203], v[240:243], v[96:99]
 v_mul_f32 v60, v60, v128
 v_mul_f32 v61, v61, v129
 v_mul_f32 v62, v62, v130
 v_mfma_f32_16x16x32_bf16 v[124:127], v[200:203], v[244:247], v[124:127]
 ds_read_b128 v[196:199], v2 offset:27648
 v_mul_f32 v63, v63, v131
 s_waitcnt vmcnt(10) lgkmcnt(4)
 v_mfma_f32_16x16x32_bf16 v[72:75], v[204:207], v[248:251], v[72:75]
 buffer_load_dwordx4 v[240:243], v2, s[4:7], s85 offen offset:2048 sc1
 v_exp_f32 v60, v60
 s_waitcnt vmcnt(10)
 v_mfma_f32_16x16x32_bf16 v[100:103], v[204:207], v[252:255], v[100:103]
 ds_read_b128 v[200:203], v2 offset:28672
 v_mfma_f32_16x16x32_bf16 v[76:79], v[208:211], v[248:251], v[76:79]
 v_mul_f32 v64, v128, v132
 v_exp_f32 v61, v61
 v_mfma_f32_16x16x32_bf16 v[104:107], v[208:211], v[252:255], v[104:107]
 ds_read_b128 v[204:207], v2 offset:29696
 v_mul_f32 v65, v129, v133
 v_mfma_f32_16x16x32_bf16 v[80:83], v[212:215], v[248:251], v[80:83]
 s_add_u32 s91, s78, 0xc000
 buffer_load_dwordx4 a[140:143], v2, s[4:7], s91 offen offset:3072 sc1
 v_mfma_f32_16x16x32_bf16 v[108:111], v[212:215], v[252:255], v[108:111]
 ds_read_b128 v[208:211], v2 offset:30720
 v_exp_f32 v62, v62
 s_waitcnt lgkmcnt(3)
 v_mfma_f32_16x16x32_bf16 v[84:87], v[184:187], v[248:251], v[84:87]
 v_mul_f32 v66, v130, v134
 v_exp_f32 v63, v63
 v_mfma_f32_16x16x32_bf16 v[112:115], v[184:187], v[252:255], v[112:115]
 ds_read_b128 v[212:215], v2 offset:31744
 v_mfma_f32_16x16x32_bf16 v[88:91], v[188:191], v[248:251], v[88:91]
 buffer_load_dwordx4 v[244:247], v2, s[4:7], s85 offen offset:3072 sc1
 v_mul_f32 v67, v131, v135
 v_fma_f32 v60, v60, v44, v44
 v_mfma_f32_16x16x32_bf16 v[116:119], v[188:191], v[252:255], v[116:119]
 ds_read_b128 v[184:187], v2 offset:32768
 v_mfma_f32_16x16x32_bf16 v[92:95], v[192:195], v[248:251], v[92:95]
 v_rcp_f32 v60, v60
 v_fma_f32 v61, v61, v44, v44
 v_mfma_f32_16x16x32_bf16 v[120:123], v[192:195], v[252:255], v[120:123]
 ds_read_b128 v[188:191], v2 offset:33792
 v_rcp_f32 v61, v61
 v_mfma_f32_16x16x32_bf16 v[96:99], v[196:199], v[248:251], v[96:99]
 v_fma_f32 v62, v62, v44, v44
 v_mfma_f32_16x16x32_bf16 v[124:127], v[196:199], v[252:255], v[124:127]
 ds_read_b128 v[192:195], v2 offset:34816
 v_rcp_f32 v62, v62
 s_waitcnt vmcnt(11) lgkmcnt(4)
 v_mfma_f32_16x16x32_bf16 v[72:75], v[200:203], v[216:219], v[72:75]
 s_add_u32 s85, s73, 0x4000
 buffer_load_dwordx4 v[248:251], v2, s[4:7], s85 offen sc1
 s_waitcnt vmcnt(10)
 v_mfma_f32_16x16x32_bf16 v[100:103], v[200:203], v[220:223], v[100:103]
 ds_read_b128 v[196:199], v2 offset:35840
 v_fma_f32 v63, v63, v44, v44
 v_mfma_f32_16x16x32_bf16 v[76:79], v[204:207], v[216:219], v[76:79]
 v_rcp_f32 v63, v63
 v_mul_f32 v60, v60, v64
 v_mfma_f32_16x16x32_bf16 v[104:107], v[204:207], v[220:223], v[104:107]
 ds_read_b128 v[200:203], v2 offset:36864
 v_mul_f32 v61, v61, v65
 v_mfma_f32_16x16x32_bf16 v[80:83], v[208:211], v[216:219], v[80:83]
 v_mul_f32 v62, v62, v66
 v_mul_f32 v63, v63, v67
 v_mfma_f32_16x16x32_bf16 v[108:111], v[208:211], v[220:223], v[108:111]
 ds_read_b128 v[204:207], v2 offset:37888
 v_cvt_pk_bf16_f32 v34, v60, v61
 v_cvt_pk_bf16_f32 v35, v62, v63
 s_waitcnt lgkmcnt(3)
 v_mfma_f32_16x16x32_bf16 v[84:87], v[212:215], v[216:219], v[84:87]
 v_mul_f32 v60, v136, v136
 v_mul_f32 v61, v137, v137
 v_mfma_f32_16x16x32_bf16 v[112:115], v[212:215], v[220:223], v[112:115]
 ds_read_b128 v[208:211], v2 offset:38912
 v_mul_f32 v62, v138, v138
 v_mfma_f32_16x16x32_bf16 v[88:91], v[184:187], v[216:219], v[88:91]
 buffer_load_dwordx4 v[252:255], v2, s[4:7], s85 offen offset:1024 sc1
 v_mul_f32 v63, v139, v139
 v_mfma_f32_16x16x32_bf16 v[116:119], v[184:187], v[220:223], v[116:119]
 ds_read_b128 v[212:215], v2 offset:39936
 v_fma_f32 v60, v60, v42, v40
 v_mfma_f32_16x16x32_bf16 v[92:95], v[188:191], v[216:219], v[92:95]
 v_fma_f32 v61, v61, v42, v40
 v_fma_f32 v62, v62, v42, v40
 v_fma_f32 v63, v63, v42, v40
 v_mfma_f32_16x16x32_bf16 v[120:123], v[188:191], v[220:223], v[120:123]
 s_add_u32 s91, s78, 0xd000
 buffer_load_dwordx4 a[144:147], v2, s[4:7], s91 offen sc1
 ds_read_b128 v[184:187], v2 offset:40960
 v_mfma_f32_16x16x32_bf16 v[96:99], v[192:195], v[216:219], v[96:99]
 v_mul_f32 v60, v60, v136
 v_mul_f32 v61, v61, v137
 v_mfma_f32_16x16x32_bf16 v[124:127], v[192:195], v[220:223], v[124:127]
 ds_read_b128 v[188:191], v2 offset:41984
 v_mul_f32 v62, v62, v138
 s_waitcnt vmcnt(11) lgkmcnt(4)
 v_mfma_f32_16x16x32_bf16 v[72:75], v[196:199], v[224:227], v[72:75]
 buffer_load_dwordx4 v[216:219], v2, s[4:7], s85 offen offset:2048 sc1
 v_mul_f32 v63, v63, v139
 s_waitcnt vmcnt(11)
 v_mfma_f32_16x16x32_bf16 v[100:103], v[196:199], v[228:231], v[100:103]
 ds_read_b128 v[192:195], v2 offset:43008
 v_exp_f32 v60, v60
 v_mfma_f32_16x16x32_bf16 v[76:79], v[200:203], v[224:227], v[76:79]
 v_mul_f32 v64, v136, v140
 v_mfma_f32_16x16x32_bf16 v[104:107], v[200:203], v[228:231], v[104:107]
 ds_read_b128 v[196:199], v2 offset:44032
 v_exp_f32 v61, v61
 v_mfma_f32_16x16x32_bf16 v[80:83], v[204:207], v[224:227], v[80:83]
 v_mul_f32 v65, v137, v141
 v_exp_f32 v62, v62
 v_mfma_f32_16x16x32_bf16 v[108:111], v[204:207], v[228:231], v[108:111]
 ds_read_b128 v[200:203], v2 offset:45056
 s_waitcnt lgkmcnt(3)
 v_mfma_f32_16x16x32_bf16 v[84:87], v[208:211], v[224:227], v[84:87]
 v_mul_f32 v66, v138, v142
 v_exp_f32 v63, v63
 v_mfma_f32_16x16x32_bf16 v[112:115], v[208:211], v[228:231], v[112:115]
 ds_read_b128 v[204:207], v2 offset:46080
 v_mul_f32 v67, v139, v143
 v_mfma_f32_16x16x32_bf16 v[88:91], v[212:215], v[224:227], v[88:91]
 buffer_load_dwordx4 v[220:223], v2, s[4:7], s85 offen offset:3072 sc1
 v_fma_f32 v60, v60, v44, v44
 v_mfma_f32_16x16x32_bf16 v[116:119], v[212:215], v[228:231], v[116:119]
 ds_read_b128 v[208:211], v2 offset:47104
 v_rcp_f32 v60, v60
 v_mfma_f32_16x16x32_bf16 v[92:95], v[184:187], v[224:227], v[92:95]
 v_fma_f32 v61, v61, v44, v44
 v_mfma_f32_16x16x32_bf16 v[120:123], v[184:187], v[228:231], v[120:123]
 ds_read_b128 v[212:215], v2 offset:48128
 v_rcp_f32 v61, v61
 v_mfma_f32_16x16x32_bf16 v[96:99], v[188:191], v[224:227], v[96:99]
 v_fma_f32 v62, v62, v44, v44
 v_mfma_f32_16x16x32_bf16 v[124:127], v[188:191], v[228:231], v[124:127]
 ds_read_b128 v[184:187], v2 offset:49152
 v_rcp_f32 v62, v62
 s_waitcnt vmcnt(10) lgkmcnt(4)
 v_mfma_f32_16x16x32_bf16 v[72:75], v[192:195], v[232:235], v[72:75]
 s_add_u32 s85, s73, 0x5000
 buffer_load_dwordx4 v[224:227], v2, s[4:7], s85 offen sc1
 v_fma_f32 v63, v63, v44, v44
 s_waitcnt vmcnt(9)
 v_mfma_f32_16x16x32_bf16 v[100:103], v[192:195], v[236:239], v[100:103]
 ds_read_b128 v[188:191], v2 offset:50176
 v_mfma_f32_16x16x32_bf16 v[76:79], v[196:199], v[232:235], v[76:79]
 v_rcp_f32 v63, v63
 v_mul_f32 v60, v60, v64
 v_mfma_f32_16x16x32_bf16 v[104:107], v[196:199], v[236:239], v[104:107]
 ds_read_b128 v[192:195], v2 offset:51200
 v_mul_f32 v61, v61, v65
 v_mfma_f32_16x16x32_bf16 v[80:83], v[200:203], v[232:235], v[80:83]
 s_add_u32 s91, s78, 0xd000
 buffer_load_dwordx4 a[148:151], v2, s[4:7], s91 offen offset:1024 sc1
 v_mul_f32 v62, v62, v66
 v_mfma_f32_16x16x32_bf16 v[108:111], v[200:203], v[236:239], v[108:111]
 ds_read_b128 v[196:199], v2 offset:52224
 v_mul_f32 v63, v63, v67
 s_waitcnt lgkmcnt(3)
 v_mfma_f32_16x16x32_bf16 v[84:87], v[204:207], v[232:235], v[84:87]
 v_cvt_pk_bf16_f32 v36, v60, v61
 v_cvt_pk_bf16_f32 v37, v62, v63
 v_mfma_f32_16x16x32_bf16 v[112:115], v[204:207], v[236:239], v[112:115]
 ds_read_b128 v[200:203], v2 offset:53248
 buffer_store_dwordx4 v[34:37], v2, s[4:7], s90 offen sc1
 v_mfma_f32_16x16x32_bf16 v[88:91], v[208:211], v[232:235], v[88:91]
 buffer_load_dwordx4 v[228:231], v2, s[4:7], s85 offen offset:1024 sc1
 v_mul_f32 v60, v144, v144
 v_mul_f32 v61, v145, v145
 v_mfma_f32_16x16x32_bf16 v[116:119], v[208:211], v[236:239], v[116:119]
 ds_read_b128 v[204:207], v2 offset:54272
 v_mul_f32 v62, v146, v146
 v_mfma_f32_16x16x32_bf16 v[92:95], v[212:215], v[232:235], v[92:95]
 v_mul_f32 v63, v147, v147
 v_fma_f32 v60, v60, v42, v40
 v_mfma_f32_16x16x32_bf16 v[120:123], v[212:215], v[236:239], v[120:123]
 ds_read_b128 v[208:211], v2 offset:55296
 v_fma_f32 v61, v61, v42, v40
 v_mfma_f32_16x16x32_bf16 v[96:99], v[184:187], v[232:235], v[96:99]
 v_fma_f32 v62, v62, v42, v40
 v_fma_f32 v63, v63, v42, v40
 v_mfma_f32_16x16x32_bf16 v[124:127], v[184:187], v[236:239], v[124:127]
 ds_read_b128 v[212:215], v2 offset:56320
 v_mul_f32 v60, v60, v144
 v_mul_f32 v61, v61, v145
 s_waitcnt vmcnt(11) lgkmcnt(4)
 v_mfma_f32_16x16x32_bf16 v[72:75], v[188:191], v[240:243], v[72:75]
 buffer_load_dwordx4 v[232:235], v2, s[4:7], s85 offen offset:2048 sc1
 v_mul_f32 v62, v62, v146
 s_waitcnt vmcnt(10)
 v_mfma_f32_16x16x32_bf16 v[100:103], v[188:191], v[244:247], v[100:103]
 ds_read_b128 v[184:187], v26
 v_mul_f32 v63, v63, v147
 v_mfma_f32_16x16x32_bf16 v[76:79], v[192:195], v[240:243], v[76:79]
 v_exp_f32 v60, v60
 v_mfma_f32_16x16x32_bf16 v[104:107], v[192:195], v[244:247], v[104:107]
 ds_read_b128 v[188:191], v26 offset:1024
 v_mul_f32 v64, v144, v148
 v_mfma_f32_16x16x32_bf16 v[80:83], v[196:199], v[240:243], v[80:83]
 v_exp_f32 v61, v61
 v_mul_f32 v65, v145, v149
 v_mfma_f32_16x16x32_bf16 v[108:111], v[196:199], v[244:247], v[108:111]
 ds_read_b128 v[192:195], v26 offset:2048
 s_waitcnt lgkmcnt(3)
 v_mfma_f32_16x16x32_bf16 v[84:87], v[200:203], v[240:243], v[84:87]
 v_exp_f32 v62, v62
 v_mul_f32 v66, v146, v150
 v_mfma_f32_16x16x32_bf16 v[112:115], v[200:203], v[244:247], v[112:115]
 ds_read_b128 v[196:199], v26 offset:3072
 v_mfma_f32_16x16x32_bf16 v[88:91], v[204:207], v[240:243], v[88:91]
 buffer_load_dwordx4 v[236:239], v2, s[4:7], s85 offen offset:3072 sc1
 v_exp_f32 v63, v63
 v_mfma_f32_16x16x32_bf16 v[116:119], v[204:207], v[244:247], v[116:119]
 ds_read_b128 v[200:203], v26 offset:4096
 v_mul_f32 v67, v147, v151
 v_mfma_f32_16x16x32_bf16 v[92:95], v[208:211], v[240:243], v[92:95]
 v_fma_f32 v60, v60, v44, v44
 v_rcp_f32 v60, v60
 v_mfma_f32_16x16x32_bf16 v[120:123], v[208:211], v[244:247], v[120:123]
 s_add_u32 s91, s78, 0xd000
 buffer_load_dwordx4 a[152:155], v2, s[4:7], s91 offen offset:2048 sc1
 ds_read_b128 v[204:207], v26 offset:5120
 v_mfma_f32_16x16x32_bf16 v[96:99], v[212:215], v[240:243], v[96:99]
 v_fma_f32 v61, v61, v44, v44
 v_mfma_f32_16x16x32_bf16 v[124:127], v[212:215], v[244:247], v[124:127]
 ds_read_b128 v[208:211], v26 offset:6144
 v_rcp_f32 v61, v61
 s_waitcnt vmcnt(11) lgkmcnt(4)
 v_mfma_f32_16x16x32_bf16 v[72:75], v[184:187], v[248:251], v[72:75]
 s_add_u32 s85, s73, 0x6000
 buffer_load_dwordx4 v[240:243], v2, s[4:7], s85 offen sc1
 s_waitcnt vmcnt(11)
 v_mfma_f32_16x16x32_bf16 v[100:103], v[184:187], v[252:255], v[100:103]
 ds_read_b128 v[212:215], v26 offset:7168
 v_fma_f32 v62, v62, v44, v44
 v_mfma_f32_16x16x32_bf16 v[76:79], v[188:191], v[248:251], v[76:79]
 v_rcp_f32 v62, v62
 v_fma_f32 v63, v63, v44, v44
 v_mfma_f32_16x16x32_bf16 v[104:107], v[188:191], v[252:255], v[104:107]
 ds_read_b128 v[184:187], v26 offset:8192
 v_mfma_f32_16x16x32_bf16 v[80:83], v[192:195], v[248:251], v[80:83]
 v_rcp_f32 v63, v63
 v_mul_f32 v60, v60, v64
 v_mfma_f32_16x16x32_bf16 v[108:111], v[192:195], v[252:255], v[108:111]
 ds_read_b128 v[188:191], v26 offset:9216
 v_mul_f32 v61, v61, v65
 s_waitcnt lgkmcnt(3)
 v_mfma_f32_16x16x32_bf16 v[84:87], v[196:199], v[248:251], v[84:87]
 v_mul_f32 v62, v62, v66
 v_mul_f32 v63, v63, v67
 v_mfma_f32_16x16x32_bf16 v[112:115], v[196:199], v[252:255], v[112:115]
 ds_read_b128 v[192:195], v26 offset:10240
 v_cvt_pk_bf16_f32 v70, v60, v61
 v_mfma_f32_16x16x32_bf16 v[88:91], v[200:203], v[248:251], v[88:91]
 buffer_load_dwordx4 v[244:247], v2, s[4:7], s85 offen offset:1024 sc1
 v_cvt_pk_bf16_f32 v71, v62, v63
 v_mfma_f32_16x16x32_bf16 v[116:119], v[200:203], v[252:255], v[116:119]
 ds_read_b128 v[196:199], v26 offset:11264
 buffer_store_dwordx2 v[70:71], v27, s[4:7], s90 offen offset:1024 sc1
 s_add_u32 s90, s75, 0x0
 v_mfma_f32_16x16x32_bf16 v[92:95], v[204:207], v[248:251], v[92:95]
 v_mul_f32 v60, v156, v156
 v_mul_f32 v61, v157, v157
 v_mfma_f32_16x16x32_bf16 v[120:123], v[204:207], v[252:255], v[120:123]
 ds_read_b128 v[200:203], v26 offset:12288
 v_mul_f32 v62, v158, v158
 v_mul_f32 v63, v159, v159
 v_mfma_f32_16x16x32_bf16 v[96:99], v[208:211], v[248:251], v[96:99]
 v_fma_f32 v60, v60, v43, v41
 v_fma_f32 v61, v61, v43, v41
 v_mfma_f32_16x16x32_bf16 v[124:127], v[208:211], v[252:255], v[124:127]
 ds_read_b128 v[204:207], v26 offset:13312
 v_fma_f32 v62, v62, v43, v41
 s_waitcnt vmcnt(11) lgkmcnt(4)
 v_mfma_f32_16x16x32_bf16 v[72:75], v[212:215], v[216:219], v[72:75]
 buffer_load_dwordx4 v[248:251], v2, s[4:7], s85 offen offset:2048 sc1
 v_fma_f32 v63, v63, v43, v41
 s_waitcnt vmcnt(11)
 v_mfma_f32_16x16x32_bf16 v[100:103], v[212:215], v[220:223], v[100:103]
 ds_read_b128 v[208:211], v26 offset:14336
 v_mul_f32 v60, v60, v156
 v_mfma_f32_16x16x32_bf16 v[76:79], v[184:187], v[216:219], v[76:79]
 v_mul_f32 v61, v61, v157
 v_mul_f32 v62, v62, v158
 v_mfma_f32_16x16x32_bf16 v[104:107], v[184:187], v[220:223], v[104:107]
 ds_read_b128 v[212:215], v26 offset:15360
 v_mul_f32 v63, v63, v159
 v_mfma_f32_16x16x32_bf16 v[80:83], v[188:191], v[216:219], v[80:83]
 s_add_u32 s91, s78, 0xd000
 buffer_load_dwordx4 a[156:159], v2, s[4:7], s91 offen offset:3072 sc1
 v_exp_f32 v60, v60
 v_mfma_f32_16x16x32_bf16 v[108:111], v[188:191], v[220:223], v[108:111]
 ds_read_b128 v[184:187], v26 offset:16384
 s_waitcnt lgkmcnt(4)
 v_mfma_f32_16x16x32_bf16 v[84:87], v[192:195], v[216:219], v[84:87]
 v_mul_f32 v64, v156, v160
 v_exp_f32 v61, v61
 v_mfma_f32_16x16x32_bf16 v[112:115], v[192:195], v[220:223], v[112:115]
 ds_read_b128 v[188:191], v26 offset:17408
 v_mul_f32 v65, v157, v161
 v_mfma_f32_16x16x32_bf16 v[88:91], v[196:199], v[216:219], v[88:91]
 buffer_load_dwordx4 v[252:255], v2, s[4:7], s85 offen offset:3072 sc1
 v_mfma_f32_16x16x32_bf16 v[116:119], v[196:199], v[220:223], v[116:119]
 ds_read_b128 v[192:195], v26 offset:18432
 v_exp_f32 v62, v62
 v_mfma_f32_16x16x32_bf16 v[92:95], v[200:203], v[216:219], v[92:95]
 v_mul_f32 v66, v158, v162
 v_mfma_f32_16x16x32_bf16 v[120:123], v[200:203], v[220:223], v[120:123]
 ds_read_b128 v[196:199], v26 offset:19456
 v_exp_f32 v63, v63
 s_waitcnt lgkmcnt(4)
 v_mfma_f32_16x16x32_bf16 v[96:99], v[204:207], v[216:219], v[96:99]
 v_mul_f32 v67, v159, v163
 v_fma_f32 v60, v60, v45, v45
 v_mfma_f32_16x16x32_bf16 v[124:127], v[204:207], v[220:223], v[124:127]
 ds_read_b128 v[200:203], v26 offset:20480
 s_waitcnt vmcnt(12)
 v_mfma_f32_16x16x32_bf16 v[72:75], v[208:211], v[224:227], v[72:75]
 s_add_u32 s85, s73, 0x7000
 buffer_load_dwordx4 v[216:219], v2, s[4:7], s85 offen sc1
 v_rcp_f32 v60, v60
 s_waitcnt vmcnt(10)
 v_mfma_f32_16x16x32_bf16 v[100:103], v[208:211], v[228:231], v[100:103]
 ds_read_b128 v[204:207], v26 offset:21504
 v_fma_f32 v61, v61, v45, v45
 v_mfma_f32_16x16x32_bf16 v[76:79], v[212:215], v[224:227], v[76:79]
 v_rcp_f32 v61, v61
 v_mfma_f32_16x16x32_bf16 v[104:107], v[212:215], v[228:231], v[104:107]
 ds_read_b128 v[208:211], v26 offset:22528
 v_fma_f32 v62, v62, v45, v45
 s_waitcnt lgkmcnt(3)
 v_mfma_f32_16x16x32_bf16 v[80:83], v[184:187], v[224:227], v[80:83]
 v_mov_b32 v5, 5
 s_waitcnt vmcnt(4)
 buffer_store_dword v5, off, s[4:7], s68 sc1
 v_mfma_f32_16x16x32_bf16 v[108:111], v[184:187], v[228:231], v[108:111]
 ds_read_b128 v[212:215], v26 offset:23552
 v_mfma_f32_16x16x32_bf16 v[84:87], v[188:191], v[224:227], v[84:87]
 v_rcp_f32 v62, v62
 v_mfma_f32_16x16x32_bf16 v[112:115], v[188:191], v[228:231], v[112:115]
 ds_read_b128 v[184:187], v26 offset:24576
 v_fma_f32 v63, v63, v45, v45
 v_mfma_f32_16x16x32_bf16 v[88:91], v[192:195], v[224:227], v[88:91]
 buffer_load_dwordx4 v[220:223], v2, s[4:7], s85 offen offset:1024 sc1
 v_rcp_f32 v63, v63
 v_mfma_f32_16x16x32_bf16 v[116:119], v[192:195], v[228:231], v[116:119]
 ds_read_b128 v[188:191], v26 offset:25600
 v_mfma_f32_16x16x32_bf16 v[92:95], v[196:199], v[224:227], v[92:95]
 v_mul_f32 v60, v60, v64
 v_mul_f32 v61, v61, v65
 v_mul_f32 v62, v62, v66
 v_mfma_f32_16x16x32_bf16 v[120:123], v[196:199], v[228:231], v[120:123]
 ds_read_b128 v[192:195], v26 offset:26624
 v_mul_f32 v63, v63, v67
 s_waitcnt lgkmcnt(4)
 v_mfma_f32_16x16x32_bf16 v[96:99], v[200:203], v[224:227], v[96:99]
 v_cvt_pk_bf16_f32 v34, v60, v61
 v_cvt_pk_bf16_f32 v35, v62, v63
 v_mfma_f32_16x16x32_bf16 v[124:127], v[200:203], v[228:231], v[124:127]
 ds_read_b128 v[196:199], v26 offset:27648
 v_mul_f32 v60, v164, v164
 v_mfma_f32_16x16x32_bf16 v[72:75], v[204:207], v[232:235], v[72:75]
 buffer_load_dwordx4 v[224:227], v2, s[4:7], s85 offen offset:2048 sc1
 v_mul_f32 v61, v165, v165
 v_mfma_f32_16x16x32_bf16 v[100:103], v[204:207], v[236:239], v[100:103]
 ds_read_b128 v[200:203], v26 offset:28672
 v_mul_f32 v62, v166, v166
 v_mfma_f32_16x16x32_bf16 v[76:79], v[208:211], v[232:235], v[76:79]
 v_mul_f32 v63, v167, v167
 v_fma_f32 v60, v60, v43, v41
 v_mfma_f32_16x16x32_bf16 v[104:107], v[208:211], v[236:239], v[104:107]
 ds_read_b128 v[204:207], v26 offset:29696
 v_fma_f32 v61, v61, v43, v41
 s_waitcnt lgkmcnt(4)
 v_mfma_f32_16x16x32_bf16 v[80:83], v[212:215], v[232:235], v[80:83]
 v_fma_f32 v62, v62, v43, v41
 v_fma_f32 v63, v63, v43, v41
 v_mfma_f32_16x16x32_bf16 v[108:111], v[212:215], v[236:239], v[108:111]
 ds_read_b128 v[208:211], v26 offset:30720
 v_mul_f32 v60, v60, v164
 v_mfma_f32_16x16x32_bf16 v[84:87], v[184:187], v[232:235], v[84:87]
 v_mul_f32 v61, v61, v165
 v_mul_f32 v62, v62, v166
 v_mfma_f32_16x16x32_bf16 v[112:115], v[184:187], v[236:239], v[112:115]
 ds_read_b128 v[212:215], v26 offset:31744
 v_mul_f32 v63, v63, v167
 v_mfma_f32_16x16x32_bf16 v[88:91], v[188:191], v[232:235], v[88:91]
 buffer_load_dwordx4 v[228:231], v2, s[4:7], s85 offen offset:3072 sc1
 v_exp_f32 v60, v60
 v_mfma_f32_16x16x32_bf16 v[116:119], v[188:191], v[236:239], v[116:119]
 ds_read_b128 v[184:187], v26 offset:32768
 v_mul_f32 v64, v164, v168
 s_waitcnt lgkmcnt(4)
 v_mfma_f32_16x16x32_bf16 v[92:95], v[192:195], v[232:235], v[92:95]
 v_exp_f32 v61, v61
 v_mfma_f32_16x16x32_bf16 v[120:123], v[192:195], v[236:239], v[120:123]
 ds_read_b128 v[188:191], v26 offset:33792
 v_mul_f32 v65, v165, v169
 v_mfma_f32_16x16x32_bf16 v[96:99], v[196:199], v[232:235], v[96:99]
 v_exp_f32 v62, v62
 v_mfma_f32_16x16x32_bf16 v[124:127], v[196:199], v[236:239], v[124:127]
 ds_read_b128 v[192:195], v26 offset:34816
 v_mul_f32 v66, v166, v170
 v_mfma_f32_16x16x32_bf16 v[72:75], v[200:203], v[240:243], v[72:75]
 v_exp_f32 v63, v63
 v_mfma_f32_16x16x32_bf16 v[100:103], v[200:203], v[244:247], v[100:103]
 ds_read_b128 v[196:199], v26 offset:35840
 v_mul_f32 v67, v167, v171
 s_waitcnt lgkmcnt(4)
 v_mfma_f32_16x16x32_bf16 v[76:79], v[204:207], v[240:243], v[76:79]
 v_fma_f32 v60, v60, v45, v45
 v_rcp_f32 v60, v60
 v_mfma_f32_16x16x32_bf16 v[104:107], v[204:207], v[244:247], v[104:107]
 ds_read_b128 v[200:203], v26 offset:36864
 v_mfma_f32_16x16x32_bf16 v[80:83], v[208:211], v[240:243], v[80:83]
 v_fma_f32 v61, v61, v45, v45
 v_rcp_f32 v61, v61
 v_mfma_f32_16x16x32_bf16 v[108:111], v[208:211], v[244:247], v[108:111]
 ds_read_b128 v[204:207], v26 offset:37888
 v_mfma_f32_16x16x32_bf16 v[84:87], v[212:215], v[240:243], v[84:87]
 v_fma_f32 v62, v62, v45, v45
 v_rcp_f32 v62, v62
 v_mfma_f32_16x16x32_bf16 v[112:115], v[212:215], v[244:247], v[112:115]
 ds_read_b128 v[208:211], v26 offset:38912
 s_waitcnt lgkmcnt(4)
 v_mfma_f32_16x16x32_bf16 v[88:91], v[184:187], v[240:243], v[88:91]
 buffer_load_dword v3, v7, s[4:7], s66 offen sc1
 v_fma_f32 v63, v63, v45, v45
 v_mfma_f32_16x16x32_bf16 v[116:119], v[184:187], v[244:247], v[116:119]
 ds_read_b128 v[212:215], v26 offset:39936
 v_rcp_f32 v63, v63
 v_mfma_f32_16x16x32_bf16 v[92:95], v[188:191], v[240:243], v[92:95]
 v_mul_f32 v60, v60, v64
 v_mfma_f32_16x16x32_bf16 v[120:123], v[188:191], v[244:247], v[120:123]
 ds_read_b128 v[184:187], v26 offset:40960
 v_mul_f32 v61, v61, v65
 v_mfma_f32_16x16x32_bf16 v[96:99], v[192:195], v[240:243], v[96:99]
 v_mul_f32 v62, v62, v66
 v_mul_f32 v63, v63, v67
 v_mfma_f32_16x16x32_bf16 v[124:127], v[192:195], v[244:247], v[124:127]
 ds_read_b128 v[188:191], v26 offset:41984
 v_cvt_pk_bf16_f32 v36, v60, v61
 s_waitcnt vmcnt(8) lgkmcnt(4)
 v_mfma_f32_16x16x32_bf16 v[72:75], v[196:199], v[248:251], v[72:75]
 v_cvt_pk_bf16_f32 v37, v62, v63
 buffer_store_dwordx4 v[34:37], v2, s[4:7], s90 offen sc1
 s_waitcnt vmcnt(7)
 v_mfma_f32_16x16x32_bf16 v[100:103], v[196:199], v[252:255], v[100:103]
 ds_read_b128 v[192:195], v26 offset:43008
 v_mul_f32 v60, v172, v172
 v_mfma_f32_16x16x32_bf16 v[76:79], v[200:203], v[248:251], v[76:79]
 v_mul_f32 v61, v173, v173
 v_mul_f32 v62, v174, v174
 v_mfma_f32_16x16x32_bf16 v[104:107], v[200:203], v[252:255], v[104:107]
 ds_read_b128 v[196:199], v26 offset:44032
 v_mul_f32 v63, v175, v175
 v_mfma_f32_16x16x32_bf16 v[80:83], v[204:207], v[248:251], v[80:83]
 v_fma_f32 v60, v60, v43, v41
 v_fma_f32 v61, v61, v43, v41
 v_mfma_f32_16x16x32_bf16 v[108:111], v[204:207], v[252:255], v[108:111]
 ds_read_b128 v[200:203], v26 offset:45056
 v_fma_f32 v62, v62, v43, v41
 s_waitcnt lgkmcnt(4)
 v_mfma_f32_16x16x32_bf16 v[84:87], v[208:211], v[248:251], v[84:87]
 v_fma_f32 v63, v63, v43, v41
 v_mul_f32 v60, v60, v172
 v_mfma_f32_16x16x32_bf16 v[112:115], v[208:211], v[252:255], v[112:115]
 ds_read_b128 v[204:207], v26 offset:46080
 v_mul_f32 v61, v61, v173
 v_mfma_f32_16x16x32_bf16 v[88:91], v[212:215], v[248:251], v[88:91]
 v_mul_f32 v62, v62, v174
 v_mul_f32 v63, v63, v175
 v_mfma_f32_16x16x32_bf16 v[116:119], v[212:215], v[252:255], v[116:119]
 ds_read_b128 v[208:211], v26 offset:47104
 v_exp_f32 v60, v60
 v_mfma_f32_16x16x32_bf16 v[92:95], v[184:187], v[248:251], v[92:95]
 v_mul_f32 v64, v172, v176
 v_mfma_f32_16x16x32_bf16 v[120:123], v[184:187], v[252:255], v[120:123]
 ds_read_b128 v[212:215], v26 offset:48128
 s_waitcnt lgkmcnt(4)
 v_mfma_f32_16x16x32_bf16 v[96:99], v[188:191], v[248:251], v[96:99]
 v_exp_f32 v61, v61
 v_mul_f32 v65, v173, v177
 v_mfma_f32_16x16x32_bf16 v[124:127], v[188:191], v[252:255], v[124:127]
 ds_read_b128 v[184:187], v26 offset:49152
 s_waitcnt vmcnt(6)
 v_mfma_f32_16x16x32_bf16 v[72:75], v[192:195], v[216:219], v[72:75]
 v_exp_f32 v62, v62
 s_waitcnt vmcnt(4)
 v_mfma_f32_16x16x32_bf16 v[100:103], v[192:195], v[220:223], v[100:103]
 ds_read_b128 v[188:191], v26 offset:50176
 v_mul_f32 v66, v174, v178
 v_mfma_f32_16x16x32_bf16 v[76:79], v[196:199], v[216:219], v[76:79]
 v_exp_f32 v63, v63
 v_mfma_f32_16x16x32_bf16 v[104:107], v[196:199], v[220:223], v[104:107]
 ds_read_b128 v[192:195], v26 offset:51200
 v_mul_f32 v67, v175, v179
 s_waitcnt lgkmcnt(4)
 v_mfma_f32_16x16x32_bf16 v[80:83], v[200:203], v[216:219], v[80:83]
 s_waitcnt vmcnt(1)
 v_cmp_gt_u32 vcc, 5, v3
 s_nop 0
 s_cbranch_vccnz .Lps_108
.Lpb_109:
 v_fma_f32 v60, v60, v45, v45
 v_mfma_f32_16x16x32_bf16 v[108:111], v[200:203], v[220:223], v[108:111]
 s_add_u32 s85, s76, 0xe000
 buffer_load_dwordx4 a[160:163], v2, s[4:7], s85 offen sc1
 ds_read_b128 v[196:199], v26 offset:52224
 v_mfma_f32_16x16x32_bf16 v[84:87], v[204:207], v[216:219], v[84:87]
 v_rcp_f32 v60, v60
 v_mfma_f32_16x16x32_bf16 v[112:115], v[204:207], v[220:223], v[112:115]
 ds_read_b128 v[200:203], v26 offset:53248
 v_mfma_f32_16x16x32_bf16 v[88:91], v[208:211], v[216:219], v[88:91]
 buffer_load_dwordx4 a[164:167], v2, s[4:7], s85 offen offset:1024 sc1
 v_fma_f32 v61, v61, v45, v45
 v_mfma_f32_16x16x32_bf16 v[116:119], v[208:211], v[220:223], v[116:119]
 ds_read_b128 v[204:207], v26 offset:54272
 s_waitcnt lgkmcnt(4)
 v_mfma_f32_16x16x32_bf16 v[92:95], v[212:215], v[216:219], v[92:95]
 v_rcp_f32 v61, v61
 v_fma_f32 v62, v62, v45, v45
 v_mfma_f32_16x16x32_bf16 v[120:123], v[212:215], v[220:223], v[120:123]
 buffer_load_dwordx4 a[168:171], v2, s[4:7], s85 offen offset:2048 sc1
 ds_read_b128 v[208:211], v26 offset:55296
 v_mfma_f32_16x16x32_bf16 v[96:99], v[184:187], v[216:219], v[96:99]
 v_rcp_f32 v62, v62
 v_mfma_f32_16x16x32_bf16 v[124:127], v[184:187], v[220:223], v[124:127]
 ds_read_b128 v[212:215], v26 offset:56320
 v_mfma_f32_16x16x32_bf16 v[72:75], v[188:191], v[224:227], v[72:75]
 buffer_load_dwordx4 a[172:175], v2, s[4:7], s85 offen offset:3072 sc1
 v_fma_f32 v63, v63, v45, v45
 v_mfma_f32_16x16x32_bf16 v[100:103], v[188:191], v[228:231], v[100:103]
 v_rcp_f32 v63, v63
 s_waitcnt lgkmcnt(3)
 v_mfma_f32_16x16x32_bf16 v[76:79], v[192:195], v[224:227], v[76:79]
 v_mul_f32 v60, v60, v64
 v_mfma_f32_16x16x32_bf16 v[104:107], v[192:195], v[228:231], v[104:107]
 s_add_u32 s85, s76, 0xf000
 buffer_load_dwordx4 a[176:179], v2, s[4:7], s85 offen sc1
 v_mfma_f32_16x16x32_bf16 v[80:83], v[196:199], v[224:227], v[80:83]
 v_mul_f32 v61, v61, v65
 v_mul_f32 v62, v62, v66
 v_mfma_f32_16x16x32_bf16 v[108:111], v[196:199], v[228:231], v[108:111]
 v_mul_f32 v63, v63, v67
 v_cvt_pk_bf16_f32 v70, v60, v61
 v_mfma_f32_16x16x32_bf16 v[84:87], v[200:203], v[224:227], v[84:87]
 buffer_load_dwordx4 a[180:183], v2, s[4:7], s85 offen offset:1024 sc1
 v_cvt_pk_bf16_f32 v71, v62, v63
 v_mfma_f32_16x16x32_bf16 v[112:115], v[200:203], v[228:231], v[112:115]
 buffer_store_dwordx2 v[70:71], v27, s[4:7], s90 offen offset:1024 sc1
 s_waitcnt lgkmcnt(0)
 v_mfma_f32_16x16x32_bf16 v[88:91], v[204:207], v[224:227], v[88:91]
 v_mfma_f32_16x16x32_bf16 v[116:119], v[204:207], v[228:231], v[116:119]
 buffer_load_dwordx4 a[184:187], v2, s[4:7], s85 offen offset:2048 sc1
 v_mfma_f32_16x16x32_bf16 v[92:95], v[208:211], v[224:227], v[92:95]
 v_mfma_f32_16x16x32_bf16 v[120:123], v[208:211], v[228:231], v[120:123]
 v_mfma_f32_16x16x32_bf16 v[96:99], v[212:215], v[224:227], v[96:99]
 buffer_load_dwordx4 a[188:191], v2, s[4:7], s85 offen offset:3072 sc1
 v_mfma_f32_16x16x32_bf16 v[124:127], v[212:215], v[228:231], v[124:127]
 s_nop 7
 v_permlane32_swap_b32 v96, v124
 v_permlane32_swap_b32 v97, v125
 v_permlane32_swap_b32 v98, v126
 v_permlane32_swap_b32 v99, v127
 s_add_u32 s90, s75, 0x400000
 v_pk_mul_f32 v[60:61], v[96:97], v[96:97]
 v_pk_mul_f32 v[62:63], v[98:99], v[98:99]
 s_add_u32 s85, s76, 0x10000
 buffer_load_dwordx4 v[128:131], v2, s[4:7], s85 offen sc1
 v_pk_fma_f32 v[60:61], v[60:61], v[56:57], v[56:57] op_sel:[0,1,0] op_sel_hi:[1,1,0]
 v_pk_fma_f32 v[62:63], v[62:63], v[56:57], v[56:57] op_sel:[0,1,0] op_sel_hi:[1,1,0]
 v_pk_mul_f32 v[60:61], v[60:61], v[96:97]
 v_pk_mul_f32 v[62:63], v[62:63], v[98:99]
 v_exp_f32 v60, v60
 v_exp_f32 v61, v61
 v_exp_f32 v62, v62
 v_exp_f32 v63, v63
 v_pk_mul_f32 v[64:65], v[96:97], v[124:125]
 v_pk_mul_f32 v[66:67], v[98:99], v[126:127]
 v_pk_fma_f32 v[60:61], v[60:61], v[58:59], v[58:59] op_sel:[0,0,0] op_sel_hi:[1,0,0]
 v_pk_fma_f32 v[62:63], v[62:63], v[58:59], v[58:59] op_sel:[0,0,0] op_sel_hi:[1,0,0]
 buffer_load_dwordx4 v[132:135], v2, s[4:7], s85 offen offset:1024 sc1
 v_rcp_f32 v60, v60
 v_rcp_f32 v61, v61
 v_rcp_f32 v62, v62
 v_rcp_f32 v63, v63
 v_pk_mul_f32 v[60:61], v[60:61], v[64:65]
 v_pk_mul_f32 v[62:63], v[62:63], v[66:67]
 v_cvt_pk_bf16_f32 v68, v60, v61
 v_cvt_pk_bf16_f32 v69, v62, v63
 buffer_store_dwordx2 v[68:69], v28, s[4:7], s90 offen offset:1536 sc1
 s_add_u32 s90, s75, 0x40e000
 v_pk_mul_f32 v[60:61], v[72:73], v[72:73]
 v_pk_mul_f32 v[62:63], v[74:75], v[74:75]
 v_pk_fma_f32 v[60:61], v[60:61], v[52:53], v[50:51] op_sel:[0,0,0] op_sel_hi:[1,0,0]
 buffer_load_dwordx4 v[136:139], v2, s[4:7], s85 offen offset:2048 sc1
 v_pk_fma_f32 v[62:63], v[62:63], v[52:53], v[50:51] op_sel:[0,0,0] op_sel_hi:[1,0,0]
 v_pk_mul_f32 v[60:61], v[60:61], v[72:73]
 v_pk_mul_f32 v[62:63], v[62:63], v[74:75]
 v_exp_f32 v60, v60
 v_exp_f32 v61, v61
 v_exp_f32 v62, v62
 v_exp_f32 v63, v63
 v_pk_mul_f32 v[64:65], v[72:73], v[76:77]
 v_pk_mul_f32 v[66:67], v[74:75], v[78:79]
 v_pk_fma_f32 v[60:61], v[60:61], v[54:55], v[54:55] op_sel:[0,0,0] op_sel_hi:[1,0,0]
 v_pk_fma_f32 v[62:63], v[62:63], v[54:55], v[54:55] op_sel:[0,0,0] op_sel_hi:[1,0,0]
 v_rcp_f32 v60, v60
 v_mov_b32 v5, 6
 s_waitcnt vmcnt(6)
 buffer_store_dword v5, off, s[4:7], s68 sc1
 v_rcp_f32 v61, v61
 v_rcp_f32 v62, v62
 v_rcp_f32 v63, v63
 v_pk_mul_f32 v[60:61], v[60:61], v[64:65]
 v_pk_mul_f32 v[62:63], v[62:63], v[66:67]
 v_cvt_pk_bf16_f32 v34, v60, v61
 v_cvt_pk_bf16_f32 v35, v62, v63
 v_pk_mul_f32 v[60:61], v[80:81], v[80:81]
 v_pk_mul_f32 v[62:63], v[82:83], v[82:83]
 v_pk_fma_f32 v[60:61], v[60:61], v[52:53], v[50:51] op_sel:[0,0,0] op_sel_hi:[1,0,0]
 v_pk_fma_f32 v[62:63], v[62:63], v[52:53], v[50:51] op_sel:[0,0,0] op_sel_hi:[1,0,0]
 v_pk_mul_f32 v[60:61], v[60:61], v[80:81]
 v_pk_mul_f32 v[62:63], v[62:63], v[82:83]
 buffer_load_dwordx4 v[140:143], v2, s[4:7], s85 offen offset:3072 sc1
 v_exp_f32 v60, v60
 v_exp_f32 v61, v61
 v_exp_f32 v62, v62
 v_exp_f32 v63, v63
 v_pk_mul_f32 v[64:65], v[80:81], v[84:85]
 v_pk_mul_f32 v[66:67], v[82:83], v[86:87]
 v_pk_fma_f32 v[60:61], v[60:61], v[54:55], v[54:55] op_sel:[0,0,0] op_sel_hi:[1,0,0]
 v_pk_fma_f32 v[62:63], v[62:63], v[54:55], v[54:55] op_sel:[0,0,0] op_sel_hi:[1,0,0]
 v_rcp_f32 v60, v60
 v_rcp_f32 v61, v61
 s_add_u32 s85, s76, 0x11000
 buffer_load_dwordx4 v[144:147], v2, s[4:7], s85 offen sc1
 v_rcp_f32 v62, v62
 v_rcp_f32 v63, v63
 v_pk_mul_f32 v[60:61], v[60:61], v[64:65]
 v_pk_mul_f32 v[62:63], v[62:63], v[66:67]
 v_cvt_pk_bf16_f32 v36, v60, v61
 v_cvt_pk_bf16_f32 v37, v62, v63
 buffer_store_dwordx4 v[34:37], v2, s[4:7], s90 offen sc1
 v_pk_mul_f32 v[60:61], v[88:89], v[88:89]
 v_pk_mul_f32 v[62:63], v[90:91], v[90:91]
 v_pk_fma_f32 v[60:61], v[60:61], v[52:53], v[50:51] op_sel:[0,0,0] op_sel_hi:[1,0,0]
 v_pk_fma_f32 v[62:63], v[62:63], v[52:53], v[50:51] op_sel:[0,0,0] op_sel_hi:[1,0,0]
 v_pk_mul_f32 v[60:61], v[60:61], v[88:89]
 v_pk_mul_f32 v[62:63], v[62:63], v[90:91]
 v_exp_f32 v60, v60
 v_exp_f32 v61, v61
 v_exp_f32 v62, v62
 v_exp_f32 v63, v63
 v_pk_mul_f32 v[64:65], v[88:89], v[92:93]
 v_pk_mul_f32 v[66:67], v[90:91], v[94:95]
 v_pk_fma_f32 v[60:61], v[60:61], v[54:55], v[54:55] op_sel:[0,0,0] op_sel_hi:[1,0,0]
 v_pk_fma_f32 v[62:63], v[62:63], v[54:55], v[54:55] op_sel:[0,0,0] op_sel_hi:[1,0,0]
 v_rcp_f32 v60, v60
 v_rcp_f32 v61, v61
 v_rcp_f32 v62, v62
 v_rcp_f32 v63, v63
 v_pk_mul_f32 v[60:61], v[60:61], v[64:65]
 v_pk_mul_f32 v[62:63], v[62:63], v[66:67]
 v_cvt_pk_bf16_f32 v70, v60, v61
 v_cvt_pk_bf16_f32 v71, v62, v63
 buffer_store_dwordx2 v[70:71], v27, s[4:7], s90 offen offset:1024 sc1
 v_mfma_f32_16x16x32_bf16 v[184:187], a[192:195], a[160:163], 0
 buffer_load_dwordx4 v[148:151], v2, s[4:7], s85 offen offset:1024 sc1
 s_add_u32 s90, s75, 0x400000
 v_mul_f32 v60, v100, v100
 v_mul_f32 v61, v101, v101
 v_mfma_f32_16x16x32_bf16 v[188:191], a[196:199], a[160:163], 0
 v_mul_f32 v62, v102, v102
 v_mul_f32 v63, v103, v103
 v_mfma_f32_16x16x32_bf16 v[192:195], a[200:203], a[160:163], 0
 v_fma_f32 v60, v60, v53, v51
 v_fma_f32 v61, v61, v53, v51
 v_fma_f32 v62, v62, v53, v51
 v_mfma_f32_16x16x32_bf16 v[196:199], a[0:3], a[160:163], 0
 v_fma_f32 v63, v63, v53, v51
 v_mul_f32 v60, v60, v100
 v_mul_f32 v61, v61, v101
 v_mfma_f32_16x16x32_bf16 v[184:187], a[204:207], a[164:167], v[184:187]
 v_mul_f32 v62, v62, v102
 v_mul_f32 v63, v63, v103
 v_exp_f32 v60, v60
 v_mfma_f32_16x16x32_bf16 v[188:191], a[208:211], a[164:167], v[188:191]
 v_mul_f32 v64, v100, v104
 v_mfma_f32_16x16x32_bf16 v[192:195], a[212:215], a[164:167], v[192:195]
 v_exp_f32 v61, v61
 v_mul_f32 v65, v101, v105
 v_mfma_f32_16x16x32_bf16 v[196:199], a[4:7], a[164:167], v[196:199]
 v_exp_f32 v62, v62
 v_mul_f32 v66, v102, v106
 v_mfma_f32_16x16x32_bf16 v[184:187], a[216:219], a[168:171], v[184:187]
 v_exp_f32 v63, v63
 v_mul_f32 v67, v103, v107
 v_mfma_f32_16x16x32_bf16 v[188:191], a[220:223], a[168:171], v[188:191]
 buffer_load_dword v3, v7, s[4:7], s66 offen sc1
 v_fma_f32 v60, v60, v55, v55
 v_mfma_f32_16x16x32_bf16 v[192:195], a[224:227], a[168:171], v[192:195]
 v_rcp_f32 v60, v60
 v_fma_f32 v61, v61, v55, v55
 v_mfma_f32_16x16x32_bf16 v[196:199], a[8:11], a[168:171], v[196:199]
 v_rcp_f32 v61, v61
 v_fma_f32 v62, v62, v55, v55
 v_mfma_f32_16x16x32_bf16 v[184:187], a[228:231], a[172:175], v[184:187]
 v_rcp_f32 v62, v62
 v_fma_f32 v63, v63, v55, v55
 v_mfma_f32_16x16x32_bf16 v[188:191], a[232:235], a[172:175], v[188:191]
 v_rcp_f32 v63, v63
 v_mul_f32 v60, v60, v64
 v_mfma_f32_16x16x32_bf16 v[192:195], a[236:239], a[172:175], v[192:195]
 v_mul_f32 v61, v61, v65
 v_mul_f32 v62, v62, v66
 v_mul_f32 v63, v63, v67
 v_mfma_f32_16x16x32_bf16 v[196:199], a[12:15], a[172:175], v[196:199]
 v_cvt_pk_bf16_f32 v34, v60, v61
 v_cvt_pk_bf16_f32 v35, v62, v63
 v_mul_f32 v60, v108, v108
 v_mfma_f32_16x16x32_bf16 v[184:187], a[240:243], a[176:179], v[184:187]
 v_mul_f32 v61, v109, v109
 v_mul_f32 v62, v110, v110
 v_mfma_f32_16x16x32_bf16 v[188:191], a[244:247], a[176:179], v[188:191]
 v_mul_f32 v63, v111, v111
 v_fma_f32 v60, v60, v53, v51
 v_fma_f32 v61, v61, v53, v51
 v_mfma_f32_16x16x32_bf16 v[192:195], a[248:251], a[176:179], v[192:195]
 v_fma_f32 v62, v62, v53, v51
 v_fma_f32 v63, v63, v53, v51
 v_mul_f32 v60, v60, v108
 v_mfma_f32_16x16x32_bf16 v[196:199], a[16:19], a[176:179], v[196:199]
 v_mul_f32 v61, v61, v109
 v_mul_f32 v62, v62, v110
 v_mul_f32 v63, v63, v111
 v_mfma_f32_16x16x32_bf16 v[184:187], a[252:255], a[180:183], v[184:187]
 v_mov_b32 v5, 7
 s_waitcnt vmcnt(2)
 buffer_store_dword v5, off, s[4:7], s68 sc1
 v_mfma_f32_16x16x32_bf16 v[188:191], a[20:23], a[180:183], v[188:191]
 v_exp_f32 v60, v60
 v_mfma_f32_16x16x32_bf16 v[192:195], a[24:27], a[180:183], v[192:195]
 v_mul_f32 v64, v108, v112
 v_exp_f32 v61, v61
 v_mfma_f32_16x16x32_bf16 v[196:199], a[28:31], a[180:183], v[196:199]
 v_mul_f32 v65, v109, v113
 v_exp_f32 v62, v62
 v_mfma_f32_16x16x32_bf16 v[184:187], a[32:35], a[184:187], v[184:187]
 v_mul_f32 v66, v110, v114
 v_exp_f32 v63, v63
 v_mfma_f32_16x16x32_bf16 v[188:191], a[36:39], a[184:187], v[188:191]
 v_mul_f32 v67, v111, v115
 v_fma_f32 v60, v60, v55, v55
 v_mfma_f32_16x16x32_bf16 v[192:195], a[40:43], a[184:187], v[192:195]
 v_rcp_f32 v60, v60
 v_fma_f32 v61, v61, v55, v55
 v_mfma_f32_16x16x32_bf16 v[196:199], a[44:47], a[184:187], v[196:199]
 v_rcp_f32 v61, v61
 v_fma_f32 v62, v62, v55, v55
 v_mfma_f32_16x16x32_bf16 v[184:187], a[48:51], a[188:191], v[184:187]
 s_waitcnt vmcnt(1)
 v_cmp_gt_u32 vcc, 6, v3
 s_nop 0
 s_cbranch_vccnz .Lps_110
.Lpb_111:
 s_add_u32 s85, s76, 0x0
 buffer_load_dwordx4 a[160:163], v2, s[4:7], s85 offen sc1
 v_mfma_f32_16x16x32_bf16 v[188:191], a[52:55], a[188:191], v[188:191]
 v_rcp_f32 v62, v62
 v_fma_f32 v63, v63, v55, v55
 v_mfma_f32_16x16x32_bf16 v[192:195], a[56:59], a[188:191], v[192:195]
 v_rcp_f32 v63, v63
 v_mfma_f32_16x16x32_bf16 v[196:199], a[60:63], a[188:191], v[196:199]
 v_mul_f32 v60, v60, v64
 v_mul_f32 v61, v61, v65
 v_mul_f32 v62, v62, v66
 v_mfma_f32_16x16x32_bf16 v[184:187], a[64:67], v[128:131], v[184:187]
 buffer_load_dwordx4 a[164:167], v2, s[4:7], s85 offen offset:1024 sc1
 v_mul_f32 v63, v63, v67
 v_cvt_pk_bf16_f32 v36, v60, v61
 v_mfma_f32_16x16x32_bf16 v[188:191], a[68:71], v[128:131], v[188:191]
 v_cvt_pk_bf16_f32 v37, v62, v63
 buffer_store_dwordx4 v[34:37], v2, s[4:7], s90 offen sc1
 v_mfma_f32_16x16x32_bf16 v[192:195], a[72:75], v[128:131], v[192:195]
 v_mul_f32 v60, v116, v116
 v_mul_f32 v61, v117, v117
 v_mul_f32 v62, v118, v118
 v_mfma_f32_16x16x32_bf16 v[196:199], a[76:79], v[128:131], v[196:199]
 v_mul_f32 v63, v119, v119
 v_fma_f32 v60, v60, v53, v51
 v_fma_f32 v61, v61, v53, v51
 v_mfma_f32_16x16x32_bf16 v[184:187], a[80:83], v[132:135], v[184:187]
 buffer_load_dwordx4 a[168:171], v2, s[4:7], s85 offen offset:2048 sc1
 v_fma_f32 v62, v62, v53, v51
 v_mfma_f32_16x16x32_bf16 v[188:191], a[84:87], v[132:135], v[188:191]
 v_fma_f32 v63, v63, v53, v51
 v_mul_f32 v60, v60, v116
 v_mul_f32 v61, v61, v117
 v_mfma_f32_16x16x32_bf16 v[192:195], a[88:91], v[132:135], v[192:195]
 v_mul_f32 v62, v62, v118
 v_mul_f32 v63, v63, v119
 v_mfma_f32_16x16x32_bf16 v[196:199], a[92:95], v[132:135], v[196:199]
 v_exp_f32 v60, v60
 v_mul_f32 v64, v116, v120
 v_mfma_f32_16x16x32_bf16 v[184:187], a[96:99], v[136:139], v[184:187]
 buffer_load_dwordx4 a[172:175], v2, s[4:7], s85 offen offset:3072 sc1
 v_exp_f32 v61, v61
 v_mfma_f32_16x16x32_bf16 v[188:191], a[100:103], v[136:139], v[188:191]
 v_mul_f32 v65, v117, v121
 v_exp_f32 v62, v62
 v_mfma_f32_16x16x32_bf16 v[192:195], a[104:107], v[136:139], v[192:195]
 v_mul_f32 v66, v118, v122
 v_mfma_f32_16x16x32_bf16 v[196:199], a[108:111], v[136:139], v[196:199]
 v_exp_f32 v63, v63
 v_mul_f32 v67, v119, v123
 v_mfma_f32_16x16x32_bf16 v[184:187], a[112:115], v[140:143], v[184:187]
 s_add_u32 s85, s76, 0x1000
 buffer_load_dwordx4 a[176:179], v2, s[4:7], s85 offen sc1
 v_fma_f32 v60, v60, v55, v55
 v_mfma_f32_16x16x32_bf16 v[188:191], a[116:119], v[140:143], v[188:191]
 v_rcp_f32 v60, v60
 v_fma_f32 v61, v61, v55, v55
 v_mfma_f32_16x16x32_bf16 v[192:195], a[120:123], v[140:143], v[192:195]
 v_rcp_f32 v61, v61
 v_mfma_f32_16x16x32_bf16 v[196:199], a[124:127], v[140:143], v[196:199]
 v_fma_f32 v62, v62, v55, v55
 v_rcp_f32 v62, v62
 v_mfma_f32_16x16x32_bf16 v[184:187], a[128:131], v[144:147], v[184:187]
 buffer_load_dwordx4 a[180:183], v2, s[4:7], s85 offen offset:1024 sc1
 v_fma_f32 v63, v63, v55, v55
 v_mfma_f32_16x16x32_bf16 v[188:191], a[132:135], v[144:147], v[188:191]
 v_rcp_f32 v63, v63
 v_mul_f32 v60, v60, v64
 v_mfma_f32_16x16x32_bf16 v[192:195], a[136:139], v[144:147], v[192:195]
 s_barrier
 v_mul_f32 v61, v61, v65
 v_mul_f32 v62, v62, v66
 v_mfma_f32_16x16x32_bf16 v[196:199], a[140:143], v[144:147], v[196:199]
 v_mul_f32 v63, v63, v67
 v_cvt_pk_bf16_f32 v70, v60, v61
 v_mfma_f32_16x16x32_bf16 v[184:187], a[144:147], v[148:151], v[184:187]
 buffer_load_dwordx4 a[184:187], v2, s[4:7], s85 offen offset:2048 sc1
 v_cvt_pk_bf16_f32 v71, v62, v63
 v_mfma_f32_16x16x32_bf16 v[188:191], a[148:151], v[148:151], v[188:191]
 buffer_load_dword v3, v7, s[4:7], s66 offen sc1
 buffer_store_dwordx2 v[70:71], v27, s[4:7], s90 offen offset:1024 sc1
 v_mfma_f32_16x16x32_bf16 v[192:195], a[152:155], v[148:151], v[192:195]
 v_mfma_f32_16x16x32_bf16 v[196:199], a[156:159], v[148:151], v[196:199]
 s_waitcnt vmcnt(9)
 v_mfma_f32_16x16x32_bf16 v[200:203], a[192:195], a[160:163], 0
 buffer_load_dwordx4 a[188:191], v2, s[4:7], s85 offen offset:3072 sc1
 v_mfma_f32_16x16x32_bf16 v[204:207], a[196:199], a[160:163], 0
 v_mfma_f32_16x16x32_bf16 v[208:211], a[200:203], a[160:163], 0
 v_mfma_f32_16x16x32_bf16 v[212:215], a[0:3], a[160:163], 0
 s_waitcnt vmcnt(9)
 v_mfma_f32_16x16x32_bf16 v[200:203], a[204:207], a[164:167], v[200:203]
 s_add_u32 s85, s76, 0x2000
 buffer_load_dwordx4 v[128:131], v2, s[4:7], s85 offen sc1
 v_mfma_f32_16x16x32_bf16 v[204:207], a[208:211], a[164:167], v[204:207]
 v_mfma_f32_16x16x32_bf16 v[208:211], a[212:215], a[164:167], v[208:211]
 ds_write_b128 v9, v[184:187]
 v_mfma_f32_16x16x32_bf16 v[212:215], a[4:7], a[164:167], v[212:215]
 s_waitcnt vmcnt(8)
 v_mfma_f32_16x16x32_bf16 v[200:203], a[216:219], a[168:171], v[200:203]
 ds_write_b128 v10, v[188:191]
 buffer_load_dwordx4 v[132:135], v2, s[4:7], s85 offen offset:1024 sc1
 v_mfma_f32_16x16x32_bf16 v[204:207], a[220:223], a[168:171], v[204:207]
 v_mfma_f32_16x16x32_bf16 v[208:211], a[224:227], a[168:171], v[208:211]
 ds_write_b128 v9, v[192:195] offset:128
 v_mfma_f32_16x16x32_bf16 v[212:215], a[8:11], a[168:171], v[212:215]
 s_waitcnt vmcnt(8)
 v_mfma_f32_16x16x32_bf16 v[200:203], a[228:231], a[172:175], v[200:203]
 ds_write_b128 v10, v[196:199] offset:128
 buffer_load_dwordx4 v[136:139], v2, s[4:7], s85 offen offset:2048 sc1
 v_mfma_f32_16x16x32_bf16 v[204:207], a[232:235], a[172:175], v[204:207]
 v_mfma_f32_16x16x32_bf16 v[208:211], a[236:239], a[172:175], v[208:211]
 v_mfma_f32_16x16x32_bf16 v[212:215], a[12:15], a[172:175], v[212:215]
 s_waitcnt vmcnt(8)
 v_mfma_f32_16x16x32_bf16 v[200:203], a[240:243], a[176:179], v[200:203]
 buffer_load_dwordx4 v[140:143], v2, s[4:7], s85 offen offset:3072 sc1
 v_mfma_f32_16x16x32_bf16 v[204:207], a[244:247], a[176:179], v[204:207]
 v_mfma_f32_16x16x32_bf16 v[208:211], a[248:251], a[176:179], v[208:211]
 v_mfma_f32_16x16x32_bf16 v[212:215], a[16:19], a[176:179], v[212:215]
 s_waitcnt vmcnt(8)
 v_mfma_f32_16x16x32_bf16 v[200:203], a[252:255], a[180:183], v[200:203]
 s_add_u32 s85, s76, 0x3000
 buffer_load_dwordx4 v[144:147], v2, s[4:7], s85 offen sc1
 v_mfma_f32_16x16x32_bf16 v[204:207], a[20:23], a[180:183], v[204:207]
 v_mfma_f32_16x16x32_bf16 v[208:211], a[24:27], a[180:183], v[208:211]
 s_waitcnt lgkmcnt(0)
 s_barrier
 v_mov_b32 v5, 8
 s_waitcnt vmcnt(6)
 buffer_store_dword v5, off, s[4:7], s68 sc1
 v_mfma_f32_16x16x32_bf16 v[212:215], a[28:31], a[180:183], v[212:215]
 ds_read_b128 v[216:219], v11
 v_mfma_f32_16x16x32_bf16 v[200:203], a[32:35], a[184:187], v[200:203]
 ds_read_b128 v[220:223], v11 offset:4096
 buffer_load_dwordx4 v[148:151], v2, s[4:7], s85 offen offset:1024 sc1
 v_mfma_f32_16x16x32_bf16 v[204:207], a[36:39], a[184:187], v[204:207]
 ds_read_b128 v[224:227], v11 offset:8192
 v_mfma_f32_16x16x32_bf16 v[208:211], a[40:43], a[184:187], v[208:211]
 ds_read_b128 v[228:231], v11 offset:12288
 v_mfma_f32_16x16x32_bf16 v[212:215], a[44:47], a[184:187], v[212:215]
 s_waitcnt vmcnt(7)
 v_mfma_f32_16x16x32_bf16 v[200:203], a[48:51], a[188:191], v[200:203]
 v_cmp_gt_u32 vcc, 7, v3
 s_nop 0
 s_cbranch_vccnz .Lps_112
.Lpb_113:
 s_add_u32 s85, s76, 0x40e000
 buffer_load_dwordx4 a[160:163], v2, s[4:7], s85 offen sc1
 v_mfma_f32_16x16x32_bf16 v[204:207], a[52:55], a[188:191], v[204:207]
 v_mfma_f32_16x16x32_bf16 v[208:211], a[56:59], a[188:191], v[208:211]
 v_mfma_f32_16x16x32_bf16 v[212:215], a[60:63], a[188:191], v[212:215]
 s_waitcnt vmcnt(7)
 v_mfma_f32_16x16x32_bf16 v[200:203], a[64:67], v[128:131], v[200:203]
 buffer_load_dwordx4 a[164:167], v2, s[4:7], s85 offen offset:1024 sc1
 s_add_u32 s91, s56, 0x18000
 v_mfma_f32_16x16x32_bf16 v[204:207], a[68:71], v[128:131], v[204:207]
 v_lshlrev_b32 v232, 16, v22
 v_and_b32 v233, 0xffff0000, v22
 v_mfma_f32_16x16x32_bf16 v[208:211], a[72:75], v[128:131], v[208:211]
 v_lshlrev_b32 v234, 16, v23
 v_mfma_f32_16x16x32_bf16 v[212:215], a[76:79], v[128:131], v[212:215]
 v_and_b32 v235, 0xffff0000, v23
 s_waitcnt vmcnt(7)
 v_mfma_f32_16x16x32_bf16 v[200:203], a[80:83], v[132:135], v[200:203]
 buffer_load_dwordx4 a[168:171], v2, s[4:7], s85 offen offset:2048 sc1
 s_waitcnt lgkmcnt(0)
 v_add_f32 v216, v216, v220
 v_mfma_f32_16x16x32_bf16 v[204:207], a[84:87], v[132:135], v[204:207]
 v_add_f32 v224, v224, v228
 v_mfma_f32_16x16x32_bf16 v[208:211], a[88:91], v[132:135], v[208:211]
 v_add_f32 v217, v217, v221
 v_add_f32 v225, v225, v229
 v_mfma_f32_16x16x32_bf16 v[212:215], a[92:95], v[132:135], v[212:215]
 v_add_f32 v218, v218, v222
 s_waitcnt vmcnt(7)
 v_mfma_f32_16x16x32_bf16 v[200:203], a[96:99], v[136:139], v[200:203]
 buffer_load_dwordx4 a[172:175], v2, s[4:7], s85 offen offset:3072 sc1
 v_mfma_f32_16x16x32_bf16 v[204:207], a[100:103], v[136:139], v[204:207]
 v_add_f32 v226, v226, v230
 v_add_f32 v219, v219, v223
 v_mfma_f32_16x16x32_bf16 v[208:211], a[104:107], v[136:139], v[208:211]
 v_add_f32 v227, v227, v231
 v_mfma_f32_16x16x32_bf16 v[212:215], a[108:111], v[136:139], v[212:215]
 v_add_f32 v216, v216, v224
 v_add_f32 v217, v217, v225
 s_waitcnt vmcnt(7)
 v_mfma_f32_16x16x32_bf16 v[200:203], a[112:115], v[140:143], v[200:203]
 s_add_u32 s85, s76, 0x40f000
 buffer_load_dwordx4 a[176:179], v2, s[4:7], s85 offen sc1
 v_mfma_f32_16x16x32_bf16 v[204:207], a[116:119], v[140:143], v[204:207]
 v_add_f32 v218, v218, v226
 v_mfma_f32_16x16x32_bf16 v[208:211], a[120:123], v[140:143], v[208:211]
 v_add_f32 v219, v219, v227
 v_mfma_f32_16x16x32_bf16 v[212:215], a[124:127], v[140:143], v[212:215]
 v_add_f32 v232, v232, v216
 v_add_f32 v233, v233, v217
 s_waitcnt vmcnt(7)
 v_mfma_f32_16x16x32_bf16 v[200:203], a[128:131], v[144:147], v[200:203]
 buffer_load_dwordx4 a[180:183], v2, s[4:7], s85 offen offset:1024 sc1
 v_mfma_f32_16x16x32_bf16 v[204:207], a[132:135], v[144:147], v[204:207]
 v_add_f32 v234, v234, v218
 v_mfma_f32_16x16x32_bf16 v[208:211], a[136:139], v[144:147], v[208:211]
 v_add_f32 v235, v235, v219
 v_mfma_f32_16x16x32_bf16 v[212:215], a[140:143], v[144:147], v[212:215]
 v_cvt_pk_bf16_f32 v22, v232, v233
 v_cvt_pk_bf16_f32 v23, v234, v235
 s_waitcnt vmcnt(6)
 v_mfma_f32_16x16x32_bf16 v[200:203], a[144:147], v[148:151], v[200:203]
 buffer_load_dwordx4 a[184:187], v2, s[4:7], s85 offen offset:2048 sc1
 v_mfma_f32_16x16x32_bf16 v[204:207], a[148:151], v[148:151], v[204:207]
 buffer_load_dword v3, v7, s[4:7], s66 offen sc1
 v_mfma_f32_16x16x32_bf16 v[208:211], a[152:155], v[148:151], v[208:211]
 buffer_store_dwordx2 v[22:23], v13, s[12:15], s91 offen sc1
 v_mfma_f32_16x16x32_bf16 v[212:215], a[156:159], v[148:151], v[212:215]
 s_waitcnt vmcnt(8)
 v_mfma_f32_16x16x32_bf16 v[184:187], a[192:195], a[160:163], 0
 buffer_load_dwordx4 a[188:191], v2, s[4:7], s85 offen offset:3072 sc1
 v_mfma_f32_16x16x32_bf16 v[188:191], a[196:199], a[160:163], 0
 v_mfma_f32_16x16x32_bf16 v[192:195], a[200:203], a[160:163], 0
 v_mfma_f32_16x16x32_bf16 v[196:199], a[0:3], a[160:163], 0
 s_waitcnt vmcnt(8)
 v_mfma_f32_16x16x32_bf16 v[184:187], a[204:207], a[164:167], v[184:187]
 s_add_u32 s85, s76, 0x410000
 buffer_load_dwordx4 v[128:131], v2, s[4:7], s85 offen sc1
 v_mfma_f32_16x16x32_bf16 v[188:191], a[208:211], a[164:167], v[188:191]
 v_mfma_f32_16x16x32_bf16 v[192:195], a[212:215], a[164:167], v[192:195]
 ds_write_b128 v9, v[200:203] offset:16384
 v_mfma_f32_16x16x32_bf16 v[196:199], a[4:7], a[164:167], v[196:199]
 s_waitcnt vmcnt(8)
 v_mfma_f32_16x16x32_bf16 v[184:187], a[216:219], a[168:171], v[184:187]
 ds_write_b128 v10, v[204:207] offset:16384
 buffer_load_dwordx4 v[132:135], v2, s[4:7], s85 offen offset:1024 sc1
 v_mfma_f32_16x16x32_bf16 v[188:191], a[220:223], a[168:171], v[188:191]
 v_mfma_f32_16x16x32_bf16 v[192:195], a[224:227], a[168:171], v[192:195]
 ds_write_b128 v9, v[208:211] offset:16512
 v_mfma_f32_16x16x32_bf16 v[196:199], a[8:11], a[168:171], v[196:199]
 s_waitcnt vmcnt(8)
 v_mfma_f32_16x16x32_bf16 v[184:187], a[228:231], a[172:175], v[184:187]
 ds_write_b128 v10, v[212:215] offset:16512
 buffer_load_dwordx4 v[136:139], v2, s[4:7], s85 offen offset:2048 sc1
 v_mfma_f32_16x16x32_bf16 v[188:191], a[232:235], a[172:175], v[188:191]
 v_mfma_f32_16x16x32_bf16 v[192:195], a[236:239], a[172:175], v[192:195]
 v_mfma_f32_16x16x32_bf16 v[196:199], a[12:15], a[172:175], v[196:199]
 s_waitcnt vmcnt(8)
 v_mfma_f32_16x16x32_bf16 v[184:187], a[240:243], a[176:179], v[184:187]
 buffer_load_dwordx4 v[140:143], v2, s[4:7], s85 offen offset:3072 sc1
 v_mfma_f32_16x16x32_bf16 v[188:191], a[244:247], a[176:179], v[188:191]
 v_mfma_f32_16x16x32_bf16 v[192:195], a[248:251], a[176:179], v[192:195]
 v_mfma_f32_16x16x32_bf16 v[196:199], a[16:19], a[176:179], v[196:199]
 s_waitcnt vmcnt(8)
 v_mfma_f32_16x16x32_bf16 v[184:187], a[252:255], a[180:183], v[184:187]
 s_add_u32 s85, s76, 0x411000
 buffer_load_dwordx4 v[144:147], v2, s[4:7], s85 offen sc1
 v_mfma_f32_16x16x32_bf16 v[188:191], a[20:23], a[180:183], v[188:191]
 v_mfma_f32_16x16x32_bf16 v[192:195], a[24:27], a[180:183], v[192:195]
 s_waitcnt lgkmcnt(0)
 s_barrier
 v_mfma_f32_16x16x32_bf16 v[196:199], a[28:31], a[180:183], v[196:199]
 ds_read_b128 v[216:219], v11 offset:16384
 s_waitcnt vmcnt(8)
 v_mfma_f32_16x16x32_bf16 v[184:187], a[32:35], a[184:187], v[184:187]
 ds_read_b128 v[220:223], v11 offset:20480
 buffer_load_dwordx4 v[148:151], v2, s[4:7], s85 offen offset:1024 sc1
 v_mfma_f32_16x16x32_bf16 v[188:191], a[36:39], a[184:187], v[188:191]
 ds_read_b128 v[224:227], v11 offset:24576
 v_mfma_f32_16x16x32_bf16 v[192:195], a[40:43], a[184:187], v[192:195]
 ds_read_b128 v[228:231], v11 offset:28672
 v_mfma_f32_16x16x32_bf16 v[196:199], a[44:47], a[184:187], v[196:199]
 s_waitcnt vmcnt(6)
 v_mfma_f32_16x16x32_bf16 v[184:187], a[48:51], a[188:191], v[184:187]
 v_cmp_gt_u32 vcc, 8, v3
 s_nop 0
 s_cbranch_vccnz .Lps_114
.Lpb_115:
 s_add_u32 s85, s76, 0x400000
 buffer_load_dwordx4 a[160:163], v2, s[4:7], s85 offen sc1
 v_mfma_f32_16x16x32_bf16 v[188:191], a[52:55], a[188:191], v[188:191]
 v_mfma_f32_16x16x32_bf16 v[192:195], a[56:59], a[188:191], v[192:195]
 v_mfma_f32_16x16x32_bf16 v[196:199], a[60:63], a[188:191], v[196:199]
 s_waitcnt vmcnt(6)
 v_mfma_f32_16x16x32_bf16 v[184:187], a[64:67], v[128:131], v[184:187]
 buffer_load_dwordx4 a[164:167], v2, s[4:7], s85 offen offset:1024 sc1
 s_add_u32 s91, s56, 0x10000
 v_mfma_f32_16x16x32_bf16 v[188:191], a[68:71], v[128:131], v[188:191]
 v_lshlrev_b32 v232, 16, v20
 v_mfma_f32_16x16x32_bf16 v[192:195], a[72:75], v[128:131], v[192:195]
 v_and_b32 v233, 0xffff0000, v20
 v_lshlrev_b32 v234, 16, v21
 v_mfma_f32_16x16x32_bf16 v[196:199], a[76:79], v[128:131], v[196:199]
 v_and_b32 v235, 0xffff0000, v21
 s_waitcnt vmcnt(6)
 v_mfma_f32_16x16x32_bf16 v[184:187], a[80:83], v[132:135], v[184:187]
 buffer_load_dwordx4 a[168:171], v2, s[4:7], s85 offen offset:2048 sc1
 s_waitcnt lgkmcnt(0)
 v_add_f32 v216, v216, v220
 v_mfma_f32_16x16x32_bf16 v[188:191], a[84:87], v[132:135], v[188:191]
 v_add_f32 v224, v224, v228
 v_mfma_f32_16x16x32_bf16 v[192:195], a[88:91], v[132:135], v[192:195]
 v_add_f32 v217, v217, v221
 v_mfma_f32_16x16x32_bf16 v[196:199], a[92:95], v[132:135], v[196:199]
 v_add_f32 v225, v225, v229
 v_add_f32 v218, v218, v222
 s_waitcnt vmcnt(6)
 v_mfma_f32_16x16x32_bf16 v[184:187], a[96:99], v[136:139], v[184:187]
 buffer_load_dwordx4 a[172:175], v2, s[4:7], s85 offen offset:3072 sc1
 v_mfma_f32_16x16x32_bf16 v[188:191], a[100:103], v[136:139], v[188:191]
 v_add_f32 v226, v226, v230
 v_mfma_f32_16x16x32_bf16 v[192:195], a[104:107], v[136:139], v[192:195]
 v_add_f32 v219, v219, v223
 v_add_f32 v227, v227, v231
 v_mfma_f32_16x16x32_bf16 v[196:199], a[108:111], v[136:139], v[196:199]
 v_add_f32 v216, v216, v224
 s_waitcnt vmcnt(6)
 v_mfma_f32_16x16x32_bf16 v[184:187], a[112:115], v[140:143], v[184:187]
 s_add_u32 s85, s76, 0x401000
 buffer_load_dwordx4 a[176:179], v2, s[4:7], s85 offen sc1
 v_mfma_f32_16x16x32_bf16 v[188:191], a[116:119], v[140:143], v[188:191]
 v_add_f32 v217, v217, v225
 v_mfma_f32_16x16x32_bf16 v[192:195], a[120:123], v[140:143], v[192:195]
 v_add_f32 v218, v218, v226
 v_add_f32 v219, v219, v227
 v_mfma_f32_16x16x32_bf16 v[196:199], a[124:127], v[140:143], v[196:199]
 v_add_f32 v232, v232, v216
 s_waitcnt vmcnt(6)
 v_mfma_f32_16x16x32_bf16 v[184:187], a[128:131], v[144:147], v[184:187]
 buffer_load_dwordx4 a[180:183], v2, s[4:7], s85 offen offset:1024 sc1
 v_mfma_f32_16x16x32_bf16 v[188:191], a[132:135], v[144:147], v[188:191]
 v_add_f32 v233, v233, v217
 v_mfma_f32_16x16x32_bf16 v[192:195], a[136:139], v[144:147], v[192:195]
 v_add_f32 v234, v234, v218
 v_add_f32 v235, v235, v219
 v_mfma_f32_16x16x32_bf16 v[196:199], a[140:143], v[144:147], v[196:199]
 v_cvt_pk_bf16_f32 v20, v232, v233
 s_waitcnt vmcnt(6)
 v_mfma_f32_16x16x32_bf16 v[184:187], a[144:147], v[148:151], v[184:187]
 buffer_load_dwordx4 a[184:187], v2, s[4:7], s85 offen offset:2048 sc1
 v_mfma_f32_16x16x32_bf16 v[188:191], a[148:151], v[148:151], v[188:191]
 v_cvt_pk_bf16_f32 v21, v234, v235
 v_mfma_f32_16x16x32_bf16 v[192:195], a[152:155], v[148:151], v[192:195]
 buffer_store_dwordx2 v[20:21], v13, s[12:15], s91 offen sc1
 v_mfma_f32_16x16x32_bf16 v[196:199], a[156:159], v[148:151], v[196:199]
 s_waitcnt vmcnt(7)
 v_mfma_f32_16x16x32_bf16 v[200:203], a[192:195], a[160:163], 0
 buffer_load_dwordx4 a[188:191], v2, s[4:7], s85 offen offset:3072 sc1
 v_mfma_f32_16x16x32_bf16 v[204:207], a[196:199], a[160:163], 0
 v_mfma_f32_16x16x32_bf16 v[208:211], a[200:203], a[160:163], 0
 v_mfma_f32_16x16x32_bf16 v[212:215], a[0:3], a[160:163], 0
 s_waitcnt vmcnt(7)
 v_mfma_f32_16x16x32_bf16 v[200:203], a[204:207], a[164:167], v[200:203]
 s_add_u32 s85, s76, 0x402000
 buffer_load_dwordx4 v[128:131], v2, s[4:7], s85 offen sc1
 v_mfma_f32_16x16x32_bf16 v[204:207], a[208:211], a[164:167], v[204:207]
 v_mfma_f32_16x16x32_bf16 v[208:211], a[212:215], a[164:167], v[208:211]
 ds_write_b128 v9, v[184:187]
 v_mfma_f32_16x16x32_bf16 v[212:215], a[4:7], a[164:167], v[212:215]
 s_waitcnt vmcnt(7)
 v_mfma_f32_16x16x32_bf16 v[200:203], a[216:219], a[168:171], v[200:203]
 ds_write_b128 v10, v[188:191]
 buffer_load_dwordx4 v[132:135], v2, s[4:7], s85 offen offset:1024 sc1
 v_mfma_f32_16x16x32_bf16 v[204:207], a[220:223], a[168:171], v[204:207]
 v_mfma_f32_16x16x32_bf16 v[208:211], a[224:227], a[168:171], v[208:211]
 ds_write_b128 v9, v[192:195] offset:128
 v_mfma_f32_16x16x32_bf16 v[212:215], a[8:11], a[168:171], v[212:215]
 s_waitcnt vmcnt(7)
 v_mfma_f32_16x16x32_bf16 v[200:203], a[228:231], a[172:175], v[200:203]
 ds_write_b128 v10, v[196:199] offset:128
 buffer_load_dwordx4 v[136:139], v2, s[4:7], s85 offen offset:2048 sc1
 v_mfma_f32_16x16x32_bf16 v[204:207], a[232:235], a[172:175], v[204:207]
 v_mfma_f32_16x16x32_bf16 v[208:211], a[236:239], a[172:175], v[208:211]
 v_mfma_f32_16x16x32_bf16 v[212:215], a[12:15], a[172:175], v[212:215]
 s_waitcnt vmcnt(7)
 v_mfma_f32_16x16x32_bf16 v[200:203], a[240:243], a[176:179], v[200:203]
 buffer_load_dwordx4 v[140:143], v2, s[4:7], s85 offen offset:3072 sc1
 v_mfma_f32_16x16x32_bf16 v[204:207], a[244:247], a[176:179], v[204:207]
 v_mfma_f32_16x16x32_bf16 v[208:211], a[248:251], a[176:179], v[208:211]
 v_mfma_f32_16x16x32_bf16 v[212:215], a[16:19], a[176:179], v[212:215]
 s_waitcnt vmcnt(7)
 v_mfma_f32_16x16x32_bf16 v[200:203], a[252:255], a[180:183], v[200:203]
 s_add_u32 s85, s76, 0x403000
 buffer_load_dwordx4 v[144:147], v2, s[4:7], s85 offen sc1
 v_mfma_f32_16x16x32_bf16 v[204:207], a[20:23], a[180:183], v[204:207]
 v_mfma_f32_16x16x32_bf16 v[208:211], a[24:27], a[180:183], v[208:211]
 s_waitcnt lgkmcnt(0)
 s_barrier
 v_mfma_f32_16x16x32_bf16 v[212:215], a[28:31], a[180:183], v[212:215]
 ds_read_b128 v[216:219], v11
 s_waitcnt vmcnt(7)
 v_mfma_f32_16x16x32_bf16 v[200:203], a[32:35], a[184:187], v[200:203]
 ds_read_b128 v[220:223], v11 offset:4096
 buffer_load_dwordx4 v[148:151], v2, s[4:7], s85 offen offset:1024 sc1
 v_mfma_f32_16x16x32_bf16 v[204:207], a[36:39], a[184:187], v[204:207]
 ds_read_b128 v[224:227], v11 offset:8192
 v_mfma_f32_16x16x32_bf16 v[208:211], a[40:43], a[184:187], v[208:211]
 ds_read_b128 v[228:231], v11 offset:12288
 v_mfma_f32_16x16x32_bf16 v[212:215], a[44:47], a[184:187], v[212:215]
 s_waitcnt vmcnt(6)
 v_mfma_f32_16x16x32_bf16 v[200:203], a[48:51], a[188:191], v[200:203]
 v_mfma_f32_16x16x32_bf16 v[204:207], a[52:55], a[188:191], v[204:207]
 v_mfma_f32_16x16x32_bf16 v[208:211], a[56:59], a[188:191], v[208:211]
 v_mfma_f32_16x16x32_bf16 v[212:215], a[60:63], a[188:191], v[212:215]
 s_waitcnt vmcnt(5)
 v_mfma_f32_16x16x32_bf16 v[200:203], a[64:67], v[128:131], v[200:203]
 s_add_u32 s91, s56, 0x8000
 v_lshlrev_b32 v232, 16, v18
 v_mfma_f32_16x16x32_bf16 v[204:207], a[68:71], v[128:131], v[204:207]
 v_and_b32 v233, 0xffff0000, v18
 v_mfma_f32_16x16x32_bf16 v[208:211], a[72:75], v[128:131], v[208:211]
 v_lshlrev_b32 v234, 16, v19
 v_mfma_f32_16x16x32_bf16 v[212:215], a[76:79], v[128:131], v[212:215]
 v_and_b32 v235, 0xffff0000, v19
 s_waitcnt vmcnt(4)
 v_mfma_f32_16x16x32_bf16 v[200:203], a[80:83], v[132:135], v[200:203]
 s_waitcnt lgkmcnt(1)
 v_add_f32 v216, v216, v220
 v_mfma_f32_16x16x32_bf16 v[204:207], a[84:87], v[132:135], v[204:207]
 s_waitcnt lgkmcnt(0)
 v_add_f32 v224, v224, v228
 v_mfma_f32_16x16x32_bf16 v[208:211], a[88:91], v[132:135], v[208:211]
 v_add_f32 v217, v217, v221
 v_mfma_f32_16x16x32_bf16 v[212:215], a[92:95], v[132:135], v[212:215]
 v_add_f32 v225, v225, v229
 s_waitcnt vmcnt(3)
 v_mfma_f32_16x16x32_bf16 v[200:203], a[96:99], v[136:139], v[200:203]
 v_add_f32 v218, v218, v222
 v_mfma_f32_16x16x32_bf16 v[204:207], a[100:103], v[136:139], v[204:207]
 v_add_f32 v226, v226, v230
 v_add_f32 v219, v219, v223
 v_mfma_f32_16x16x32_bf16 v[208:211], a[104:107], v[136:139], v[208:211]
 v_add_f32 v227, v227, v231
 v_mfma_f32_16x16x32_bf16 v[212:215], a[108:111], v[136:139], v[212:215]
 v_add_f32 v216, v216, v224
 s_waitcnt vmcnt(2)
 v_mfma_f32_16x16x32_bf16 v[200:203], a[112:115], v[140:143], v[200:203]
 v_mfma_f32_16x16x32_bf16 v[204:207], a[116:119], v[140:143], v[204:207]
 v_add_f32 v217, v217, v225
 v_add_f32 v218, v218, v226
 v_mfma_f32_16x16x32_bf16 v[208:211], a[120:123], v[140:143], v[208:211]
 v_add_f32 v219, v219, v227
 v_mfma_f32_16x16x32_bf16 v[212:215], a[124:127], v[140:143], v[212:215]
 s_waitcnt vmcnt(1)
 v_mfma_f32_16x16x32_bf16 v[200:203], a[128:131], v[144:147], v[200:203]
 v_add_f32 v232, v232, v216
 v_add_f32 v233, v233, v217
 v_mfma_f32_16x16x32_bf16 v[204:207], a[132:135], v[144:147], v[204:207]
 v_mfma_f32_16x16x32_bf16 v[208:211], a[136:139], v[144:147], v[208:211]
 v_add_f32 v234, v234, v218
 v_add_f32 v235, v235, v219
 v_mfma_f32_16x16x32_bf16 v[212:215], a[140:143], v[144:147], v[212:215]
 s_waitcnt vmcnt(0)
 v_mfma_f32_16x16x32_bf16 v[200:203], a[144:147], v[148:151], v[200:203]
 v_cvt_pk_bf16_f32 v18, v232, v233
 v_mfma_f32_16x16x32_bf16 v[204:207], a[148:151], v[148:151], v[204:207]
 v_cvt_pk_bf16_f32 v19, v234, v235
 v_mfma_f32_16x16x32_bf16 v[208:211], a[152:155], v[148:151], v[208:211]
 buffer_store_dwordx2 v[18:19], v13, s[12:15], s91 offen sc1
 v_mfma_f32_16x16x32_bf16 v[212:215], a[156:159], v[148:151], v[212:215]
 s_nop 1
 ds_write_b128 v9, v[200:203] offset:16384
 s_nop 0
 ds_write_b128 v10, v[204:207] offset:16384
 s_nop 0
 ds_write_b128 v9, v[208:211] offset:16512
 s_nop 0
 ds_write_b128 v10, v[212:215] offset:16512
 s_waitcnt lgkmcnt(0)
 s_barrier
 ds_read_b128 v[216:219], v11 offset:16384
 ds_read_b128 v[220:223], v11 offset:20480
 ds_read_b128 v[224:227], v11 offset:24576
 ds_read_b128 v[228:231], v11 offset:28672
 s_add_u32 s91, s56, 0x0
 v_lshlrev_b32 v232, 16, v16
 v_and_b32 v233, 0xffff0000, v16
 v_lshlrev_b32 v234, 16, v17
 v_and_b32 v235, 0xffff0000, v17
 s_waitcnt lgkmcnt(2)
 v_pk_add_f32 v[216:217], v[216:217], v[220:221]
 s_waitcnt lgkmcnt(0)
 v_pk_add_f32 v[224:225], v[224:225], v[228:229]
 v_pk_add_f32 v[218:219], v[218:219], v[222:223]
 v_pk_add_f32 v[226:227], v[226:227], v[230:231]
 v_pk_add_f32 v[216:217], v[216:217], v[224:225]
 v_pk_add_f32 v[218:219], v[218:219], v[226:227]
 v_pk_add_f32 v[232:233], v[232:233], v[216:217]
 v_pk_add_f32 v[234:235], v[234:235], v[218:219]
 v_cvt_pk_bf16_f32 v16, v232, v233
 v_cvt_pk_bf16_f32 v17, v234, v235
 buffer_store_dwordx2 v[16:17], v13, s[12:15], s91 offen sc1
 s_endpgm
.Lps_64:
 s_sleep 8
 buffer_load_dword v3, v7, s[4:7], s64 offen sc1
 s_add_u32 s54, s54, 1
 s_cmp_gt_u32 s54, 1000000
 s_cbranch_scc1 .Lends
 s_waitcnt vmcnt(0)
 v_cmp_gt_u32 vcc, 1, v3
 s_nop 1
 s_cbranch_vccnz .Lps_64
 s_branch .Lpb_65
.Lps_66:
 s_sleep 8
 buffer_load_dword v3, v7, s[4:7], s64 offen sc1
 s_add_u32 s54, s54, 1
 s_cmp_gt_u32 s54, 1000000
 s_cbranch_scc1 .Lends
 s_waitcnt vmcnt(0)
 v_cmp_gt_u32 vcc, 2, v3
 s_nop 1
 s_cbranch_vccnz .Lps_66
 s_branch .Lpb_67
.Lps_68:
 s_sleep 8
 buffer_load_dword v3, v7, s[4:7], s64 offen sc1
 s_add_u32 s54, s54, 1
 s_cmp_gt_u32 s54, 1000000
 s_cbranch_scc1 .Lends
 s_waitcnt vmcnt(0)
 v_cmp_gt_u32 vcc, 3, v3
 s_nop 1
 s_cbranch_vccnz .Lps_68
 s_branch .Lpb_69
.Lps_70:
 s_sleep 8
 buffer_load_dword v3, v7, s[4:7], s64 offen sc1
 s_add_u32 s54, s54, 1
 s_cmp_gt_u32 s54, 1000000
 s_cbranch_scc1 .Lends
 s_waitcnt vmcnt(0)
 v_cmp_gt_u32 vcc, 4, v3
 s_nop 1
 s_cbranch_vccnz .Lps_70
 s_branch .Lpb_71
.Lps_72:
 s_sleep 8
 buffer_load_dword v3, v6, s[4:7], s65 offen sc1
 s_add_u32 s54, s54, 1
 s_cmp_gt_u32 s54, 1000000
 s_cbranch_scc1 .Lends
 s_waitcnt vmcnt(0)
 v_cmp_gt_u32 vcc, 2, v3
 s_nop 1
 s_cbranch_vccnz .Lps_72
 s_branch .Lpb_73
.Lps_74:
 s_sleep 8
 buffer_load_dword v3, v6, s[4:7], s65 offen sc1
 s_add_u32 s54, s54, 1
 s_cmp_gt_u32 s54, 1000000
 s_cbranch_scc1 .Lends
 s_waitcnt vmcnt(0)
 v_cmp_gt_u32 vcc, 4, v3
 s_nop 1
 s_cbranch_vccnz .Lps_74
 s_branch .Lpb_75
.Lps_76:
 s_sleep 16
 buffer_load_dword v3, v30, s[4:7], s86 offen offset:2560 sc1
 s_add_u32 s54, s54, 1
 s_cmp_gt_u32 s54, 1000000
 s_cbranch_scc1 .Lends
 s_waitcnt vmcnt(0)
 v_cmp_gt_u32 vcc, 1, v3
 s_nop 1
 s_cbranch_vccnz .Lps_76
 s_branch .Lpb_77
.Lps_78:
 s_sleep 8
 buffer_load_dword v3, v7, s[4:7], s66 offen sc1
 s_add_u32 s54, s54, 1
 s_cmp_gt_u32 s54, 1000000
 s_cbranch_scc1 .Lends
 s_waitcnt vmcnt(0)
 v_cmp_gt_u32 vcc, 1, v3
 s_nop 1
 s_cbranch_vccnz .Lps_78
 s_branch .Lpb_79
.Lps_80:
 s_sleep 8
 buffer_load_dword v3, v7, s[4:7], s66 offen sc1
 s_add_u32 s54, s54, 1
 s_cmp_gt_u32 s54, 1000000
 s_cbranch_scc1 .Lends
 s_waitcnt vmcnt(0)
 v_cmp_gt_u32 vcc, 2, v3
 s_nop 1
 s_cbranch_vccnz .Lps_80
 s_branch .Lpb_81
.Lps_82:
 s_sleep 8
 buffer_load_dword v3, v7, s[4:7], s66 offen sc1
 s_add_u32 s54, s54, 1
 s_cmp_gt_u32 s54, 1000000
 s_cbranch_scc1 .Lends
 s_waitcnt vmcnt(0)
 v_cmp_gt_u32 vcc, 3, v3
 s_nop 1
 s_cbranch_vccnz .Lps_82
 s_branch .Lpb_83
.Lps_84:
 s_sleep 8
 buffer_load_dword v3, v7, s[4:7], s66 offen sc1
 s_add_u32 s54, s54, 1
 s_cmp_gt_u32 s54, 1000000
 s_cbranch_scc1 .Lends
 s_waitcnt vmcnt(0)
 v_cmp_gt_u32 vcc, 4, v3
 s_nop 1
 s_cbranch_vccnz .Lps_84
 s_branch .Lpb_85
.Lps_86:
 s_sleep 8
 buffer_load_dword v3, v6, s[4:7], s63 offen sc1
 s_add_u32 s54, s54, 1
 s_cmp_gt_u32 s54, 1000000
 s_cbranch_scc1 .Lends
 s_waitcnt vmcnt(0)
 v_cmp_gt_u32 vcc, 1, v3
 s_nop 1
 s_cbranch_vccnz .Lps_86
 s_branch .Lpb_87
.Lps_88:
 s_sleep 8
 buffer_load_dword v3, v6, s[4:7], s62 offen sc1
 s_add_u32 s54, s54, 1
 s_cmp_gt_u32 s54, 1000000
 s_cbranch_scc1 .Lends
 s_waitcnt vmcnt(0)
 v_cmp_gt_u32 vcc, 1, v3
 s_nop 1
 s_cbranch_vccnz .Lps_88
 s_branch .Lpb_89
.Lps_90:
 s_sleep 8
 buffer_load_dword v3, v6, s[4:7], s63 offen sc1
 s_add_u32 s54, s54, 1
 s_cmp_gt_u32 s54, 1000000
 s_cbranch_scc1 .Lends
 s_waitcnt vmcnt(0)
 v_cmp_gt_u32 vcc, 2, v3
 s_nop 1
 s_cbranch_vccnz .Lps_90
 s_branch .Lpb_91
.Lps_92:
 s_sleep 8
 buffer_load_dword v3, v6, s[4:7], s63 offen sc1
 s_add_u32 s54, s54, 1
 s_cmp_gt_u32 s54, 1000000
 s_cbranch_scc1 .Lends
 s_waitcnt vmcnt(0)
 v_cmp_gt_u32 vcc, 3, v3
 s_nop 1
 s_cbranch_vccnz .Lps_92
 s_branch .Lpb_93
.Lps_94:
 s_sleep 8
 buffer_load_dword v3, v6, s[4:7], s63 offen sc1
 s_add_u32 s54, s54, 1
 s_cmp_gt_u32 s54, 1000000
 s_cbranch_scc1 .Lends
 s_waitcnt vmcnt(0)
 v_cmp_gt_u32 vcc, 4, v3
 s_nop 1
 s_cbranch_vccnz .Lps_94
 s_branch .Lpb_95
.Lps_96:
 s_sleep 8
 buffer_load_dword v3, v7, s[4:7], s64 offen sc1
 s_add_u32 s54, s54, 1
 s_cmp_gt_u32 s54, 1000000
 s_cbranch_scc1 .Lends
 s_waitcnt vmcnt(0)
 v_cmp_gt_u32 vcc, 5, v3
 s_nop 1
 s_cbranch_vccnz .Lps_96
 s_branch .Lpb_97
.Lps_98:
 s_sleep 8
 buffer_load_dword v3, v7, s[4:7], s64 offen sc1
 s_add_u32 s54, s54, 1
 s_cmp_gt_u32 s54, 1000000
 s_cbranch_scc1 .Lends
 s_waitcnt vmcnt(0)
 v_cmp_gt_u32 vcc, 6, v3
 s_nop 1
 s_cbranch_vccnz .Lps_98
 s_branch .Lpb_99
.Lps_100:
 s_sleep 8
 buffer_load_dword v3, v7, s[4:7], s64 offen sc1
 s_add_u32 s54, s54, 1
 s_cmp_gt_u32 s54, 1000000
 s_cbranch_scc1 .Lends
 s_waitcnt vmcnt(0)
 v_cmp_gt_u32 vcc, 7, v3
 s_nop 1
 s_cbranch_vccnz .Lps_100
 s_branch .Lpb_101
.Lps_102:
 s_sleep 8
 buffer_load_dword v3, v7, s[4:7], s64 offen sc1
 s_add_u32 s54, s54, 1
 s_cmp_gt_u32 s54, 1000000
 s_cbranch_scc1 .Lends
 s_waitcnt vmcnt(0)
 v_cmp_gt_u32 vcc, 8, v3
 s_nop 1
 s_cbranch_vccnz .Lps_102
 s_branch .Lpb_103
.Lps_104:
 s_sleep 8
 buffer_load_dword v3, v6, s[4:7], s65 offen sc1
 s_add_u32 s54, s54, 1
 s_cmp_gt_u32 s54, 1000000
 s_cbranch_scc1 .Lends
 s_waitcnt vmcnt(0)
 v_cmp_gt_u32 vcc, 6, v3
 s_nop 1
 s_cbranch_vccnz .Lps_104
 s_branch .Lpb_105
.Lps_106:
 s_sleep 8
 buffer_load_dword v3, v6, s[4:7], s65 offen sc1
 s_add_u32 s54, s54, 1
 s_cmp_gt_u32 s54, 1000000
 s_cbranch_scc1 .Lends
 s_waitcnt vmcnt(0)
 v_cmp_gt_u32 vcc, 8, v3
 s_nop 1
 s_cbranch_vccnz .Lps_106
 s_branch .Lpb_107
.Lps_108:
 s_sleep 8
 buffer_load_dword v3, v7, s[4:7], s66 offen sc1
 s_add_u32 s54, s54, 1
 s_cmp_gt_u32 s54, 1000000
 s_cbranch_scc1 .Lends
 s_waitcnt vmcnt(0)
 v_cmp_gt_u32 vcc, 5, v3
 s_nop 1
 s_cbranch_vccnz .Lps_108
 s_branch .Lpb_109
.Lps_110:
 s_sleep 8
 buffer_load_dword v3, v7, s[4:7], s66 offen sc1
 s_add_u32 s54, s54, 1
 s_cmp_gt_u32 s54, 1000000
 s_cbranch_scc1 .Lends
 s_waitcnt vmcnt(0)
 v_cmp_gt_u32 vcc, 6, v3
 s_nop 1
 s_cbranch_vccnz .Lps_110
 s_branch .Lpb_111
.Lps_112:
 s_sleep 8
 buffer_load_dword v3, v7, s[4:7], s66 offen sc1
 s_add_u32 s54, s54, 1
 s_cmp_gt_u32 s54, 1000000
 s_cbranch_scc1 .Lends
 s_waitcnt vmcnt(0)
 v_cmp_gt_u32 vcc, 7, v3
 s_nop 1
 s_cbranch_vccnz .Lps_112
 s_branch .Lpb_113
.Lps_114:
 s_sleep 8
 buffer_load_dword v3, v7, s[4:7], s66 offen sc1
 s_add_u32 s54, s54, 1
 s_cmp_gt_u32 s54, 1000000
 s_cbranch_scc1 .Lends
 s_waitcnt vmcnt(0)
 v_cmp_gt_u32 vcc, 8, v3
 s_nop 1
 s_cbranch_vccnz .Lps_114
 s_branch .Lpb_115
.Lends:
 s_endpgm
.section .rodata,"a"
.p2align 6
.amdhsa_kernel interleave_layers__sliding_local_dilated__geglu_ffn__prompt_kernel
  .amdhsa_next_free_vgpr 512
  .amdhsa_next_free_sgpr 102
  .amdhsa_accum_offset 256
  .amdhsa_group_segment_fixed_size 0
  .amdhsa_kernarg_size 80
  .amdhsa_user_sgpr_count 2
  .amdhsa_user_sgpr_kernarg_segment_ptr 1
  .amdhsa_system_sgpr_workgroup_id_x 1
.end_amdhsa_kernel
```
